```python
import torch

def _softmax(x, axis=-1):
    return torch.softmax(x, dim=axis)

def _gelu(x):
    return torch.nn.functional.gelu(x, approximate='tanh')

def _silu(x):
    return torch.nn.functional.silu(x)

def _sigmoid(x):
    return torch.sigmoid(x)

def _layernorm(x, axis=-1, eps=1e-05):
    m = x.mean(dim=axis, keepdim=True)
    v = x.var(dim=axis, keepdim=True, unbiased=False)
    return (x - m) / torch.sqrt(v + eps)

def _scatter_add(tgt, idx, src, axis=0):
    return tgt.clone().index_add_(axis, idx, src)

def _segment_sum(src, seg, n):
    out = torch.zeros((n,) + src.shape[1:], dtype=src.dtype)
    return out.index_add_(0, seg, src)

def _pad(x, pw):
    flat = tuple((v for pair in reversed(pw) for v in pair))
    return torch.nn.functional.pad(x, flat)
kernel_name = 'adaLN_cond__spectral_gfnet__dense_activation_silu__prompt'

def setup_inputs():

    _w = lambda a: (lambda t: t.to(torch.bfloat16) if t.is_floating_point() else t)(torch.as_tensor(a))

    def _A_setup():
        B, S, D = (1, 2048, 512)
        Df = D // 2 + 1
        return {'x': _w((lambda *s: torch.randn(*s, dtype=torch.bfloat16) * 0.05)(B, S, D)), 'w_r': _w((lambda *s: torch.randn(*s, dtype=torch.bfloat16) * 1.6)(S, Df) * 0.02), 'w_i': _w((lambda *s: torch.randn(*s, dtype=torch.bfloat16) * 1.6)(S, Df) * 0.02)}
    _A_in = _A_setup()

    def _B_setup():
        B, S, D, F = (1, 2048, 512, 1376)
        return {'x': _w((lambda *s: torch.randn(*s, dtype=torch.bfloat16) * 0.05)(B, S, D)), 'w1': _w((lambda *s: torch.randn(*s, dtype=torch.bfloat16) * 0.8)(D, F) * D ** (-0.5)), 'w2': _w((lambda *s: torch.randn(*s, dtype=torch.bfloat16) * 0.2)(F, D) * F ** (-0.5))}
    _B_in = _B_setup()
    return {'A_x': _A_in['x'], 'A_w_r': _A_in['w_r'], 'A_w_i': _A_in['w_i'], 'B_x': _B_in['x'], 'B_w1': _B_in['w1'], 'B_w2': _B_in['w2'], 'c': _w((lambda *s: torch.randn(*s, dtype=torch.bfloat16) * 0.2)(1, 512) * 8.0), 'w_mod': _w((lambda *s: torch.randn(*s, dtype=torch.bfloat16) * 0.2)(512, 6 * 512) * 512 ** (-0.5) * 8.0)}

def reference(A_x, A_w_r, A_w_i, B_x, B_w1, B_w2, c, w_mod):

    def _A_ref(x, w_r, w_i):
        B, S, D = x.shape
        X = (lambda x, axes=(-2, -1): torch.fft.rfft2(x.float(), dim=axes))(x, axes=(-2, -1))
        W = w_r + 1j * w_i
        X = X * W
        y = (lambda x, s, axes=(-2, -1): torch.fft.irfft2(x, s=s, dim=axes).to(torch.bfloat16))(X, (S, D), axes=(-2, -1))
        return y

    def _B_ref(x, w1, w2):
        h = torch.einsum('bsd,df->bsf', x, w1)
        h = _silu(h)
        out = torch.einsum('bsf,fd->bsd', h, w2)
        return out
    x = A_x
    mod = (_silu(c) @ w_mod).reshape(c.shape[0], 6, 1, -1)
    sa, ca, ga, sb, cb, gb = (mod[:, 0].clone(), mod[:, 1].clone(), mod[:, 2].clone(), mod[:, 3].clone(), mod[:, 4].clone(), mod[:, 5].clone())
    h = _layernorm(x, axis=-1) * (1 + ca) + sa
    x = x + ga * _A_ref(h, A_w_r, A_w_i)
    h = _layernorm(x, axis=-1) * (1 + cb) + sb
    x = x + gb * _B_ref(h, B_w1, B_w2)
    return x
```

```asm
; @launch grid=(256,1,1) block=(256,1,1) lds=160512
.amdgcn_target "amdgcn-amd-amdhsa--gfx950"
.text
.globl adaLN_cond__spectral_gfnet__dense_activation_silu__prompt_kernel
.p2align 8
.type adaLN_cond__spectral_gfnet__dense_activation_silu__prompt_kernel,@function
adaLN_cond__spectral_gfnet__dense_activation_silu__prompt_kernel:
    s_load_dwordx2 s[4:5], s[0:1], 56
    s_load_dwordx2 s[12:13], s[0:1], 48
    s_load_dwordx2 s[8:9], s[0:1], 80
    s_getpc_b64 s[44:45]
L_pc:
    s_cmp_ge_u32 s2, 32
    s_cbranch_scc1 L_nopf
    s_lshr_b32 s3, s2, 3
    s_lshl_b32 s3, s3, 15
    v_lshl_add_u32 v1, v0, 7, s3
    v_min_u32 v1, .Lwgtab-L_pc-4, v1
    global_load_dword v1, v1, s[44:45]
L_nopf:
    s_cmp_ge_u32 s2, 256
    s_cbranch_scc1 L_exit
    s_and_b32 s48, s2, 7
    s_lshr_b32 s3, s2, 7
    s_lshl3_add_u32 s3, s3, s48
    s_bfe_u32 s51, s2, 0x20003
    s_lshl2_add_u32 s51, s3, s51
    s_lshl_b32 s51, s51, 5
    s_bfe_u32 s50, s2, 0x20005
    s_mul_i32 s3, s50, 786432
    s_add_u32 s51, s51, s3
    s_lshl_b32 s50, s50, 8
    v_and_b32 v7, -2, v0
    v_mul_u32_u24 v6, 3072, v7
    v_lshlrev_b32 v4, 4, v0
    v_and_b32 v2, 16, v4
    v_add_u32 v6, v6, v2
    s_mov_b32 s6, 3145728
    s_mov_b32 s7, 0x20000
    s_mov_b32 s14, 1024
    s_mov_b32 s15, 0x20000
    s_mov_b32 s10, 24117248
    s_mov_b32 s11, 0x20000
    s_waitcnt lgkmcnt(0)
    buffer_load_dwordx4 v[12:15], v6, s[4:7], s51 offen
    buffer_load_ushort v8, v7, s[12:15], s50 offen
    s_load_dword s53, s[8:9], 0
    s_load_dwordx2 s[16:17], s[0:1], 0
    s_load_dwordx2 s[20:21], s[0:1], 8
    s_load_dwordx2 s[24:25], s[0:1], 16
    s_load_dwordx2 s[28:29], s[0:1], 40
    s_load_dwordx2 s[32:33], s[0:1], 32
    s_load_dwordx2 s[36:37], s[0:1], 64
    s_load_dwordx2 s[40:41], s[0:1], 72
    v_pk_mov_b32 v[16:17], -1, -1
    v_pk_mov_b32 v[18:19], -1, -1
    s_lshl_b32 s48, s48, 5
    s_lshr_b32 s3, s2, 3
    s_add_u32 s3, s3, s48
    s_lshl_b32 s3, s3, 13
    s_add_u32 s3, s3, 4194304
    s_add_u32 s48, s3, 4096
    buffer_store_dwordx4 v[16:19], v4, s[8:11], s3 offen sc1
    buffer_store_dwordx4 v[16:19], v4, s[8:11], s48 offen sc1
    s_mul_i32 s3, s2, 192
    s_add_u32 s3, s3, .Lwgtab-L_pc
    s_add_u32 s46, s44, s3
    s_addc_u32 s47, s45, 0
    s_load_dwordx16 s[56:71], s[46:47], 0
    v_lshrrev_b32 v2, 6, v0
    v_and_b32 v3, 0x3f0, v4
    v_readfirstlane_b32 s49, v2
    v_mul_u32_u24 v5, .Lktab-.Ltabw3, v2
    v_add_u32 v5, v5, v3
    s_add_u32 s72, s44, .Ltabw-L_pc+4096
    s_addc_u32 s73, s45, 0
    s_add_u32 s54, s44, L_tabc-L_pc+0
    s_addc_u32 s55, s45, 0
    s_add_u32 s74, s44, .Lktab-L_pc
    s_addc_u32 s75, s45, 0
    s_mov_b32 s18, 2097152
    s_mov_b32 s19, 0x20000
    s_mov_b32 s22, 1052672
    s_mov_b32 s23, 0x20000
    s_mov_b32 s26, 1052672
    s_mov_b32 s27, 0x20000
    s_mov_b32 s30, 1409024
    s_mov_b32 s31, 0x20000
    s_mov_b32 s34, 1409024
    s_mov_b32 s35, 0x20000
    s_mov_b32 s38, 2097152
    s_mov_b32 s39, 0x20000
    s_mov_b32 s42, 256
    s_mov_b32 s43, 0x20000
    s_mul_i32 s76, s49, 2304
    s_add_u32 s76, s76, 98304
    s_mov_b32 s77, 126464
    v_and_b32 v36, 16, v0
    v_bfe_u32 v37, v0, 5, 1
    v_lshl_add_u32 v38, v37, 3, v36
    v_and_b32 v39, 1, v0
    v_lshl_add_u32 v38, v39, 5, v38
    v_and_b32 v28, 0xc0, v0
    v_add3_u32 v28, v28, v38, s77
    v_and_b32 v29, 48, v3
    v_add_u32 v30, 126464, v29
    v_lshl_add_u32 v31, v2, 16, v3
    v_and_b32 v33, 0xc0, v0
    v_lshl_add_u32 v33, v39, 8, v33
    v_and_b32 v34, 2, v0
    v_lshlrev_b32 v34, 8, v34
    v_mul_u32_u24 v35, 72, v36
    v_lshl_add_u32 v35, v37, 8, v35
    v_and_b32 v36, 0xf0, v3
    v_lshrrev_b32 v37, 1, v36
    v_add3_u32 v35, v35, v37, s76
    v_bfe_u32 v37, v0, 4, 2
    v_lshl_add_u32 v37, v2, 3, v37
    v_mul_u32_u24 v37, 32896, v37
    v_add_u32 v37, v37, v36
    v_mov_b32 v38, 2130706432
    v_cmp_gt_u32 vcc, 160, v36
    s_nop 1
    v_cndmask_b32 v32, v38, v37, vcc
    s_lshr_b32 s78, s2, 3
    s_and_b32 s78, s78, 7
    s_lshl_b32 s78, s78, 10
    s_lshl_b32 s79, s49, 13
    v_and_b32 v10, 15, v0
    v_lshlrev_b32 v114, 31, v0
    v_cvt_f32_u32 v10, v10
    v_bfe_u32 v11, v0, 4, 2
    v_cvt_f32_u32 v11, v11
    v_and_b32 v115, 0xc0, v0
    v_cvt_f32_u32 v115, v115
    v_lshrrev_b32 v113, 16, v114
    v_or_b32 v114, v114, v113
    v_mul_f32 v115, 0x3e800000, v115
    v_add_f32 v112, v115, v10
    v_mul_f32 v112, 0x3c800000, v112
    v_mul_f32 v113, v11, v112
    v_mul_f32 v113, 0x41000000, v113
    v_mov_b32 v116, v113
    v_add_f32 v117, v112, v113
    v_fmamk_f32 v118, v112, 0x40000000, v113
    v_fmamk_f32 v119, v112, 0x40400000, v113
    v_fmamk_f32 v120, v112, 0x40800000, v113
    v_fmamk_f32 v121, v112, 0x40a00000, v113
    v_fmamk_f32 v122, v112, 0x40c00000, v113
    v_fmamk_f32 v123, v112, 0x40e00000, v113
    v_cos_f32 v124, v116
    v_sin_f32 v116, v116
    v_cos_f32 v125, v117
    v_sin_f32 v117, v117
    v_cos_f32 v126, v118
    v_sin_f32 v118, v118
    v_cos_f32 v127, v119
    v_sin_f32 v119, v119
    v_cos_f32 v128, v120
    v_sin_f32 v120, v120
    v_cos_f32 v129, v121
    v_sin_f32 v121, v121
    v_cos_f32 v130, v122
    v_sin_f32 v122, v122
    v_cos_f32 v131, v123
    v_sin_f32 v123, v123
    v_cvt_pk_bf16_f32 v124, v124, v125
    v_cvt_pk_bf16_f32 v116, v116, v117
    v_cvt_pk_bf16_f32 v125, v126, v127
    v_cvt_pk_bf16_f32 v117, v118, v119
    v_cvt_pk_bf16_f32 v126, v128, v129
    v_cvt_pk_bf16_f32 v118, v120, v121
    v_cvt_pk_bf16_f32 v127, v130, v131
    v_cvt_pk_bf16_f32 v119, v122, v123
    v_xor_b32 v128, v114, v124
    v_xor_b32 v129, 0x80008000, v116
    v_xor_b32 v130, v114, v129
    v_xor_b32 v131, v114, v116
    v_accvgpr_write_b32 a0, v124
    v_accvgpr_write_b32 a4, v128
    v_accvgpr_write_b32 a8, v129
    v_accvgpr_write_b32 a12, v130
    v_accvgpr_write_b32 a16, v116
    v_accvgpr_write_b32 a20, v131
    v_xor_b32 v128, v114, v125
    v_xor_b32 v129, 0x80008000, v117
    v_xor_b32 v130, v114, v129
    v_xor_b32 v131, v114, v117
    v_accvgpr_write_b32 a1, v125
    v_accvgpr_write_b32 a5, v128
    v_accvgpr_write_b32 a9, v129
    v_accvgpr_write_b32 a13, v130
    v_accvgpr_write_b32 a17, v117
    v_accvgpr_write_b32 a21, v131
    v_xor_b32 v128, v114, v126
    v_xor_b32 v129, 0x80008000, v118
    v_xor_b32 v130, v114, v129
    v_xor_b32 v131, v114, v118
    v_accvgpr_write_b32 a2, v126
    v_accvgpr_write_b32 a6, v128
    v_accvgpr_write_b32 a10, v129
    v_accvgpr_write_b32 a14, v130
    v_accvgpr_write_b32 a18, v118
    v_accvgpr_write_b32 a22, v131
    v_xor_b32 v128, v114, v127
    v_xor_b32 v129, 0x80008000, v119
    v_xor_b32 v130, v114, v129
    v_xor_b32 v131, v114, v119
    v_accvgpr_write_b32 a3, v127
    v_accvgpr_write_b32 a7, v128
    v_accvgpr_write_b32 a11, v129
    v_accvgpr_write_b32 a15, v130
    v_accvgpr_write_b32 a19, v119
    v_accvgpr_write_b32 a23, v131
    v_mul_f32 v112, 0x3d000000, v112
    v_mul_f32 v113, 0x3c800000, v113
    v_mov_b32 v116, v113
    v_add_f32 v117, v112, v113
    v_fmamk_f32 v118, v112, 0x40000000, v113
    v_fmamk_f32 v119, v112, 0x40400000, v113
    v_fmamk_f32 v120, v112, 0x41800000, v113
    v_fmamk_f32 v121, v112, 0x41880000, v113
    v_fmamk_f32 v122, v112, 0x41900000, v113
    v_fmamk_f32 v123, v112, 0x41980000, v113
    v_cos_f32 v80, v116
    v_sin_f32 v88, v116
    v_cos_f32 v81, v117
    v_sin_f32 v89, v117
    v_cos_f32 v82, v118
    v_sin_f32 v90, v118
    v_cos_f32 v83, v119
    v_sin_f32 v91, v119
    v_cos_f32 v84, v120
    v_sin_f32 v92, v120
    v_cos_f32 v85, v121
    v_sin_f32 v93, v121
    v_cos_f32 v86, v122
    v_sin_f32 v94, v122
    v_cos_f32 v87, v123
    v_sin_f32 v95, v123
    v_fmac_f32 v115, 4.0, v11
    v_mul_f32 v112, 0x3a000000, v10
    v_mul_f32 v113, v115, v112
    v_mov_b32 v116, v113
    v_add_f32 v117, v112, v113
    v_fmamk_f32 v118, v112, 0x40000000, v113
    v_fmamk_f32 v119, v112, 0x40400000, v113
    v_add_f32 v112, 0x3c000000, v112
    v_mul_f32 v113, v115, v112
    v_mov_b32 v120, v113
    v_add_f32 v121, v112, v113
    v_fmamk_f32 v122, v112, 0x40000000, v113
    v_fmamk_f32 v123, v112, 0x40400000, v113
    v_cos_f32 v96, v116
    v_sin_f32 v104, v116
    v_cos_f32 v97, v117
    v_sin_f32 v105, v117
    v_cos_f32 v98, v118
    v_sin_f32 v106, v118
    v_cos_f32 v99, v119
    v_sin_f32 v107, v119
    v_cos_f32 v100, v120
    v_sin_f32 v108, v120
    v_cos_f32 v101, v121
    v_sin_f32 v109, v121
    v_cos_f32 v102, v122
    v_sin_f32 v110, v122
    v_cos_f32 v103, v123
    v_sin_f32 v111, v123
    v_mov_b32 v116, 0x36000000
    v_pk_mul_f32 v[96:97], v[96:97], v[116:117] op_sel_hi:[1,0]
    v_pk_mul_f32 v[98:99], v[98:99], v[116:117] op_sel_hi:[1,0]
    v_pk_mul_f32 v[100:101], v[100:101], v[116:117] op_sel_hi:[1,0]
    v_pk_mul_f32 v[102:103], v[102:103], v[116:117] op_sel_hi:[1,0]
    v_pk_mul_f32 v[104:105], v[104:105], v[116:117] op_sel_hi:[1,0]
    v_pk_mul_f32 v[106:107], v[106:107], v[116:117] op_sel_hi:[1,0]
    v_pk_mul_f32 v[108:109], v[108:109], v[116:117] op_sel_hi:[1,0]
    v_pk_mul_f32 v[110:111], v[110:111], v[116:117] op_sel_hi:[1,0]
    global_load_dwordx4 v[36:39], v5, s[72:73] offset:-4096
    global_load_dwordx4 v[40:43], v5, s[72:73] offset:-3072
    global_load_dwordx4 v[44:47], v5, s[72:73] offset:-2048
    s_waitcnt lgkmcnt(0)
    s_mul_i32 s3, s53, 0x9e3779b1
    s_add_u32 s3, s3, 0x7f4a7c15
    s_andn2_b32 s48, 1, s3
    s_lshl_b32 s48, s48, 8
    s_andn2_b32 s3, s3, 0x100
    s_or_b32 s52, s3, s48
    s_getreg_b32 s3, hwreg(HW_REG_XCC_ID, 0, 4)
    s_lshl_b32 s3, s3, 28
    s_xor_b32 s44, s52, s3
    s_waitcnt vmcnt(5)
    v_lshlrev_b32 v20, 16, v8
    v_mul_f32 v22, 0xbfb8aa3b, v20
    v_exp_f32 v22, v22
    v_lshlrev_b32 v116, 16, v12
    v_and_b32 v117, 0xffff0000, v12
    v_add_f32 v22, 1.0, v22
    v_rcp_f32 v22, v22
    v_lshlrev_b32 v118, 16, v13
    v_and_b32 v119, 0xffff0000, v13
    v_mul_f32 v20, v20, v22
    v_cvt_pk_bf16_f32 v20, v20, v20
    v_lshlrev_b32 v120, 16, v14
    v_and_b32 v121, 0xffff0000, v14
    v_lshlrev_b32 v122, 16, v15
    v_and_b32 v123, 0xffff0000, v15
    v_and_b32 v10, 0xffff0000, v20
    v_mul_f32 v116, v10, v116
    v_mul_f32 v117, v10, v117
    v_mul_f32 v118, v10, v118
    v_mul_f32 v119, v10, v119
    v_mul_f32 v120, v10, v120
    v_mul_f32 v121, v10, v121
    v_mul_f32 v122, v10, v122
    v_mul_f32 v123, v10, v123
    v_add_f32_dpp v116, v116, v116 row_ror:2 row_mask:0xf bank_mask:0xf
    v_add_f32_dpp v117, v117, v117 row_ror:2 row_mask:0xf bank_mask:0xf
    v_add_f32_dpp v118, v118, v118 row_ror:2 row_mask:0xf bank_mask:0xf
    v_add_f32_dpp v119, v119, v119 row_ror:2 row_mask:0xf bank_mask:0xf
    v_add_f32_dpp v120, v120, v120 row_ror:2 row_mask:0xf bank_mask:0xf
    v_add_f32_dpp v121, v121, v121 row_ror:2 row_mask:0xf bank_mask:0xf
    v_add_f32_dpp v122, v122, v122 row_ror:2 row_mask:0xf bank_mask:0xf
    v_add_f32_dpp v123, v123, v123 row_ror:2 row_mask:0xf bank_mask:0xf
    v_add_f32_dpp v116, v116, v116 row_ror:4 row_mask:0xf bank_mask:0xf
    v_add_f32_dpp v117, v117, v117 row_ror:4 row_mask:0xf bank_mask:0xf
    v_add_f32_dpp v118, v118, v118 row_ror:4 row_mask:0xf bank_mask:0xf
    v_add_f32_dpp v119, v119, v119 row_ror:4 row_mask:0xf bank_mask:0xf
    v_add_f32_dpp v120, v120, v120 row_ror:4 row_mask:0xf bank_mask:0xf
    v_add_f32_dpp v121, v121, v121 row_ror:4 row_mask:0xf bank_mask:0xf
    v_add_f32_dpp v122, v122, v122 row_ror:4 row_mask:0xf bank_mask:0xf
    v_add_f32_dpp v123, v123, v123 row_ror:4 row_mask:0xf bank_mask:0xf
    v_add_f32_dpp v116, v116, v116 row_ror:8 row_mask:0xf bank_mask:0xf
    v_add_f32_dpp v117, v117, v117 row_ror:8 row_mask:0xf bank_mask:0xf
    v_add_f32_dpp v118, v118, v118 row_ror:8 row_mask:0xf bank_mask:0xf
    v_add_f32_dpp v119, v119, v119 row_ror:8 row_mask:0xf bank_mask:0xf
    v_add_f32_dpp v120, v120, v120 row_ror:8 row_mask:0xf bank_mask:0xf
    v_add_f32_dpp v121, v121, v121 row_ror:8 row_mask:0xf bank_mask:0xf
    v_add_f32_dpp v122, v122, v122 row_ror:8 row_mask:0xf bank_mask:0xf
    v_add_f32_dpp v123, v123, v123 row_ror:8 row_mask:0xf bank_mask:0xf
    v_permlane16_swap_b32 v116, v120
    v_permlane16_swap_b32 v117, v121
    v_permlane16_swap_b32 v118, v122
    v_permlane16_swap_b32 v119, v123
    v_add_f32 v116, v116, v120
    v_add_f32 v117, v117, v121
    v_add_f32 v118, v118, v122
    v_add_f32 v119, v119, v123
    s_nop 0
    v_permlane32_swap_b32 v116, v118
    v_permlane32_swap_b32 v117, v119
    v_add_f32 v116, v116, v118
    v_add_f32 v117, v117, v119
    v_mov_b32 v20, 127232
    v_mov_b32 v21, 0
    s_mov_b32 exec_lo, 0x00030003
    s_mov_b32 exec_hi, 0x00030003
    ds_write_b64 v28, v[116:117]
    ds_write_b32 v20, v21
    s_mov_b64 exec, -1
    s_mov_b32 m0, s76
    s_add_u32 s3, s76, 1152
    buffer_load_dwordx4 v31, s[16:19], s60 offen lds
    s_mov_b32 m0, s3
    s_add_u32 s60, s60, 32768
    buffer_load_dwordx4 v31, s[16:19], s60 offen lds
    s_waitcnt vmcnt(5)
    s_waitcnt lgkmcnt(0)
    s_barrier
    s_cmp_lg_u32 s49, 0
    s_cbranch_scc1 L_nopub
    ds_read_b128 v[124:127], v30 offset:0
    ds_read_b128 v[128:131], v30 offset:64
    ds_read_b128 v[132:135], v30 offset:128
    ds_read_b128 v[136:139], v30 offset:192
    s_waitcnt lgkmcnt(0)
    v_pk_add_f32 v[124:125], v[124:125], v[128:129]
    v_pk_add_f32 v[126:127], v[126:127], v[130:131]
    v_pk_add_f32 v[132:133], v[132:133], v[136:137]
    v_pk_add_f32 v[134:135], v[134:135], v[138:139]
    v_pk_add_f32 v[124:125], v[124:125], v[132:133]
    v_pk_add_f32 v[126:127], v[126:127], v[134:135]
    v_mov_b32 v128, s44
    s_mov_b32 s3, 0x7060500
    v_perm_b32 v124, v124, v128, s3
    s_mov_b32 s3, 0x7060501
    v_perm_b32 v125, v125, v128, s3
    s_mov_b32 s3, 0x7060502
    v_perm_b32 v126, v126, v128, s3
    s_mov_b32 s3, 0x7060503
    v_perm_b32 v127, v127, v128, s3
    s_mov_b64 exec, 15
    buffer_store_dwordx4 v[124:127], v29, s[8:11], s61 offen sc1
    s_mov_b64 exec, -1
L_nopub:
    s_mul_i32 s3, s49, 2080
    s_add_u32 s3, s3, 135680
    s_mov_b32 m0, s3
    s_add_u32 s48, s3, 8320
    buffer_load_dwordx4 v32, s[20:23], s62 offen lds
    s_mov_b32 m0, s48
    s_add_u32 s3, s3, 1040
    buffer_load_dwordx4 v32, s[24:27], s62 offen lds
    s_add_u32 s62, s62, 131584
    s_mov_b32 m0, s3
    s_add_u32 s48, s3, 8320
    buffer_load_dwordx4 v32, s[20:23], s62 offen lds
    s_mov_b32 m0, s48
    s_add_u32 s3, s3, 1040
    buffer_load_dwordx4 v32, s[24:27], s62 offen lds
    v_add_u32 v22, s64, v33
    v_sub_u32 v23, 2048, v22
    v_and_b32 v23, 2047, v23
    s_movk_i32 s3, 514
    v_mad_u32_u24 v22, v22, s3, v34
    v_mad_u32_u24 v23, v23, s3, v34
    s_mov_b64 exec, 15
    buffer_load_ushort v112, v22, s[20:23], 0 offen
    buffer_load_ushort v113, v22, s[24:27], 0 offen
    buffer_load_ushort v114, v23, s[20:23], 0 offen
    buffer_load_ushort v115, v23, s[24:27], 0 offen
    s_mov_b64 exec, -1
    s_load_dwordx16 s[12:27], s[46:47], 64
    s_add_u32 s51, s78, s79
    s_mov_b32 m0, s51
    v_add_u32 v9, s51, v3
    global_load_lds_dwordx4 v9, s[54:55]
    s_add_u32 s78, s78, 1024
    s_and_b32 s78, s78, 0x1fff
    s_add_u32 s51, s78, s79
    s_mov_b32 m0, s51
    v_add_u32 v9, s51, v3
    global_load_lds_dwordx4 v9, s[54:55]
    s_add_u32 s78, s78, 1024
    s_and_b32 s78, s78, 0x1fff
    s_add_u32 s51, s78, s79
    s_mov_b32 m0, s51
    v_add_u32 v9, s51, v3
    global_load_lds_dwordx4 v9, s[54:55]
    s_add_u32 s78, s78, 1024
    s_and_b32 s78, s78, 0x1fff
    s_add_u32 s51, s78, s79
    s_mov_b32 m0, s51
    v_add_u32 v9, s51, v3
    global_load_lds_dwordx4 v9, s[54:55]
    s_add_u32 s78, s78, 1024
    s_and_b32 s78, s78, 0x1fff
    s_add_u32 s51, s78, s79
    s_mov_b32 m0, s51
    v_add_u32 v9, s51, v3
    global_load_lds_dwordx4 v9, s[54:55]
    s_add_u32 s78, s78, 1024
    s_and_b32 s78, s78, 0x1fff
    s_add_u32 s51, s78, s79
    s_mov_b32 m0, s51
    v_add_u32 v9, s51, v3
    global_load_lds_dwordx4 v9, s[54:55]
    s_add_u32 s78, s78, 1024
    s_and_b32 s78, s78, 0x1fff
    s_add_u32 s51, s78, s79
    s_mov_b32 m0, s51
    v_add_u32 v9, s51, v3
    global_load_lds_dwordx4 v9, s[54:55]
    s_add_u32 s78, s78, 1024
    s_and_b32 s78, s78, 0x1fff
    s_add_u32 s51, s78, s79
    s_mov_b32 m0, s51
    v_add_u32 v9, s51, v3
    global_load_lds_dwordx4 v9, s[54:55]
    s_add_u32 s78, s78, 1024
    s_and_b32 s78, s78, 0x1fff
    global_load_dwordx4 v[64:67], v5, s[72:73] offset:-1024
    global_load_dwordx4 v[68:71], v5, s[72:73] offset:0
    global_load_dwordx4 v[72:75], v5, s[72:73] offset:1024
    global_load_dwordx4 v[76:79], v5, s[72:73] offset:2048
    s_mov_b32 s54, 0x0c0c0400
    s_mov_b32 s55, 0x04000c0c
    s_movk_i32 s56, 0xff00
    s_cmp_ge_u32 s49, 2
    s_cselect_b32 s57, 1.0, 0
    v_bfe_u32 v20, v0, 4, 3
    v_cmp_eq_u32 vcc, s71, v20
    s_nop 1
    v_cndmask_b32 v1, 0, -1, vcc
    v_and_b32 v20, 16, v4
    v_add_u32 v6, v6, v20
    s_lshl_b32 s60, s49, 11
    s_add_u32 s60, s60, 152320
    s_mul_i32 s61, s49, 24576
    s_waitcnt lgkmcnt(0)
    s_waitcnt vmcnt(20)
    ds_read_b64_tr_b16 v[124:125], v35 offset:0
    ds_read_b64_tr_b16 v[126:127], v35 offset:128
    ds_read_b64_tr_b16 v[128:129], v35 offset:512
    ds_read_b64_tr_b16 v[130:131], v35 offset:640
    s_waitcnt lgkmcnt(0)
    v_lshlrev_b32 v132, 16, v124
    v_and_b32 v133, 0xffff0000, v124
    v_lshlrev_b32 v134, 16, v125
    v_and_b32 v135, 0xffff0000, v125
    v_lshlrev_b32 v136, 16, v126
    v_and_b32 v137, 0xffff0000, v126
    v_lshlrev_b32 v138, 16, v127
    v_and_b32 v139, 0xffff0000, v127
    v_lshlrev_b32 v140, 16, v128
    v_and_b32 v141, 0xffff0000, v128
    v_lshlrev_b32 v142, 16, v129
    v_and_b32 v143, 0xffff0000, v129
    v_lshlrev_b32 v144, 16, v130
    v_and_b32 v145, 0xffff0000, v130
    v_lshlrev_b32 v146, 16, v131
    v_and_b32 v147, 0xffff0000, v131
    v_pk_add_f32 v[20:21], v[132:133], v[134:135]
    v_pk_add_f32 v[22:23], v[136:137], v[138:139]
    v_pk_add_f32 v[24:25], v[140:141], v[142:143]
    v_pk_add_f32 v[26:27], v[144:145], v[146:147]
    v_pk_add_f32 v[20:21], v[20:21], v[22:23]
    v_pk_add_f32 v[24:25], v[24:25], v[26:27]
    v_pk_add_f32 v[20:21], v[20:21], v[24:25]
    v_add_f32 v20, v20, v21
    s_nop 1
    v_add_f32_dpp v20, v20, v20 row_ror:1 row_mask:0xf bank_mask:0xf
    s_nop 1
    v_add_f32_dpp v20, v20, v20 row_ror:2 row_mask:0xf bank_mask:0xf
    s_nop 1
    v_add_f32_dpp v20, v20, v20 row_ror:4 row_mask:0xf bank_mask:0xf
    s_nop 1
    v_add_f32_dpp v20, v20, v20 row_ror:8 row_mask:0xf bank_mask:0xf
    v_mov_b32 v21, v20
    s_nop 1
    v_permlane32_swap_b32 v20, v21
    v_add_f32 v20, v20, v21
    v_mul_f32 v20, 0xbb000000, v20
    v_pk_add_f32 v[132:133], v[132:133], v[20:21] op_sel_hi:[1,0]
    v_pk_add_f32 v[134:135], v[134:135], v[20:21] op_sel_hi:[1,0]
    v_pk_add_f32 v[136:137], v[136:137], v[20:21] op_sel_hi:[1,0]
    v_pk_add_f32 v[138:139], v[138:139], v[20:21] op_sel_hi:[1,0]
    v_pk_add_f32 v[140:141], v[140:141], v[20:21] op_sel_hi:[1,0]
    v_pk_add_f32 v[142:143], v[142:143], v[20:21] op_sel_hi:[1,0]
    v_pk_add_f32 v[144:145], v[144:145], v[20:21] op_sel_hi:[1,0]
    v_pk_add_f32 v[146:147], v[146:147], v[20:21] op_sel_hi:[1,0]
    v_pk_mul_f32 v[22:23], v[132:133], v[132:133]
    v_pk_mul_f32 v[24:25], v[134:135], v[134:135]
    v_pk_fma_f32 v[22:23], v[136:137], v[136:137], v[22:23]
    v_pk_fma_f32 v[24:25], v[138:139], v[138:139], v[24:25]
    v_pk_fma_f32 v[22:23], v[140:141], v[140:141], v[22:23]
    v_pk_fma_f32 v[24:25], v[142:143], v[142:143], v[24:25]
    v_pk_fma_f32 v[22:23], v[144:145], v[144:145], v[22:23]
    v_pk_fma_f32 v[24:25], v[146:147], v[146:147], v[24:25]
    v_pk_add_f32 v[22:23], v[22:23], v[24:25]
    v_add_f32 v20, v22, v23
    s_nop 1
    v_add_f32_dpp v20, v20, v20 row_ror:1 row_mask:0xf bank_mask:0xf
    s_nop 1
    v_add_f32_dpp v20, v20, v20 row_ror:2 row_mask:0xf bank_mask:0xf
    s_nop 1
    v_add_f32_dpp v20, v20, v20 row_ror:4 row_mask:0xf bank_mask:0xf
    s_nop 1
    v_add_f32_dpp v20, v20, v20 row_ror:8 row_mask:0xf bank_mask:0xf
    v_mov_b32 v21, v20
    s_nop 1
    v_permlane32_swap_b32 v20, v21
    v_add_f32 v20, v20, v21
    v_mov_b32 v21, 0x3727c5ac
    v_fmac_f32 v21, 0x3b000000, v20
    v_rsq_f32 v20, v21
    s_nop 0
    v_pk_mul_f32 v[132:133], v[132:133], v[20:21] op_sel_hi:[1,0]
    v_pk_mul_f32 v[134:135], v[134:135], v[20:21] op_sel_hi:[1,0]
    v_pk_mul_f32 v[136:137], v[136:137], v[20:21] op_sel_hi:[1,0]
    v_pk_mul_f32 v[138:139], v[138:139], v[20:21] op_sel_hi:[1,0]
    v_pk_mul_f32 v[140:141], v[140:141], v[20:21] op_sel_hi:[1,0]
    v_pk_mul_f32 v[142:143], v[142:143], v[20:21] op_sel_hi:[1,0]
    v_pk_mul_f32 v[144:145], v[144:145], v[20:21] op_sel_hi:[1,0]
    v_pk_mul_f32 v[146:147], v[146:147], v[20:21] op_sel_hi:[1,0]
    s_mov_b32 s62, 16384
    s_mov_b32 s64, 20480
    s_mov_b32 s71, 24576
    s_mov_b32 s77, 28672
    s_waitcnt vmcnt(12)
    s_waitcnt vmcnt(4)
    s_barrier
    buffer_load_dwordx4 v[20:23], v4, s[8:11], s62 offen sc1
    buffer_load_dwordx4 v[24:27], v4, s[8:11], s64 offen sc1
    buffer_load_dwordx4 v[28:31], v4, s[8:11], s71 offen sc1
    buffer_load_dwordx4 v[32:35], v4, s[8:11], s77 offen sc1
    v_add_u32 v41, s63, v41
    ds_read_u16 v156, v41 offset:0
    ds_read_u16 v164, v41 offset:8320
    ds_read_u16 v157, v41 offset:256
    ds_read_u16 v165, v41 offset:8576
    ds_read_u16 v158, v41 offset:512
    ds_read_u16 v166, v41 offset:8832
    ds_read_u16 v159, v41 offset:768
    ds_read_u16 v167, v41 offset:9088
    ds_read_u16 v160, v41 offset:16
    ds_read_u16 v168, v41 offset:8336
    ds_read_u16 v161, v41 offset:272
    ds_read_u16 v169, v41 offset:8592
    ds_read_u16 v162, v41 offset:528
    ds_read_u16 v170, v41 offset:8848
    ds_read_u16 v163, v41 offset:784
    ds_read_u16 v171, v41 offset:9104
    s_and_b32 s3, s2, 0x18
    s_cselect_b32 s3, 0, 8192
    v_mov_b32 v150, 2130706432
    v_cmp_gt_u32 vcc, s3, v42
    s_nop 1
    v_cndmask_b32 v154, v42, v150, vcc
    s_add_u32 s48, s65, 65536
    v_lshlrev_b32 v112, 16, v112
    v_lshlrev_b32 v113, 16, v113
    v_lshlrev_b32 v114, 16, v114
    v_lshlrev_b32 v115, 16, v115
    v_add_f32 v150, v112, v114
    v_sub_f32 v151, v113, v115
    v_mul_f32 v150, 0x3e800000, v150
    v_mul_f32 v151, 0x3e800000, v151
    v_cvt_pk_bf16_f32 v152, v150, v151
    v_cvt_pk_bf16_f32 v153, -v151, v150
    v_cmp_lt_u32 vcc, 16, v3
    s_nop 1
    v_cndmask_b32 v152, v152, v153, vcc
    s_waitcnt lgkmcnt(12)
    v_lshl_or_b32 v156, v164, 16, v156
    v_lshl_or_b32 v157, v165, 16, v157
    s_waitcnt lgkmcnt(8)
    v_lshl_or_b32 v158, v166, 16, v158
    v_lshl_or_b32 v159, v167, 16, v159
    buffer_store_dwordx4 v[156:159], v154, s[8:11], s65 offen sc1
    s_waitcnt lgkmcnt(4)
    v_lshl_or_b32 v160, v168, 16, v160
    v_lshl_or_b32 v161, v169, 16, v161
    s_waitcnt lgkmcnt(0)
    v_lshl_or_b32 v162, v170, 16, v162
    v_lshl_or_b32 v163, v171, 16, v163
    buffer_store_dwordx4 v[160:163], v42, s[8:11], s48 offen sc1
    s_mov_b64 exec, 15
    buffer_store_dword v152, v43, s[8:11], s66 offen sc1
    s_mov_b64 exec, -1
    s_nop 0
    buffer_store_dwordx4 v[16:19], v4, s[8:11], s59 offen sc1
    s_add_u32 s51, s59, 4096
    buffer_store_dwordx4 v[16:19], v4, s[8:11], s51 offen sc1
    s_mov_b32 m0, s60
    s_add_u32 s60, s60, 1024
    buffer_load_dwordx4 v45, s[28:31], s68 offen lds
    s_mov_b32 m0, s60
    s_add_u32 s68, s68, 8192
    buffer_load_dwordx4 v45, s[28:31], s68 offen lds
    ds_read_b128 a[212:215], v3 offset:0
    ds_read_b128 a[216:219], v3 offset:1024
    ds_read_b128 a[220:223], v3 offset:2048
    ds_read_b128 a[224:227], v3 offset:3072
    ds_read_b128 v[48:51], v3 offset:4096
    ds_read_b128 v[52:55], v3 offset:5120
    ds_read_b128 v[56:59], v3 offset:6144
    ds_read_b128 v[60:63], v3 offset:7168
    ds_read_b128 a[228:231], v3 offset:8192
    ds_read_b128 a[232:235], v3 offset:9216
    ds_read_b128 a[24:27], v3 offset:10240
    ds_read_b128 a[28:31], v3 offset:11264
    ds_read_b128 a[32:35], v3 offset:12288
    ds_read_b128 a[36:39], v3 offset:13312
    ds_read_b128 a[40:43], v3 offset:14336
    ds_read_b128 a[44:47], v3 offset:15360
    ds_read_b128 a[176:179], v3 offset:16384
    ds_read_b128 a[180:183], v3 offset:17408
    ds_read_b128 a[184:187], v3 offset:18432
    ds_read_b128 a[188:191], v3 offset:19456
    ds_read_b128 a[192:195], v3 offset:20480
    ds_read_b128 a[196:199], v3 offset:21504
    ds_read_b128 a[200:203], v3 offset:22528
    ds_read_b128 a[204:207], v3 offset:23552
    ds_read_b128 a[48:51], v3 offset:24576
    ds_read_b128 a[52:55], v3 offset:25600
    ds_read_b128 a[56:59], v3 offset:26624
    ds_read_b128 a[60:63], v3 offset:27648
    ds_read_b128 a[64:67], v3 offset:28672
    ds_read_b128 a[68:71], v3 offset:29696
    ds_read_b128 a[72:75], v3 offset:30720
    ds_read_b128 a[76:79], v3 offset:31744
    s_mov_b32 s50, 0
    s_waitcnt vmcnt(10)
    v_perm_b32 v125, v21, v20, s54
    v_perm_b32 v126, v23, v22, s55
    v_or_b32 v125, v125, v126
    v_xor_b32 v124, s44, v125
    v_and_b32 v20, s56, v20
    v_and_b32 v21, s56, v21
    v_and_b32 v22, s56, v22
    v_and_b32 v23, s56, v23
    s_waitcnt vmcnt(9)
    v_perm_b32 v125, v25, v24, s54
    v_perm_b32 v126, v27, v26, s55
    v_or_b32 v125, v125, v126
    v_xor_b32 v125, s44, v125
    v_or_b32 v124, v124, v125
    v_and_b32 v24, s56, v24
    v_and_b32 v25, s56, v25
    v_and_b32 v26, s56, v26
    v_and_b32 v27, s56, v27
    s_waitcnt vmcnt(8)
    v_perm_b32 v125, v29, v28, s54
    v_perm_b32 v126, v31, v30, s55
    v_or_b32 v125, v125, v126
    v_xor_b32 v125, s44, v125
    v_or_b32 v124, v124, v125
    v_and_b32 v28, s56, v28
    v_and_b32 v29, s56, v29
    v_and_b32 v30, s56, v30
    v_and_b32 v31, s56, v31
    s_waitcnt vmcnt(7)
    v_perm_b32 v125, v33, v32, s54
    v_perm_b32 v126, v35, v34, s55
    v_or_b32 v125, v125, v126
    v_xor_b32 v125, s44, v125
    v_or_b32 v124, v124, v125
    v_and_b32 v32, s56, v32
    v_and_b32 v33, s56, v33
    v_and_b32 v34, s56, v34
    v_and_b32 v35, s56, v35
    v_lshrrev_b32 v131, 28, v124
    v_and_b32 v124, 0x0fffffff, v124
    v_cmp_ne_u32 vcc, 0, v124
    s_cbranch_vccz L_mod_ok
L_mod_rty:
    s_add_u32 s50, s50, 1
    s_cmp_ge_u32 s50, 131072
    s_cbranch_scc1 L_mod_dead
    s_mov_b64 exec, vcc
    buffer_load_dwordx4 v[20:23], v4, s[8:11], s62 offen sc1
    buffer_load_dwordx4 v[24:27], v4, s[8:11], s64 offen sc1
    buffer_load_dwordx4 v[28:31], v4, s[8:11], s71 offen sc1
    buffer_load_dwordx4 v[32:35], v4, s[8:11], s77 offen sc1
    s_waitcnt vmcnt(3)
    v_perm_b32 v125, v21, v20, s54
    v_perm_b32 v126, v23, v22, s55
    v_or_b32 v125, v125, v126
    v_xor_b32 v124, s44, v125
    v_and_b32 v20, s56, v20
    v_and_b32 v21, s56, v21
    v_and_b32 v22, s56, v22
    v_and_b32 v23, s56, v23
    s_waitcnt vmcnt(2)
    v_perm_b32 v125, v25, v24, s54
    v_perm_b32 v126, v27, v26, s55
    v_or_b32 v125, v125, v126
    v_xor_b32 v125, s44, v125
    v_or_b32 v124, v124, v125
    v_and_b32 v24, s56, v24
    v_and_b32 v25, s56, v25
    v_and_b32 v26, s56, v26
    v_and_b32 v27, s56, v27
    s_waitcnt vmcnt(1)
    v_perm_b32 v125, v29, v28, s54
    v_perm_b32 v126, v31, v30, s55
    v_or_b32 v125, v125, v126
    v_xor_b32 v125, s44, v125
    v_or_b32 v124, v124, v125
    v_and_b32 v28, s56, v28
    v_and_b32 v29, s56, v29
    v_and_b32 v30, s56, v30
    v_and_b32 v31, s56, v31
    s_waitcnt vmcnt(0)
    v_perm_b32 v125, v33, v32, s54
    v_perm_b32 v126, v35, v34, s55
    v_or_b32 v125, v125, v126
    v_xor_b32 v125, s44, v125
    v_or_b32 v124, v124, v125
    v_and_b32 v32, s56, v32
    v_and_b32 v33, s56, v33
    v_and_b32 v34, s56, v34
    v_and_b32 v35, s56, v35
    v_lshrrev_b32 v131, 28, v124
    v_and_b32 v124, 0x0fffffff, v124
    v_cmp_ne_u32 vcc, 0, v124
    s_mov_b64 exec, -1
    s_cbranch_vccnz L_mod_rty
L_mod_ok:
    v_pk_add_f32 v[20:21], v[20:21], v[24:25]
    v_pk_add_f32 v[22:23], v[22:23], v[26:27]
    v_pk_add_f32 v[28:29], v[28:29], v[32:33]
    v_pk_add_f32 v[30:31], v[30:31], v[34:35]
    v_pk_add_f32 v[20:21], v[20:21], v[28:29]
    v_pk_add_f32 v[22:23], v[22:23], v[30:31]
    v_cvt_pk_bf16_f32 v124, v20, v21
    v_cvt_pk_bf16_f32 v125, v22, v23
    v_lshlrev_b32 v20, 16, v124
    v_and_b32 v21, 0xffff0000, v124
    v_lshlrev_b32 v22, 16, v125
    v_and_b32 v23, 0xffff0000, v125
    v_add_f32 v20, s57, v20
    v_add_f32 v21, s57, v21
    v_add_f32 v22, s57, v22
    v_add_f32 v23, s57, v23
    v_cvt_pk_bf16_f32 v124, v20, v21
    v_cvt_pk_bf16_f32 v125, v22, v23
    v_lshlrev_b32 v20, 16, v124
    v_and_b32 v21, 0xffff0000, v124
    v_lshlrev_b32 v22, 16, v125
    v_and_b32 v23, 0xffff0000, v125
    ds_write_b32 v36, v20 offset:0
    ds_write_b32 v36, v21 offset:144
    ds_write_b32 v36, v22 offset:288
    ds_write_b32 v36, v23 offset:432
    v_and_b32 v131, v131, v1
    ds_or_b32 v47, v131
    s_waitcnt lgkmcnt(0)
    s_barrier
    ds_read_b128 v[164:167], v37 offset:2304
    ds_read_b128 v[148:151], v37 offset:0
    ds_read_b128 v[168:171], v37 offset:2320
    ds_read_b128 v[152:155], v37 offset:16
    ds_read_b128 v[172:175], v37 offset:2368
    ds_read_b128 v[156:159], v37 offset:64
    ds_read_b128 v[176:179], v37 offset:2384
    ds_read_b128 v[160:163], v37 offset:80
    ds_read_b32 v131, v47
    buffer_load_dwordx4 v[116:119], v6, s[4:7], s67 offen offset:2048
    buffer_load_dwordx4 v[120:123], v6, s[4:7], s67 offen offset:2064
    s_mov_b64 exec, 0x7ff
    buffer_load_dword a208, v70, s[32:35], s25 offen
    s_mov_b64 exec, -1
    s_waitcnt lgkmcnt(7)
    v_pk_fma_f32 v[132:133], v[132:133], v[164:165], v[148:149]
    v_pk_fma_f32 v[134:135], v[134:135], v[166:167], v[150:151]
    v_cvt_pk_bf16_f32 v180, v132, v133
    v_cvt_pk_bf16_f32 v181, v134, v135
    s_waitcnt lgkmcnt(5)
    v_pk_fma_f32 v[136:137], v[136:137], v[168:169], v[152:153]
    v_pk_fma_f32 v[138:139], v[138:139], v[170:171], v[154:155]
    v_cvt_pk_bf16_f32 v182, v136, v137
    v_cvt_pk_bf16_f32 v183, v138, v139
    s_waitcnt lgkmcnt(3)
    v_pk_fma_f32 v[140:141], v[140:141], v[172:173], v[156:157]
    v_pk_fma_f32 v[142:143], v[142:143], v[174:175], v[158:159]
    v_cvt_pk_bf16_f32 v184, v140, v141
    v_cvt_pk_bf16_f32 v185, v142, v143
    s_waitcnt lgkmcnt(1)
    v_pk_fma_f32 v[144:145], v[144:145], v[176:177], v[160:161]
    v_pk_fma_f32 v[146:147], v[146:147], v[178:179], v[162:163]
    v_cvt_pk_bf16_f32 v186, v144, v145
    v_cvt_pk_bf16_f32 v187, v146, v147
    v_mfma_f32_32x32x16_bf16 v[20:35], v[180:183], a[212:215], 0
    v_mfma_f32_32x32x16_bf16 v[188:203], v[180:183], a[220:223], 0
    v_mfma_f32_32x32x16_bf16 v[20:35], v[184:187], a[216:219], v[20:35]
    v_mfma_f32_32x32x16_bf16 v[188:203], v[184:187], a[224:227], v[188:203]
    s_xor_b32 s3, s49, 3
    s_or_b32 s3, s3, s2
    s_cbranch_scc1 L_noepoch
    s_add_u32 s3, s53, 1
    v_mov_b32 v125, s3
    s_mov_b64 exec, 1
    buffer_store_dword v125, off, s[8:11], 0 offset:0 sc1
    s_mov_b64 exec, -1
L_noepoch:
    s_waitcnt lgkmcnt(0)
    v_readfirstlane_b32 s45, v131
    s_nop 5
    v_pk_mul_f32 v[124:125], v[20:21], v[48:49]
    v_pk_mul_f32 v[126:127], v[188:189], v[48:49]
    v_pk_fma_f32 v[124:125], v[188:189], v[56:57], v[124:125]
    v_pk_fma_f32 v[188:189], v[20:21], v[56:57], v[126:127] neg_lo:[1,0,0] neg_hi:[1,0,0]
    v_cvt_pk_bf16_f32 v132, v124, v125
    v_cvt_pk_bf16_f32 v134, v188, v189
    v_pk_mul_f32 v[128:129], v[22:23], v[50:51]
    v_pk_mul_f32 v[130:131], v[190:191], v[50:51]
    v_pk_fma_f32 v[128:129], v[190:191], v[58:59], v[128:129]
    v_pk_fma_f32 v[190:191], v[22:23], v[58:59], v[130:131] neg_lo:[1,0,0] neg_hi:[1,0,0]
    v_cvt_pk_bf16_f32 v133, v128, v129
    v_cvt_pk_bf16_f32 v135, v190, v191
    v_pk_mul_f32 v[124:125], v[24:25], v[52:53]
    v_pk_mul_f32 v[126:127], v[192:193], v[52:53]
    v_pk_fma_f32 v[124:125], v[192:193], v[60:61], v[124:125]
    v_pk_fma_f32 v[192:193], v[24:25], v[60:61], v[126:127] neg_lo:[1,0,0] neg_hi:[1,0,0]
    v_cvt_pk_bf16_f32 v136, v124, v125
    v_cvt_pk_bf16_f32 v138, v192, v193
    v_pk_mul_f32 v[128:129], v[26:27], v[54:55]
    v_pk_mul_f32 v[130:131], v[194:195], v[54:55]
    v_pk_fma_f32 v[128:129], v[194:195], v[62:63], v[128:129]
    v_pk_fma_f32 v[194:195], v[26:27], v[62:63], v[130:131] neg_lo:[1,0,0] neg_hi:[1,0,0]
    v_cvt_pk_bf16_f32 v137, v128, v129
    v_cvt_pk_bf16_f32 v139, v194, v195
    v_pk_mul_f32 v[124:125], v[28:29], v[48:49]
    v_pk_mul_f32 v[126:127], v[196:197], v[48:49]
    v_pk_fma_f32 v[124:125], v[196:197], v[56:57], v[124:125]
    v_pk_fma_f32 v[196:197], v[28:29], v[56:57], v[126:127] neg_lo:[1,0,0] neg_hi:[1,0,0]
    v_cvt_pk_bf16_f32 v140, v124, v125
    v_cvt_pk_bf16_f32 v142, v196, v197
    v_pk_mul_f32 v[128:129], v[30:31], v[50:51]
    v_pk_mul_f32 v[130:131], v[198:199], v[50:51]
    v_pk_fma_f32 v[128:129], v[198:199], v[58:59], v[128:129]
    v_pk_fma_f32 v[198:199], v[30:31], v[58:59], v[130:131] neg_lo:[1,0,0] neg_hi:[1,0,0]
    v_cvt_pk_bf16_f32 v141, v128, v129
    v_cvt_pk_bf16_f32 v143, v198, v199
    v_pk_mul_f32 v[124:125], v[32:33], v[52:53]
    v_pk_mul_f32 v[126:127], v[200:201], v[52:53]
    v_pk_fma_f32 v[124:125], v[200:201], v[60:61], v[124:125]
    v_pk_fma_f32 v[200:201], v[32:33], v[60:61], v[126:127] neg_lo:[1,0,0] neg_hi:[1,0,0]
    v_cvt_pk_bf16_f32 v144, v124, v125
    v_cvt_pk_bf16_f32 v146, v200, v201
    v_pk_mul_f32 v[128:129], v[34:35], v[54:55]
    v_pk_mul_f32 v[130:131], v[202:203], v[54:55]
    v_pk_fma_f32 v[128:129], v[202:203], v[62:63], v[128:129]
    v_pk_fma_f32 v[202:203], v[34:35], v[62:63], v[130:131] neg_lo:[1,0,0] neg_hi:[1,0,0]
    v_cvt_pk_bf16_f32 v145, v128, v129
    v_cvt_pk_bf16_f32 v147, v202, v203
    v_mfma_f32_32x32x16_bf16 v[164:179], a[228:231], v[132:135], 0
    v_mfma_f32_32x32x16_bf16 v[148:163], a[228:231], v[140:143], 0
    v_mfma_f32_32x32x16_bf16 v[164:179], a[232:235], v[136:139], v[164:179]
    v_mfma_f32_32x32x16_bf16 v[148:163], a[232:235], v[144:147], v[148:163]
    v_cmp_eq_u32 vcc, 0, v3
    s_waitcnt vmcnt(7)
    s_waitcnt vmcnt(5)
    s_nop 7
    v_cndmask_b32 v165, v165, v172, vcc
    v_cndmask_b32 v149, v149, v156, vcc
    v_cvt_pk_bf16_f32 v124, v164, v148
    ds_write_b32 v38, v124 offset:0
    v_cvt_pk_bf16_f32 v125, v165, v149
    ds_write_b32 v38, v125 offset:4160
    v_cvt_pk_bf16_f32 v126, v166, v150
    ds_write_b32 v38, v126 offset:512
    v_cvt_pk_bf16_f32 v127, v167, v151
    ds_write_b32 v38, v127 offset:4672
    v_cvt_pk_bf16_f32 v128, v168, v152
    ds_write_b32 v38, v128 offset:2048
    v_cvt_pk_bf16_f32 v129, v169, v153
    ds_write_b32 v38, v129 offset:6208
    v_cvt_pk_bf16_f32 v130, v170, v154
    ds_write_b32 v38, v130 offset:2560
    v_cvt_pk_bf16_f32 v131, v171, v155
    ds_write_b32 v38, v131 offset:6720
    s_waitcnt lgkmcnt(0)
    s_barrier
    ds_read2_b32 v[180:181], v39 offset0:0 offset1:32
    ds_read2_b32 v[182:183], v39 offset0:64 offset1:96
    ds_read2_b32 v[184:185], v39 offset0:128 offset1:160
    ds_read2_b32 v[186:187], v39 offset0:192 offset1:224
    s_waitcnt lgkmcnt(2)
    v_min_u32 v180, -2, v180
    buffer_store_dwordx4 v[180:183], v40, s[8:11], s58 offen offset:0 sc1
    s_waitcnt lgkmcnt(0)
    v_min_u32 v184, -2, v184
    buffer_store_dwordx4 v[184:187], v40, s[8:11], s58 offen offset:1024 sc1
    s_cmp_lg_u32 s45, 0
    s_cbranch_scc1 L_lst1
    buffer_store_dwordx4 v[16:19], v68, s[8:11], s19 offen
L_lse1:
    s_cmp_lg_u32 s45, 0
    s_cbranch_scc1 L_lst2
    buffer_store_dwordx4 v[16:19], v68, s[8:11], s20 offen
L_lse2:
    s_cmp_lg_u32 s45, 0
    s_cbranch_scc1 L_lst3
    buffer_store_dwordx4 v[16:19], v40, s[8:11], s21 offen
L_lse3:
    s_cmp_lg_u32 s45, 0
    s_cbranch_scc1 L_lst4
    buffer_store_dwordx4 v[16:19], v40, s[8:11], s21 offen offset:1024
L_lse4:
    s_cmp_lg_u32 s45, 0
    s_cbranch_scc1 L_lst5
    buffer_store_dwordx4 v[16:19], v69, s[8:11], s22 offen offset:0
L_lse5:
    s_cmp_lg_u32 s45, 0
    s_cbranch_scc1 L_lst6
    buffer_store_dwordx4 v[16:19], v69, s[8:11], s22 offen offset:1024
L_lse6:
    s_cmp_lg_u32 s45, 0
    s_cbranch_scc1 L_lst7
    buffer_store_dwordx4 v[16:19], v69, s[8:11], s22 offen offset:2048
L_lse7:
    s_cmp_lg_u32 s45, 0
    s_cbranch_scc1 L_lst8
    buffer_store_dwordx4 v[16:19], v69, s[8:11], s22 offen offset:3072
L_lse8:
    s_cmp_lg_u32 s45, 0
    s_cbranch_scc1 L_lst9
    buffer_store_dwordx4 v[16:19], v69, s[8:11], s23 offen offset:0
L_lse9:
    s_cmp_lg_u32 s45, 0
    s_cbranch_scc1 L_lst10
    buffer_store_dwordx4 v[16:19], v69, s[8:11], s23 offen offset:1024
L_lse10:
    s_mov_b32 m0, s61
    s_add_u32 s61, s61, 1024
    buffer_load_dwordx4 v64, s[32:35], s24 offen lds
    s_mov_b32 m0, s61
    s_add_u32 s61, s61, 1024
    buffer_load_dwordx4 v65, s[32:35], s24 offen lds
    s_mov_b32 m0, s61
    s_add_u32 s61, s61, 1024
    buffer_load_dwordx4 v66, s[32:35], s24 offen lds
    s_add_u32 s24, s24, 44032
    s_mov_b32 m0, s61
    s_add_u32 s61, s61, 1024
    buffer_load_dwordx4 v64, s[32:35], s24 offen lds
    s_mov_b32 m0, s61
    s_add_u32 s61, s61, 1024
    buffer_load_dwordx4 v65, s[32:35], s24 offen lds
    s_mov_b32 m0, s61
    s_add_u32 s61, s61, 1024
    buffer_load_dwordx4 v66, s[32:35], s24 offen lds
    s_add_u32 s24, s24, 44032
    s_mov_b32 m0, s61
    s_add_u32 s61, s61, 1024
    buffer_load_dwordx4 v64, s[32:35], s24 offen lds
    s_mov_b32 m0, s61
    s_add_u32 s61, s61, 1024
    buffer_load_dwordx4 v65, s[32:35], s24 offen lds
    s_mov_b32 s44, 0
    s_add_u32 s53, s59, 4096
    v_pk_mov_b32 v[20:21], 0, 0
    v_pk_mov_b32 v[28:29], 0, 0
    v_pk_mov_b32 v[22:23], 0, 0
    v_pk_mov_b32 v[30:31], 0, 0
    v_pk_mov_b32 v[24:25], 0, 0
    v_pk_mov_b32 v[32:33], 0, 0
    v_pk_mov_b32 v[26:27], 0, 0
    v_pk_mov_b32 v[34:35], 0, 0
    s_waitcnt vmcnt(23)
    ds_read_b64_tr_b16 v[132:133], v46 offset:0
    ds_read_b64_tr_b16 v[134:135], v46 offset:1024
    ds_read_b64_tr_b16 v[136:137], v46 offset:64
    ds_read_b64_tr_b16 v[138:139], v46 offset:1088
    s_waitcnt lgkmcnt(2)
    buffer_store_dwordx4 v[132:135], v40, s[8:11], s69 offen sc1
    s_waitcnt lgkmcnt(0)
    buffer_store_dwordx4 v[136:139], v40, s[8:11], s69 offen offset:1024 sc1
    s_waitcnt vmcnt(23)
    s_sleep 4
    buffer_load_dwordx4 v[124:127], v72, s[8:11], s13 offen sc1
    buffer_load_dwordx4 v[128:131], v72, s[8:11], s14 offen sc1
    v_lshlrev_b32 v140, 16, v116
    v_and_b32 v141, 0xffff0000, v116
    v_lshlrev_b32 v142, 16, v117
    v_and_b32 v143, 0xffff0000, v117
    v_lshlrev_b32 v144, 16, v118
    v_and_b32 v145, 0xffff0000, v118
    v_lshlrev_b32 v146, 16, v119
    v_and_b32 v147, 0xffff0000, v119
    v_lshlrev_b32 v148, 16, v120
    v_and_b32 v149, 0xffff0000, v120
    v_lshlrev_b32 v150, 16, v121
    v_and_b32 v151, 0xffff0000, v121
    v_lshlrev_b32 v152, 16, v122
    v_and_b32 v153, 0xffff0000, v122
    v_lshlrev_b32 v154, 16, v123
    v_and_b32 v155, 0xffff0000, v123
    v_mov_b32 v156, v10
    v_pk_mul_f32 v[140:141], v[140:141], v[156:157] op_sel_hi:[1,0]
    v_pk_mul_f32 v[142:143], v[142:143], v[156:157] op_sel_hi:[1,0]
    v_pk_mul_f32 v[144:145], v[144:145], v[156:157] op_sel_hi:[1,0]
    v_pk_mul_f32 v[146:147], v[146:147], v[156:157] op_sel_hi:[1,0]
    v_pk_mul_f32 v[148:149], v[148:149], v[156:157] op_sel_hi:[1,0]
    v_pk_mul_f32 v[150:151], v[150:151], v[156:157] op_sel_hi:[1,0]
    v_pk_mul_f32 v[152:153], v[152:153], v[156:157] op_sel_hi:[1,0]
    v_pk_mul_f32 v[154:155], v[154:155], v[156:157] op_sel_hi:[1,0]
    v_add_f32_dpp v140, v140, v140 row_ror:2 row_mask:0xf bank_mask:0xf
    v_add_f32_dpp v141, v141, v141 row_ror:2 row_mask:0xf bank_mask:0xf
    v_add_f32_dpp v142, v142, v142 row_ror:2 row_mask:0xf bank_mask:0xf
    v_add_f32_dpp v143, v143, v143 row_ror:2 row_mask:0xf bank_mask:0xf
    v_add_f32_dpp v144, v144, v144 row_ror:2 row_mask:0xf bank_mask:0xf
    v_add_f32_dpp v145, v145, v145 row_ror:2 row_mask:0xf bank_mask:0xf
    v_add_f32_dpp v146, v146, v146 row_ror:2 row_mask:0xf bank_mask:0xf
    v_add_f32_dpp v147, v147, v147 row_ror:2 row_mask:0xf bank_mask:0xf
    v_add_f32_dpp v148, v148, v148 row_ror:2 row_mask:0xf bank_mask:0xf
    v_add_f32_dpp v149, v149, v149 row_ror:2 row_mask:0xf bank_mask:0xf
    v_add_f32_dpp v150, v150, v150 row_ror:2 row_mask:0xf bank_mask:0xf
    v_add_f32_dpp v151, v151, v151 row_ror:2 row_mask:0xf bank_mask:0xf
    v_add_f32_dpp v152, v152, v152 row_ror:2 row_mask:0xf bank_mask:0xf
    v_add_f32_dpp v153, v153, v153 row_ror:2 row_mask:0xf bank_mask:0xf
    v_add_f32_dpp v154, v154, v154 row_ror:2 row_mask:0xf bank_mask:0xf
    v_add_f32_dpp v155, v155, v155 row_ror:2 row_mask:0xf bank_mask:0xf
    v_add_f32_dpp v140, v140, v140 row_ror:4 row_mask:0xf bank_mask:0xf
    v_add_f32_dpp v141, v141, v141 row_ror:4 row_mask:0xf bank_mask:0xf
    v_add_f32_dpp v142, v142, v142 row_ror:4 row_mask:0xf bank_mask:0xf
    v_add_f32_dpp v143, v143, v143 row_ror:4 row_mask:0xf bank_mask:0xf
    v_add_f32_dpp v144, v144, v144 row_ror:4 row_mask:0xf bank_mask:0xf
    v_add_f32_dpp v145, v145, v145 row_ror:4 row_mask:0xf bank_mask:0xf
    v_add_f32_dpp v146, v146, v146 row_ror:4 row_mask:0xf bank_mask:0xf
    v_add_f32_dpp v147, v147, v147 row_ror:4 row_mask:0xf bank_mask:0xf
    v_add_f32_dpp v148, v148, v148 row_ror:4 row_mask:0xf bank_mask:0xf
    v_add_f32_dpp v149, v149, v149 row_ror:4 row_mask:0xf bank_mask:0xf
    v_add_f32_dpp v150, v150, v150 row_ror:4 row_mask:0xf bank_mask:0xf
    v_add_f32_dpp v151, v151, v151 row_ror:4 row_mask:0xf bank_mask:0xf
    v_add_f32_dpp v152, v152, v152 row_ror:4 row_mask:0xf bank_mask:0xf
    v_add_f32_dpp v153, v153, v153 row_ror:4 row_mask:0xf bank_mask:0xf
    v_add_f32_dpp v154, v154, v154 row_ror:4 row_mask:0xf bank_mask:0xf
    v_add_f32_dpp v155, v155, v155 row_ror:4 row_mask:0xf bank_mask:0xf
    v_add_f32_dpp v140, v140, v140 row_ror:8 row_mask:0xf bank_mask:0xf
    v_add_f32_dpp v141, v141, v141 row_ror:8 row_mask:0xf bank_mask:0xf
    v_add_f32_dpp v142, v142, v142 row_ror:8 row_mask:0xf bank_mask:0xf
    v_add_f32_dpp v143, v143, v143 row_ror:8 row_mask:0xf bank_mask:0xf
    v_add_f32_dpp v144, v144, v144 row_ror:8 row_mask:0xf bank_mask:0xf
    v_add_f32_dpp v145, v145, v145 row_ror:8 row_mask:0xf bank_mask:0xf
    v_add_f32_dpp v146, v146, v146 row_ror:8 row_mask:0xf bank_mask:0xf
    v_add_f32_dpp v147, v147, v147 row_ror:8 row_mask:0xf bank_mask:0xf
    v_add_f32_dpp v148, v148, v148 row_ror:8 row_mask:0xf bank_mask:0xf
    v_add_f32_dpp v149, v149, v149 row_ror:8 row_mask:0xf bank_mask:0xf
    v_add_f32_dpp v150, v150, v150 row_ror:8 row_mask:0xf bank_mask:0xf
    v_add_f32_dpp v151, v151, v151 row_ror:8 row_mask:0xf bank_mask:0xf
    v_add_f32_dpp v152, v152, v152 row_ror:8 row_mask:0xf bank_mask:0xf
    v_add_f32_dpp v153, v153, v153 row_ror:8 row_mask:0xf bank_mask:0xf
    v_add_f32_dpp v154, v154, v154 row_ror:8 row_mask:0xf bank_mask:0xf
    v_add_f32_dpp v155, v155, v155 row_ror:8 row_mask:0xf bank_mask:0xf
    v_permlane16_swap_b32 v140, v148
    v_permlane16_swap_b32 v141, v149
    v_permlane16_swap_b32 v142, v150
    v_permlane16_swap_b32 v143, v151
    v_permlane16_swap_b32 v144, v152
    v_permlane16_swap_b32 v145, v153
    v_permlane16_swap_b32 v146, v154
    v_permlane16_swap_b32 v147, v155
    v_add_f32 v140, v140, v148
    v_add_f32 v141, v141, v149
    v_add_f32 v142, v142, v150
    v_add_f32 v143, v143, v151
    v_add_f32 v144, v144, v152
    v_add_f32 v145, v145, v153
    v_add_f32 v146, v146, v154
    v_add_f32 v147, v147, v155
    v_permlane32_swap_b32 v140, v144
    v_permlane32_swap_b32 v141, v145
    v_permlane32_swap_b32 v142, v146
    v_permlane32_swap_b32 v143, v147
    v_add_f32 v140, v140, v144
    v_add_f32 v141, v141, v145
    v_add_f32 v142, v142, v146
    v_add_f32 v143, v143, v147
    s_mov_b32 exec_lo, 0x00030003
    s_mov_b32 exec_hi, 0x00030003
    ds_write_b128 v44, v[140:143]
    s_mov_b64 exec, -1
    s_waitcnt lgkmcnt(0)
    s_barrier
    s_cmp_lg_u32 s49, 1
    s_cbranch_scc1 L_nomodn
    v_and_b32 v140, 112, v3
    v_add_u32 v141, 126720, v140
    ds_read_b128 v[156:159], v141 offset:0
    ds_read_b128 v[160:163], v141 offset:128
    ds_read_b128 v[164:167], v141 offset:256
    ds_read_b128 v[168:171], v141 offset:384
    s_waitcnt lgkmcnt(0)
    v_pk_add_f32 v[156:157], v[156:157], v[160:161]
    v_pk_add_f32 v[158:159], v[158:159], v[162:163]
    v_pk_add_f32 v[164:165], v[164:165], v[168:169]
    v_pk_add_f32 v[166:167], v[166:167], v[170:171]
    v_pk_add_f32 v[156:157], v[156:157], v[164:165]
    v_pk_add_f32 v[158:159], v[158:159], v[166:167]
    v_mov_b32 v160, s52
    s_mov_b32 s3, 0x7060500
    v_perm_b32 v156, v156, v160, s3
    s_mov_b32 s3, 0x7060501
    v_perm_b32 v157, v157, v160, s3
    s_mov_b32 s3, 0x7060502
    v_perm_b32 v158, v158, v160, s3
    s_mov_b32 s3, 0x7060503
    v_perm_b32 v159, v159, v160, s3
    s_mov_b64 exec, 0xff
    buffer_store_dwordx4 v[156:159], v140, s[8:11], s70 offen sc1
    s_mov_b64 exec, -1
L_nomodn:
    s_nop 1
    s_mov_b32 s50, 0
    s_waitcnt vmcnt(0)
    v_max_u32 v2, v124, v128
    v_cmp_eq_u32 vcc, -1, v2
    s_cbranch_vccz L_z1_ok
L_z1_rty:
    s_add_u32 s50, s50, 1
    s_cmp_ge_u32 s50, 131072
    s_cbranch_scc1 L_z1_dead
    s_mov_b64 exec, vcc
    buffer_load_dwordx4 v[124:127], v72, s[8:11], s13 offen sc1
    buffer_load_dwordx4 v[128:131], v72, s[8:11], s14 offen sc1
    s_waitcnt vmcnt(0)
    v_max_u32 v2, v124, v128
    v_cmp_eq_u32 vcc, -1, v2
    s_mov_b64 exec, -1
    s_cbranch_vccnz L_z1_rty
L_z1_ok:
    ds_write_b128 v73, v[124:127]
    ds_write_b128 v73, v[128:131] offset:512
    s_waitcnt lgkmcnt(0)
    s_barrier
    ds_read_b128 v[156:159], v74 offset:0
    ds_read_b128 v[160:163], v74 offset:2176
    ds_read_b128 v[164:167], v74 offset:4352
    ds_read_b128 v[168:171], v74 offset:6528
    ds_read_b128 v[172:175], v74 offset:1088
    ds_read_b128 v[176:179], v74 offset:3264
    ds_read_b128 v[180:183], v74 offset:5440
    ds_read_b128 v[184:187], v74 offset:7616
    buffer_load_dwordx4 v[140:143], v75, s[8:11], s15 offen offset:0 sc1
    buffer_load_dwordx4 v[144:147], v75, s[8:11], s15 offen offset:64 sc1
    buffer_load_dwordx4 v[148:151], v75, s[8:11], s16 offen offset:0 sc1
    buffer_load_dwordx4 v[152:155], v75, s[8:11], s16 offen offset:64 sc1
    global_load_dwordx4 v[48:51], v5, s[72:73] offset:3072
    s_add_u32 s72, s72, 8192
    s_addc_u32 s73, s73, 0
    global_load_dwordx4 v[52:55], v5, s[72:73] offset:-4096
    global_load_dwordx4 v[56:59], v5, s[72:73] offset:-3072
    global_load_dwordx4 v[60:63], v5, s[72:73] offset:-2048
    s_mov_b32 m0, s61
    s_add_u32 s61, s61, 1024
    buffer_load_dwordx4 v66, s[32:35], s24 offen lds
    s_add_u32 s24, s24, 44032
L_job:
    s_waitcnt lgkmcnt(7)
    v_mfma_f32_16x16x32_bf16 v[132:135], v[156:159], a[0:3], 0
    v_mfma_f32_16x16x32_bf16 v[188:191], v[156:159], a[8:11], 0
    s_waitcnt lgkmcnt(6)
    v_mfma_f32_16x16x32_bf16 v[132:135], v[160:163], a[4:7], v[132:135]
    v_mfma_f32_16x16x32_bf16 v[188:191], v[160:163], a[12:15], v[188:191]
    s_waitcnt lgkmcnt(5)
    v_mfma_f32_16x16x32_bf16 v[136:139], v[164:167], a[0:3], 0
    v_mfma_f32_16x16x32_bf16 v[192:195], v[164:167], a[8:11], 0
    s_waitcnt lgkmcnt(4)
    v_mfma_f32_16x16x32_bf16 v[136:139], v[168:171], a[4:7], v[136:139]
    v_mfma_f32_16x16x32_bf16 v[192:195], v[168:171], a[12:15], v[192:195]
    s_cmp_eq_u32 s12, 0
    s_cbranch_scc1 L_noim
    s_waitcnt lgkmcnt(3)
    v_mfma_f32_16x16x32_bf16 v[132:135], v[172:175], a[16:19], v[132:135]
    v_mfma_f32_16x16x32_bf16 v[188:191], v[172:175], a[0:3], v[188:191]
    s_waitcnt lgkmcnt(2)
    v_mfma_f32_16x16x32_bf16 v[132:135], v[176:179], a[20:23], v[132:135]
    v_mfma_f32_16x16x32_bf16 v[188:191], v[176:179], a[4:7], v[188:191]
    s_waitcnt lgkmcnt(1)
    v_mfma_f32_16x16x32_bf16 v[136:139], v[180:183], a[16:19], v[136:139]
    v_mfma_f32_16x16x32_bf16 v[192:195], v[180:183], a[0:3], v[192:195]
    s_waitcnt lgkmcnt(0)
    v_mfma_f32_16x16x32_bf16 v[136:139], v[184:187], a[20:23], v[136:139]
    v_mfma_f32_16x16x32_bf16 v[192:195], v[184:187], a[4:7], v[192:195]
L_noim:
    s_nop 0
    v_pk_mul_f32 v[124:125], v[132:133], v[80:81]
    v_pk_mul_f32 v[126:127], v[188:189], v[80:81]
    v_pk_fma_f32 v[124:125], v[188:189], v[88:89], v[124:125]
    v_pk_fma_f32 v[188:189], v[132:133], v[88:89], v[126:127] neg_lo:[1,0,0] neg_hi:[1,0,0]
    v_cvt_pk_bf16_f32 v196, v124, v125
    v_cvt_pk_bf16_f32 v200, v188, v189
    v_pk_mul_f32 v[128:129], v[134:135], v[82:83]
    v_pk_mul_f32 v[130:131], v[190:191], v[82:83]
    v_pk_fma_f32 v[128:129], v[190:191], v[90:91], v[128:129]
    v_pk_fma_f32 v[190:191], v[134:135], v[90:91], v[130:131] neg_lo:[1,0,0] neg_hi:[1,0,0]
    v_cvt_pk_bf16_f32 v197, v128, v129
    v_cvt_pk_bf16_f32 v201, v190, v191
    v_pk_mul_f32 v[124:125], v[136:137], v[84:85]
    v_pk_mul_f32 v[126:127], v[192:193], v[84:85]
    v_pk_fma_f32 v[124:125], v[192:193], v[92:93], v[124:125]
    v_pk_fma_f32 v[192:193], v[136:137], v[92:93], v[126:127] neg_lo:[1,0,0] neg_hi:[1,0,0]
    v_cvt_pk_bf16_f32 v198, v124, v125
    v_cvt_pk_bf16_f32 v202, v192, v193
    v_pk_mul_f32 v[128:129], v[138:139], v[86:87]
    v_pk_mul_f32 v[130:131], v[194:195], v[86:87]
    v_pk_fma_f32 v[128:129], v[194:195], v[94:95], v[128:129]
    v_pk_fma_f32 v[194:195], v[138:139], v[94:95], v[130:131] neg_lo:[1,0,0] neg_hi:[1,0,0]
    v_cvt_pk_bf16_f32 v199, v128, v129
    v_cvt_pk_bf16_f32 v203, v194, v195
    s_nop 0
    v_mfma_f32_16x16x32_bf16 v[132:135], a[24:27], v[196:199], 0
    v_mfma_f32_16x16x32_bf16 v[188:191], a[32:35], v[196:199], 0
    v_mfma_f32_16x16x32_bf16 v[136:139], a[28:31], v[196:199], 0
    v_mfma_f32_16x16x32_bf16 v[192:195], a[36:39], v[196:199], 0
    v_mfma_f32_16x16x32_bf16 v[132:135], a[40:43], v[200:203], v[132:135]
    v_mfma_f32_16x16x32_bf16 v[188:191], a[24:27], v[200:203], v[188:191]
    v_mfma_f32_16x16x32_bf16 v[136:139], a[44:47], v[200:203], v[136:139]
    v_mfma_f32_16x16x32_bf16 v[192:195], a[28:31], v[200:203], v[192:195]
    s_waitcnt vmcnt(7)
    v_lshlrev_b32 v8, 16, v140
    v_and_b32 v112, 0xffff0000, v140
    v_lshlrev_b32 v9, 16, v141
    v_and_b32 v113, 0xffff0000, v141
    v_lshlrev_b32 v10, 16, v142
    v_and_b32 v114, 0xffff0000, v142
    v_lshlrev_b32 v11, 16, v143
    v_and_b32 v115, 0xffff0000, v143
    v_lshlrev_b32 v12, 16, v144
    v_and_b32 v116, 0xffff0000, v144
    v_lshlrev_b32 v13, 16, v145
    v_and_b32 v117, 0xffff0000, v145
    v_lshlrev_b32 v14, 16, v146
    v_and_b32 v118, 0xffff0000, v146
    v_lshlrev_b32 v15, 16, v147
    v_and_b32 v119, 0xffff0000, v147
    v_pk_fma_f32 v[20:21], v[132:133], v[8:9], v[20:21]
    v_pk_fma_f32 v[28:29], v[132:133], v[112:113], v[28:29]
    v_pk_fma_f32 v[20:21], v[188:189], v[112:113], v[20:21] neg_lo:[1,0,0] neg_hi:[1,0,0]
    v_pk_fma_f32 v[28:29], v[188:189], v[8:9], v[28:29]
    v_pk_fma_f32 v[22:23], v[134:135], v[10:11], v[22:23]
    v_pk_fma_f32 v[30:31], v[134:135], v[114:115], v[30:31]
    v_pk_fma_f32 v[22:23], v[190:191], v[114:115], v[22:23] neg_lo:[1,0,0] neg_hi:[1,0,0]
    v_pk_fma_f32 v[30:31], v[190:191], v[10:11], v[30:31]
    v_pk_fma_f32 v[24:25], v[136:137], v[12:13], v[24:25]
    v_pk_fma_f32 v[32:33], v[136:137], v[116:117], v[32:33]
    v_pk_fma_f32 v[24:25], v[192:193], v[116:117], v[24:25] neg_lo:[1,0,0] neg_hi:[1,0,0]
    v_pk_fma_f32 v[32:33], v[192:193], v[12:13], v[32:33]
    v_pk_fma_f32 v[26:27], v[138:139], v[14:15], v[26:27]
    v_pk_fma_f32 v[34:35], v[138:139], v[118:119], v[34:35]
    v_pk_fma_f32 v[26:27], v[194:195], v[118:119], v[26:27] neg_lo:[1,0,0] neg_hi:[1,0,0]
    v_pk_fma_f32 v[34:35], v[194:195], v[14:15], v[34:35]
    s_or_b32 s3, s12, s44
    s_cbranch_scc1 L_jobdone
    s_mov_b32 s44, 1
    s_waitcnt vmcnt(0) lgkmcnt(0)
    v_pk_mov_b32 v[156:157], v[172:173], v[172:173] op_sel:[0,1]
    v_pk_mov_b32 v[158:159], v[174:175], v[174:175] op_sel:[0,1]
    v_pk_mov_b32 v[160:161], v[176:177], v[176:177] op_sel:[0,1]
    v_pk_mov_b32 v[162:163], v[178:179], v[178:179] op_sel:[0,1]
    v_pk_mov_b32 v[164:165], v[180:181], v[180:181] op_sel:[0,1]
    v_pk_mov_b32 v[166:167], v[182:183], v[182:183] op_sel:[0,1]
    v_pk_mov_b32 v[168:169], v[184:185], v[184:185] op_sel:[0,1]
    v_pk_mov_b32 v[170:171], v[186:187], v[186:187] op_sel:[0,1]
    v_pk_mov_b32 v[140:141], v[148:149], v[148:149] op_sel:[0,1]
    v_pk_mov_b32 v[142:143], v[150:151], v[150:151] op_sel:[0,1]
    v_pk_mov_b32 v[144:145], v[152:153], v[152:153] op_sel:[0,1]
    v_pk_mov_b32 v[146:147], v[154:155], v[154:155] op_sel:[0,1]
    s_branch L_job
L_jobdone:
    v_cvt_pk_bf16_f32 v196, v20, v21
    v_cvt_pk_bf16_f32 v197, v22, v23
    v_cvt_pk_bf16_f32 v198, v24, v25
    v_cvt_pk_bf16_f32 v199, v26, v27
    v_cvt_pk_bf16_f32 v200, v28, v29
    v_cvt_pk_bf16_f32 v201, v30, v31
    v_cvt_pk_bf16_f32 v202, v32, v33
    v_cvt_pk_bf16_f32 v203, v34, v35
    v_mfma_f32_16x16x32_bf16 v[132:135], v[196:199], a[24:27], 0
    v_mfma_f32_16x16x32_bf16 v[188:191], v[196:199], a[40:43], 0
    v_mfma_f32_16x16x32_bf16 v[136:139], v[196:199], a[28:31], 0
    v_mfma_f32_16x16x32_bf16 v[192:195], v[196:199], a[44:47], 0
    v_mfma_f32_16x16x32_bf16 v[132:135], v[200:203], a[32:35], v[132:135]
    v_mfma_f32_16x16x32_bf16 v[188:191], v[200:203], a[24:27], v[188:191]
    v_mfma_f32_16x16x32_bf16 v[136:139], v[200:203], a[36:39], v[136:139]
    v_mfma_f32_16x16x32_bf16 v[192:195], v[200:203], a[28:31], v[192:195]
    s_mov_b32 m0, s61
    s_add_u32 s61, s61, 1024
    buffer_load_dwordx4 v64, s[32:35], s24 offen lds
    s_mov_b32 m0, s61
    s_add_u32 s61, s61, 1024
    buffer_load_dwordx4 v65, s[32:35], s24 offen lds
    s_mov_b32 m0, s61
    s_add_u32 s61, s61, 1024
    buffer_load_dwordx4 v66, s[32:35], s24 offen lds
    s_add_u32 s24, s24, 44032
    v_pk_mul_f32 v[124:125], v[132:133], v[96:97]
    v_pk_mul_f32 v[126:127], v[188:189], v[96:97]
    v_pk_fma_f32 v[124:125], v[188:189], v[104:105], v[124:125] neg_lo:[1,0,0] neg_hi:[1,0,0]
    v_pk_fma_f32 v[188:189], v[132:133], v[104:105], v[126:127]
    v_cvt_pk_bf16_f32 v20, v124, v125
    v_cvt_pk_bf16_f32 v24, v188, v189
    v_pk_mul_f32 v[128:129], v[134:135], v[98:99]
    v_pk_mul_f32 v[130:131], v[190:191], v[98:99]
    v_pk_fma_f32 v[128:129], v[190:191], v[106:107], v[128:129] neg_lo:[1,0,0] neg_hi:[1,0,0]
    v_pk_fma_f32 v[190:191], v[134:135], v[106:107], v[130:131]
    v_cvt_pk_bf16_f32 v21, v128, v129
    v_cvt_pk_bf16_f32 v25, v190, v191
    ds_write_b64 v76, v[20:21] offset:0
    ds_write_b64 v76, v[24:25] offset:5120
    v_pk_mul_f32 v[124:125], v[136:137], v[100:101]
    v_pk_mul_f32 v[126:127], v[192:193], v[100:101]
    v_pk_fma_f32 v[124:125], v[192:193], v[108:109], v[124:125] neg_lo:[1,0,0] neg_hi:[1,0,0]
    v_pk_fma_f32 v[192:193], v[136:137], v[108:109], v[126:127]
    v_cvt_pk_bf16_f32 v22, v124, v125
    v_cvt_pk_bf16_f32 v26, v192, v193
    v_pk_mul_f32 v[128:129], v[138:139], v[102:103]
    v_pk_mul_f32 v[130:131], v[194:195], v[102:103]
    v_pk_fma_f32 v[128:129], v[194:195], v[110:111], v[128:129] neg_lo:[1,0,0] neg_hi:[1,0,0]
    v_pk_fma_f32 v[194:195], v[138:139], v[110:111], v[130:131]
    v_cvt_pk_bf16_f32 v23, v128, v129
    v_cvt_pk_bf16_f32 v27, v194, v195
    ds_write_b64 v76, v[22:23] offset:2560
    ds_write_b64 v76, v[26:27] offset:7680
    s_mov_b32 m0, s61
    s_add_u32 s61, s61, 1024
    buffer_load_dwordx4 v64, s[32:35], s24 offen lds
    s_mov_b32 m0, s61
    s_add_u32 s61, s61, 1024
    buffer_load_dwordx4 v65, s[32:35], s24 offen lds
    s_waitcnt lgkmcnt(0)
    s_barrier
    ds_read_b128 v[156:159], v77 offset:0
    ds_read_b128 v[172:175], v77 offset:5120
    ds_read_b128 v[160:163], v77 offset:64
    ds_read_b128 v[176:179], v77 offset:5184
    ds_read_b128 v[164:167], v77 offset:2560
    ds_read_b128 v[180:183], v77 offset:7680
    ds_read_b128 v[168:171], v77 offset:2624
    ds_read_b128 v[184:187], v77 offset:7744
    s_waitcnt lgkmcnt(7)
    v_mfma_f32_16x16x32_bf16 v[132:135], a[0:3], v[156:159], 0
    v_mfma_f32_16x16x32_bf16 v[188:191], a[16:19], v[156:159], 0
    s_waitcnt lgkmcnt(6)
    v_mfma_f32_16x16x32_bf16 v[132:135], a[8:11], v[172:175], v[132:135]
    v_mfma_f32_16x16x32_bf16 v[188:191], a[0:3], v[172:175], v[188:191]
    s_waitcnt lgkmcnt(5)
    v_mfma_f32_16x16x32_bf16 v[132:135], a[4:7], v[160:163], v[132:135]
    v_mfma_f32_16x16x32_bf16 v[188:191], a[20:23], v[160:163], v[188:191]
    s_waitcnt lgkmcnt(4)
    v_mfma_f32_16x16x32_bf16 v[132:135], a[12:15], v[176:179], v[132:135]
    v_mfma_f32_16x16x32_bf16 v[188:191], a[4:7], v[176:179], v[188:191]
    s_waitcnt lgkmcnt(3)
    v_mfma_f32_16x16x32_bf16 v[136:139], a[0:3], v[164:167], 0
    v_mfma_f32_16x16x32_bf16 v[192:195], a[16:19], v[164:167], 0
    s_waitcnt lgkmcnt(2)
    v_mfma_f32_16x16x32_bf16 v[136:139], a[8:11], v[180:183], v[136:139]
    v_mfma_f32_16x16x32_bf16 v[192:195], a[0:3], v[180:183], v[192:195]
    s_waitcnt vmcnt(10)
    s_nop 0
    v_cvt_pk_bf16_f32 v124, v132, v188
    v_cvt_pk_bf16_f32 v125, v133, v189
    v_cvt_pk_bf16_f32 v126, v134, v190
    v_cvt_pk_bf16_f32 v127, v135, v191
    v_min_u32 v124, -2, v124
    buffer_store_dwordx4 v[124:127], v78, s[8:11], s59 offen sc1
    s_waitcnt lgkmcnt(1)
    v_mfma_f32_16x16x32_bf16 v[136:139], a[4:7], v[168:171], v[136:139]
    v_mfma_f32_16x16x32_bf16 v[192:195], a[20:23], v[168:171], v[192:195]
    s_waitcnt lgkmcnt(0)
    v_mfma_f32_16x16x32_bf16 v[136:139], a[12:15], v[184:187], v[136:139]
    v_mfma_f32_16x16x32_bf16 v[192:195], a[4:7], v[184:187], v[192:195]
    s_nop 7
    v_cvt_pk_bf16_f32 v128, v136, v192
    v_cvt_pk_bf16_f32 v129, v137, v193
    v_cvt_pk_bf16_f32 v130, v138, v194
    v_cvt_pk_bf16_f32 v131, v139, v195
    v_min_u32 v128, -2, v128
    buffer_store_dwordx4 v[128:131], v78, s[8:11], s53 offen sc1
    s_mov_b32 s51, 32768
    buffer_load_dwordx4 v[204:207], v4, s[8:11], s51 offen sc1
    s_mov_b32 s51, 36864
    buffer_load_dwordx4 v[208:211], v4, s[8:11], s51 offen sc1
    s_mov_b32 s51, 40960
    buffer_load_dwordx4 v[212:215], v4, s[8:11], s51 offen sc1
    s_mov_b32 s51, 45056
    buffer_load_dwordx4 v[216:219], v4, s[8:11], s51 offen sc1
    s_mov_b32 s51, 49152
    buffer_load_dwordx4 v[220:223], v4, s[8:11], s51 offen sc1
    s_mov_b32 s51, 53248
    buffer_load_dwordx4 v[224:227], v4, s[8:11], s51 offen sc1
    s_mov_b32 s51, 57344
    buffer_load_dwordx4 v[228:231], v4, s[8:11], s51 offen sc1
    s_mov_b32 s51, 61440
    buffer_load_dwordx4 v[232:235], v4, s[8:11], s51 offen sc1
    s_load_dwordx16 s[80:95], s[46:47], 128
    s_bfe_u32 s3, s2, 0x30003
    s_lshl2_add_u32 s3, s3, s49
    s_lshl_b32 s3, s3, 7
    s_add_u32 s74, s74, s3
    s_addc_u32 s75, s75, 0
    s_load_dwordx2 s[4:5], s[74:75], 0
    s_load_dwordx2 s[6:7], s[74:75], 8
    s_load_dwordx2 s[12:13], s[74:75], 16
    s_load_dwordx2 s[14:15], s[74:75], 24
    s_load_dwordx2 s[28:29], s[74:75], 32
    s_load_dwordx2 s[30:31], s[74:75], 40
    s_load_dwordx2 s[58:59], s[74:75], 48
    s_load_dwordx2 s[62:63], s[74:75], 56
    s_load_dwordx2 s[64:65], s[74:75], 64
    s_load_dwordx2 s[66:67], s[74:75], 72
    s_load_dwordx2 s[68:69], s[74:75], 80
    s_waitcnt vmcnt(16)
    ds_read_b64 v[148:149], v58 offset:0
    ds_read_b64 v[150:151], v58 offset:16
    ds_read_b64 v[152:153], v58 offset:1152
    ds_read_b64 v[154:155], v58 offset:1168
    global_load_dwordx4 v[120:123], v5, s[72:73] offset:-1024
    global_load_dwordx4 v[124:127], v5, s[72:73] offset:0
    s_mov_b32 m0, s61
    s_add_u32 s61, s61, 1024
    buffer_load_dwordx4 v66, s[32:35], s24 offen lds
    s_add_u32 s24, s24, 44032
    s_mov_b32 m0, s61
    s_add_u32 s61, s61, 1024
    buffer_load_dwordx4 v64, s[32:35], s24 offen lds
    s_mov_b32 m0, s61
    s_add_u32 s61, s61, 1024
    buffer_load_dwordx4 v65, s[32:35], s24 offen lds
    s_mov_b32 m0, s61
    s_add_u32 s61, s61, 1024
    buffer_load_dwordx4 v66, s[32:35], s24 offen lds
    s_add_u32 s24, s24, 44032
    s_cmp_lt_u32 s49, 2
    s_cselect_b32 s16, 1.0, 0
    s_cselect_b32 s70, 1.0, 0x3fb8aa3b
    s_mov_b32 s78, 0x3fb8aa3b
    s_cselect_b32 s78, s78, 0x3f317218
    s_mov_b32 s50, 0
    v_accvgpr_read_b32 v72, a48
    v_accvgpr_read_b32 v73, a49
    v_accvgpr_read_b32 v74, a50
    v_accvgpr_read_b32 v75, a51
    v_accvgpr_read_b32 v76, a52
    v_accvgpr_read_b32 v77, a53
    v_accvgpr_read_b32 v78, a54
    v_accvgpr_read_b32 v79, a55
    v_accvgpr_read_b32 v80, a56
    v_accvgpr_read_b32 v81, a57
    v_accvgpr_read_b32 v82, a58
    v_accvgpr_read_b32 v83, a59
    v_accvgpr_read_b32 v84, a60
    v_accvgpr_read_b32 v85, a61
    v_accvgpr_read_b32 v86, a62
    v_accvgpr_read_b32 v87, a63
    v_accvgpr_read_b32 v88, a64
    v_accvgpr_read_b32 v89, a65
    v_accvgpr_read_b32 v90, a66
    v_accvgpr_read_b32 v91, a67
    v_accvgpr_read_b32 v92, a68
    v_accvgpr_read_b32 v93, a69
    v_accvgpr_read_b32 v94, a70
    v_accvgpr_read_b32 v95, a71
    v_accvgpr_read_b32 v96, a72
    v_accvgpr_read_b32 v97, a73
    v_accvgpr_read_b32 v98, a74
    v_accvgpr_read_b32 v99, a75
    v_accvgpr_read_b32 v100, a76
    v_accvgpr_read_b32 v101, a77
    v_accvgpr_read_b32 v102, a78
    v_accvgpr_read_b32 v103, a79
    s_waitcnt lgkmcnt(0)
    v_lshlrev_b32 v104, 16, v148
    v_and_b32 v105, 0xffff0000, v148
    v_lshlrev_b32 v106, 16, v149
    v_and_b32 v107, 0xffff0000, v149
    v_lshlrev_b32 v108, 16, v150
    v_and_b32 v109, 0xffff0000, v150
    v_lshlrev_b32 v110, 16, v151
    v_and_b32 v111, 0xffff0000, v151
    v_lshlrev_b32 v112, 16, v152
    v_and_b32 v113, 0xffff0000, v152
    v_lshlrev_b32 v114, 16, v153
    v_and_b32 v115, 0xffff0000, v153
    v_lshlrev_b32 v116, 16, v154
    v_and_b32 v117, 0xffff0000, v154
    v_lshlrev_b32 v118, 16, v155
    v_and_b32 v119, 0xffff0000, v155
    s_waitcnt vmcnt(6)
    s_sleep 8
    buffer_load_dwordx4 v[156:159], v49, s[8:11], s17 offen sc1
    buffer_load_dwordx4 v[160:163], v49, s[8:11], s18 offen sc1
L_mn_chk:
    v_perm_b32 v133, v205, v204, s54
    v_perm_b32 v134, v207, v206, s55
    v_or_b32 v133, v133, v134
    v_xor_b32 v132, s52, v133
    v_and_b32 v204, s56, v204
    v_and_b32 v205, s56, v205
    v_and_b32 v206, s56, v206
    v_and_b32 v207, s56, v207
    v_perm_b32 v133, v209, v208, s54
    v_perm_b32 v134, v211, v210, s55
    v_or_b32 v133, v133, v134
    v_xor_b32 v133, s52, v133
    v_or_b32 v132, v132, v133
    v_and_b32 v208, s56, v208
    v_and_b32 v209, s56, v209
    v_and_b32 v210, s56, v210
    v_and_b32 v211, s56, v211
    v_perm_b32 v133, v213, v212, s54
    v_perm_b32 v134, v215, v214, s55
    v_or_b32 v133, v133, v134
    v_xor_b32 v133, s52, v133
    v_or_b32 v132, v132, v133
    v_and_b32 v212, s56, v212
    v_and_b32 v213, s56, v213
    v_and_b32 v214, s56, v214
    v_and_b32 v215, s56, v215
    v_perm_b32 v133, v217, v216, s54
    v_perm_b32 v134, v219, v218, s55
    v_or_b32 v133, v133, v134
    v_xor_b32 v133, s52, v133
    v_or_b32 v132, v132, v133
    v_and_b32 v216, s56, v216
    v_and_b32 v217, s56, v217
    v_and_b32 v218, s56, v218
    v_and_b32 v219, s56, v219
    v_perm_b32 v133, v221, v220, s54
    v_perm_b32 v134, v223, v222, s55
    v_or_b32 v133, v133, v134
    v_xor_b32 v133, s52, v133
    v_or_b32 v132, v132, v133
    v_and_b32 v220, s56, v220
    v_and_b32 v221, s56, v221
    v_and_b32 v222, s56, v222
    v_and_b32 v223, s56, v223
    v_perm_b32 v133, v225, v224, s54
    v_perm_b32 v134, v227, v226, s55
    v_or_b32 v133, v133, v134
    v_xor_b32 v133, s52, v133
    v_or_b32 v132, v132, v133
    v_and_b32 v224, s56, v224
    v_and_b32 v225, s56, v225
    v_and_b32 v226, s56, v226
    v_and_b32 v227, s56, v227
    v_perm_b32 v133, v229, v228, s54
    v_perm_b32 v134, v231, v230, s55
    v_or_b32 v133, v133, v134
    v_xor_b32 v133, s52, v133
    v_or_b32 v132, v132, v133
    v_and_b32 v228, s56, v228
    v_and_b32 v229, s56, v229
    v_and_b32 v230, s56, v230
    v_and_b32 v231, s56, v231
    v_perm_b32 v133, v233, v232, s54
    v_perm_b32 v134, v235, v234, s55
    v_or_b32 v133, v133, v134
    v_xor_b32 v133, s52, v133
    v_or_b32 v132, v132, v133
    v_and_b32 v232, s56, v232
    v_and_b32 v233, s56, v233
    v_and_b32 v234, s56, v234
    v_and_b32 v235, s56, v235
    v_cmp_ne_u32 vcc, 0, v132
    s_cbranch_vccnz L_mn_rty
    v_pk_add_f32 v[204:205], v[204:205], v[212:213]
    v_pk_add_f32 v[220:221], v[220:221], v[228:229]
    v_pk_add_f32 v[206:207], v[206:207], v[214:215]
    v_pk_add_f32 v[222:223], v[222:223], v[230:231]
    v_pk_add_f32 v[208:209], v[208:209], v[216:217]
    v_pk_add_f32 v[224:225], v[224:225], v[232:233]
    v_pk_add_f32 v[210:211], v[210:211], v[218:219]
    v_pk_add_f32 v[226:227], v[226:227], v[234:235]
    v_pk_add_f32 v[204:205], v[204:205], v[220:221]
    v_pk_add_f32 v[206:207], v[206:207], v[222:223]
    v_pk_add_f32 v[208:209], v[208:209], v[224:225]
    v_pk_add_f32 v[210:211], v[210:211], v[226:227]
    v_cvt_pk_bf16_f32 v212, v204, v205
    v_cvt_pk_bf16_f32 v213, v206, v207
    v_lshlrev_b32 v204, 16, v212
    v_and_b32 v205, 0xffff0000, v212
    v_lshlrev_b32 v206, 16, v213
    v_and_b32 v207, 0xffff0000, v213
    v_cvt_pk_bf16_f32 v212, v208, v209
    v_cvt_pk_bf16_f32 v213, v210, v211
    v_lshlrev_b32 v208, 16, v212
    v_and_b32 v209, 0xffff0000, v212
    v_lshlrev_b32 v210, 16, v213
    v_and_b32 v211, 0xffff0000, v213
    v_add_f32 v208, s16, v208
    v_add_f32 v209, s16, v209
    v_add_f32 v210, s16, v210
    v_add_f32 v211, s16, v211
    v_cvt_pk_bf16_f32 v212, v208, v209
    v_cvt_pk_bf16_f32 v213, v210, v211
    v_lshlrev_b32 v208, 16, v212
    v_and_b32 v209, 0xffff0000, v212
    v_lshlrev_b32 v210, 16, v213
    v_and_b32 v211, 0xffff0000, v213
    v_pk_mul_f32 v[204:205], v[204:205], s[70:71] op_sel_hi:[1,0]
    v_pk_mul_f32 v[206:207], v[206:207], s[70:71] op_sel_hi:[1,0]
    v_pk_mul_f32 v[208:209], v[208:209], s[78:79] op_sel_hi:[1,0]
    v_pk_mul_f32 v[210:211], v[210:211], s[78:79] op_sel_hi:[1,0]
    ds_write_b128 v61, v[204:207]
    ds_write_b128 v61, v[208:211] offset:4096
    s_mov_b32 s50, 0
    s_mov_b32 m0, s61
    s_add_u32 s61, s61, 1024
    buffer_load_dwordx4 v64, s[32:35], s24 offen lds
    s_mov_b32 m0, s61
    s_add_u32 s61, s61, 1024
    buffer_load_dwordx4 v65, s[32:35], s24 offen lds
    s_mov_b32 m0, s61
    s_add_u32 s61, s61, 1024
    buffer_load_dwordx4 v66, s[32:35], s24 offen lds
    s_add_u32 s24, s24, 44032
    s_mov_b32 m0, s61
    s_add_u32 s61, s61, 1024
    buffer_load_dwordx4 v64, s[32:35], s24 offen lds
    s_mov_b32 m0, s61
    s_add_u32 s61, s61, 1024
    buffer_load_dwordx4 v65, s[32:35], s24 offen lds
    s_mov_b32 m0, s61
    s_add_u32 s61, s61, 1024
    buffer_load_dwordx4 v66, s[32:35], s24 offen lds
    s_add_u32 s24, s24, 44032
    s_waitcnt vmcnt(6)
    v_max_u32 v2, v156, v160
    v_cmp_eq_u32 vcc, -1, v2
    s_cbranch_vccz L_y2_ok
L_y2_rty:
    s_add_u32 s50, s50, 1
    s_cmp_ge_u32 s50, 131072
    s_cbranch_scc1 L_y2_dead
    s_mov_b64 exec, vcc
    buffer_load_dwordx4 v[156:159], v49, s[8:11], s17 offen sc1
    buffer_load_dwordx4 v[160:163], v49, s[8:11], s18 offen sc1
    s_waitcnt vmcnt(0)
    v_max_u32 v2, v156, v160
    v_cmp_eq_u32 vcc, -1, v2
    s_mov_b64 exec, -1
    s_cbranch_vccnz L_y2_rty
L_y2_ok:
    ds_write_b128 v50, v[156:159]
    ds_write_b128 v50, v[160:163] offset:512
    s_waitcnt lgkmcnt(0)
    s_barrier
    ds_read_b64 v[156:157], v51 offset:0
    ds_read_b64 v[158:159], v51 offset:512
    ds_read_b64 v[160:161], v51 offset:2048
    ds_read_b64 v[162:163], v51 offset:2560
    ds_read_u16 v1, v52 offset:2
    ds_read_b128 v[8:11], v59 offset:0
    ds_read_b128 v[12:15], v59 offset:32
    ds_read_b128 v[24:27], v59 offset:2048
    ds_read_b128 v[28:31], v59 offset:2080
    ds_read_b128 v[16:19], v59 offset:4096
    ds_read_b128 v[20:23], v59 offset:4128
    v_add_u32 v62, s26, v62
    v_add_u32 v63, s26, v63
    s_waitcnt lgkmcnt(9)
    v_mfma_f32_32x32x16_bf16 v[164:179], v[156:159], a[176:179], 0
    v_mfma_f32_32x32x16_bf16 v[180:195], v[156:159], a[184:187], 0
    s_waitcnt lgkmcnt(7)
    v_mfma_f32_32x32x16_bf16 v[164:179], v[160:163], a[180:183], v[164:179]
    v_mfma_f32_32x32x16_bf16 v[180:195], v[160:163], a[188:191], v[180:195]
    s_lshl_b32 s26, s4, 4
    buffer_load_dwordx4 a[0:3], v62, s[8:11], s26 offen sc1
    buffer_load_dwordx4 a[4:7], v63, s[8:11], s26 offen sc1
    s_lshl_b32 s26, s5, 4
    buffer_load_dwordx4 a[8:11], v62, s[8:11], s26 offen sc1
    s_waitcnt lgkmcnt(6)
    v_lshlrev_b32 v1, 16, v1
    s_nop 3
    v_fmac_f32 v164, v48, v1
    v_pk_mul_f32 v[148:149], v[164:165], v[72:73]
    v_pk_mul_f32 v[150:151], v[180:181], v[72:73]
    v_pk_fma_f32 v[148:149], v[180:181], v[88:89], v[148:149] neg_lo:[1,0,0] neg_hi:[1,0,0]
    v_pk_fma_f32 v[180:181], v[164:165], v[88:89], v[150:151]
    v_cvt_pk_bf16_f32 v132, v148, v149
    v_cvt_pk_bf16_f32 v134, v180, v181
    v_pk_mul_f32 v[152:153], v[166:167], v[74:75]
    v_pk_mul_f32 v[154:155], v[182:183], v[74:75]
    v_pk_fma_f32 v[152:153], v[182:183], v[90:91], v[152:153] neg_lo:[1,0,0] neg_hi:[1,0,0]
    v_pk_fma_f32 v[182:183], v[166:167], v[90:91], v[154:155]
    v_cvt_pk_bf16_f32 v133, v152, v153
    v_cvt_pk_bf16_f32 v135, v182, v183
    v_pk_mul_f32 v[148:149], v[168:169], v[76:77]
    v_pk_mul_f32 v[150:151], v[184:185], v[76:77]
    v_pk_fma_f32 v[148:149], v[184:185], v[92:93], v[148:149] neg_lo:[1,0,0] neg_hi:[1,0,0]
    v_pk_fma_f32 v[184:185], v[168:169], v[92:93], v[150:151]
    v_cvt_pk_bf16_f32 v136, v148, v149
    v_cvt_pk_bf16_f32 v138, v184, v185
    v_pk_mul_f32 v[152:153], v[170:171], v[78:79]
    v_pk_mul_f32 v[154:155], v[186:187], v[78:79]
    v_pk_fma_f32 v[152:153], v[186:187], v[94:95], v[152:153] neg_lo:[1,0,0] neg_hi:[1,0,0]
    v_pk_fma_f32 v[186:187], v[170:171], v[94:95], v[154:155]
    v_cvt_pk_bf16_f32 v137, v152, v153
    v_cvt_pk_bf16_f32 v139, v186, v187
    v_pk_mul_f32 v[148:149], v[172:173], v[80:81]
    v_pk_mul_f32 v[150:151], v[188:189], v[80:81]
    v_pk_fma_f32 v[148:149], v[188:189], v[96:97], v[148:149] neg_lo:[1,0,0] neg_hi:[1,0,0]
    v_pk_fma_f32 v[188:189], v[172:173], v[96:97], v[150:151]
    v_cvt_pk_bf16_f32 v140, v148, v149
    v_cvt_pk_bf16_f32 v142, v188, v189
    v_pk_mul_f32 v[152:153], v[174:175], v[82:83]
    v_pk_mul_f32 v[154:155], v[190:191], v[82:83]
    v_pk_fma_f32 v[152:153], v[190:191], v[98:99], v[152:153] neg_lo:[1,0,0] neg_hi:[1,0,0]
    v_pk_fma_f32 v[190:191], v[174:175], v[98:99], v[154:155]
    v_cvt_pk_bf16_f32 v141, v152, v153
    v_cvt_pk_bf16_f32 v143, v190, v191
    v_pk_mul_f32 v[148:149], v[176:177], v[84:85]
    v_pk_mul_f32 v[150:151], v[192:193], v[84:85]
    v_pk_fma_f32 v[148:149], v[192:193], v[100:101], v[148:149] neg_lo:[1,0,0] neg_hi:[1,0,0]
    v_pk_fma_f32 v[192:193], v[176:177], v[100:101], v[150:151]
    v_cvt_pk_bf16_f32 v144, v148, v149
    v_cvt_pk_bf16_f32 v146, v192, v193
    v_pk_mul_f32 v[152:153], v[178:179], v[86:87]
    v_pk_mul_f32 v[154:155], v[194:195], v[86:87]
    v_pk_fma_f32 v[152:153], v[194:195], v[102:103], v[152:153] neg_lo:[1,0,0] neg_hi:[1,0,0]
    v_pk_fma_f32 v[194:195], v[178:179], v[102:103], v[154:155]
    v_cvt_pk_bf16_f32 v145, v152, v153
    v_cvt_pk_bf16_f32 v147, v194, v195
    v_mfma_f32_32x32x16_bf16 v[164:179], v[132:135], a[192:195], 0
    v_mfma_f32_32x32x16_bf16 v[164:179], v[136:139], a[196:199], v[164:179]
    v_mfma_f32_32x32x16_bf16 v[164:179], v[140:143], a[200:203], v[164:179]
    v_mfma_f32_32x32x16_bf16 v[164:179], v[144:147], a[204:207], v[164:179]
    buffer_load_dwordx4 a[12:15], v63, s[8:11], s26 offen sc1
    s_lshl_b32 s26, s6, 4
    buffer_load_dwordx4 a[16:19], v62, s[8:11], s26 offen sc1
    buffer_load_dwordx4 a[20:23], v63, s[8:11], s26 offen sc1
    s_waitcnt lgkmcnt(0)
    s_nop 6
    v_pk_fma_f32 v[164:165], v[164:165], v[8:9], v[104:105]
    v_pk_fma_f32 v[166:167], v[166:167], v[10:11], v[106:107]
    v_pk_fma_f32 v[168:169], v[168:169], v[12:13], v[108:109]
    v_pk_fma_f32 v[170:171], v[170:171], v[14:15], v[110:111]
    v_pk_fma_f32 v[172:173], v[172:173], v[8:9], v[112:113]
    v_pk_fma_f32 v[174:175], v[174:175], v[10:11], v[114:115]
    v_pk_fma_f32 v[176:177], v[176:177], v[12:13], v[116:117]
    v_pk_fma_f32 v[178:179], v[178:179], v[14:15], v[118:119]
    v_pk_add_f32 v[148:149], v[164:165], v[166:167]
    v_pk_add_f32 v[150:151], v[168:169], v[170:171]
    v_pk_add_f32 v[152:153], v[172:173], v[174:175]
    v_pk_add_f32 v[154:155], v[176:177], v[178:179]
    v_pk_add_f32 v[148:149], v[148:149], v[150:151]
    v_pk_add_f32 v[152:153], v[152:153], v[154:155]
    v_add_f32 v148, v148, v149
    v_add_f32 v152, v152, v153
    s_nop 0
    v_add_f32_dpp v148, v148, v148 row_ror:1 row_mask:0xf bank_mask:0xf
    v_add_f32_dpp v152, v152, v152 row_ror:1 row_mask:0xf bank_mask:0xf
    v_cvt_pk_bf16_f32 v156, v164, v165
    v_add_f32_dpp v148, v148, v148 row_ror:2 row_mask:0xf bank_mask:0xf
    v_add_f32_dpp v152, v152, v152 row_ror:2 row_mask:0xf bank_mask:0xf
    v_cvt_pk_bf16_f32 v157, v166, v167
    v_add_f32_dpp v148, v148, v148 row_ror:4 row_mask:0xf bank_mask:0xf
    v_add_f32_dpp v152, v152, v152 row_ror:4 row_mask:0xf bank_mask:0xf
    v_cvt_pk_bf16_f32 v158, v168, v169
    v_add_f32_dpp v148, v148, v148 row_ror:8 row_mask:0xf bank_mask:0xf
    v_add_f32_dpp v152, v152, v152 row_ror:8 row_mask:0xf bank_mask:0xf
    v_cvt_pk_bf16_f32 v159, v170, v171
    v_mov_b32 v149, v148
    v_mov_b32 v153, v152
    v_cvt_pk_bf16_f32 v160, v172, v173
    v_permlane16_swap_b32 v148, v149
    v_permlane16_swap_b32 v152, v153
    v_cvt_pk_bf16_f32 v161, v174, v175
    v_add_f32 v148, v148, v149
    v_add_f32 v152, v152, v153
    v_cvt_pk_bf16_f32 v162, v176, v177
    v_mov_b32 v149, v148
    v_mov_b32 v153, v152
    v_cvt_pk_bf16_f32 v163, v178, v179
    v_permlane32_swap_b32 v148, v149
    v_permlane32_swap_b32 v152, v153
    v_add_f32 v148, v148, v149
    v_add_f32 v152, v152, v153
    v_mul_f32 v150, 0xbb000000, v148
    v_mul_f32 v154, 0xbb000000, v152
    v_pk_add_f32 v[164:165], v[164:165], v[150:151] op_sel_hi:[1,0]
    v_pk_add_f32 v[166:167], v[166:167], v[150:151] op_sel_hi:[1,0]
    v_pk_add_f32 v[168:169], v[168:169], v[150:151] op_sel_hi:[1,0]
    v_pk_add_f32 v[170:171], v[170:171], v[150:151] op_sel_hi:[1,0]
    v_pk_add_f32 v[172:173], v[172:173], v[154:155] op_sel_hi:[1,0]
    v_pk_add_f32 v[174:175], v[174:175], v[154:155] op_sel_hi:[1,0]
    v_pk_add_f32 v[176:177], v[176:177], v[154:155] op_sel_hi:[1,0]
    v_pk_add_f32 v[178:179], v[178:179], v[154:155] op_sel_hi:[1,0]
    v_pk_mul_f32 v[148:149], v[164:165], v[164:165]
    v_pk_mul_f32 v[152:153], v[172:173], v[172:173]
    v_pk_fma_f32 v[148:149], v[166:167], v[166:167], v[148:149]
    v_pk_fma_f32 v[152:153], v[174:175], v[174:175], v[152:153]
    v_pk_fma_f32 v[148:149], v[168:169], v[168:169], v[148:149]
    v_pk_fma_f32 v[152:153], v[176:177], v[176:177], v[152:153]
    v_pk_fma_f32 v[148:149], v[170:171], v[170:171], v[148:149]
    v_pk_fma_f32 v[152:153], v[178:179], v[178:179], v[152:153]
    v_add_f32 v148, v148, v149
    v_add_f32 v152, v152, v153
    s_nop 0
    v_add_f32_dpp v148, v148, v148 row_ror:1 row_mask:0xf bank_mask:0xf
    v_add_f32_dpp v152, v152, v152 row_ror:1 row_mask:0xf bank_mask:0xf
    v_pk_mul_f32 v[164:165], v[164:165], v[16:17]
    v_add_f32_dpp v148, v148, v148 row_ror:2 row_mask:0xf bank_mask:0xf
    v_add_f32_dpp v152, v152, v152 row_ror:2 row_mask:0xf bank_mask:0xf
    v_pk_mul_f32 v[166:167], v[166:167], v[18:19]
    v_add_f32_dpp v148, v148, v148 row_ror:4 row_mask:0xf bank_mask:0xf
    v_add_f32_dpp v152, v152, v152 row_ror:4 row_mask:0xf bank_mask:0xf
    v_pk_mul_f32 v[168:169], v[168:169], v[20:21]
    v_add_f32_dpp v148, v148, v148 row_ror:8 row_mask:0xf bank_mask:0xf
    v_add_f32_dpp v152, v152, v152 row_ror:8 row_mask:0xf bank_mask:0xf
    v_pk_mul_f32 v[170:171], v[170:171], v[22:23]
    v_mov_b32 v149, v148
    v_mov_b32 v153, v152
    v_pk_mul_f32 v[172:173], v[172:173], v[16:17]
    v_permlane16_swap_b32 v148, v149
    v_permlane16_swap_b32 v152, v153
    v_pk_mul_f32 v[174:175], v[174:175], v[18:19]
    v_add_f32 v148, v148, v149
    v_add_f32 v152, v152, v153
    v_pk_mul_f32 v[176:177], v[176:177], v[20:21]
    v_mov_b32 v149, v148
    v_mov_b32 v153, v152
    v_pk_mul_f32 v[178:179], v[178:179], v[22:23]
    v_permlane32_swap_b32 v148, v149
    v_permlane32_swap_b32 v152, v153
    v_add_f32 v148, v148, v149
    v_add_f32 v152, v152, v153
    v_mov_b32 v149, 0x3727c5ac
    v_fmac_f32 v149, 0x3b000000, v148
    v_mov_b32 v153, 0x3727c5ac
    v_fmac_f32 v153, 0x3b000000, v152
    v_rsq_f32 v150, v149
    v_rsq_f32 v154, v153
    v_pk_fma_f32 v[164:165], v[164:165], v[150:151], v[24:25] op_sel_hi:[1,0,1]
    v_pk_fma_f32 v[166:167], v[166:167], v[150:151], v[26:27] op_sel_hi:[1,0,1]
    v_pk_fma_f32 v[168:169], v[168:169], v[150:151], v[28:29] op_sel_hi:[1,0,1]
    v_pk_fma_f32 v[170:171], v[170:171], v[150:151], v[30:31] op_sel_hi:[1,0,1]
    v_cvt_pk_bf16_f32 v180, v164, v165
    v_cvt_pk_bf16_f32 v181, v166, v167
    v_cvt_pk_bf16_f32 v182, v168, v169
    v_cvt_pk_bf16_f32 v183, v170, v171
    ds_write_b128 v54, v[180:183]
    v_pk_fma_f32 v[172:173], v[172:173], v[154:155], v[24:25] op_sel_hi:[1,0,1]
    v_pk_fma_f32 v[174:175], v[174:175], v[154:155], v[26:27] op_sel_hi:[1,0,1]
    v_pk_fma_f32 v[176:177], v[176:177], v[154:155], v[28:29] op_sel_hi:[1,0,1]
    v_pk_fma_f32 v[178:179], v[178:179], v[154:155], v[30:31] op_sel_hi:[1,0,1]
    v_cvt_pk_bf16_f32 v184, v172, v173
    v_cvt_pk_bf16_f32 v185, v174, v175
    v_cvt_pk_bf16_f32 v186, v176, v177
    v_cvt_pk_bf16_f32 v187, v178, v179
    ds_write_b128 v55, v[184:187]
    v_min_u32 v156, -2, v156
    v_min_u32 v160, -2, v160
    s_waitcnt lgkmcnt(0)
    s_barrier
    ds_read_b128 v[188:191], v56
    ds_read_b128 v[192:195], v57 offset:1024
    s_waitcnt lgkmcnt(1)
    v_min_u32 v188, -2, v188
    s_cmp_lg_u32 s45, 0
    s_cbranch_scc1 L_lst11
    buffer_store_dwordx4 v[188:191], v68, s[8:11], s19 offen
L_lse11:
    s_waitcnt lgkmcnt(0)
    v_min_u32 v192, -2, v192
    s_cmp_lg_u32 s45, 0
    s_cbranch_scc1 L_lst12
    buffer_store_dwordx4 v[192:195], v68, s[8:11], s20 offen
L_lse12:
    s_cmp_lg_u32 s45, 0
    s_cbranch_scc1 L_lst13
    buffer_store_dwordx4 v[156:159], v53, s[8:11], s21 offen offset:0
L_lse13:
    s_cmp_lg_u32 s45, 0
    s_cbranch_scc1 L_lst14
    buffer_store_dwordx4 v[160:163], v53, s[8:11], s21 offen offset:1024
L_lse14:
    s_mov_b32 s50, 0
    buffer_load_dwordx4 v[4:7], v71, s[8:11], s80 offen offset:0 sc1
    buffer_load_dwordx4 v[8:11], v71, s[8:11], s80 offen offset:1024 sc1
    buffer_load_dwordx4 v[12:15], v71, s[8:11], s80 offen offset:2048 sc1
    buffer_load_dwordx4 v[16:19], v71, s[8:11], s80 offen offset:3072 sc1
    buffer_load_dwordx4 v[20:23], v71, s[8:11], s81 offen offset:0 sc1
    buffer_load_dwordx4 v[24:27], v71, s[8:11], s81 offen offset:1024 sc1
    buffer_load_dwordx4 v[28:31], v71, s[8:11], s81 offen offset:2048 sc1
    buffer_load_dwordx4 v[32:35], v71, s[8:11], s81 offen offset:3072 sc1
    v_add_u32 v1, s88, v67
    s_add_u32 s88, s88, 12288
    s_cmp_ge_u32 s88, 98304
    s_cselect_b32 s3, 98304, 0
    s_sub_u32 s88, s88, s3
    ds_read_b64_tr_b16 v[52:53], v1 offset:0
    ds_read_b64_tr_b16 v[54:55], v1 offset:1536
    ds_read_b64_tr_b16 v[56:57], v1 offset:64
    ds_read_b64_tr_b16 v[58:59], v1 offset:1600
    ds_read_b64_tr_b16 v[208:209], v1 offset:128
    ds_read_b64_tr_b16 v[210:211], v1 offset:1664
L_h2_chk0:
    s_waitcnt vmcnt(4)
    v_max3_u32 v2, v4, v8, v12
    v_max3_u32 v2, v2, v16, v16
    v_cmp_eq_u32 vcc, -1, v2
    s_cbranch_vccnz L_h2_rty0
    ds_read_b64_tr_b16 v[212:213], v1 offset:3072
    ds_read_b64_tr_b16 v[214:215], v1 offset:4608
    s_waitcnt lgkmcnt(2)
    v_mfma_f32_32x32x16_bf16 v[160:175], v[52:55], v[4:7], 0
    buffer_load_dwordx4 v[36:39], v71, s[8:11], s82 offen offset:0 sc1
    ds_read_b64_tr_b16 v[216:217], v1 offset:3136
    ds_read_b64_tr_b16 v[218:219], v1 offset:4672
    v_mfma_f32_32x32x16_bf16 v[176:191], v[56:59], v[4:7], 0
    ds_read_b64_tr_b16 v[220:221], v1 offset:3200
    ds_read_b64_tr_b16 v[222:223], v1 offset:4736
    v_mfma_f32_32x32x16_bf16 v[192:207], v[208:211], v[4:7], 0
    ds_read_b64_tr_b16 v[52:53], v1 offset:6144
    ds_read_b64_tr_b16 v[54:55], v1 offset:7680
    s_waitcnt lgkmcnt(2)
    v_mfma_f32_32x32x16_bf16 v[160:175], v[212:215], v[8:11], v[160:175]
    buffer_load_dwordx4 v[40:43], v71, s[8:11], s82 offen offset:1024 sc1
    ds_read_b64_tr_b16 v[56:57], v1 offset:6208
    ds_read_b64_tr_b16 v[58:59], v1 offset:7744
    v_mfma_f32_32x32x16_bf16 v[176:191], v[216:219], v[8:11], v[176:191]
    v_add_u32 v60, s88, v67
    ds_read_b64_tr_b16 v[208:209], v1 offset:6272
    ds_read_b64_tr_b16 v[210:211], v1 offset:7808
    v_mfma_f32_32x32x16_bf16 v[192:207], v[220:223], v[8:11], v[192:207]
    ds_read_b64_tr_b16 v[212:213], v1 offset:9216
    ds_read_b64_tr_b16 v[214:215], v1 offset:10752
    s_waitcnt lgkmcnt(2)
    v_mfma_f32_32x32x16_bf16 v[160:175], v[52:55], v[12:15], v[160:175]
    buffer_load_dwordx4 v[44:47], v71, s[8:11], s82 offen offset:2048 sc1
    ds_read_b64_tr_b16 v[216:217], v1 offset:9280
    ds_read_b64_tr_b16 v[218:219], v1 offset:10816
    v_mfma_f32_32x32x16_bf16 v[176:191], v[56:59], v[12:15], v[176:191]
    s_add_u32 s88, s88, 12288
    s_cmp_ge_u32 s88, 98304
    s_cselect_b32 s3, 98304, 0
    s_sub_u32 s88, s88, s3
    ds_read_b64_tr_b16 v[220:221], v1 offset:9344
    ds_read_b64_tr_b16 v[222:223], v1 offset:10880
    v_mfma_f32_32x32x16_bf16 v[192:207], v[208:211], v[12:15], v[192:207]
    ds_read_b64_tr_b16 v[52:53], v60 offset:0
    ds_read_b64_tr_b16 v[54:55], v60 offset:1536
    s_waitcnt lgkmcnt(2)
    v_mfma_f32_32x32x16_bf16 v[160:175], v[212:215], v[16:19], v[160:175]
    buffer_load_dwordx4 v[48:51], v71, s[8:11], s82 offen offset:3072 sc1
L_h2_chk1:
    s_waitcnt vmcnt(4)
    v_max3_u32 v2, v20, v24, v28
    v_max3_u32 v2, v2, v32, v32
    v_cmp_eq_u32 vcc, -1, v2
    s_cbranch_vccnz L_h2_rty1
    ds_read_b64_tr_b16 v[56:57], v60 offset:64
    ds_read_b64_tr_b16 v[58:59], v60 offset:1600
    v_mfma_f32_32x32x16_bf16 v[176:191], v[216:219], v[16:19], v[176:191]
    ds_read_b64_tr_b16 v[208:209], v60 offset:128
    ds_read_b64_tr_b16 v[210:211], v60 offset:1664
    v_mfma_f32_32x32x16_bf16 v[192:207], v[220:223], v[16:19], v[192:207]
    ds_read_b64_tr_b16 v[212:213], v60 offset:3072
    ds_read_b64_tr_b16 v[214:215], v60 offset:4608
    s_waitcnt lgkmcnt(2)
    v_mfma_f32_32x32x16_bf16 v[160:175], v[52:55], v[20:23], v[160:175]
    buffer_load_dwordx4 v[72:75], v71, s[8:11], s83 offen offset:0 sc1
    ds_read_b64_tr_b16 v[216:217], v60 offset:3136
    ds_read_b64_tr_b16 v[218:219], v60 offset:4672
    v_mfma_f32_32x32x16_bf16 v[176:191], v[56:59], v[20:23], v[176:191]
    ds_read_b64_tr_b16 v[220:221], v60 offset:3200
    ds_read_b64_tr_b16 v[222:223], v60 offset:4736
    v_mfma_f32_32x32x16_bf16 v[192:207], v[208:211], v[20:23], v[192:207]
    ds_read_b64_tr_b16 v[52:53], v60 offset:6144
    ds_read_b64_tr_b16 v[54:55], v60 offset:7680
    s_waitcnt lgkmcnt(2)
    v_mfma_f32_32x32x16_bf16 v[160:175], v[212:215], v[24:27], v[160:175]
    buffer_load_dwordx4 v[76:79], v71, s[8:11], s83 offen offset:1024 sc1
    ds_read_b64_tr_b16 v[56:57], v60 offset:6208
    ds_read_b64_tr_b16 v[58:59], v60 offset:7744
    v_mfma_f32_32x32x16_bf16 v[176:191], v[216:219], v[24:27], v[176:191]
    v_add_u32 v1, s88, v67
    ds_read_b64_tr_b16 v[208:209], v60 offset:6272
    ds_read_b64_tr_b16 v[210:211], v60 offset:7808
    v_mfma_f32_32x32x16_bf16 v[192:207], v[220:223], v[24:27], v[192:207]
    ds_read_b64_tr_b16 v[212:213], v60 offset:9216
    ds_read_b64_tr_b16 v[214:215], v60 offset:10752
    s_waitcnt lgkmcnt(2)
    v_mfma_f32_32x32x16_bf16 v[160:175], v[52:55], v[28:31], v[160:175]
    buffer_load_dwordx4 v[80:83], v71, s[8:11], s83 offen offset:2048 sc1
    ds_read_b64_tr_b16 v[216:217], v60 offset:9280
    ds_read_b64_tr_b16 v[218:219], v60 offset:10816
    v_mfma_f32_32x32x16_bf16 v[176:191], v[56:59], v[28:31], v[176:191]
    s_add_u32 s88, s88, 12288
    s_cmp_ge_u32 s88, 98304
    s_cselect_b32 s3, 98304, 0
    s_sub_u32 s88, s88, s3
    ds_read_b64_tr_b16 v[220:221], v60 offset:9344
    ds_read_b64_tr_b16 v[222:223], v60 offset:10880
    v_mfma_f32_32x32x16_bf16 v[192:207], v[208:211], v[28:31], v[192:207]
    ds_read_b64_tr_b16 v[52:53], v1 offset:0
    ds_read_b64_tr_b16 v[54:55], v1 offset:1536
    s_waitcnt lgkmcnt(2)
    v_mfma_f32_32x32x16_bf16 v[160:175], v[212:215], v[32:35], v[160:175]
    buffer_load_dwordx4 v[84:87], v71, s[8:11], s83 offen offset:3072 sc1
L_h2_chk2:
    s_waitcnt vmcnt(4)
    v_max3_u32 v2, v36, v40, v44
    v_max3_u32 v2, v2, v48, v48
    v_cmp_eq_u32 vcc, -1, v2
    s_cbranch_vccnz L_h2_rty2
    ds_read_b64_tr_b16 v[56:57], v1 offset:64
    ds_read_b64_tr_b16 v[58:59], v1 offset:1600
    v_mfma_f32_32x32x16_bf16 v[176:191], v[216:219], v[32:35], v[176:191]
    v_mfma_f32_32x32x16_bf16 v[192:207], v[220:223], v[32:35], v[192:207]
    ds_read_b64_tr_b16 v[212:213], v1 offset:3072
    ds_read_b64_tr_b16 v[214:215], v1 offset:4608
    s_waitcnt lgkmcnt(2)
    v_mfma_f32_32x32x16_bf16 v[160:175], v[52:55], v[36:39], v[160:175]
    buffer_load_dwordx4 v[88:91], v71, s[8:11], s84 offen offset:0 sc1
    ds_read_b64_tr_b16 v[216:217], v1 offset:3136
    ds_read_b64_tr_b16 v[218:219], v1 offset:4672
    v_mfma_f32_32x32x16_bf16 v[176:191], v[56:59], v[36:39], v[176:191]
    ds_read_b64_tr_b16 v[52:53], v1 offset:6144
    ds_read_b64_tr_b16 v[54:55], v1 offset:7680
    s_waitcnt lgkmcnt(2)
    v_mfma_f32_32x32x16_bf16 v[160:175], v[212:215], v[40:43], v[160:175]
    buffer_load_dwordx4 v[92:95], v71, s[8:11], s84 offen offset:1024 sc1
    ds_read_b64_tr_b16 v[56:57], v1 offset:6208
    ds_read_b64_tr_b16 v[58:59], v1 offset:7744
    v_mfma_f32_32x32x16_bf16 v[176:191], v[216:219], v[40:43], v[176:191]
    v_add_u32 v60, s88, v67
    ds_read_b64_tr_b16 v[212:213], v1 offset:9216
    ds_read_b64_tr_b16 v[214:215], v1 offset:10752
    s_waitcnt lgkmcnt(2)
    v_mfma_f32_32x32x16_bf16 v[160:175], v[52:55], v[44:47], v[160:175]
    buffer_load_dwordx4 v[96:99], v71, s[8:11], s84 offen offset:2048 sc1
    ds_read_b64_tr_b16 v[216:217], v1 offset:9280
    ds_read_b64_tr_b16 v[218:219], v1 offset:10816
    v_mfma_f32_32x32x16_bf16 v[176:191], v[56:59], v[44:47], v[176:191]
    s_add_u32 s88, s88, 12288
    s_cmp_ge_u32 s88, 98304
    s_cselect_b32 s3, 98304, 0
    s_sub_u32 s88, s88, s3
    ds_read_b64_tr_b16 v[52:53], v60 offset:0
    ds_read_b64_tr_b16 v[54:55], v60 offset:1536
    s_waitcnt lgkmcnt(2)
    v_mfma_f32_32x32x16_bf16 v[160:175], v[212:215], v[48:51], v[160:175]
    buffer_load_dwordx4 v[100:103], v71, s[8:11], s84 offen offset:3072 sc1
L_h2_chk3:
    s_waitcnt vmcnt(4)
    v_max3_u32 v2, v72, v76, v80
    v_max3_u32 v2, v2, v84, v84
    v_cmp_eq_u32 vcc, -1, v2
    s_cbranch_vccnz L_h2_rty3
    ds_read_b64_tr_b16 v[56:57], v60 offset:64
    ds_read_b64_tr_b16 v[58:59], v60 offset:1600
    v_mfma_f32_32x32x16_bf16 v[176:191], v[216:219], v[48:51], v[176:191]
    ds_read_b64_tr_b16 v[212:213], v60 offset:3072
    ds_read_b64_tr_b16 v[214:215], v60 offset:4608
    s_waitcnt lgkmcnt(2)
    v_mfma_f32_32x32x16_bf16 v[160:175], v[52:55], v[72:75], v[160:175]
    buffer_load_dwordx4 v[104:107], v71, s[8:11], s85 offen offset:0 sc1
    ds_read_b64_tr_b16 v[216:217], v60 offset:3136
    ds_read_b64_tr_b16 v[218:219], v60 offset:4672
    v_mfma_f32_32x32x16_bf16 v[176:191], v[56:59], v[72:75], v[176:191]
    ds_read_b64_tr_b16 v[52:53], v60 offset:6144
    ds_read_b64_tr_b16 v[54:55], v60 offset:7680
    s_waitcnt lgkmcnt(2)
    v_mfma_f32_32x32x16_bf16 v[160:175], v[212:215], v[76:79], v[160:175]
    buffer_load_dwordx4 v[108:111], v71, s[8:11], s85 offen offset:1024 sc1
    ds_read_b64_tr_b16 v[56:57], v60 offset:6208
    ds_read_b64_tr_b16 v[58:59], v60 offset:7744
    v_mfma_f32_32x32x16_bf16 v[176:191], v[216:219], v[76:79], v[176:191]
    v_add_u32 v1, s88, v67
    ds_read_b64_tr_b16 v[212:213], v60 offset:9216
    ds_read_b64_tr_b16 v[214:215], v60 offset:10752
    s_waitcnt lgkmcnt(2)
    v_mfma_f32_32x32x16_bf16 v[160:175], v[52:55], v[80:83], v[160:175]
    buffer_load_dwordx4 v[112:115], v71, s[8:11], s85 offen offset:2048 sc1
    ds_read_b64_tr_b16 v[216:217], v60 offset:9280
    ds_read_b64_tr_b16 v[218:219], v60 offset:10816
    v_mfma_f32_32x32x16_bf16 v[176:191], v[56:59], v[80:83], v[176:191]
    s_add_u32 s88, s88, 12288
    s_cmp_ge_u32 s88, 98304
    s_cselect_b32 s3, 98304, 0
    s_sub_u32 s88, s88, s3
    ds_read_b64_tr_b16 v[52:53], v1 offset:0
    ds_read_b64_tr_b16 v[54:55], v1 offset:1536
    s_waitcnt lgkmcnt(2)
    v_mfma_f32_32x32x16_bf16 v[160:175], v[212:215], v[84:87], v[160:175]
    buffer_load_dwordx4 v[116:119], v71, s[8:11], s85 offen offset:3072 sc1
L_h2_chk4:
    s_waitcnt vmcnt(4)
    v_max3_u32 v2, v88, v92, v96
    v_max3_u32 v2, v2, v100, v100
    v_cmp_eq_u32 vcc, -1, v2
    s_cbranch_vccnz L_h2_rty4
    ds_read_b64_tr_b16 v[56:57], v1 offset:64
    ds_read_b64_tr_b16 v[58:59], v1 offset:1600
    v_mfma_f32_32x32x16_bf16 v[176:191], v[216:219], v[84:87], v[176:191]
    ds_read_b64_tr_b16 v[212:213], v1 offset:3072
    ds_read_b64_tr_b16 v[214:215], v1 offset:4608
    s_waitcnt lgkmcnt(2)
    v_mfma_f32_32x32x16_bf16 v[160:175], v[52:55], v[88:91], v[160:175]
    buffer_load_dwordx4 v[128:131], v71, s[8:11], s86 offen offset:0 sc1
    ds_read_b64_tr_b16 v[216:217], v1 offset:3136
    ds_read_b64_tr_b16 v[218:219], v1 offset:4672
    v_mfma_f32_32x32x16_bf16 v[176:191], v[56:59], v[88:91], v[176:191]
    ds_read_b64_tr_b16 v[52:53], v1 offset:6144
    ds_read_b64_tr_b16 v[54:55], v1 offset:7680
    s_waitcnt lgkmcnt(2)
    v_mfma_f32_32x32x16_bf16 v[160:175], v[212:215], v[92:95], v[160:175]
    buffer_load_dwordx4 v[132:135], v71, s[8:11], s86 offen offset:1024 sc1
    ds_read_b64_tr_b16 v[56:57], v1 offset:6208
    ds_read_b64_tr_b16 v[58:59], v1 offset:7744
    v_mfma_f32_32x32x16_bf16 v[176:191], v[216:219], v[92:95], v[176:191]
    v_add_u32 v60, s88, v67
    ds_read_b64_tr_b16 v[212:213], v1 offset:9216
    ds_read_b64_tr_b16 v[214:215], v1 offset:10752
    s_waitcnt lgkmcnt(2)
    v_mfma_f32_32x32x16_bf16 v[160:175], v[52:55], v[96:99], v[160:175]
    buffer_load_dwordx4 v[136:139], v71, s[8:11], s86 offen offset:2048 sc1
    ds_read_b64_tr_b16 v[216:217], v1 offset:9280
    ds_read_b64_tr_b16 v[218:219], v1 offset:10816
    v_mfma_f32_32x32x16_bf16 v[176:191], v[56:59], v[96:99], v[176:191]
    s_add_u32 s88, s88, 12288
    s_cmp_ge_u32 s88, 98304
    s_cselect_b32 s3, 98304, 0
    s_sub_u32 s88, s88, s3
    ds_read_b64_tr_b16 v[52:53], v60 offset:0
    ds_read_b64_tr_b16 v[54:55], v60 offset:1536
    s_waitcnt lgkmcnt(2)
    v_mfma_f32_32x32x16_bf16 v[160:175], v[212:215], v[100:103], v[160:175]
    buffer_load_dwordx4 v[140:143], v71, s[8:11], s86 offen offset:3072 sc1
L_h2_chk5:
    s_waitcnt vmcnt(4)
    v_max3_u32 v2, v104, v108, v112
    v_max3_u32 v2, v2, v116, v116
    v_cmp_eq_u32 vcc, -1, v2
    s_cbranch_vccnz L_h2_rty5
    ds_read_b64_tr_b16 v[56:57], v60 offset:64
    ds_read_b64_tr_b16 v[58:59], v60 offset:1600
    v_mfma_f32_32x32x16_bf16 v[176:191], v[216:219], v[100:103], v[176:191]
    ds_read_b64_tr_b16 v[212:213], v60 offset:3072
    ds_read_b64_tr_b16 v[214:215], v60 offset:4608
    s_waitcnt lgkmcnt(2)
    v_mfma_f32_32x32x16_bf16 v[160:175], v[52:55], v[104:107], v[160:175]
    buffer_load_dwordx4 v[144:147], v71, s[8:11], s87 offen offset:0 sc1
    ds_read_b64_tr_b16 v[216:217], v60 offset:3136
    ds_read_b64_tr_b16 v[218:219], v60 offset:4672
    v_mfma_f32_32x32x16_bf16 v[176:191], v[56:59], v[104:107], v[176:191]
    ds_read_b64_tr_b16 v[52:53], v60 offset:6144
    ds_read_b64_tr_b16 v[54:55], v60 offset:7680
    s_waitcnt lgkmcnt(2)
    v_mfma_f32_32x32x16_bf16 v[160:175], v[212:215], v[108:111], v[160:175]
    buffer_load_dwordx4 v[148:151], v71, s[8:11], s87 offen offset:1024 sc1
    ds_read_b64_tr_b16 v[56:57], v60 offset:6208
    ds_read_b64_tr_b16 v[58:59], v60 offset:7744
    v_mfma_f32_32x32x16_bf16 v[176:191], v[216:219], v[108:111], v[176:191]
    v_add_u32 v1, s88, v67
    ds_read_b64_tr_b16 v[212:213], v60 offset:9216
    ds_read_b64_tr_b16 v[214:215], v60 offset:10752
    s_waitcnt lgkmcnt(2)
    v_mfma_f32_32x32x16_bf16 v[160:175], v[52:55], v[112:115], v[160:175]
    buffer_load_dwordx4 v[152:155], v71, s[8:11], s87 offen offset:2048 sc1
    ds_read_b64_tr_b16 v[216:217], v60 offset:9280
    ds_read_b64_tr_b16 v[218:219], v60 offset:10816
    v_mfma_f32_32x32x16_bf16 v[176:191], v[56:59], v[112:115], v[176:191]
    s_add_u32 s88, s88, 12288
    s_cmp_ge_u32 s88, 98304
    s_cselect_b32 s3, 98304, 0
    s_sub_u32 s88, s88, s3
    ds_read_b64_tr_b16 v[52:53], v1 offset:0
    ds_read_b64_tr_b16 v[54:55], v1 offset:1536
    s_waitcnt lgkmcnt(2)
    v_mfma_f32_32x32x16_bf16 v[160:175], v[212:215], v[116:119], v[160:175]
    buffer_load_dwordx4 v[156:159], v71, s[8:11], s87 offen offset:3072 sc1
L_h2_chk6:
    s_waitcnt vmcnt(4)
    v_max3_u32 v2, v128, v132, v136
    v_max3_u32 v2, v2, v140, v140
    v_cmp_eq_u32 vcc, -1, v2
    s_cbranch_vccnz L_h2_rty6
    ds_read_b64_tr_b16 v[56:57], v1 offset:64
    ds_read_b64_tr_b16 v[58:59], v1 offset:1600
    v_mfma_f32_32x32x16_bf16 v[176:191], v[216:219], v[116:119], v[176:191]
    ds_read_b64_tr_b16 v[212:213], v1 offset:3072
    ds_read_b64_tr_b16 v[214:215], v1 offset:4608
    s_waitcnt lgkmcnt(2)
    v_mfma_f32_32x32x16_bf16 v[160:175], v[52:55], v[128:131], v[160:175]
    ds_read_b64_tr_b16 v[216:217], v1 offset:3136
    ds_read_b64_tr_b16 v[218:219], v1 offset:4672
    v_mfma_f32_32x32x16_bf16 v[176:191], v[56:59], v[128:131], v[176:191]
    ds_read_b64_tr_b16 v[52:53], v1 offset:6144
    ds_read_b64_tr_b16 v[54:55], v1 offset:7680
    s_waitcnt lgkmcnt(2)
    v_mfma_f32_32x32x16_bf16 v[160:175], v[212:215], v[132:135], v[160:175]
    ds_read_b64_tr_b16 v[56:57], v1 offset:6208
    ds_read_b64_tr_b16 v[58:59], v1 offset:7744
    v_mfma_f32_32x32x16_bf16 v[176:191], v[216:219], v[132:135], v[176:191]
    v_add_u32 v60, s88, v67
    ds_read_b64_tr_b16 v[212:213], v1 offset:9216
    ds_read_b64_tr_b16 v[214:215], v1 offset:10752
    s_waitcnt lgkmcnt(2)
    v_mfma_f32_32x32x16_bf16 v[160:175], v[52:55], v[136:139], v[160:175]
    ds_read_b64_tr_b16 v[216:217], v1 offset:9280
    ds_read_b64_tr_b16 v[218:219], v1 offset:10816
    v_mfma_f32_32x32x16_bf16 v[176:191], v[56:59], v[136:139], v[176:191]
    s_add_u32 s88, s88, 12288
    s_cmp_ge_u32 s88, 98304
    s_cselect_b32 s3, 98304, 0
    s_sub_u32 s88, s88, s3
    ds_read_b64_tr_b16 v[52:53], v60 offset:0
    ds_read_b64_tr_b16 v[54:55], v60 offset:1536
    s_waitcnt lgkmcnt(2)
    v_mfma_f32_32x32x16_bf16 v[160:175], v[212:215], v[140:143], v[160:175]
L_h2_chk7:
    s_waitcnt vmcnt(0)
    v_max3_u32 v2, v144, v148, v152
    v_max3_u32 v2, v2, v156, v156
    v_cmp_eq_u32 vcc, -1, v2
    s_cbranch_vccnz L_h2_rty7
    ds_read_b64_tr_b16 v[56:57], v60 offset:64
    ds_read_b64_tr_b16 v[58:59], v60 offset:1600
    v_mfma_f32_32x32x16_bf16 v[176:191], v[216:219], v[140:143], v[176:191]
    ds_read_b64_tr_b16 v[212:213], v60 offset:3072
    ds_read_b64_tr_b16 v[214:215], v60 offset:4608
    s_waitcnt lgkmcnt(2)
    v_mfma_f32_32x32x16_bf16 v[160:175], v[52:55], v[144:147], v[160:175]
    ds_read_b64_tr_b16 v[216:217], v60 offset:3136
    ds_read_b64_tr_b16 v[218:219], v60 offset:4672
    v_mfma_f32_32x32x16_bf16 v[176:191], v[56:59], v[144:147], v[176:191]
    ds_read_b64_tr_b16 v[52:53], v60 offset:6144
    ds_read_b64_tr_b16 v[54:55], v60 offset:7680
    s_waitcnt lgkmcnt(2)
    v_mfma_f32_32x32x16_bf16 v[160:175], v[212:215], v[148:151], v[160:175]
    ds_read_b64_tr_b16 v[56:57], v60 offset:6208
    ds_read_b64_tr_b16 v[58:59], v60 offset:7744
    v_mfma_f32_32x32x16_bf16 v[176:191], v[216:219], v[148:151], v[176:191]
    s_add_u32 s88, s88, 24576
    s_cmp_ge_u32 s88, 98304
    s_cselect_b32 s3, 98304, 0
    s_sub_u32 s88, s88, s3
    v_add_u32 v1, s88, v67
    ds_read_b64_tr_b16 v[212:213], v60 offset:9216
    ds_read_b64_tr_b16 v[214:215], v60 offset:10752
    s_waitcnt lgkmcnt(2)
    v_mfma_f32_32x32x16_bf16 v[160:175], v[52:55], v[152:155], v[160:175]
    ds_read_b64_tr_b16 v[216:217], v60 offset:9280
    ds_read_b64_tr_b16 v[218:219], v60 offset:10816
    v_mfma_f32_32x32x16_bf16 v[176:191], v[56:59], v[152:155], v[176:191]
    s_add_u32 s88, s88, 12288
    s_cmp_ge_u32 s88, 98304
    s_cselect_b32 s3, 98304, 0
    s_sub_u32 s88, s88, s3
    ds_read_b64_tr_b16 v[52:53], v1 offset:128
    ds_read_b64_tr_b16 v[54:55], v1 offset:1664
    s_waitcnt lgkmcnt(2)
    v_mfma_f32_32x32x16_bf16 v[160:175], v[212:215], v[156:159], v[160:175]
    ds_read_b64_tr_b16 v[56:57], v1 offset:3200
    ds_read_b64_tr_b16 v[58:59], v1 offset:4736
    v_mfma_f32_32x32x16_bf16 v[176:191], v[216:219], v[156:159], v[176:191]
    s_cmp_lg_u32 s89, 0
    s_cbranch_scc1 L_twoblk
    ds_read_b64_tr_b16 v[208:209], v1 offset:6272
    ds_read_b64_tr_b16 v[210:211], v1 offset:7808
    s_waitcnt lgkmcnt(4)
    v_mfma_f32_32x32x16_bf16 v[192:207], v[52:55], v[36:39], v[192:207]
    v_add_u32 v60, s88, v67
    ds_read_b64_tr_b16 v[52:53], v1 offset:9344
    ds_read_b64_tr_b16 v[54:55], v1 offset:10880
    s_waitcnt lgkmcnt(4)
    v_mfma_f32_32x32x16_bf16 v[192:207], v[56:59], v[40:43], v[192:207]
    v_exp_f32_e64 v224, -v160
    v_exp_f32_e64 v225, -v161
    v_exp_f32_e64 v226, -v162
    v_exp_f32_e64 v227, -v163
    s_lshl_b32 s26, s7, 4
    buffer_load_dwordx4 a[24:27], v62, s[8:11], s26 offen sc1
    ds_read_b64_tr_b16 v[56:57], v60 offset:128
    ds_read_b64_tr_b16 v[58:59], v60 offset:1664
    s_waitcnt lgkmcnt(4)
    v_mfma_f32_32x32x16_bf16 v[192:207], v[208:211], v[44:47], v[192:207]
    v_exp_f32_e64 v228, -v164
    v_exp_f32_e64 v229, -v165
    v_exp_f32_e64 v230, -v166
    v_exp_f32_e64 v231, -v167
    v_add_f32 v224, 1.0, v224
    s_add_u32 s88, s88, 12288
    s_cmp_ge_u32 s88, 98304
    s_cselect_b32 s3, 98304, 0
    s_sub_u32 s88, s88, s3
    ds_read_b64_tr_b16 v[208:209], v60 offset:3200
    ds_read_b64_tr_b16 v[210:211], v60 offset:4736
    s_waitcnt lgkmcnt(4)
    v_mfma_f32_32x32x16_bf16 v[192:207], v[52:55], v[48:51], v[192:207]
    v_add_f32 v225, 1.0, v225
    v_add_f32 v226, 1.0, v226
    v_add_f32 v227, 1.0, v227
    v_add_f32 v228, 1.0, v228
    buffer_load_dwordx4 a[28:31], v63, s[8:11], s26 offen sc1
    ds_read_b64_tr_b16 v[52:53], v60 offset:6272
    ds_read_b64_tr_b16 v[54:55], v60 offset:7808
    s_waitcnt lgkmcnt(4)
    v_mfma_f32_32x32x16_bf16 v[192:207], v[56:59], v[72:75], v[192:207]
    v_add_f32 v229, 1.0, v229
    v_add_f32 v230, 1.0, v230
    v_add_f32 v231, 1.0, v231
    v_rcp_f32 v224, v224
    v_rcp_f32 v225, v225
    v_add_u32 v1, s88, v67
    ds_read_b64_tr_b16 v[56:57], v60 offset:9344
    ds_read_b64_tr_b16 v[58:59], v60 offset:10880
    s_waitcnt lgkmcnt(4)
    v_mfma_f32_32x32x16_bf16 v[192:207], v[208:211], v[76:79], v[192:207]
    v_rcp_f32 v226, v226
    v_rcp_f32 v227, v227
    v_rcp_f32 v228, v228
    v_rcp_f32 v229, v229
    s_lshl_b32 s26, s12, 4
    buffer_load_dwordx4 a[32:35], v62, s[8:11], s26 offen sc1
    ds_read_b64_tr_b16 v[208:209], v1 offset:128
    ds_read_b64_tr_b16 v[210:211], v1 offset:1664
    s_waitcnt lgkmcnt(4)
    v_mfma_f32_32x32x16_bf16 v[192:207], v[52:55], v[80:83], v[192:207]
    v_rcp_f32 v230, v230
    v_rcp_f32 v231, v231
    v_mul_f32 v224, v224, v160
    v_mul_f32 v225, v225, v161
    v_mul_f32 v226, v226, v162
    s_add_u32 s88, s88, 12288
    s_cmp_ge_u32 s88, 98304
    s_cselect_b32 s3, 98304, 0
    s_sub_u32 s88, s88, s3
    ds_read_b64_tr_b16 v[52:53], v1 offset:3200
    ds_read_b64_tr_b16 v[54:55], v1 offset:4736
    s_waitcnt lgkmcnt(4)
    v_mfma_f32_32x32x16_bf16 v[192:207], v[56:59], v[84:87], v[192:207]
    v_mul_f32 v227, v227, v163
    v_mul_f32 v228, v228, v164
    v_mul_f32 v229, v229, v165
    v_mul_f32 v230, v230, v166
    buffer_load_dwordx4 a[36:39], v63, s[8:11], s26 offen sc1
    ds_read_b64_tr_b16 v[56:57], v1 offset:6272
    ds_read_b64_tr_b16 v[58:59], v1 offset:7808
    s_waitcnt lgkmcnt(4)
    v_mfma_f32_32x32x16_bf16 v[192:207], v[208:211], v[88:91], v[192:207]
    v_mul_f32 v231, v231, v167
    v_cvt_pk_bf16_f32 v4, v224, v225
    v_cvt_pk_bf16_f32 v5, v226, v227
    v_cvt_pk_bf16_f32 v6, v228, v229
    v_cvt_pk_bf16_f32 v7, v230, v231
    v_add_u32 v60, s88, v67
    ds_read_b64_tr_b16 v[208:209], v1 offset:9344
    ds_read_b64_tr_b16 v[210:211], v1 offset:10880
    s_waitcnt lgkmcnt(4)
    v_mfma_f32_32x32x16_bf16 v[192:207], v[52:55], v[92:95], v[192:207]
    v_min_u32 v4, -2, v4
    s_cmp_lg_u32 s45, 0
    s_cbranch_scc1 L_lst15
    buffer_store_dwordx4 v[4:7], v69, s[8:11], s22 offen offset:0
L_lse15:
    v_exp_f32_e64 v224, -v168
    v_exp_f32_e64 v225, -v169
    s_lshl_b32 s26, s13, 4
    buffer_load_dwordx4 a[40:43], v62, s[8:11], s26 offen sc1
    ds_read_b64_tr_b16 v[52:53], v60 offset:128
    ds_read_b64_tr_b16 v[54:55], v60 offset:1664
    s_waitcnt lgkmcnt(4)
    v_mfma_f32_32x32x16_bf16 v[192:207], v[56:59], v[96:99], v[192:207]
    v_exp_f32_e64 v226, -v170
    v_exp_f32_e64 v227, -v171
    v_exp_f32_e64 v228, -v172
    v_exp_f32_e64 v229, -v173
    v_exp_f32_e64 v230, -v174
    s_add_u32 s88, s88, 12288
    s_cmp_ge_u32 s88, 98304
    s_cselect_b32 s3, 98304, 0
    s_sub_u32 s88, s88, s3
    ds_read_b64_tr_b16 v[56:57], v60 offset:3200
    ds_read_b64_tr_b16 v[58:59], v60 offset:4736
    s_waitcnt lgkmcnt(4)
    v_mfma_f32_32x32x16_bf16 v[192:207], v[208:211], v[100:103], v[192:207]
    v_exp_f32_e64 v231, -v175
    v_add_f32 v224, 1.0, v224
    v_add_f32 v225, 1.0, v225
    v_add_f32 v226, 1.0, v226
    buffer_load_dwordx4 a[44:47], v63, s[8:11], s26 offen sc1
    ds_read_b64_tr_b16 v[208:209], v60 offset:6272
    ds_read_b64_tr_b16 v[210:211], v60 offset:7808
    s_waitcnt lgkmcnt(4)
    v_mfma_f32_32x32x16_bf16 v[192:207], v[52:55], v[104:107], v[192:207]
    v_add_f32 v227, 1.0, v227
    v_add_f32 v228, 1.0, v228
    v_add_f32 v229, 1.0, v229
    v_add_f32 v230, 1.0, v230
    v_add_f32 v231, 1.0, v231
    v_add_u32 v1, s88, v67
    ds_read_b64_tr_b16 v[52:53], v60 offset:9344
    ds_read_b64_tr_b16 v[54:55], v60 offset:10880
    s_waitcnt lgkmcnt(4)
    v_mfma_f32_32x32x16_bf16 v[192:207], v[56:59], v[108:111], v[192:207]
    v_rcp_f32 v224, v224
    v_rcp_f32 v225, v225
    v_rcp_f32 v226, v226
    v_rcp_f32 v227, v227
    s_lshl_b32 s26, s14, 4
    buffer_load_dwordx4 a[48:51], v62, s[8:11], s26 offen sc1
    ds_read_b64_tr_b16 v[56:57], v1 offset:128
    ds_read_b64_tr_b16 v[58:59], v1 offset:1664
    s_waitcnt lgkmcnt(4)
    v_mfma_f32_32x32x16_bf16 v[192:207], v[208:211], v[112:115], v[192:207]
    v_rcp_f32 v228, v228
    v_rcp_f32 v229, v229
    v_rcp_f32 v230, v230
    v_rcp_f32 v231, v231
    v_mul_f32 v224, v224, v168
    s_add_u32 s88, s88, 12288
    s_cmp_ge_u32 s88, 98304
    s_cselect_b32 s3, 98304, 0
    s_sub_u32 s88, s88, s3
    ds_read_b64_tr_b16 v[208:209], v1 offset:3200
    ds_read_b64_tr_b16 v[210:211], v1 offset:4736
    s_waitcnt lgkmcnt(4)
    v_mfma_f32_32x32x16_bf16 v[192:207], v[52:55], v[116:119], v[192:207]
    v_mul_f32 v225, v225, v169
    v_mul_f32 v226, v226, v170
    v_mul_f32 v227, v227, v171
    v_mul_f32 v228, v228, v172
    buffer_load_dwordx4 a[52:55], v63, s[8:11], s26 offen sc1
    ds_read_b64_tr_b16 v[52:53], v1 offset:6272
    ds_read_b64_tr_b16 v[54:55], v1 offset:7808
    s_waitcnt lgkmcnt(4)
    v_mfma_f32_32x32x16_bf16 v[192:207], v[56:59], v[128:131], v[192:207]
    v_mul_f32 v229, v229, v173
    v_mul_f32 v230, v230, v174
    v_mul_f32 v231, v231, v175
    v_cvt_pk_bf16_f32 v8, v224, v225
    v_cvt_pk_bf16_f32 v9, v226, v227
    v_add_u32 v60, s88, v67
    ds_read_b64_tr_b16 v[56:57], v1 offset:9344
    ds_read_b64_tr_b16 v[58:59], v1 offset:10880
    s_waitcnt lgkmcnt(4)
    v_mfma_f32_32x32x16_bf16 v[192:207], v[208:211], v[132:135], v[192:207]
    v_cvt_pk_bf16_f32 v10, v228, v229
    v_cvt_pk_bf16_f32 v11, v230, v231
    v_min_u32 v8, -2, v8
    s_cmp_lg_u32 s45, 0
    s_cbranch_scc1 L_lst16
    buffer_store_dwordx4 v[8:11], v69, s[8:11], s22 offen offset:1024
L_lse16:
    s_lshl_b32 s26, s15, 4
    buffer_load_dwordx4 a[56:59], v62, s[8:11], s26 offen sc1
    ds_read_b64_tr_b16 v[208:209], v60 offset:128
    ds_read_b64_tr_b16 v[210:211], v60 offset:1664
    s_waitcnt lgkmcnt(4)
    v_mfma_f32_32x32x16_bf16 v[192:207], v[52:55], v[136:139], v[192:207]
    v_exp_f32_e64 v224, -v176
    v_exp_f32_e64 v225, -v177
    v_exp_f32_e64 v226, -v178
    v_exp_f32_e64 v227, -v179
    v_exp_f32_e64 v228, -v180
    s_add_u32 s88, s88, 12288
    s_cmp_ge_u32 s88, 98304
    s_cselect_b32 s3, 98304, 0
    s_sub_u32 s88, s88, s3
    ds_read_b64_tr_b16 v[52:53], v60 offset:3200
    ds_read_b64_tr_b16 v[54:55], v60 offset:4736
    s_waitcnt lgkmcnt(4)
    v_mfma_f32_32x32x16_bf16 v[192:207], v[56:59], v[140:143], v[192:207]
    v_exp_f32_e64 v229, -v181
    v_exp_f32_e64 v230, -v182
    v_exp_f32_e64 v231, -v183
    v_add_f32 v224, 1.0, v224
    buffer_load_dwordx4 a[60:63], v63, s[8:11], s26 offen sc1
    ds_read_b64_tr_b16 v[56:57], v60 offset:6272
    ds_read_b64_tr_b16 v[58:59], v60 offset:7808
    s_waitcnt lgkmcnt(4)
    v_mfma_f32_32x32x16_bf16 v[192:207], v[208:211], v[144:147], v[192:207]
    v_add_f32 v225, 1.0, v225
    v_add_f32 v226, 1.0, v226
    v_add_f32 v227, 1.0, v227
    v_add_f32 v228, 1.0, v228
    v_add_f32 v229, 1.0, v229
    ds_read_b64_tr_b16 v[208:209], v60 offset:9344
    ds_read_b64_tr_b16 v[210:211], v60 offset:10880
    s_waitcnt lgkmcnt(4)
    v_mfma_f32_32x32x16_bf16 v[192:207], v[52:55], v[148:151], v[192:207]
    v_add_f32 v230, 1.0, v230
    v_add_f32 v231, 1.0, v231
    v_rcp_f32 v224, v224
    v_rcp_f32 v225, v225
    s_lshl_b32 s26, s28, 4
    buffer_load_dwordx4 a[64:67], v62, s[8:11], s26 offen sc1
    s_waitcnt lgkmcnt(2)
    v_mfma_f32_32x32x16_bf16 v[192:207], v[56:59], v[152:155], v[192:207]
    v_rcp_f32 v226, v226
    v_rcp_f32 v227, v227
    v_rcp_f32 v228, v228
    v_rcp_f32 v229, v229
    v_rcp_f32 v230, v230
    s_waitcnt lgkmcnt(0)
    v_mfma_f32_32x32x16_bf16 v[192:207], v[208:211], v[156:159], v[192:207]
    v_rcp_f32 v231, v231
    v_mul_f32 v224, v224, v176
    v_mul_f32 v225, v225, v177
    v_mul_f32 v226, v226, v178
    buffer_load_dwordx4 a[68:71], v63, s[8:11], s26 offen sc1
    v_mul_f32 v227, v227, v179
    v_mul_f32 v228, v228, v180
    v_mul_f32 v229, v229, v181
    v_mul_f32 v230, v230, v182
    v_mul_f32 v231, v231, v183
    v_cvt_pk_bf16_f32 v12, v224, v225
    v_cvt_pk_bf16_f32 v13, v226, v227
    v_cvt_pk_bf16_f32 v14, v228, v229
    v_cvt_pk_bf16_f32 v15, v230, v231
    v_min_u32 v12, -2, v12
    s_cmp_lg_u32 s45, 0
    s_cbranch_scc1 L_lst17
    buffer_store_dwordx4 v[12:15], v69, s[8:11], s22 offen offset:2048
L_lse17:
    v_exp_f32_e64 v224, -v184
    v_exp_f32_e64 v225, -v185
    v_exp_f32_e64 v226, -v186
    s_lshl_b32 s26, s29, 4
    buffer_load_dwordx4 a[72:75], v62, s[8:11], s26 offen sc1
    v_exp_f32_e64 v227, -v187
    v_exp_f32_e64 v228, -v188
    v_exp_f32_e64 v229, -v189
    v_exp_f32_e64 v230, -v190
    v_exp_f32_e64 v231, -v191
    v_add_f32 v224, 1.0, v224
    v_add_f32 v225, 1.0, v225
    v_add_f32 v226, 1.0, v226
    v_add_f32 v227, 1.0, v227
    v_add_f32 v228, 1.0, v228
    v_add_f32 v229, 1.0, v229
    buffer_load_dwordx4 a[76:79], v63, s[8:11], s26 offen sc1
    v_add_f32 v230, 1.0, v230
    v_add_f32 v231, 1.0, v231
    v_rcp_f32 v224, v224
    v_rcp_f32 v225, v225
    v_rcp_f32 v226, v226
    v_rcp_f32 v227, v227
    v_rcp_f32 v228, v228
    v_rcp_f32 v229, v229
    v_rcp_f32 v230, v230
    s_lshl_b32 s26, s30, 4
    buffer_load_dwordx4 a[80:83], v62, s[8:11], s26 offen sc1
    v_rcp_f32 v231, v231
    v_mul_f32 v224, v224, v184
    v_mul_f32 v225, v225, v185
    v_mul_f32 v226, v226, v186
    v_mul_f32 v227, v227, v187
    v_mul_f32 v228, v228, v188
    v_mul_f32 v229, v229, v189
    v_mul_f32 v230, v230, v190
    v_mul_f32 v231, v231, v191
    v_cvt_pk_bf16_f32 v16, v224, v225
    v_cvt_pk_bf16_f32 v17, v226, v227
    v_cvt_pk_bf16_f32 v18, v228, v229
    v_cvt_pk_bf16_f32 v19, v230, v231
    v_min_u32 v16, -2, v16
    s_cmp_lg_u32 s45, 0
    s_cbranch_scc1 L_lst18
    buffer_store_dwordx4 v[16:19], v69, s[8:11], s22 offen offset:3072
L_lse18:
    v_exp_f32_e64 v224, -v192
    v_exp_f32_e64 v225, -v193
    v_exp_f32_e64 v226, -v194
    v_exp_f32_e64 v227, -v195
    v_exp_f32_e64 v228, -v196
    v_exp_f32_e64 v229, -v197
    v_exp_f32_e64 v230, -v198
    v_exp_f32_e64 v231, -v199
    v_pk_add_f32 v[224:225], v[224:225], 1.0 op_sel_hi:[1,0]
    v_pk_add_f32 v[226:227], v[226:227], 1.0 op_sel_hi:[1,0]
    v_pk_add_f32 v[228:229], v[228:229], 1.0 op_sel_hi:[1,0]
    v_pk_add_f32 v[230:231], v[230:231], 1.0 op_sel_hi:[1,0]
    v_rcp_f32 v224, v224
    v_rcp_f32 v225, v225
    v_rcp_f32 v226, v226
    v_rcp_f32 v227, v227
    v_rcp_f32 v228, v228
    v_rcp_f32 v229, v229
    v_rcp_f32 v230, v230
    v_rcp_f32 v231, v231
    v_pk_mul_f32 v[224:225], v[224:225], v[192:193]
    v_pk_mul_f32 v[226:227], v[226:227], v[194:195]
    v_pk_mul_f32 v[228:229], v[228:229], v[196:197]
    v_pk_mul_f32 v[230:231], v[230:231], v[198:199]
    v_cvt_pk_bf16_f32 v20, v224, v225
    v_cvt_pk_bf16_f32 v21, v226, v227
    v_cvt_pk_bf16_f32 v22, v228, v229
    v_cvt_pk_bf16_f32 v23, v230, v231
    v_min_u32 v20, -2, v20
    s_cmp_lg_u32 s45, 0
    s_cbranch_scc1 L_lst19
    buffer_store_dwordx4 v[20:23], v69, s[8:11], s23 offen offset:0
L_lse19:
    buffer_load_dwordx4 a[84:87], v63, s[8:11], s26 offen sc1
    s_lshl_b32 s26, s31, 4
    buffer_load_dwordx4 a[88:91], v62, s[8:11], s26 offen sc1
    v_exp_f32_e64 v224, -v200
    v_exp_f32_e64 v225, -v201
    v_exp_f32_e64 v226, -v202
    v_exp_f32_e64 v227, -v203
    v_exp_f32_e64 v228, -v204
    v_exp_f32_e64 v229, -v205
    v_exp_f32_e64 v230, -v206
    v_exp_f32_e64 v231, -v207
    v_pk_add_f32 v[224:225], v[224:225], 1.0 op_sel_hi:[1,0]
    v_pk_add_f32 v[226:227], v[226:227], 1.0 op_sel_hi:[1,0]
    v_pk_add_f32 v[228:229], v[228:229], 1.0 op_sel_hi:[1,0]
    v_pk_add_f32 v[230:231], v[230:231], 1.0 op_sel_hi:[1,0]
    v_rcp_f32 v224, v224
    v_rcp_f32 v225, v225
    v_rcp_f32 v226, v226
    v_rcp_f32 v227, v227
    v_rcp_f32 v228, v228
    v_rcp_f32 v229, v229
    v_rcp_f32 v230, v230
    v_rcp_f32 v231, v231
    v_pk_mul_f32 v[224:225], v[224:225], v[200:201]
    v_pk_mul_f32 v[226:227], v[226:227], v[202:203]
    v_pk_mul_f32 v[228:229], v[228:229], v[204:205]
    v_pk_mul_f32 v[230:231], v[230:231], v[206:207]
    v_cvt_pk_bf16_f32 v24, v224, v225
    v_cvt_pk_bf16_f32 v25, v226, v227
    v_cvt_pk_bf16_f32 v26, v228, v229
    v_cvt_pk_bf16_f32 v27, v230, v231
    v_min_u32 v24, -2, v24
    s_cmp_lg_u32 s45, 0
    s_cbranch_scc1 L_lst20
    buffer_store_dwordx4 v[24:27], v69, s[8:11], s23 offen offset:1024
L_lse20:
    buffer_load_dwordx4 a[92:95], v63, s[8:11], s26 offen sc1
    s_lshl_b32 s26, s58, 4
    buffer_load_dwordx4 a[96:99], v62, s[8:11], s26 offen sc1
    buffer_load_dwordx4 a[100:103], v63, s[8:11], s26 offen sc1
    s_lshl_b32 s26, s59, 4
    buffer_load_dwordx4 a[104:107], v62, s[8:11], s26 offen sc1
    buffer_load_dwordx4 a[108:111], v63, s[8:11], s26 offen sc1
    s_lshl_b32 s26, s62, 4
    buffer_load_dwordx4 a[112:115], v62, s[8:11], s26 offen sc1
L_g1done:
    v_add_u32 v120, s90, v120
    v_add_u32 v121, s90, v121
    buffer_load_dwordx4 v[4:7], v122, s[8:11], s91 offen offset:0 sc1
    buffer_load_dwordx4 v[8:11], v122, s[8:11], s91 offen offset:32 sc1
    v_add_u32 v123, s93, v123
    s_mov_b32 s50, 0
    s_barrier
    buffer_load_dwordx4 v[80:83], v120, s[8:11], s4 offen sc1
    buffer_load_dwordx4 v[84:87], v121, s[8:11], s4 offen sc1
    buffer_load_dwordx4 v[88:91], v120, s[8:11], s5 offen sc1
    buffer_load_dwordx4 v[92:95], v121, s[8:11], s5 offen sc1
    buffer_load_dwordx4 v[96:99], v120, s[8:11], s6 offen sc1
    buffer_load_dwordx4 v[100:103], v121, s[8:11], s6 offen sc1
    buffer_load_dwordx4 v[104:107], v120, s[8:11], s7 offen sc1
    buffer_load_dwordx4 v[108:111], v121, s[8:11], s7 offen sc1
L_h1_chk0:
    s_waitcnt vmcnt(4)
    v_max3_u32 v2, v80, v84, v88
    v_max3_u32 v2, v2, v92, v92
    v_cmp_eq_u32 vcc, -1, v2
    s_cbranch_vccnz L_h1_rty0
    v_mfma_f32_32x32x16_bf16 v[44:59], a[4:7], v[80:83], 0
    buffer_load_dwordx4 v[112:115], v120, s[8:11], s12 offen sc1
    v_mfma_f32_32x32x16_bf16 v[28:43], a[0:3], v[84:87], 0
    buffer_load_dwordx4 v[116:119], v121, s[8:11], s12 offen sc1
    v_mfma_f32_32x32x16_bf16 v[64:79], a[4:7], v[84:87], 0
    buffer_load_dwordx4 v[128:131], v120, s[8:11], s13 offen sc1
    v_mfma_f32_32x32x16_bf16 v[12:27], a[0:3], v[80:83], 0
    buffer_load_dwordx4 v[132:135], v121, s[8:11], s13 offen sc1
    v_mfma_f32_32x32x16_bf16 v[44:59], a[12:15], v[88:91], v[44:59]
    buffer_load_dwordx4 v[136:139], v120, s[8:11], s14 offen sc1
    v_mfma_f32_32x32x16_bf16 v[28:43], a[8:11], v[92:95], v[28:43]
    buffer_load_dwordx4 v[140:143], v121, s[8:11], s14 offen sc1
    v_mfma_f32_32x32x16_bf16 v[64:79], a[12:15], v[92:95], v[64:79]
    buffer_load_dwordx4 v[144:147], v120, s[8:11], s15 offen sc1
L_h1_chk1:
    s_waitcnt vmcnt(7)
    v_max3_u32 v2, v96, v100, v104
    v_max3_u32 v2, v2, v108, v108
    v_cmp_eq_u32 vcc, -1, v2
    s_cbranch_vccnz L_h1_rty1
    v_mfma_f32_32x32x16_bf16 v[12:27], a[8:11], v[88:91], v[12:27]
    buffer_load_dwordx4 v[148:151], v121, s[8:11], s15 offen sc1
    v_mfma_f32_32x32x16_bf16 v[44:59], a[20:23], v[96:99], v[44:59]
    buffer_load_dwordx4 v[152:155], v120, s[8:11], s28 offen sc1
    v_mfma_f32_32x32x16_bf16 v[28:43], a[16:19], v[100:103], v[28:43]
    buffer_load_dwordx4 v[156:159], v121, s[8:11], s28 offen sc1
    v_mfma_f32_32x32x16_bf16 v[64:79], a[20:23], v[100:103], v[64:79]
    buffer_load_dwordx4 v[160:163], v120, s[8:11], s29 offen sc1
    v_mfma_f32_32x32x16_bf16 v[12:27], a[16:19], v[96:99], v[12:27]
    buffer_load_dwordx4 v[164:167], v121, s[8:11], s29 offen sc1
    v_mfma_f32_32x32x16_bf16 v[44:59], a[28:31], v[104:107], v[44:59]
    buffer_load_dwordx4 v[168:171], v120, s[8:11], s30 offen sc1
    v_mfma_f32_32x32x16_bf16 v[28:43], a[24:27], v[108:111], v[28:43]
    buffer_load_dwordx4 v[172:175], v121, s[8:11], s30 offen sc1
    v_mfma_f32_32x32x16_bf16 v[64:79], a[28:31], v[108:111], v[64:79]
    buffer_load_dwordx4 a[116:119], v63, s[8:11], s26 offen sc1
L_h1_chk2:
    s_waitcnt vmcnt(11)
    v_max3_u32 v2, v112, v116, v128
    v_max3_u32 v2, v2, v132, v132
    v_cmp_eq_u32 vcc, -1, v2
    s_cbranch_vccnz L_h1_rty2
    v_mfma_f32_32x32x16_bf16 v[12:27], a[24:27], v[104:107], v[12:27]
    s_lshl_b32 s26, s63, 4
    buffer_load_dwordx4 a[120:123], v62, s[8:11], s26 offen sc1
    v_mfma_f32_32x32x16_bf16 v[44:59], a[36:39], v[112:115], v[44:59]
    buffer_load_dwordx4 v[176:179], v120, s[8:11], s31 offen sc1
    v_mfma_f32_32x32x16_bf16 v[28:43], a[32:35], v[116:119], v[28:43]
    buffer_load_dwordx4 v[180:183], v121, s[8:11], s31 offen sc1
    v_mfma_f32_32x32x16_bf16 v[64:79], a[36:39], v[116:119], v[64:79]
    buffer_load_dwordx4 a[124:127], v63, s[8:11], s26 offen sc1
    v_mfma_f32_32x32x16_bf16 v[12:27], a[32:35], v[112:115], v[12:27]
    s_lshl_b32 s26, s64, 4
    buffer_load_dwordx4 a[128:131], v62, s[8:11], s26 offen sc1
    v_mfma_f32_32x32x16_bf16 v[44:59], a[44:47], v[128:131], v[44:59]
    buffer_load_dwordx4 v[184:187], v120, s[8:11], s58 offen sc1
    v_mfma_f32_32x32x16_bf16 v[28:43], a[40:43], v[132:135], v[28:43]
    buffer_load_dwordx4 v[188:191], v121, s[8:11], s58 offen sc1
    v_mfma_f32_32x32x16_bf16 v[64:79], a[44:47], v[132:135], v[64:79]
    buffer_load_dwordx4 a[132:135], v63, s[8:11], s26 offen sc1
L_h1_chk3:
    s_waitcnt vmcnt(15)
    v_max3_u32 v2, v136, v140, v144
    v_max3_u32 v2, v2, v148, v148
    v_cmp_eq_u32 vcc, -1, v2
    s_cbranch_vccnz L_h1_rty3
    v_mfma_f32_32x32x16_bf16 v[12:27], a[40:43], v[128:131], v[12:27]
    s_lshl_b32 s26, s65, 4
    buffer_load_dwordx4 a[136:139], v62, s[8:11], s26 offen sc1
    v_mfma_f32_32x32x16_bf16 v[44:59], a[52:55], v[136:139], v[44:59]
    buffer_load_dwordx4 v[192:195], v120, s[8:11], s59 offen sc1
    v_mfma_f32_32x32x16_bf16 v[28:43], a[48:51], v[140:143], v[28:43]
    buffer_load_dwordx4 v[196:199], v121, s[8:11], s59 offen sc1
    v_mfma_f32_32x32x16_bf16 v[64:79], a[52:55], v[140:143], v[64:79]
    buffer_load_dwordx4 a[140:143], v63, s[8:11], s26 offen sc1
    v_mfma_f32_32x32x16_bf16 v[12:27], a[48:51], v[136:139], v[12:27]
    s_lshl_b32 s26, s66, 4
    buffer_load_dwordx4 a[144:147], v62, s[8:11], s26 offen sc1
    v_mfma_f32_32x32x16_bf16 v[44:59], a[60:63], v[144:147], v[44:59]
    buffer_load_dwordx4 v[200:203], v120, s[8:11], s62 offen sc1
    v_mfma_f32_32x32x16_bf16 v[28:43], a[56:59], v[148:151], v[28:43]
    buffer_load_dwordx4 v[204:207], v121, s[8:11], s62 offen sc1
    v_mfma_f32_32x32x16_bf16 v[64:79], a[60:63], v[148:151], v[64:79]
    buffer_load_dwordx4 a[148:151], v63, s[8:11], s26 offen sc1
L_h1_chk4:
    s_waitcnt vmcnt(19)
    v_max3_u32 v2, v152, v156, v160
    v_max3_u32 v2, v2, v164, v164
    v_cmp_eq_u32 vcc, -1, v2
    s_cbranch_vccnz L_h1_rty4
    v_mfma_f32_32x32x16_bf16 v[12:27], a[56:59], v[144:147], v[12:27]
    s_lshl_b32 s26, s67, 4
    buffer_load_dwordx4 a[152:155], v62, s[8:11], s26 offen sc1
    v_mfma_f32_32x32x16_bf16 v[44:59], a[68:71], v[152:155], v[44:59]
    buffer_load_dwordx4 v[208:211], v120, s[8:11], s63 offen sc1
    v_mfma_f32_32x32x16_bf16 v[28:43], a[64:67], v[156:159], v[28:43]
    buffer_load_dwordx4 v[212:215], v121, s[8:11], s63 offen sc1
    v_mfma_f32_32x32x16_bf16 v[64:79], a[68:71], v[156:159], v[64:79]
    buffer_load_dwordx4 a[156:159], v63, s[8:11], s26 offen sc1
    v_mfma_f32_32x32x16_bf16 v[12:27], a[64:67], v[152:155], v[12:27]
    s_lshl_b32 s26, s68, 4
    buffer_load_dwordx4 a[160:163], v62, s[8:11], s26 offen sc1
    v_mfma_f32_32x32x16_bf16 v[44:59], a[76:79], v[160:163], v[44:59]
    buffer_load_dwordx4 v[216:219], v120, s[8:11], s64 offen sc1
    v_mfma_f32_32x32x16_bf16 v[28:43], a[72:75], v[164:167], v[28:43]
    buffer_load_dwordx4 v[220:223], v121, s[8:11], s64 offen sc1
    v_mfma_f32_32x32x16_bf16 v[64:79], a[76:79], v[164:167], v[64:79]
    buffer_load_dwordx4 a[164:167], v63, s[8:11], s26 offen sc1
L_h1_chk5:
    s_waitcnt vmcnt(21)
    v_max3_u32 v2, v168, v172, v176
    v_max3_u32 v2, v2, v180, v180
    v_cmp_eq_u32 vcc, -1, v2
    s_cbranch_vccnz L_h1_rty5
    v_mfma_f32_32x32x16_bf16 v[12:27], a[72:75], v[160:163], v[12:27]
    s_lshl_b32 s26, s69, 4
    buffer_load_dwordx4 a[168:171], v62, s[8:11], s26 offen sc1
    v_mfma_f32_32x32x16_bf16 v[44:59], a[84:87], v[168:171], v[44:59]
    buffer_load_dwordx4 v[224:227], v120, s[8:11], s65 offen sc1
    v_mfma_f32_32x32x16_bf16 v[28:43], a[80:83], v[172:175], v[28:43]
    buffer_load_dwordx4 v[228:231], v121, s[8:11], s65 offen sc1
    v_mfma_f32_32x32x16_bf16 v[64:79], a[84:87], v[172:175], v[64:79]
    buffer_load_dwordx4 a[172:175], v63, s[8:11], s26 offen sc1
    v_mfma_f32_32x32x16_bf16 v[12:27], a[80:83], v[168:171], v[12:27]
    v_mfma_f32_32x32x16_bf16 v[44:59], a[92:95], v[176:179], v[44:59]
    buffer_load_dwordx4 v[232:235], v120, s[8:11], s66 offen sc1
    v_mfma_f32_32x32x16_bf16 v[28:43], a[88:91], v[180:183], v[28:43]
    buffer_load_dwordx4 v[236:239], v121, s[8:11], s66 offen sc1
    v_mfma_f32_32x32x16_bf16 v[64:79], a[92:95], v[180:183], v[64:79]
L_h1_chk6:
    s_waitcnt vmcnt(19)
    v_max3_u32 v2, v184, v188, v192
    v_max3_u32 v2, v2, v196, v196
    v_cmp_eq_u32 vcc, -1, v2
    s_cbranch_vccnz L_h1_rty6
    v_mfma_f32_32x32x16_bf16 v[12:27], a[88:91], v[176:179], v[12:27]
    v_mfma_f32_32x32x16_bf16 v[44:59], a[100:103], v[184:187], v[44:59]
    buffer_load_dwordx4 v[240:243], v120, s[8:11], s67 offen sc1
    v_mfma_f32_32x32x16_bf16 v[28:43], a[96:99], v[188:191], v[28:43]
    buffer_load_dwordx4 v[244:247], v121, s[8:11], s67 offen sc1
    v_mfma_f32_32x32x16_bf16 v[64:79], a[100:103], v[188:191], v[64:79]
    v_mfma_f32_32x32x16_bf16 v[12:27], a[96:99], v[184:187], v[12:27]
    v_mfma_f32_32x32x16_bf16 v[44:59], a[108:111], v[192:195], v[44:59]
    buffer_load_dwordx4 v[128:131], v120, s[8:11], s68 offen sc1
    v_mfma_f32_32x32x16_bf16 v[28:43], a[104:107], v[196:199], v[28:43]
    buffer_load_dwordx4 v[132:135], v121, s[8:11], s68 offen sc1
    v_mfma_f32_32x32x16_bf16 v[64:79], a[108:111], v[196:199], v[64:79]
L_h1_chk7:
    s_waitcnt vmcnt(15)
    v_max3_u32 v2, v200, v204, v208
    v_max3_u32 v2, v2, v212, v212
    v_cmp_eq_u32 vcc, -1, v2
    s_cbranch_vccnz L_h1_rty7
    v_mfma_f32_32x32x16_bf16 v[12:27], a[104:107], v[192:195], v[12:27]
    v_mfma_f32_32x32x16_bf16 v[44:59], a[116:119], v[200:203], v[44:59]
    buffer_load_dwordx4 v[80:83], v120, s[8:11], s69 offen sc1
    v_mfma_f32_32x32x16_bf16 v[28:43], a[112:115], v[204:207], v[28:43]
    buffer_load_dwordx4 v[84:87], v121, s[8:11], s69 offen sc1
    v_mfma_f32_32x32x16_bf16 v[64:79], a[116:119], v[204:207], v[64:79]
    v_mfma_f32_32x32x16_bf16 v[12:27], a[112:115], v[200:203], v[12:27]
    v_mfma_f32_32x32x16_bf16 v[44:59], a[124:127], v[208:211], v[44:59]
    v_mfma_f32_32x32x16_bf16 v[28:43], a[120:123], v[212:215], v[28:43]
    v_mfma_f32_32x32x16_bf16 v[64:79], a[124:127], v[212:215], v[64:79]
L_h1_chk8:
    s_waitcnt vmcnt(9)
    v_max3_u32 v2, v216, v220, v224
    v_max3_u32 v2, v2, v228, v228
    v_cmp_eq_u32 vcc, -1, v2
    s_cbranch_vccnz L_h1_rty8
    v_mfma_f32_32x32x16_bf16 v[12:27], a[120:123], v[208:211], v[12:27]
    v_mfma_f32_32x32x16_bf16 v[44:59], a[132:135], v[216:219], v[44:59]
    v_mfma_f32_32x32x16_bf16 v[28:43], a[128:131], v[220:223], v[28:43]
    v_mfma_f32_32x32x16_bf16 v[64:79], a[132:135], v[220:223], v[64:79]
    v_mfma_f32_32x32x16_bf16 v[12:27], a[128:131], v[216:219], v[12:27]
    v_mfma_f32_32x32x16_bf16 v[44:59], a[140:143], v[224:227], v[44:59]
    v_mfma_f32_32x32x16_bf16 v[28:43], a[136:139], v[228:231], v[28:43]
    v_mfma_f32_32x32x16_bf16 v[64:79], a[140:143], v[228:231], v[64:79]
L_h1_chk9:
    s_waitcnt vmcnt(4)
    v_max3_u32 v2, v232, v236, v240
    v_max3_u32 v2, v2, v244, v244
    v_cmp_eq_u32 vcc, -1, v2
    s_cbranch_vccnz L_h1_rty9
    v_mfma_f32_32x32x16_bf16 v[12:27], a[136:139], v[224:227], v[12:27]
    v_mfma_f32_32x32x16_bf16 v[44:59], a[148:151], v[232:235], v[44:59]
    v_mfma_f32_32x32x16_bf16 v[28:43], a[144:147], v[236:239], v[28:43]
    v_mfma_f32_32x32x16_bf16 v[64:79], a[148:151], v[236:239], v[64:79]
    v_mfma_f32_32x32x16_bf16 v[44:59], a[156:159], v[240:243], v[44:59]
    v_mfma_f32_32x32x16_bf16 v[28:43], a[152:155], v[244:247], v[28:43]
    v_mfma_f32_32x32x16_bf16 v[64:79], a[156:159], v[244:247], v[64:79]
L_h1_chk10:
    s_waitcnt vmcnt(0)
    v_max3_u32 v2, v128, v132, v80
    v_max3_u32 v2, v2, v84, v84
    v_cmp_eq_u32 vcc, -1, v2
    s_cbranch_vccnz L_h1_rty10
    s_cmp_lt_u32 s49, 2
    s_cbranch_scc1 L_full
    v_accvgpr_write_b32 a168, 0
    v_accvgpr_write_b32 a169, 0
    v_accvgpr_write_b32 a170, 0
    v_accvgpr_write_b32 a171, 0
    v_accvgpr_write_b32 a172, 0
    v_accvgpr_write_b32 a173, 0
    v_accvgpr_write_b32 a174, 0
    v_accvgpr_write_b32 a175, 0
L_full:
    ds_read_b128 v[88:91], v123 offset:0
    ds_read_b128 v[92:95], v123 offset:32
    ds_read_b128 v[96:99], v123 offset:64
    ds_read_b128 v[100:103], v123 offset:96
    v_mfma_f32_32x32x16_bf16 v[44:59], a[164:167], v[128:131], v[44:59]
L_x1_chk:
    v_max_u32 v2, v4, v8
    v_cmp_eq_u32 vcc, -1, v2
    s_cbranch_vccnz L_x1_rty
    v_mfma_f32_32x32x16_bf16 v[44:59], a[172:175], v[80:83], v[44:59]
    v_lshlrev_b32 v104, 16, v4
    v_and_b32 v105, 0xffff0000, v4
    v_lshlrev_b32 v106, 16, v5
    v_and_b32 v107, 0xffff0000, v5
    v_mfma_f32_32x32x16_bf16 v[28:43], a[160:163], v[132:135], v[28:43]
    v_lshlrev_b32 v108, 16, v6
    v_and_b32 v109, 0xffff0000, v6
    v_lshlrev_b32 v110, 16, v7
    v_and_b32 v111, 0xffff0000, v7
    v_mfma_f32_32x32x16_bf16 v[28:43], a[168:171], v[84:87], v[28:43]
    v_lshlrev_b32 v112, 16, v8
    v_and_b32 v113, 0xffff0000, v8
    v_lshlrev_b32 v114, 16, v9
    v_and_b32 v115, 0xffff0000, v9
    v_mfma_f32_32x32x16_bf16 v[64:79], a[164:167], v[132:135], v[64:79]
    v_lshlrev_b32 v116, 16, v10
    v_and_b32 v117, 0xffff0000, v10
    v_lshlrev_b32 v118, 16, v11
    v_and_b32 v119, 0xffff0000, v11
    v_mfma_f32_32x32x16_bf16 v[64:79], a[172:175], v[84:87], v[64:79]
    v_mfma_f32_32x32x16_bf16 v[12:27], a[144:147], v[232:235], v[12:27]
    s_mul_i32 s3, s49, 12288
    v_add_u32 v120, s3, v3
    ds_write_b128 v125, v[44:47] offset:0
    ds_write_b128 v125, v[48:51] offset:1024
    ds_write_b128 v125, v[52:55] offset:2048
    ds_write_b128 v125, v[56:59] offset:3072
    v_mfma_f32_32x32x16_bf16 v[12:27], a[152:155], v[240:243], v[12:27]
    ds_write_b128 v126, v[28:31] offset:0
    ds_write_b128 v126, v[32:35] offset:1024
    ds_write_b128 v126, v[36:39] offset:2048
    ds_write_b128 v126, v[40:43] offset:3072
    v_mfma_f32_32x32x16_bf16 v[12:27], a[160:163], v[128:131], v[12:27]
    ds_write_b128 v127, v[64:67] offset:0
    ds_write_b128 v127, v[68:71] offset:1024
    ds_write_b128 v127, v[72:75] offset:2048
    ds_write_b128 v127, v[76:79] offset:3072
    v_mfma_f32_32x32x16_bf16 v[12:27], a[168:171], v[80:83], v[12:27]
    s_waitcnt lgkmcnt(0)
    s_barrier
    ds_read_b128 v[128:131], v120 offset:0
    ds_read_b128 v[144:147], v120 offset:4096
    ds_read_b128 v[160:163], v120 offset:8192
    ds_read_b128 v[132:135], v120 offset:1024
    ds_read_b128 v[148:151], v120 offset:5120
    ds_read_b128 v[164:167], v120 offset:9216
    ds_read_b128 v[136:139], v120 offset:2048
    ds_read_b128 v[152:155], v120 offset:6144
    ds_read_b128 v[168:171], v120 offset:10240
    ds_read_b128 v[140:143], v120 offset:3072
    ds_read_b128 v[156:159], v120 offset:7168
    ds_read_b128 v[172:175], v120 offset:11264
    s_waitcnt lgkmcnt(11)
    v_pk_add_f32 v[12:13], v[12:13], v[128:129]
    v_pk_add_f32 v[14:15], v[14:15], v[130:131]
    s_waitcnt lgkmcnt(10)
    v_pk_add_f32 v[12:13], v[12:13], v[144:145]
    v_pk_add_f32 v[14:15], v[14:15], v[146:147]
    s_waitcnt lgkmcnt(9)
    v_pk_add_f32 v[12:13], v[12:13], v[160:161]
    v_pk_add_f32 v[14:15], v[14:15], v[162:163]
    s_waitcnt lgkmcnt(8)
    v_pk_add_f32 v[16:17], v[16:17], v[132:133]
    v_pk_add_f32 v[18:19], v[18:19], v[134:135]
    s_waitcnt lgkmcnt(7)
    v_pk_add_f32 v[16:17], v[16:17], v[148:149]
    v_pk_add_f32 v[18:19], v[18:19], v[150:151]
    s_waitcnt lgkmcnt(6)
    v_pk_add_f32 v[16:17], v[16:17], v[164:165]
    v_pk_add_f32 v[18:19], v[18:19], v[166:167]
    v_pk_fma_f32 v[12:13], v[12:13], v[88:89], v[104:105]
    v_pk_fma_f32 v[14:15], v[14:15], v[90:91], v[106:107]
    v_pk_fma_f32 v[16:17], v[16:17], v[92:93], v[108:109]
    v_pk_fma_f32 v[18:19], v[18:19], v[94:95], v[110:111]
    v_cvt_pk_bf16_f32 v176, v12, v13
    v_cvt_pk_bf16_f32 v177, v14, v15
    v_cvt_pk_bf16_f32 v178, v16, v17
    v_cvt_pk_bf16_f32 v179, v18, v19
    s_nop 0
    v_permlane32_swap_b32 v176, v178
    v_permlane32_swap_b32 v177, v179
    buffer_store_dwordx4 v[176:179], v124, s[36:39], s92 offen offset:0
    s_waitcnt lgkmcnt(5)
    v_pk_add_f32 v[20:21], v[20:21], v[136:137]
    v_pk_add_f32 v[22:23], v[22:23], v[138:139]
    s_waitcnt lgkmcnt(4)
    v_pk_add_f32 v[20:21], v[20:21], v[152:153]
    v_pk_add_f32 v[22:23], v[22:23], v[154:155]
    s_waitcnt lgkmcnt(3)
    v_pk_add_f32 v[20:21], v[20:21], v[168:169]
    v_pk_add_f32 v[22:23], v[22:23], v[170:171]
    s_waitcnt lgkmcnt(2)
    v_pk_add_f32 v[24:25], v[24:25], v[140:141]
    v_pk_add_f32 v[26:27], v[26:27], v[142:143]
    s_waitcnt lgkmcnt(1)
    v_pk_add_f32 v[24:25], v[24:25], v[156:157]
    v_pk_add_f32 v[26:27], v[26:27], v[158:159]
    s_waitcnt lgkmcnt(0)
    v_pk_add_f32 v[24:25], v[24:25], v[172:173]
    v_pk_add_f32 v[26:27], v[26:27], v[174:175]
    v_pk_fma_f32 v[20:21], v[20:21], v[96:97], v[112:113]
    v_pk_fma_f32 v[22:23], v[22:23], v[98:99], v[114:115]
    v_pk_fma_f32 v[24:25], v[24:25], v[100:101], v[116:117]
    v_pk_fma_f32 v[26:27], v[26:27], v[102:103], v[118:119]
    v_cvt_pk_bf16_f32 v180, v20, v21
    v_cvt_pk_bf16_f32 v181, v22, v23
    v_cvt_pk_bf16_f32 v182, v24, v25
    v_cvt_pk_bf16_f32 v183, v26, v27
    s_nop 0
    v_permlane32_swap_b32 v180, v182
    v_permlane32_swap_b32 v181, v183
    buffer_store_dwordx4 v[180:183], v124, s[36:39], s92 offen offset:32
    s_endpgm
L_mod_dead:
    s_mov_b64 exec, 1
    v_mov_b32 v2, 2
    buffer_store_dword v2, off, s[40:43], 0 offset:8
    s_endpgm
L_lst1:
    buffer_store_dwordx4 v[16:19], v68, s[8:11], s19 offen sc1
    s_branch L_lse1
L_lst2:
    buffer_store_dwordx4 v[16:19], v68, s[8:11], s20 offen sc1
    s_branch L_lse2
L_lst3:
    buffer_store_dwordx4 v[16:19], v40, s[8:11], s21 offen sc1
    s_branch L_lse3
L_lst4:
    buffer_store_dwordx4 v[16:19], v40, s[8:11], s21 offen offset:1024 sc1
    s_branch L_lse4
L_lst5:
    buffer_store_dwordx4 v[16:19], v69, s[8:11], s22 offen offset:0 sc1
    s_branch L_lse5
L_lst6:
    buffer_store_dwordx4 v[16:19], v69, s[8:11], s22 offen offset:1024 sc1
    s_branch L_lse6
L_lst7:
    buffer_store_dwordx4 v[16:19], v69, s[8:11], s22 offen offset:2048 sc1
    s_branch L_lse7
L_lst8:
    buffer_store_dwordx4 v[16:19], v69, s[8:11], s22 offen offset:3072 sc1
    s_branch L_lse8
L_lst9:
    buffer_store_dwordx4 v[16:19], v69, s[8:11], s23 offen offset:0 sc1
    s_branch L_lse9
L_lst10:
    buffer_store_dwordx4 v[16:19], v69, s[8:11], s23 offen offset:1024 sc1
    s_branch L_lse10
L_z1_dead:
    s_mov_b64 exec, 1
    v_mov_b32 v2, 3
    buffer_store_dword v2, off, s[40:43], 0 offset:12
    s_endpgm
L_mn_rty:
    s_mov_b32 s51, 32768
    buffer_load_dwordx4 v[204:207], v4, s[8:11], s51 offen sc1
    s_mov_b32 s51, 36864
    buffer_load_dwordx4 v[208:211], v4, s[8:11], s51 offen sc1
    s_mov_b32 s51, 40960
    buffer_load_dwordx4 v[212:215], v4, s[8:11], s51 offen sc1
    s_mov_b32 s51, 45056
    buffer_load_dwordx4 v[216:219], v4, s[8:11], s51 offen sc1
    s_mov_b32 s51, 49152
    buffer_load_dwordx4 v[220:223], v4, s[8:11], s51 offen sc1
    s_mov_b32 s51, 53248
    buffer_load_dwordx4 v[224:227], v4, s[8:11], s51 offen sc1
    s_mov_b32 s51, 57344
    buffer_load_dwordx4 v[228:231], v4, s[8:11], s51 offen sc1
    s_mov_b32 s51, 61440
    buffer_load_dwordx4 v[232:235], v4, s[8:11], s51 offen sc1
    s_waitcnt vmcnt(0)
    s_add_u32 s50, s50, 1
    s_cmp_lt_u32 s50, 131072
    s_cbranch_scc1 L_mn_chk
    s_mov_b64 exec, 1
    v_mov_b32 v2, 8
    buffer_store_dword v2, off, s[40:43], 0 offset:32
    s_endpgm
L_y2_dead:
    s_mov_b64 exec, 1
    v_mov_b32 v2, 4
    buffer_store_dword v2, off, s[40:43], 0 offset:16
    s_endpgm
L_lst11:
    buffer_store_dwordx4 v[188:191], v68, s[8:11], s19 offen sc1
    s_branch L_lse11
L_lst12:
    buffer_store_dwordx4 v[192:195], v68, s[8:11], s20 offen sc1
    s_branch L_lse12
L_lst13:
    buffer_store_dwordx4 v[156:159], v53, s[8:11], s21 offen offset:0 sc1
    s_branch L_lse13
L_lst14:
    buffer_store_dwordx4 v[160:163], v53, s[8:11], s21 offen offset:1024 sc1
    s_branch L_lse14
L_lst15:
    buffer_store_dwordx4 v[4:7], v69, s[8:11], s22 offen offset:0 sc1
    s_branch L_lse15
L_lst16:
    buffer_store_dwordx4 v[8:11], v69, s[8:11], s22 offen offset:1024 sc1
    s_branch L_lse16
L_lst17:
    buffer_store_dwordx4 v[12:15], v69, s[8:11], s22 offen offset:2048 sc1
    s_branch L_lse17
L_lst18:
    buffer_store_dwordx4 v[16:19], v69, s[8:11], s22 offen offset:3072 sc1
    s_branch L_lse18
L_lst19:
    buffer_store_dwordx4 v[20:23], v69, s[8:11], s23 offen offset:0 sc1
    s_branch L_lse19
L_lst20:
    buffer_store_dwordx4 v[24:27], v69, s[8:11], s23 offen offset:1024 sc1
    s_branch L_lse20
L_lst21:
    buffer_store_dwordx4 v[4:7], v69, s[8:11], s22 offen offset:0 sc1
    s_branch L_lse21
L_lst22:
    buffer_store_dwordx4 v[8:11], v69, s[8:11], s22 offen offset:1024 sc1
    s_branch L_lse22
L_lst23:
    buffer_store_dwordx4 v[12:15], v69, s[8:11], s22 offen offset:2048 sc1
    s_branch L_lse23
L_lst24:
    buffer_store_dwordx4 v[16:19], v69, s[8:11], s22 offen offset:3072 sc1
    s_branch L_lse24
L_twoblk:
    s_nop 6
    v_exp_f32_e64 v224, -v160
    v_exp_f32_e64 v225, -v161
    v_exp_f32_e64 v226, -v162
    v_exp_f32_e64 v227, -v163
    v_exp_f32_e64 v228, -v164
    v_exp_f32_e64 v229, -v165
    v_exp_f32_e64 v230, -v166
    v_exp_f32_e64 v231, -v167
    v_pk_add_f32 v[224:225], v[224:225], 1.0 op_sel_hi:[1,0]
    v_pk_add_f32 v[226:227], v[226:227], 1.0 op_sel_hi:[1,0]
    v_pk_add_f32 v[228:229], v[228:229], 1.0 op_sel_hi:[1,0]
    v_pk_add_f32 v[230:231], v[230:231], 1.0 op_sel_hi:[1,0]
    v_rcp_f32 v224, v224
    v_rcp_f32 v225, v225
    v_rcp_f32 v226, v226
    v_rcp_f32 v227, v227
    v_rcp_f32 v228, v228
    v_rcp_f32 v229, v229
    v_rcp_f32 v230, v230
    v_rcp_f32 v231, v231
    v_pk_mul_f32 v[224:225], v[224:225], v[160:161]
    v_pk_mul_f32 v[226:227], v[226:227], v[162:163]
    v_pk_mul_f32 v[228:229], v[228:229], v[164:165]
    v_pk_mul_f32 v[230:231], v[230:231], v[166:167]
    v_cvt_pk_bf16_f32 v4, v224, v225
    v_cvt_pk_bf16_f32 v5, v226, v227
    v_cvt_pk_bf16_f32 v6, v228, v229
    v_cvt_pk_bf16_f32 v7, v230, v231
    v_min_u32 v4, -2, v4
    s_cmp_lg_u32 s45, 0
    s_cbranch_scc1 L_lst21
    buffer_store_dwordx4 v[4:7], v69, s[8:11], s22 offen offset:0
L_lse21:
    v_exp_f32_e64 v224, -v168
    v_exp_f32_e64 v225, -v169
    v_exp_f32_e64 v226, -v170
    v_exp_f32_e64 v227, -v171
    v_exp_f32_e64 v228, -v172
    v_exp_f32_e64 v229, -v173
    v_exp_f32_e64 v230, -v174
    v_exp_f32_e64 v231, -v175
    v_pk_add_f32 v[224:225], v[224:225], 1.0 op_sel_hi:[1,0]
    v_pk_add_f32 v[226:227], v[226:227], 1.0 op_sel_hi:[1,0]
    v_pk_add_f32 v[228:229], v[228:229], 1.0 op_sel_hi:[1,0]
    v_pk_add_f32 v[230:231], v[230:231], 1.0 op_sel_hi:[1,0]
    v_rcp_f32 v224, v224
    v_rcp_f32 v225, v225
    v_rcp_f32 v226, v226
    v_rcp_f32 v227, v227
    v_rcp_f32 v228, v228
    v_rcp_f32 v229, v229
    v_rcp_f32 v230, v230
    v_rcp_f32 v231, v231
    v_pk_mul_f32 v[224:225], v[224:225], v[168:169]
    v_pk_mul_f32 v[226:227], v[226:227], v[170:171]
    v_pk_mul_f32 v[228:229], v[228:229], v[172:173]
    v_pk_mul_f32 v[230:231], v[230:231], v[174:175]
    v_cvt_pk_bf16_f32 v8, v224, v225
    v_cvt_pk_bf16_f32 v9, v226, v227
    v_cvt_pk_bf16_f32 v10, v228, v229
    v_cvt_pk_bf16_f32 v11, v230, v231
    v_min_u32 v8, -2, v8
    s_cmp_lg_u32 s45, 0
    s_cbranch_scc1 L_lst22
    buffer_store_dwordx4 v[8:11], v69, s[8:11], s22 offen offset:1024
L_lse22:
    v_exp_f32_e64 v224, -v176
    v_exp_f32_e64 v225, -v177
    v_exp_f32_e64 v226, -v178
    v_exp_f32_e64 v227, -v179
    v_exp_f32_e64 v228, -v180
    v_exp_f32_e64 v229, -v181
    v_exp_f32_e64 v230, -v182
    v_exp_f32_e64 v231, -v183
    v_pk_add_f32 v[224:225], v[224:225], 1.0 op_sel_hi:[1,0]
    v_pk_add_f32 v[226:227], v[226:227], 1.0 op_sel_hi:[1,0]
    v_pk_add_f32 v[228:229], v[228:229], 1.0 op_sel_hi:[1,0]
    v_pk_add_f32 v[230:231], v[230:231], 1.0 op_sel_hi:[1,0]
    v_rcp_f32 v224, v224
    v_rcp_f32 v225, v225
    v_rcp_f32 v226, v226
    v_rcp_f32 v227, v227
    v_rcp_f32 v228, v228
    v_rcp_f32 v229, v229
    v_rcp_f32 v230, v230
    v_rcp_f32 v231, v231
    v_pk_mul_f32 v[224:225], v[224:225], v[176:177]
    v_pk_mul_f32 v[226:227], v[226:227], v[178:179]
    v_pk_mul_f32 v[228:229], v[228:229], v[180:181]
    v_pk_mul_f32 v[230:231], v[230:231], v[182:183]
    v_cvt_pk_bf16_f32 v12, v224, v225
    v_cvt_pk_bf16_f32 v13, v226, v227
    v_cvt_pk_bf16_f32 v14, v228, v229
    v_cvt_pk_bf16_f32 v15, v230, v231
    v_min_u32 v12, -2, v12
    s_cmp_lg_u32 s45, 0
    s_cbranch_scc1 L_lst23
    buffer_store_dwordx4 v[12:15], v69, s[8:11], s22 offen offset:2048
L_lse23:
    v_exp_f32_e64 v224, -v184
    v_exp_f32_e64 v225, -v185
    v_exp_f32_e64 v226, -v186
    v_exp_f32_e64 v227, -v187
    v_exp_f32_e64 v228, -v188
    v_exp_f32_e64 v229, -v189
    v_exp_f32_e64 v230, -v190
    v_exp_f32_e64 v231, -v191
    v_pk_add_f32 v[224:225], v[224:225], 1.0 op_sel_hi:[1,0]
    v_pk_add_f32 v[226:227], v[226:227], 1.0 op_sel_hi:[1,0]
    v_pk_add_f32 v[228:229], v[228:229], 1.0 op_sel_hi:[1,0]
    v_pk_add_f32 v[230:231], v[230:231], 1.0 op_sel_hi:[1,0]
    v_rcp_f32 v224, v224
    v_rcp_f32 v225, v225
    v_rcp_f32 v226, v226
    v_rcp_f32 v227, v227
    v_rcp_f32 v228, v228
    v_rcp_f32 v229, v229
    v_rcp_f32 v230, v230
    v_rcp_f32 v231, v231
    v_pk_mul_f32 v[224:225], v[224:225], v[184:185]
    v_pk_mul_f32 v[226:227], v[226:227], v[186:187]
    v_pk_mul_f32 v[228:229], v[228:229], v[188:189]
    v_pk_mul_f32 v[230:231], v[230:231], v[190:191]
    v_cvt_pk_bf16_f32 v16, v224, v225
    v_cvt_pk_bf16_f32 v17, v226, v227
    v_cvt_pk_bf16_f32 v18, v228, v229
    v_cvt_pk_bf16_f32 v19, v230, v231
    v_min_u32 v16, -2, v16
    s_cmp_lg_u32 s45, 0
    s_cbranch_scc1 L_lst24
    buffer_store_dwordx4 v[16:19], v69, s[8:11], s22 offen offset:3072
L_lse24:
    s_lshl_b32 s26, s7, 4
    buffer_load_dwordx4 a[24:27], v62, s[8:11], s26 offen sc1
    buffer_load_dwordx4 a[28:31], v63, s[8:11], s26 offen sc1
    s_lshl_b32 s26, s12, 4
    buffer_load_dwordx4 a[32:35], v62, s[8:11], s26 offen sc1
    buffer_load_dwordx4 a[36:39], v63, s[8:11], s26 offen sc1
    s_lshl_b32 s26, s13, 4
    buffer_load_dwordx4 a[40:43], v62, s[8:11], s26 offen sc1
    buffer_load_dwordx4 a[44:47], v63, s[8:11], s26 offen sc1
    s_lshl_b32 s26, s14, 4
    buffer_load_dwordx4 a[48:51], v62, s[8:11], s26 offen sc1
    buffer_load_dwordx4 a[52:55], v63, s[8:11], s26 offen sc1
    s_lshl_b32 s26, s15, 4
    buffer_load_dwordx4 a[56:59], v62, s[8:11], s26 offen sc1
    buffer_load_dwordx4 a[60:63], v63, s[8:11], s26 offen sc1
    s_lshl_b32 s26, s28, 4
    buffer_load_dwordx4 a[64:67], v62, s[8:11], s26 offen sc1
    buffer_load_dwordx4 a[68:71], v63, s[8:11], s26 offen sc1
    s_lshl_b32 s26, s29, 4
    buffer_load_dwordx4 a[72:75], v62, s[8:11], s26 offen sc1
    buffer_load_dwordx4 a[76:79], v63, s[8:11], s26 offen sc1
    s_lshl_b32 s26, s30, 4
    buffer_load_dwordx4 a[80:83], v62, s[8:11], s26 offen sc1
    buffer_load_dwordx4 a[84:87], v63, s[8:11], s26 offen sc1
    s_lshl_b32 s26, s31, 4
    buffer_load_dwordx4 a[88:91], v62, s[8:11], s26 offen sc1
    buffer_load_dwordx4 a[92:95], v63, s[8:11], s26 offen sc1
    s_lshl_b32 s26, s58, 4
    buffer_load_dwordx4 a[96:99], v62, s[8:11], s26 offen sc1
    buffer_load_dwordx4 a[100:103], v63, s[8:11], s26 offen sc1
    s_lshl_b32 s26, s59, 4
    buffer_load_dwordx4 a[104:107], v62, s[8:11], s26 offen sc1
    buffer_load_dwordx4 a[108:111], v63, s[8:11], s26 offen sc1
    s_lshl_b32 s26, s62, 4
    buffer_load_dwordx4 a[112:115], v62, s[8:11], s26 offen sc1
    s_waitcnt lgkmcnt(0)
    s_branch L_g1done
L_h2_rty0:
    buffer_load_dwordx4 v[4:7], v71, s[8:11], s80 offen offset:0 sc1
    buffer_load_dwordx4 v[8:11], v71, s[8:11], s80 offen offset:1024 sc1
    buffer_load_dwordx4 v[12:15], v71, s[8:11], s80 offen offset:2048 sc1
    buffer_load_dwordx4 v[16:19], v71, s[8:11], s80 offen offset:3072 sc1
    buffer_load_dwordx4 v[20:23], v71, s[8:11], s81 offen offset:0 sc1
    buffer_load_dwordx4 v[24:27], v71, s[8:11], s81 offen offset:1024 sc1
    buffer_load_dwordx4 v[28:31], v71, s[8:11], s81 offen offset:2048 sc1
    buffer_load_dwordx4 v[32:35], v71, s[8:11], s81 offen offset:3072 sc1
    s_waitcnt vmcnt(0)
    s_add_u32 s50, s50, 1
    s_cmp_lt_u32 s50, 131072
    s_cbranch_scc1 L_h2_chk0
    s_branch L_h2_dead
L_h2_rty1:
    buffer_load_dwordx4 v[20:23], v71, s[8:11], s81 offen offset:0 sc1
    buffer_load_dwordx4 v[24:27], v71, s[8:11], s81 offen offset:1024 sc1
    buffer_load_dwordx4 v[28:31], v71, s[8:11], s81 offen offset:2048 sc1
    buffer_load_dwordx4 v[32:35], v71, s[8:11], s81 offen offset:3072 sc1
    buffer_load_dwordx4 v[36:39], v71, s[8:11], s82 offen offset:0 sc1
    buffer_load_dwordx4 v[40:43], v71, s[8:11], s82 offen offset:1024 sc1
    buffer_load_dwordx4 v[44:47], v71, s[8:11], s82 offen offset:2048 sc1
    buffer_load_dwordx4 v[48:51], v71, s[8:11], s82 offen offset:3072 sc1
    s_waitcnt vmcnt(0)
    s_add_u32 s50, s50, 1
    s_cmp_lt_u32 s50, 131072
    s_cbranch_scc1 L_h2_chk1
    s_branch L_h2_dead
L_h2_rty2:
    buffer_load_dwordx4 v[36:39], v71, s[8:11], s82 offen offset:0 sc1
    buffer_load_dwordx4 v[40:43], v71, s[8:11], s82 offen offset:1024 sc1
    buffer_load_dwordx4 v[44:47], v71, s[8:11], s82 offen offset:2048 sc1
    buffer_load_dwordx4 v[48:51], v71, s[8:11], s82 offen offset:3072 sc1
    buffer_load_dwordx4 v[72:75], v71, s[8:11], s83 offen offset:0 sc1
    buffer_load_dwordx4 v[76:79], v71, s[8:11], s83 offen offset:1024 sc1
    buffer_load_dwordx4 v[80:83], v71, s[8:11], s83 offen offset:2048 sc1
    buffer_load_dwordx4 v[84:87], v71, s[8:11], s83 offen offset:3072 sc1
    s_waitcnt vmcnt(0)
    s_add_u32 s50, s50, 1
    s_cmp_lt_u32 s50, 131072
    s_cbranch_scc1 L_h2_chk2
    s_branch L_h2_dead
L_h2_rty3:
    buffer_load_dwordx4 v[72:75], v71, s[8:11], s83 offen offset:0 sc1
    buffer_load_dwordx4 v[76:79], v71, s[8:11], s83 offen offset:1024 sc1
    buffer_load_dwordx4 v[80:83], v71, s[8:11], s83 offen offset:2048 sc1
    buffer_load_dwordx4 v[84:87], v71, s[8:11], s83 offen offset:3072 sc1
    buffer_load_dwordx4 v[88:91], v71, s[8:11], s84 offen offset:0 sc1
    buffer_load_dwordx4 v[92:95], v71, s[8:11], s84 offen offset:1024 sc1
    buffer_load_dwordx4 v[96:99], v71, s[8:11], s84 offen offset:2048 sc1
    buffer_load_dwordx4 v[100:103], v71, s[8:11], s84 offen offset:3072 sc1
    s_waitcnt vmcnt(0)
    s_add_u32 s50, s50, 1
    s_cmp_lt_u32 s50, 131072
    s_cbranch_scc1 L_h2_chk3
    s_branch L_h2_dead
L_h2_rty4:
    buffer_load_dwordx4 v[88:91], v71, s[8:11], s84 offen offset:0 sc1
    buffer_load_dwordx4 v[92:95], v71, s[8:11], s84 offen offset:1024 sc1
    buffer_load_dwordx4 v[96:99], v71, s[8:11], s84 offen offset:2048 sc1
    buffer_load_dwordx4 v[100:103], v71, s[8:11], s84 offen offset:3072 sc1
    buffer_load_dwordx4 v[104:107], v71, s[8:11], s85 offen offset:0 sc1
    buffer_load_dwordx4 v[108:111], v71, s[8:11], s85 offen offset:1024 sc1
    buffer_load_dwordx4 v[112:115], v71, s[8:11], s85 offen offset:2048 sc1
    buffer_load_dwordx4 v[116:119], v71, s[8:11], s85 offen offset:3072 sc1
    s_waitcnt vmcnt(0)
    s_add_u32 s50, s50, 1
    s_cmp_lt_u32 s50, 131072
    s_cbranch_scc1 L_h2_chk4
    s_branch L_h2_dead
L_h2_rty5:
    buffer_load_dwordx4 v[104:107], v71, s[8:11], s85 offen offset:0 sc1
    buffer_load_dwordx4 v[108:111], v71, s[8:11], s85 offen offset:1024 sc1
    buffer_load_dwordx4 v[112:115], v71, s[8:11], s85 offen offset:2048 sc1
    buffer_load_dwordx4 v[116:119], v71, s[8:11], s85 offen offset:3072 sc1
    buffer_load_dwordx4 v[128:131], v71, s[8:11], s86 offen offset:0 sc1
    buffer_load_dwordx4 v[132:135], v71, s[8:11], s86 offen offset:1024 sc1
    buffer_load_dwordx4 v[136:139], v71, s[8:11], s86 offen offset:2048 sc1
    buffer_load_dwordx4 v[140:143], v71, s[8:11], s86 offen offset:3072 sc1
    s_waitcnt vmcnt(0)
    s_add_u32 s50, s50, 1
    s_cmp_lt_u32 s50, 131072
    s_cbranch_scc1 L_h2_chk5
    s_branch L_h2_dead
L_h2_rty6:
    buffer_load_dwordx4 v[128:131], v71, s[8:11], s86 offen offset:0 sc1
    buffer_load_dwordx4 v[132:135], v71, s[8:11], s86 offen offset:1024 sc1
    buffer_load_dwordx4 v[136:139], v71, s[8:11], s86 offen offset:2048 sc1
    buffer_load_dwordx4 v[140:143], v71, s[8:11], s86 offen offset:3072 sc1
    buffer_load_dwordx4 v[144:147], v71, s[8:11], s87 offen offset:0 sc1
    buffer_load_dwordx4 v[148:151], v71, s[8:11], s87 offen offset:1024 sc1
    buffer_load_dwordx4 v[152:155], v71, s[8:11], s87 offen offset:2048 sc1
    buffer_load_dwordx4 v[156:159], v71, s[8:11], s87 offen offset:3072 sc1
    s_waitcnt vmcnt(0)
    s_add_u32 s50, s50, 1
    s_cmp_lt_u32 s50, 131072
    s_cbranch_scc1 L_h2_chk6
    s_branch L_h2_dead
L_h2_rty7:
    buffer_load_dwordx4 v[144:147], v71, s[8:11], s87 offen offset:0 sc1
    buffer_load_dwordx4 v[148:151], v71, s[8:11], s87 offen offset:1024 sc1
    buffer_load_dwordx4 v[152:155], v71, s[8:11], s87 offen offset:2048 sc1
    buffer_load_dwordx4 v[156:159], v71, s[8:11], s87 offen offset:3072 sc1
    s_waitcnt vmcnt(0)
    s_add_u32 s50, s50, 1
    s_cmp_lt_u32 s50, 131072
    s_cbranch_scc1 L_h2_chk7
    s_branch L_h2_dead
L_h2_dead:
    s_mov_b64 exec, 1
    v_mov_b32 v2, 5
    buffer_store_dword v2, off, s[40:43], 0 offset:20
    s_endpgm
L_x1_rty:
    buffer_load_dwordx4 v[4:7], v122, s[8:11], s91 offen offset:0 sc1
    buffer_load_dwordx4 v[8:11], v122, s[8:11], s91 offen offset:32 sc1
    s_waitcnt vmcnt(0)
    s_add_u32 s50, s50, 1
    s_cmp_lt_u32 s50, 131072
    s_cbranch_scc1 L_x1_chk
    s_mov_b64 exec, 1
    v_mov_b32 v2, 7
    buffer_store_dword v2, off, s[40:43], 0 offset:28
    s_endpgm
L_h1_rty0:
    buffer_load_dwordx4 v[80:83], v120, s[8:11], s4 offen sc1
    buffer_load_dwordx4 v[84:87], v121, s[8:11], s4 offen sc1
    buffer_load_dwordx4 v[88:91], v120, s[8:11], s5 offen sc1
    buffer_load_dwordx4 v[92:95], v121, s[8:11], s5 offen sc1
    buffer_load_dwordx4 v[96:99], v120, s[8:11], s6 offen sc1
    buffer_load_dwordx4 v[100:103], v121, s[8:11], s6 offen sc1
    buffer_load_dwordx4 v[104:107], v120, s[8:11], s7 offen sc1
    buffer_load_dwordx4 v[108:111], v121, s[8:11], s7 offen sc1
    s_waitcnt vmcnt(0)
    s_add_u32 s50, s50, 1
    s_cmp_lt_u32 s50, 131072
    s_cbranch_scc1 L_h1_chk0
    s_branch L_h1_dead
L_h1_rty1:
    buffer_load_dwordx4 v[96:99], v120, s[8:11], s6 offen sc1
    buffer_load_dwordx4 v[100:103], v121, s[8:11], s6 offen sc1
    buffer_load_dwordx4 v[104:107], v120, s[8:11], s7 offen sc1
    buffer_load_dwordx4 v[108:111], v121, s[8:11], s7 offen sc1
    buffer_load_dwordx4 v[112:115], v120, s[8:11], s12 offen sc1
    buffer_load_dwordx4 v[116:119], v121, s[8:11], s12 offen sc1
    buffer_load_dwordx4 v[128:131], v120, s[8:11], s13 offen sc1
    buffer_load_dwordx4 v[132:135], v121, s[8:11], s13 offen sc1
    buffer_load_dwordx4 v[136:139], v120, s[8:11], s14 offen sc1
    buffer_load_dwordx4 v[140:143], v121, s[8:11], s14 offen sc1
    buffer_load_dwordx4 v[144:147], v120, s[8:11], s15 offen sc1
    s_waitcnt vmcnt(0)
    s_add_u32 s50, s50, 1
    s_cmp_lt_u32 s50, 131072
    s_cbranch_scc1 L_h1_chk1
    s_branch L_h1_dead
L_h1_rty2:
    buffer_load_dwordx4 v[112:115], v120, s[8:11], s12 offen sc1
    buffer_load_dwordx4 v[116:119], v121, s[8:11], s12 offen sc1
    buffer_load_dwordx4 v[128:131], v120, s[8:11], s13 offen sc1
    buffer_load_dwordx4 v[132:135], v121, s[8:11], s13 offen sc1
    buffer_load_dwordx4 v[136:139], v120, s[8:11], s14 offen sc1
    buffer_load_dwordx4 v[140:143], v121, s[8:11], s14 offen sc1
    buffer_load_dwordx4 v[144:147], v120, s[8:11], s15 offen sc1
    buffer_load_dwordx4 v[148:151], v121, s[8:11], s15 offen sc1
    buffer_load_dwordx4 v[152:155], v120, s[8:11], s28 offen sc1
    buffer_load_dwordx4 v[156:159], v121, s[8:11], s28 offen sc1
    buffer_load_dwordx4 v[160:163], v120, s[8:11], s29 offen sc1
    buffer_load_dwordx4 v[164:167], v121, s[8:11], s29 offen sc1
    buffer_load_dwordx4 v[168:171], v120, s[8:11], s30 offen sc1
    buffer_load_dwordx4 v[172:175], v121, s[8:11], s30 offen sc1
    s_waitcnt vmcnt(0)
    s_add_u32 s50, s50, 1
    s_cmp_lt_u32 s50, 131072
    s_cbranch_scc1 L_h1_chk2
    s_branch L_h1_dead
L_h1_rty3:
    buffer_load_dwordx4 v[136:139], v120, s[8:11], s14 offen sc1
    buffer_load_dwordx4 v[140:143], v121, s[8:11], s14 offen sc1
    buffer_load_dwordx4 v[144:147], v120, s[8:11], s15 offen sc1
    buffer_load_dwordx4 v[148:151], v121, s[8:11], s15 offen sc1
    buffer_load_dwordx4 v[152:155], v120, s[8:11], s28 offen sc1
    buffer_load_dwordx4 v[156:159], v121, s[8:11], s28 offen sc1
    buffer_load_dwordx4 v[160:163], v120, s[8:11], s29 offen sc1
    buffer_load_dwordx4 v[164:167], v121, s[8:11], s29 offen sc1
    buffer_load_dwordx4 v[168:171], v120, s[8:11], s30 offen sc1
    buffer_load_dwordx4 v[172:175], v121, s[8:11], s30 offen sc1
    buffer_load_dwordx4 v[176:179], v120, s[8:11], s31 offen sc1
    buffer_load_dwordx4 v[180:183], v121, s[8:11], s31 offen sc1
    buffer_load_dwordx4 v[184:187], v120, s[8:11], s58 offen sc1
    buffer_load_dwordx4 v[188:191], v121, s[8:11], s58 offen sc1
    s_waitcnt vmcnt(0)
    s_add_u32 s50, s50, 1
    s_cmp_lt_u32 s50, 131072
    s_cbranch_scc1 L_h1_chk3
    s_branch L_h1_dead
L_h1_rty4:
    buffer_load_dwordx4 v[152:155], v120, s[8:11], s28 offen sc1
    buffer_load_dwordx4 v[156:159], v121, s[8:11], s28 offen sc1
    buffer_load_dwordx4 v[160:163], v120, s[8:11], s29 offen sc1
    buffer_load_dwordx4 v[164:167], v121, s[8:11], s29 offen sc1
    buffer_load_dwordx4 v[168:171], v120, s[8:11], s30 offen sc1
    buffer_load_dwordx4 v[172:175], v121, s[8:11], s30 offen sc1
    buffer_load_dwordx4 v[176:179], v120, s[8:11], s31 offen sc1
    buffer_load_dwordx4 v[180:183], v121, s[8:11], s31 offen sc1
    buffer_load_dwordx4 v[184:187], v120, s[8:11], s58 offen sc1
    buffer_load_dwordx4 v[188:191], v121, s[8:11], s58 offen sc1
    buffer_load_dwordx4 v[192:195], v120, s[8:11], s59 offen sc1
    buffer_load_dwordx4 v[196:199], v121, s[8:11], s59 offen sc1
    buffer_load_dwordx4 v[200:203], v120, s[8:11], s62 offen sc1
    buffer_load_dwordx4 v[204:207], v121, s[8:11], s62 offen sc1
    s_waitcnt vmcnt(0)
    s_add_u32 s50, s50, 1
    s_cmp_lt_u32 s50, 131072
    s_cbranch_scc1 L_h1_chk4
    s_branch L_h1_dead
L_h1_rty5:
    buffer_load_dwordx4 v[168:171], v120, s[8:11], s30 offen sc1
    buffer_load_dwordx4 v[172:175], v121, s[8:11], s30 offen sc1
    buffer_load_dwordx4 v[176:179], v120, s[8:11], s31 offen sc1
    buffer_load_dwordx4 v[180:183], v121, s[8:11], s31 offen sc1
    buffer_load_dwordx4 v[184:187], v120, s[8:11], s58 offen sc1
    buffer_load_dwordx4 v[188:191], v121, s[8:11], s58 offen sc1
    buffer_load_dwordx4 v[192:195], v120, s[8:11], s59 offen sc1
    buffer_load_dwordx4 v[196:199], v121, s[8:11], s59 offen sc1
    buffer_load_dwordx4 v[200:203], v120, s[8:11], s62 offen sc1
    buffer_load_dwordx4 v[204:207], v121, s[8:11], s62 offen sc1
    buffer_load_dwordx4 v[208:211], v120, s[8:11], s63 offen sc1
    buffer_load_dwordx4 v[212:215], v121, s[8:11], s63 offen sc1
    buffer_load_dwordx4 v[216:219], v120, s[8:11], s64 offen sc1
    buffer_load_dwordx4 v[220:223], v121, s[8:11], s64 offen sc1
    s_waitcnt vmcnt(0)
    s_add_u32 s50, s50, 1
    s_cmp_lt_u32 s50, 131072
    s_cbranch_scc1 L_h1_chk5
    s_branch L_h1_dead
L_h1_rty6:
    buffer_load_dwordx4 v[184:187], v120, s[8:11], s58 offen sc1
    buffer_load_dwordx4 v[188:191], v121, s[8:11], s58 offen sc1
    buffer_load_dwordx4 v[192:195], v120, s[8:11], s59 offen sc1
    buffer_load_dwordx4 v[196:199], v121, s[8:11], s59 offen sc1
    buffer_load_dwordx4 v[200:203], v120, s[8:11], s62 offen sc1
    buffer_load_dwordx4 v[204:207], v121, s[8:11], s62 offen sc1
    buffer_load_dwordx4 v[208:211], v120, s[8:11], s63 offen sc1
    buffer_load_dwordx4 v[212:215], v121, s[8:11], s63 offen sc1
    buffer_load_dwordx4 v[216:219], v120, s[8:11], s64 offen sc1
    buffer_load_dwordx4 v[220:223], v121, s[8:11], s64 offen sc1
    buffer_load_dwordx4 v[224:227], v120, s[8:11], s65 offen sc1
    buffer_load_dwordx4 v[228:231], v121, s[8:11], s65 offen sc1
    buffer_load_dwordx4 v[232:235], v120, s[8:11], s66 offen sc1
    buffer_load_dwordx4 v[236:239], v121, s[8:11], s66 offen sc1
    s_waitcnt vmcnt(0)
    s_add_u32 s50, s50, 1
    s_cmp_lt_u32 s50, 131072
    s_cbranch_scc1 L_h1_chk6
    s_branch L_h1_dead
L_h1_rty7:
    buffer_load_dwordx4 v[200:203], v120, s[8:11], s62 offen sc1
    buffer_load_dwordx4 v[204:207], v121, s[8:11], s62 offen sc1
    buffer_load_dwordx4 v[208:211], v120, s[8:11], s63 offen sc1
    buffer_load_dwordx4 v[212:215], v121, s[8:11], s63 offen sc1
    buffer_load_dwordx4 v[216:219], v120, s[8:11], s64 offen sc1
    buffer_load_dwordx4 v[220:223], v121, s[8:11], s64 offen sc1
    buffer_load_dwordx4 v[224:227], v120, s[8:11], s65 offen sc1
    buffer_load_dwordx4 v[228:231], v121, s[8:11], s65 offen sc1
    buffer_load_dwordx4 v[232:235], v120, s[8:11], s66 offen sc1
    buffer_load_dwordx4 v[236:239], v121, s[8:11], s66 offen sc1
    buffer_load_dwordx4 v[240:243], v120, s[8:11], s67 offen sc1
    buffer_load_dwordx4 v[244:247], v121, s[8:11], s67 offen sc1
    buffer_load_dwordx4 v[128:131], v120, s[8:11], s68 offen sc1
    buffer_load_dwordx4 v[132:135], v121, s[8:11], s68 offen sc1
    s_waitcnt vmcnt(0)
    s_add_u32 s50, s50, 1
    s_cmp_lt_u32 s50, 131072
    s_cbranch_scc1 L_h1_chk7
    s_branch L_h1_dead
L_h1_rty8:
    buffer_load_dwordx4 v[216:219], v120, s[8:11], s64 offen sc1
    buffer_load_dwordx4 v[220:223], v121, s[8:11], s64 offen sc1
    buffer_load_dwordx4 v[224:227], v120, s[8:11], s65 offen sc1
    buffer_load_dwordx4 v[228:231], v121, s[8:11], s65 offen sc1
    buffer_load_dwordx4 v[232:235], v120, s[8:11], s66 offen sc1
    buffer_load_dwordx4 v[236:239], v121, s[8:11], s66 offen sc1
    buffer_load_dwordx4 v[240:243], v120, s[8:11], s67 offen sc1
    buffer_load_dwordx4 v[244:247], v121, s[8:11], s67 offen sc1
    buffer_load_dwordx4 v[128:131], v120, s[8:11], s68 offen sc1
    buffer_load_dwordx4 v[132:135], v121, s[8:11], s68 offen sc1
    buffer_load_dwordx4 v[80:83], v120, s[8:11], s69 offen sc1
    buffer_load_dwordx4 v[84:87], v121, s[8:11], s69 offen sc1
    s_waitcnt vmcnt(0)
    s_add_u32 s50, s50, 1
    s_cmp_lt_u32 s50, 131072
    s_cbranch_scc1 L_h1_chk8
    s_branch L_h1_dead
L_h1_rty9:
    buffer_load_dwordx4 v[232:235], v120, s[8:11], s66 offen sc1
    buffer_load_dwordx4 v[236:239], v121, s[8:11], s66 offen sc1
    buffer_load_dwordx4 v[240:243], v120, s[8:11], s67 offen sc1
    buffer_load_dwordx4 v[244:247], v121, s[8:11], s67 offen sc1
    buffer_load_dwordx4 v[128:131], v120, s[8:11], s68 offen sc1
    buffer_load_dwordx4 v[132:135], v121, s[8:11], s68 offen sc1
    buffer_load_dwordx4 v[80:83], v120, s[8:11], s69 offen sc1
    buffer_load_dwordx4 v[84:87], v121, s[8:11], s69 offen sc1
    s_waitcnt vmcnt(0)
    s_add_u32 s50, s50, 1
    s_cmp_lt_u32 s50, 131072
    s_cbranch_scc1 L_h1_chk9
    s_branch L_h1_dead
L_h1_rty10:
    buffer_load_dwordx4 v[128:131], v120, s[8:11], s68 offen sc1
    buffer_load_dwordx4 v[132:135], v121, s[8:11], s68 offen sc1
    buffer_load_dwordx4 v[80:83], v120, s[8:11], s69 offen sc1
    buffer_load_dwordx4 v[84:87], v121, s[8:11], s69 offen sc1
    s_waitcnt vmcnt(0)
    s_add_u32 s50, s50, 1
    s_cmp_lt_u32 s50, 131072
    s_cbranch_scc1 L_h1_chk10
    s_branch L_h1_dead
L_h1_dead:
    s_mov_b64 exec, 1
    v_mov_b32 v2, 6
    buffer_store_dword v2, off, s[40:43], 0 offset:24
    s_endpgm
L_exit:
    s_endpgm
.p2align 8
.type L_tabc,@object
L_tabc:
.quad 0x3f803f803f803f80,0x3f803f803f803f80,0x3f553f6d3f7b3f80,0x3e483ec43f0e3f35
.quad 0x3ec43f353f6d3f80,0xbf6dbf35bec40000,0xbe483ec43f553f80,0xbf0ebf6dbf7bbf35
.quad 0xbf3500003f353f80,0x3f350000bf35bf80,0xbf7bbec43f0e3f80,0x3f553f6d3e48bf35
.quad 0xbf6dbf353ec43f80,0xbec43f353f6d0000,0xbf0ebf6d3e483f80,0xbf7bbec43f553f35
.quad 0xbf8000003f80,0xbf8000003f80,0x3f0ebf6dbe483f80,0x3f7bbec4bf553f35
.quad 0x3f6dbf35bec43f80,0x3ec43f35bf6d0000,0x3f7bbec4bf0e3f80,0xbf553f6dbe48bf35
.quad 0x3f350000bf353f80,0xbf3500003f35bf80,0x3e483ec4bf553f80,0x3f0ebf6d3f7bbf35
.quad 0xbec43f35bf6d3f80,0x3f6dbf353ec40000,0xbf553f6dbf7b3f80,0xbe483ec4bf0e3f35
.quad 0xbf803f80bf803f80,0xbf803f80bf803f80,0xbf553f6dbf7b3f80,0xbe483ec4bf0e3f35
.quad 0xbec43f35bf6d3f80,0x3f6dbf353ec40000,0x3e483ec4bf553f80,0x3f0ebf6d3f7bbf35
.quad 0x3f350000bf353f80,0xbf3500003f35bf80,0x3f7bbec4bf0e3f80,0xbf553f6dbe48bf35
.quad 0x3f6dbf35bec43f80,0x3ec43f35bf6d0000,0x3f0ebf6dbe483f80,0x3f7bbec4bf553f35
.quad 0xbf8000003f80,0xbf8000003f80,0xbf0ebf6d3e483f80,0xbf7bbec43f553f35
.quad 0xbf6dbf353ec43f80,0xbec43f353f6d0000,0xbf7bbec43f0e3f80,0x3f553f6d3e48bf35
.quad 0xbf3500003f353f80,0x3f350000bf35bf80,0xbe483ec43f553f80,0xbf0ebf6dbf7bbf35
.quad 0x3ec43f353f6d3f80,0xbf6dbf35bec40000,0x3f553f6d3f7b3f80,0x3e483ec43f0e3f35
.quad 0x3f803f803f803f80,0x3f803f803f803f80,0xbf0ebec4be480000,0xbf7bbf6dbf55bf35
.quad 0xbec4bf35bf6dbf80,0x3f6d3f353ec40000,0x3f7b3f6d3f0e0000,0xbf55bec43e483f35
.quad 0xbf3500003f353f80,0x3f350000bf35bf80,0xbe48bf6dbf550000,0xbf0e3ec43f7b3f35
.quad 0x3f6d3f35bec4bf80,0x3ec4bf35bf6d0000,0xbf553ec43f7b0000,0xbe483f6d3f0ebf35
.quad 0xbf8000003f80,0xbf8000003f80,0x3f553ec4bf7b0000,0x3e483f6dbf0ebf35
.quad 0xbf6d3f353ec4bf80,0xbec4bf353f6d0000,0x3e48bf6d3f550000,0x3f0e3ec4bf7b3f35
.quad 0x3f350000bf353f80,0xbf3500003f35bf80,0xbf7b3f6dbf0e0000,0x3f55bec4be483f35
.quad 0x3ec4bf353f6dbf80,0xbf6d3f35bec40000,0x3f0ebec43e480000,0x3f7bbf6d3f55bf35
.quad 0xbf803f80bf803f80,0xbf803f80bf803f80,0x3f0ebec43e480000,0x3f7bbf6d3f55bf35
.quad 0x3ec4bf353f6dbf80,0xbf6d3f35bec40000,0xbf7b3f6dbf0e0000,0x3f55bec4be483f35
.quad 0x3f350000bf353f80,0xbf3500003f35bf80,0x3e48bf6d3f550000,0x3f0e3ec4bf7b3f35
.quad 0xbf6d3f353ec4bf80,0xbec4bf353f6d0000,0x3f553ec4bf7b0000,0x3e483f6dbf0ebf35
.quad 0xbf8000003f80,0xbf8000003f80,0xbf553ec43f7b0000,0xbe483f6d3f0ebf35
.quad 0x3f6d3f35bec4bf80,0x3ec4bf35bf6d0000,0xbe48bf6dbf550000,0xbf0e3ec43f7b3f35
.quad 0xbf3500003f353f80,0x3f350000bf35bf80,0x3f7b3f6d3f0e0000,0xbf55bec43e483f35
.quad 0xbec4bf35bf6dbf80,0x3f6d3f353ec40000,0xbf0ebec4be480000,0xbf7bbf6dbf55bf35
.quad 0x3f803f803f803f80,0x3f803f803f803f80,0xbf55bf6dbf7bbf80,0xbe48bec4bf0ebf35
.quad 0x3ec43f353f6d3f80,0xbf6dbf35bec40000,0x3e48bec4bf55bf80,0x3f0e3f6d3f7b3f35
.quad 0xbf3500003f353f80,0x3f350000bf35bf80,0x3f7b3ec4bf0ebf80,0xbf55bf6dbe483f35
.quad 0xbf6dbf353ec43f80,0xbec43f353f6d0000,0x3f0e3f6dbe48bf80,0x3f7b3ec4bf55bf35
.quad 0xbf8000003f80,0xbf8000003f80,0xbf0e3f6d3e48bf80,0xbf7b3ec43f55bf35
.quad 0x3f6dbf35bec43f80,0x3ec43f35bf6d0000,0xbf7b3ec43f0ebf80,0x3f55bf6d3e483f35
.quad 0x3f350000bf353f80,0xbf3500003f35bf80,0xbe48bec43f55bf80,0xbf0e3f6dbf7b3f35
.quad 0xbec43f35bf6d3f80,0x3f6dbf353ec40000,0x3f55bf6d3f7bbf80,0x3e48bec43f0ebf35
.quad 0xbf803f80bf803f80,0xbf803f80bf803f80,0x3f55bf6d3f7bbf80,0x3e48bec43f0ebf35
.quad 0xbec43f35bf6d3f80,0x3f6dbf353ec40000,0xbe48bec43f55bf80,0xbf0e3f6dbf7b3f35
.quad 0x3f350000bf353f80,0xbf3500003f35bf80,0xbf7b3ec43f0ebf80,0x3f55bf6d3e483f35
.quad 0x3f6dbf35bec43f80,0x3ec43f35bf6d0000,0xbf0e3f6d3e48bf80,0xbf7b3ec43f55bf35
.quad 0xbf8000003f80,0xbf8000003f80,0x3f0e3f6dbe48bf80,0x3f7b3ec4bf55bf35
.quad 0xbf6dbf353ec43f80,0xbec43f353f6d0000,0x3f7b3ec4bf0ebf80,0xbf55bf6dbe483f35
.quad 0xbf3500003f353f80,0x3f350000bf35bf80,0x3e48bec4bf55bf80,0x3f0e3f6d3f7b3f35
.quad 0x3ec43f353f6d3f80,0xbf6dbf35bec40000,0xbf55bf6dbf7bbf80,0xbe48bec4bf0ebf35
.quad 0x3f803f803f803f80,0x3f803f803f803f80,0x3f0e3ec43e480000,0x3f7b3f6d3f553f35
.quad 0xbec4bf35bf6dbf80,0x3f6d3f353ec40000,0xbf7bbf6dbf0e0000,0x3f553ec4be48bf35
.quad 0xbf3500003f353f80,0x3f350000bf35bf80,0x3e483f6d3f550000,0x3f0ebec4bf7bbf35
.quad 0x3f6d3f35bec4bf80,0x3ec4bf35bf6d0000,0x3f55bec4bf7b0000,0x3e48bf6dbf0e3f35
.quad 0xbf8000003f80,0xbf8000003f80,0xbf55bec43f7b0000,0xbe48bf6d3f0e3f35
.quad 0xbf6d3f353ec4bf80,0xbec4bf353f6d0000,0xbe483f6dbf550000,0xbf0ebec43f7bbf35
.quad 0x3f350000bf353f80,0xbf3500003f35bf80,0x3f7bbf6d3f0e0000,0xbf553ec43e48bf35
.quad 0x3ec4bf353f6dbf80,0xbf6d3f35bec40000,0xbf0e3ec4be480000,0xbf7b3f6dbf553f35
.quad 0xbf803f80bf803f80,0xbf803f80bf803f80,0xbf0e3ec4be480000,0xbf7b3f6dbf553f35
.quad 0x3ec4bf353f6dbf80,0xbf6d3f35bec40000,0x3f7bbf6d3f0e0000,0xbf553ec43e48bf35
.quad 0x3f350000bf353f80,0xbf3500003f35bf80,0xbe483f6dbf550000,0xbf0ebec43f7bbf35
.quad 0xbf6d3f353ec4bf80,0xbec4bf353f6d0000,0xbf55bec43f7b0000,0xbe48bf6d3f0e3f35
.quad 0xbf8000003f80,0xbf8000003f80,0x3f55bec4bf7b0000,0x3e48bf6dbf0e3f35
.quad 0x3f6d3f35bec4bf80,0x3ec4bf35bf6d0000,0x3e483f6d3f550000,0x3f0ebec4bf7bbf35
.quad 0xbf3500003f353f80,0x3f350000bf35bf80,0xbf7bbf6dbf0e0000,0x3f553ec4be48bf35
.quad 0xbec4bf35bf6dbf80,0x3f6d3f353ec40000,0x3f0e3ec43e480000,0x3f7b3f6d3f553f35
.quad 0x8000800080008000,0x8000800080008000,0xbf0ebec4be488000,0xbf7bbf6dbf55bf35
.quad 0xbf6dbf35bec48000,0xbec4bf35bf6dbf80,0xbf7bbf6dbf0e8000,0x3f553ec4be48bf35
.quad 0xbf35bf80bf358000,0x3f353f803f358000,0xbe48bf6dbf558000,0xbf0e3ec43f7b3f35
.quad 0x3ec4bf35bf6d8000,0xbf6dbf353ec43f80,0x3f55bec4bf7b8000,0x3e48bf6dbf0e3f35
.quad 0x3f808000bf808000,0x3f808000bf808000,0x3f553ec4bf7b8000,0x3e483f6dbf0ebf35
.quad 0x3ec43f35bf6d8000,0xbf6d3f353ec4bf80,0xbe483f6dbf558000,0xbf0ebec43f7bbf35
.quad 0xbf353f80bf358000,0x3f35bf803f358000,0xbf7b3f6dbf0e8000,0x3f55bec4be483f35
.quad 0xbf6d3f35bec48000,0xbec43f35bf6d3f80,0xbf0e3ec4be488000,0xbf7b3f6dbf553f35
.quad 0x8000800080008000,0x8000800080008000,0x3f0ebec43e488000,0x3f7bbf6d3f55bf35
.quad 0x3f6dbf353ec48000,0x3ec4bf353f6dbf80,0x3f7bbf6d3f0e8000,0xbf553ec43e48bf35
.quad 0x3f35bf803f358000,0xbf353f80bf358000,0x3e48bf6d3f558000,0x3f0e3ec4bf7b3f35
.quad 0xbec4bf353f6d8000,0x3f6dbf35bec43f80,0xbf55bec43f7b8000,0xbe48bf6d3f0e3f35
.quad 0xbf8080003f808000,0xbf8080003f808000,0xbf553ec43f7b8000,0xbe483f6d3f0ebf35
.quad 0xbec43f353f6d8000,0x3f6d3f35bec4bf80,0x3e483f6d3f558000,0x3f0ebec4bf7bbf35
.quad 0x3f353f803f358000,0xbf35bf80bf358000,0x3f7b3f6d3f0e8000,0xbf55bec43e483f35
.quad 0x3f6d3f353ec48000,0x3ec43f353f6d3f80,0x3f0e3ec43e488000,0x3f7b3f6d3f553f35
.quad 0x8000800080008000,0x8000800080008000,0xbf55bf6dbf7bbf80,0xbe48bec4bf0ebf35
.quad 0x3f6d3f353ec48000,0x3ec43f353f6d3f80,0xbe483ec43f553f80,0xbf0ebf6dbf7bbf35
.quad 0xbf35bf80bf358000,0x3f353f803f358000,0x3f7b3ec4bf0ebf80,0xbf55bf6dbe483f35
.quad 0xbec43f353f6d8000,0x3f6d3f35bec4bf80,0xbf0ebf6d3e483f80,0xbf7bbec43f553f35
.quad 0x3f808000bf808000,0x3f808000bf808000,0xbf0e3f6d3e48bf80,0xbf7b3ec43f55bf35
.quad 0xbec4bf353f6d8000,0x3f6dbf35bec43f80,0x3f7bbec4bf0e3f80,0xbf553f6dbe48bf35
.quad 0xbf353f80bf358000,0x3f35bf803f358000,0xbe48bec43f55bf80,0xbf0e3f6dbf7b3f35
.quad 0x3f6dbf353ec48000,0x3ec4bf353f6dbf80,0xbf553f6dbf7b3f80,0xbe483ec4bf0e3f35
.quad 0x8000800080008000,0x8000800080008000,0x3f55bf6d3f7bbf80,0x3e48bec43f0ebf35
.quad 0xbf6d3f35bec48000,0xbec43f35bf6d3f80,0x3e483ec4bf553f80,0x3f0ebf6d3f7bbf35
.quad 0x3f35bf803f358000,0xbf353f80bf358000,0xbf7b3ec43f0ebf80,0x3f55bf6d3e483f35
.quad 0x3ec43f35bf6d8000,0xbf6d3f353ec4bf80,0x3f0ebf6dbe483f80,0x3f7bbec4bf553f35
.quad 0xbf8080003f808000,0xbf8080003f808000,0x3f0e3f6dbe48bf80,0x3f7b3ec4bf55bf35
.quad 0x3ec4bf35bf6d8000,0xbf6dbf353ec43f80,0xbf7bbec43f0e3f80,0x3f553f6d3e48bf35
.quad 0x3f353f803f358000,0xbf35bf80bf358000,0x3e48bec4bf55bf80,0x3f0e3f6d3f7b3f35
.quad 0xbf6dbf35bec48000,0xbec4bf35bf6dbf80,0x3f553f6d3f7b3f80,0x3e483ec43f0e3f35
.quad 0x8000800080008000,0x8000800080008000,0x3f0e3ec43e488000,0x3f7b3f6d3f553f35
.quad 0xbf6dbf35bec48000,0xbec4bf35bf6dbf80,0x3f7b3f6d3f0e8000,0xbf55bec43e483f35
.quad 0xbf35bf80bf358000,0x3f353f803f358000,0x3e483f6d3f558000,0x3f0ebec4bf7bbf35
.quad 0x3ec4bf35bf6d8000,0xbf6dbf353ec43f80,0xbf553ec43f7b8000,0xbe483f6d3f0ebf35
.quad 0x3f808000bf808000,0x3f808000bf808000,0xbf55bec43f7b8000,0xbe48bf6d3f0e3f35
.quad 0x3ec43f35bf6d8000,0xbf6d3f353ec4bf80,0x3e48bf6d3f558000,0x3f0e3ec4bf7b3f35
.quad 0xbf353f80bf358000,0x3f35bf803f358000,0x3f7bbf6d3f0e8000,0xbf553ec43e48bf35
.quad 0xbf6d3f35bec48000,0xbec43f35bf6d3f80,0x3f0ebec43e488000,0x3f7bbf6d3f55bf35
.quad 0x8000800080008000,0x8000800080008000,0xbf0e3ec4be488000,0xbf7b3f6dbf553f35
.quad 0x3f6dbf353ec48000,0x3ec4bf353f6dbf80,0xbf7b3f6dbf0e8000,0x3f55bec4be483f35
.quad 0x3f35bf803f358000,0xbf353f80bf358000,0xbe483f6dbf558000,0xbf0ebec43f7bbf35
.quad 0xbec4bf353f6d8000,0x3f6dbf35bec43f80,0x3f553ec4bf7b8000,0x3e483f6dbf0ebf35
.quad 0xbf8080003f808000,0xbf8080003f808000,0x3f55bec4bf7b8000,0x3e48bf6dbf0e3f35
.quad 0xbec43f353f6d8000,0x3f6d3f35bec4bf80,0xbe48bf6dbf558000,0xbf0e3ec43f7b3f35
.quad 0x3f353f803f358000,0xbf35bf80bf358000,0xbf7bbf6dbf0e8000,0x3f553ec4be48bf35
.quad 0x3f6d3f353ec48000,0x3ec43f353f6d3f80,0xbf0ebec4be488000,0xbf7bbf6dbf55bf35
.quad 0x8000800080008000,0x8000800080008000,0x3f553f6d3f7b3f80,0x3e483ec43f0e3f35
.quad 0x3f6d3f353ec48000,0x3ec43f353f6d3f80,0x3e48bec4bf55bf80,0x3f0e3f6d3f7b3f35
.quad 0xbf35bf80bf358000,0x3f353f803f358000,0xbf7bbec43f0e3f80,0x3f553f6d3e48bf35
.quad 0xbec43f353f6d8000,0x3f6d3f35bec4bf80,0x3f0e3f6dbe48bf80,0x3f7b3ec4bf55bf35
.quad 0x3f808000bf808000,0x3f808000bf808000,0x3f0ebf6dbe483f80,0x3f7bbec4bf553f35
.quad 0xbec4bf353f6d8000,0x3f6dbf35bec43f80,0xbf7b3ec43f0ebf80,0x3f55bf6d3e483f35
.quad 0xbf353f80bf358000,0x3f35bf803f358000,0x3e483ec4bf553f80,0x3f0ebf6d3f7bbf35
.quad 0x3f6dbf353ec48000,0x3ec4bf353f6dbf80,0x3f55bf6d3f7bbf80,0x3e48bec43f0ebf35
.quad 0x8000800080008000,0x8000800080008000,0xbf553f6dbf7b3f80,0xbe483ec4bf0e3f35
.quad 0xbf6d3f35bec48000,0xbec43f35bf6d3f80,0xbe48bec43f55bf80,0xbf0e3f6dbf7b3f35
.quad 0x3f35bf803f358000,0xbf353f80bf358000,0x3f7bbec4bf0e3f80,0xbf553f6dbe48bf35
.quad 0x3ec43f35bf6d8000,0xbf6d3f353ec4bf80,0xbf0e3f6d3e48bf80,0xbf7b3ec43f55bf35
.quad 0xbf8080003f808000,0xbf8080003f808000,0xbf0ebf6d3e483f80,0xbf7bbec43f553f35
.quad 0x3ec4bf35bf6d8000,0xbf6dbf353ec43f80,0x3f7b3ec4bf0ebf80,0xbf55bf6dbe483f35
.quad 0x3f353f803f358000,0xbf35bf80bf358000,0xbe483ec43f553f80,0xbf0ebf6dbf7bbf35
.quad 0xbf6dbf35bec48000,0xbec4bf35bf6dbf80,0xbf55bf6dbf7bbf80,0xbe48bec4bf0ebf35
.quad 0x3f8000003f800000,0x3f8000003f800000,0x3f7ffb113f800000,0x3f7fd3973f7fec43
.quad 0x3f7fec433f800000,0x3f7f4e6d3f7fb10f,0x3f7fd3973f800000,0x3f7e70b03f7f4e6d
.quad 0x3f7fb10f3f800000,0x3f7d3aac3f7ec46d,0x3f7f84ab3f800000,0x3f7baccd3f7e1324
.quad 0x3f7f4e6d3f800000,0x3f79c79d3f7d3aac,0x3f7f0e583f800000,0x3f778bc53f7c3b28
.quad 0x3f7ec46d3f800000,0x3f74fa0b3f7b14be,0x3f7e70b03f800000,0x3f7213523f79c79d
.quad 0x3f7e13243f800000,0x3f6ed89e3f7853f8,0x3f7dabcc3f800000,0x3f6b4b0c3f76ba07
.quad 0x3f7d3aac3f800000,0x3f676bd83f74fa0b,0x3f7cbfc93f800000,0x3f633c5a3f731447
.quad 0x3f7c3b283f800000,0x3f5ebe053f710908,0x3f7baccd3f800000,0x3f59f26a3f6ed89e
.quad 0x3f7b14be3f800000,0x3f54db313f6c835e,0x3f7a73023f800000,0x3f4f7a1f3f6a09a7
.quad 0x3f79c79d3f800000,0x3f49d1123f676bd8,0x3f7912983f800000,0x3f43e2003f64aa59
.quad 0x3f7853f83f800000,0x3f3daef93f61c598,0x3f778bc53f800000,0x3f373a233f5ebe05
.quad 0x3f76ba073f800000,0x3f3085bb3f5b941a,0x3f75dec63f800000,0x3f2994153f584853
.quad 0x3f74fa0b3f800000,0x3f2267993f54db31,0x3f740bdd3f800000,0x3f1b02c63f514d3d
.quad 0x3f7314473f800000,0x3f13682a3f4d9f02,0x3f7213523f800000,0x3f0b9a6b3f49d112
.quad 0x3f7109083f800000,0x3f039c3d3f45e403,0x3f6ff5733f800000,0x3ef6e0cb3f41d870
.quad 0x3f6ed89e3f800000,0x3ee633753f3daef9,0x3f6db2933f800000,0x3ed536413f396842
.quad 0x3f8000003f800000,0x3f8000003f800000,0x3f7f84ab3f7fb10f,0x3f7f0e583f7f4e6d
.quad 0x3f7e13243f7ec46d,0x3f7c3b283f7d3aac,0x3f7baccd3f7d3aac,0x3f778bc53f79c79d
.quad 0x3f7853f83f7b14be,0x3f7109083f74fa0b,0x3f740bdd3f7853f8,0x3f68bf3c3f6ed89e
.quad 0x3f6ed89e3f74fa0b,0x3f5ebe053f676bd8,0x3f68bf3c3f710908,0x3f5318493f5ebe05
.quad 0x3f61c5983f6c835e,0x3f45e4033f54db31,0x3f59f26a3f676bd8,0x3f373a233f49d112
.quad 0x3f514d3d3f61c598,0x3f2736563f3daef9,0x3f47de653f5b941a,0x3f15f6d93f3085bb
.quad 0x3f3daef93f54db31,0x3f039c3d3f226799,0x3f32c8c93f4d9f02,0x3ee0924f3f13682a
.quad 0x3f2736563f45e403,0x3eb8442a3f039c3d,0x3f1b02c63f3daef9,0x3e8e9a223ee63375
.quad 0x3f0e39da3f3504f3,0x3e47c5c23ec3ef15,0x3f00e7e43f2beb4a,0x3de1bc2e3ea09ae5
.quad 0x3ee633753f226799,0x3cc90ab03e78cfcc,0x3ec9b9533f187fc0,0xbd7b2b743e2f10a2
.quad 0x3eac7cd43f0e39da,0xbe1640833dc8bd36,0x3e8e9a223f039c3d,0xbe6c9a7f3cc90ab0
.quad 0x3e605c133ef15aea,0xbea09ae5bd48fb30,0x3e22abb63edae880,0xbec9b953bdfab273
.quad 0x3dc8bd363ec3ef15,0xbef15aeabe47c5c2,0x3d16c32c3eac7cd4,0xbf0b9a6bbe888e93
.quad 0xbcc90ab03e94a031,0xbf1d7fd1beac7cd4,0xbdafb6803e78cfcc,0xbf2e3bdebecf7bca
.quad 0xbe1640833e47c5c2,0xbf3daef9bef15aea,0xbe5415013e164083,0xbf4bbbf8bf08f59b
.quad 0xbe888e933dc8bd36,0xbf584853bf187fc0,0xbea68f123d48fb30,0xbf633c5abf273656
.quad 0x3f8000003f800000,0x3f8000003f800000,0x3f7e70b03f7ec46d,0x3f7dabcc3f7e1324
.quad 0x3f79c79d3f7b14be,0x3f76ba073f7853f8,0x3f7213523f74fa0b,0x3f6b4b0c3f6ed89e
.quad 0x3f676bd83f6c835e,0x3f5b941a3f61c598,0x3f59f26a3f61c598,0x3f47de653f514d3d
.quad 0x3f49d1123f54db31,0x3f3085bb3f3daef9,0x3f373a233f45e403,0x3f15f6d93f273656
.quad 0x3f2267993f3504f3,0x3ef15aea3f0e39da,0x3f0b9a6b3f226799,0x3eb263ef3ee63375
.quad 0x3ee633753f0e39da,0x3e605c133eac7cd4,0x3eb263ef3ef15aea,0x3dafb6803e605c13
.quad 0x3e78cfcc3ec3ef15,0xbd48fb303dc8bd36,0x3e09cf863e94a031,0xbe3b6ecfbcc90ab0
.quad 0x3cc90ab03e47c5c2,0xbea09ae5be164083,0xbdafb6803dc8bd36,0xbee0924fbe888e93
.quad 0xbe47c5c200000000,0xbf0e39dabec3ef15,0xbe9aa086bdc8bd36,0xbf299415befc5d27
.quad 0xbecf7bcabe47c5c2,0xbf41d870bf187fc0,0xbf00e7e4be94a031,0xbf5695e5bf3085bb
.quad 0xbf187fc0bec3ef15,0xbf676bd8bf45e403,0xbf2e3bdebef15aea,0xbf740bddbf584853
.quad 0xbf41d870bf0e39da,0xbf7c3b28bf676bd8,0xbf531849bf226799,0xbf7fd397bf731447
.quad 0xbf61c598bf3504f3,0xbf7ec46dbf7b14be,0xbf6db293bf45e403,0xbf791298bf7f4e6d
.quad 0xbf76ba07bf54db31,0xbf6ed89ebf7fb10f,0xbf7cbfc9bf61c598,0xbf604621bf7c3b28
.quad 0xbf7fb10fbf6c835e,0xbf4d9f02bf74fa0b,0xbf7f84abbf74fa0b,0xbf373a23bf6a09a7
.quad 0xbf7c3b28bf7b14be,0xbf1d7fd1bf5b941a,0xbf75dec6bf7ec46d,0xbf00e7e4bf49d112
.quad 0x3f8000003f800000,0x3f8000003f800000,0x3f7cbfc93f7d3aac,0x3f7baccd3f7c3b28
.quad 0x3f7314473f74fa0b,0x3f6ed89e3f710908,0x3f633c5a3f676bd8,0x3f59f26a3f5ebe05
.quad 0x3f4d9f023f54db31,0x3f3daef93f45e403,0x3f32c8c93f3daef9,0x3f1b02c63f273656
.quad 0x3f13682a3f226799,0x3ee633753f039c3d,0x3ee0924f3f039c3d,0x3e8e9a223eb8442a
.quad 0x3e94a0313ec3ef15,0x3dc8bd363e47c5c2,0x3e09cf863e78cfcc,0xbdafb6803cc90ab0
.quad 0xbcc90ab03dc8bd36,0xbe888e93be164083,0xbe3b6ecfbd48fb30,0xbee0924fbea09ae5
.quad 0xbeac7cd4be47c5c2,0xbf187fc0bef15aea,0xbef6e0cbbeac7cd4,0xbf3b8f3bbf1d7fd1
.quad 0xbf1d7fd1bef15aea,0xbf584853bf3daef9,0xbf3b8f3bbf187fc0,0xbf6db293bf584853
.quad 0xbf54db31bf3504f3,0xbf7b14bebf6c835e,0xbf68bf3cbf4d9f02,0xbf7ffb11bf79c79d
.quad 0xbf76ba07bf61c598,0xbf7c3b28bf7fb10f,0xbf7e70b0bf710908,0xbf6ff573bf7e1324
.quad 0xbf7fb10fbf7b14be,0xbf5b941abf74fa0b,0xbf7a7302bf7fb10f,0xbf3fc767bf64aa59
.quad 0xbf6ed89ebf7ec46d,0xbf1d7fd1bf4d9f02,0xbf5d2d53bf7853f8,0xbeebcbbbbf3085bb
.quad 0xbf45e403bf6c835e,0xbe94a031bf0e39da,0xbf299415bf5b941a,0xbde1bc2ebecf7bca
.quad 0xbf08f59bbf45e403,0x3d96a905be78cfcc,0xbec9b953bf2beb4a,0x3e827dc0bd96a905
.quad 0xbe78cfccbf0e39da,0x3edae8803dc8bd36,0xbdafb680bedae880,0x3f15f6d93e888e93
.quad 0x3d96a905be94a031,0x3f3968423edae880,0x3e6c9a7fbe164083,0x3f5695e53f13682a
.quad 0x0,0x0,0x3c490e9000000000,0x3d16c32c3cc90ab0
.quad 0x3cc90ab000000000,0x3d96a9053d48fb30,0x3d16c32c00000000,0x3de1bc2e3d96a905
.quad 0x3d48fb3000000000,0x3e1640833dc8bd36,0x3d7b2b7400000000,0x3e3b6ecf3dfab273
.quad 0x3d96a90500000000,0x3e605c133e164083,0x3dafb68000000000,0x3e827dc03e2f10a2
.quad 0x3dc8bd3600000000,0x3e94a0313e47c5c2,0x3de1bc2e00000000,0x3ea68f123e605c13
.quad 0x3dfab27300000000,0x3eb8442a3e78cfcc,0x3e09cf8600000000,0x3ec9b9533e888e93
.quad 0x3e16408300000000,0x3edae8803e94a031,0x3e22abb600000000,0x3eebcbbb3ea09ae5
.quad 0x3e2f10a200000000,0x3efc5d273eac7cd4,0x3e3b6ecf00000000,0x3f064b823eb8442a
.quad 0x3e47c5c200000000,0x3f0e39da3ec3ef15,0x3e54150100000000,0x3f15f6d93ecf7bca
.quad 0x3e605c1300000000,0x3f1d7fd13edae880,0x3e6c9a7f00000000,0x3f24d2253ee63375
.quad 0x3e78cfcc00000000,0x3f2beb4a3ef15aea,0x3e827dc000000000,0x3f32c8c93efc5d27
.quad 0x3e888e9300000000,0x3f3968423f039c3d,0x3e8e9a2200000000,0x3f3fc7673f08f59b
.quad 0x3e94a03100000000,0x3f45e4033f0e39da,0x3e9aa08600000000,0x3f4bbbf83f13682a
.quad 0x3ea09ae500000000,0x3f514d3d3f187fc0,0x3ea68f1200000000,0x3f5695e53f1d7fd1
.quad 0x3eac7cd400000000,0x3f5b941a3f226799,0x3eb263ef00000000,0x3f6046213f273656
.quad 0x3eb8442a00000000,0x3f64aa593f2beb4a,0x3ebe1d4a00000000,0x3f68bf3c3f3085bb
.quad 0x0,0x0,0x3d7b2b743d48fb30,0x3dafb6803d96a905
.quad 0x3dfab2733dc8bd36,0x3e2f10a23e164083,0x3e3b6ecf3e164083,0x3e827dc03e605c13
.quad 0x3e78cfcc3e47c5c2,0x3eac7cd43e94a031,0x3e9aa0863e78cfcc,0x3ed536413eb8442a
.quad 0x3eb8442a3e94a031,0x3efc5d273edae880,0x3ed536413eac7cd4,0x3f10d3cd3efc5d27
.quad 0x3ef15aea3ec3ef15,0x3f2267993f0e39da,0x3f064b823edae880,0x3f32c8c93f1d7fd1
.quad 0x3f13682a3ef15aea,0x3f41d8703f2beb4a,0x3f1ff6cb3f039c3d,0x3f4f7a1f3f396842
.quad 0x3f2beb4a3f0e39da,0x3f5b941a3f45e403,0x3f373a233f187fc0,0x3f660f883f514d3d
.quad 0x3f41d8703f226799,0x3f6ed89e3f5b941a,0x3f4bbbf83f2beb4a,0x3f75dec63f64aa59
.quad 0x3f54db313f3504f3,0x3f7b14be3f6c835e,0x3f5d2d533f3daef9,0x3f7e70b03f731447
.quad 0x3f64aa593f45e403,0x3f7fec433f7853f8,0x3f6b4b0c3f4d9f02,0x3f7f84ab3f7c3b28
.quad 0x3f7109083f54db31,0x3f7d3aac3f7ec46d,0x3f75dec63f5b941a,0x3f7912983f7fec43
.quad 0x3f79c79d3f61c598,0x3f7314473f7fb10f,0x3f7cbfc93f676bd8,0x3f6b4b0c3f7e1324
.quad 0x3f7ec46d3f6c835e,0x3f61c5983f7b14be,0x3f7fd3973f710908,0x3f5695e53f76ba07
.quad 0x3f7fec433f74fa0b,0x3f49d1123f710908,0x3f7f0e583f7853f8,0x3f3b8f3b3f6a09a7
.quad 0x3f7d3aac3f7b14be,0x3f2beb4a3f61c598,0x3f7a73023f7d3aac,0x3f1b02c63f584853
.quad 0x3f76ba073f7ec46d,0x3f08f59b3f4d9f02,0x3f7213523f7fb10f,0x3eebcbbb3f41d870
.quad 0x0,0x0,0x3de1bc2e3dc8bd36,0x3e09cf863dfab273
.quad 0x3e605c133e47c5c2,0x3e888e933e78cfcc,0x3ea68f123e94a031,0x3ec9b9533eb8442a
.quad 0x3edae8803ec3ef15,0x3f039c3d3ef15aea,0x3f064b823ef15aea,0x3f1ff6cb3f13682a
.quad 0x3f1d7fd13f0e39da,0x3f3968423f2beb4a,0x3f32c8c93f226799,0x3f4f7a1f3f41d870
.quad 0x3f45e4033f3504f3,0x3f61c5983f54db31,0x3f5695e53f45e403,0x3f6ff5733f64aa59
.quad 0x3f64aa593f54db31,0x3f79c79d3f710908,0x3f6ff5733f61c598,0x3f7f0e583f79c79d
.quad 0x3f7853f83f6c835e,0x3f7fb10f3f7ec46d,0x3f7dabcc3f74fa0b,0x3f7baccd3f7fec43
.quad 0x3f7fec433f7b14be,0x3f7314473f7d3aac,0x3f7f0e583f7ec46d,0x3f660f883f76ba07
.quad 0x3f7b14be3f800000,0x3f54db313f6c835e,0x3f740bdd3f7ec46d,0x3f3fc7673f5ebe05
.quad 0x3f6a09a73f7b14be,0x3f2736563f4d9f02,0x3f5d2d533f74fa0b,0x3f0b9a6b3f396842
.quad 0x3f4d9f023f6c835e,0x3edae8803f226799,0x3f3b8f3b3f61c598,0x3e9aa0863f08f59b
.quad 0x3f2736563f54db31,0x3e2f10a23edae880,0x3f10d3cd3f45e403,0x3d16c32c3ea09ae5
.quad 0x3ef15aea3f3504f3,0xbdc8bd363e47c5c2,0x3ebe1d4a3f226799,0xbe6c9a7f3d96a905
.quad 0x3e888e933f0e39da,0xbeb8442abd48fb30,0x3e22abb63ef15aea,0xbef6e0cbbe2f10a2
.quad 0x3d48fb303ec3ef15,0xbf187fc0be94a031,0xbd7b2b743e94a031,0xbf32c8c9becf7bca
.quad 0xbe2f10a23e47c5c2,0xbf49d112bf039c3d,0xbe8e9a223dc8bd36,0xbf5d2d53bf1d7fd1
.quad 0x0,0x0,0x3e22abb63e164083,0x3e3b6ecf3e2f10a2
.quad 0x3ea09ae53e94a031,0x3eb8442a3eac7cd4,0x3eebcbbb3edae880,0x3f064b823efc5d27
.quad 0x3f187fc03f0e39da,0x3f2beb4a3f226799,0x3f373a233f2beb4a,0x3f4bbbf83f41d870
.quad 0x3f514d3d3f45e403,0x3f64aa593f5b941a,0x3f660f883f5b941a,0x3f75dec63f6ed89e
.quad 0x3f74fa0b3f6c835e,0x3f7ec46d3f7b14be,0x3f7dabcc3f7853f8,0x3f7f0e583f7fec43
.quad 0x3f7fec433f7ec46d,0x3f76ba073f7d3aac,0x3f7baccd3f7fb10f,0x3f660f883f731447
.quad 0x3f7109083f7b14be,0x3f4d9f023f61c598,0x3f6046213f710908,0x3f2e3bde3f49d112
.quad 0x3f49d1123f61c598,0x3f08f59b3f2beb4a,0x3f2e3bde3f4d9f02,0x3ebe1d4a3f08f59b
.quad 0x3f0e39da3f3504f3,0x3e47c5c23ec3ef15,0x3ed536413f187fc0,0x3c490e903e605c13
.quad 0x3e888e933ef15aea,0xbe2f10a23d48fb30,0x3de1bc2e3eac7cd4,0xbeb263efbdfab273
.quad 0xbd48fb303e47c5c2,0xbf039c3dbe94a031,0xbe5415013d48fb30,0xbf299415bee63375
.quad 0xbeb8442abdc8bd36,0xbf49d112bf187fc0,0xbf00e7e4be78cfcc,0xbf633c5abf396842
.quad 0xbf226799bec3ef15,0xbf74fa0bbf54db31,0xbf3fc767bf039c3d,0xbf7e70b0bf6a09a7
.quad 0xbf584853bf226799,0xbf7f4e6dbf7853f8,0xbf6b4b0cbf3daef9,0xbf778bc5bf7f4e6d
.quad 0xbf7853f8bf54db31,0xbf676bd8bf7ec46d,0xbf7f0e58bf676bd8,0xbf4f7a1fbf76ba07
.quad 0xbf7f4e6dbf74fa0b,0xbf3085bbbf676bd8,0xbf791298bf7d3aac,0xbf0b9a6bbf514d3d
.quad 0x3f803f803f803f80,0x0,0x0,0x3f803f803f803f80
.quad 0x3ec43f353f6d3f80,0x3f6d3f353ec40000,0xbf6dbf35bec40000,0x3ec43f353f6d3f80
.quad 0xbf3500003f353f80,0x3f353f803f350000,0xbf35bf80bf350000,0xbf3500003f353f80
.quad 0xbf6dbf353ec43f80,0xbec43f353f6d0000,0x3ec4bf35bf6d0000,0xbf6dbf353ec43f80
.quad 0xbf8000003f80,0xbf8000003f800000,0x3f800000bf800000,0xbf8000003f80
.quad 0x3f6dbf35bec43f80,0xbec4bf353f6d0000,0x3ec43f35bf6d0000,0x3f6dbf35bec43f80
.quad 0x3f350000bf353f80,0x3f35bf803f350000,0xbf353f80bf350000,0x3f350000bf353f80
.quad 0xbec43f35bf6d3f80,0x3f6dbf353ec40000,0xbf6d3f35bec40000,0xbec43f35bf6d3f80
.quad 0xbf803f80bf803f80,0x0,0x0,0xbf803f80bf803f80
.quad 0xbec43f35bf6d3f80,0xbf6d3f35bec40000,0x3f6dbf353ec40000,0xbec43f35bf6d3f80
.quad 0x3f350000bf353f80,0xbf353f80bf350000,0x3f35bf803f350000,0x3f350000bf353f80
.quad 0x3f6dbf35bec43f80,0x3ec43f35bf6d0000,0xbec4bf353f6d0000,0x3f6dbf35bec43f80
.quad 0xbf8000003f80,0x3f800000bf800000,0xbf8000003f800000,0xbf8000003f80
.quad 0xbf6dbf353ec43f80,0x3ec4bf35bf6d0000,0xbec43f353f6d0000,0xbf6dbf353ec43f80
.quad 0xbf3500003f353f80,0xbf35bf80bf350000,0x3f353f803f350000,0xbf3500003f353f80
.quad 0x3ec43f353f6d3f80,0xbf6dbf35bec40000,0x3f6d3f353ec40000,0x3ec43f353f6d3f80
.quad 0x3f803f803f803f80,0x0,0x0,0x3f803f803f803f80
.quad 0xbf6dbf35bec40000,0x3ec43f353f6d3f80,0xbec4bf35bf6dbf80,0xbf6dbf35bec40000
.quad 0x3f350000bf35bf80,0xbf35bf80bf350000,0x3f353f803f350000,0x3f350000bf35bf80
.quad 0xbec43f353f6d0000,0x3f6d3f35bec4bf80,0xbf6dbf353ec43f80,0xbec43f353f6d0000
.quad 0xbf8000003f80,0xbf8000003f800000,0x3f800000bf800000,0xbf8000003f80
.quad 0x3ec43f35bf6d0000,0x3f6dbf35bec43f80,0xbf6d3f353ec4bf80,0x3ec43f35bf6d0000
.quad 0xbf3500003f35bf80,0xbf353f80bf350000,0x3f35bf803f350000,0xbf3500003f35bf80
.quad 0x3f6dbf353ec40000,0x3ec4bf353f6dbf80,0xbec43f35bf6d3f80,0x3f6dbf353ec40000
.quad 0xbf803f80bf803f80,0x0,0x0,0xbf803f80bf803f80
.quad 0x3f6dbf353ec40000,0xbec43f35bf6d3f80,0x3ec4bf353f6dbf80,0x3f6dbf353ec40000
.quad 0xbf3500003f35bf80,0x3f35bf803f350000,0xbf353f80bf350000,0xbf3500003f35bf80
.quad 0x3ec43f35bf6d0000,0xbf6d3f353ec4bf80,0x3f6dbf35bec43f80,0x3ec43f35bf6d0000
.quad 0xbf8000003f80,0x3f800000bf800000,0xbf8000003f800000,0xbf8000003f80
.quad 0xbec43f353f6d0000,0xbf6dbf353ec43f80,0x3f6d3f35bec4bf80,0xbec43f353f6d0000
.quad 0x3f350000bf35bf80,0x3f353f803f350000,0xbf35bf80bf350000,0x3f350000bf35bf80
.quad 0xbf6dbf35bec40000,0xbec4bf35bf6dbf80,0x3ec43f353f6d3f80,0xbf6dbf35bec40000
.quad 0x3f803f803f803f80,0x0,0x0,0x3f803f803f803f80
.quad 0xbec4bf35bf6dbf80,0xbf6dbf35bec40000,0x3f6d3f353ec40000,0xbec4bf35bf6dbf80
.quad 0xbf3500003f353f80,0x3f353f803f350000,0xbf35bf80bf350000,0xbf3500003f353f80
.quad 0x3f6d3f35bec4bf80,0x3ec4bf35bf6d0000,0xbec43f353f6d0000,0x3f6d3f35bec4bf80
.quad 0xbf8000003f80,0xbf8000003f800000,0x3f800000bf800000,0xbf8000003f80
.quad 0xbf6d3f353ec4bf80,0x3ec43f35bf6d0000,0xbec4bf353f6d0000,0xbf6d3f353ec4bf80
.quad 0x3f350000bf353f80,0x3f35bf803f350000,0xbf353f80bf350000,0x3f350000bf353f80
.quad 0x3ec4bf353f6dbf80,0xbf6d3f35bec40000,0x3f6dbf353ec40000,0x3ec4bf353f6dbf80
.quad 0xbf803f80bf803f80,0x0,0x0,0xbf803f80bf803f80
.quad 0x3ec4bf353f6dbf80,0x3f6dbf353ec40000,0xbf6d3f35bec40000,0x3ec4bf353f6dbf80
.quad 0x3f350000bf353f80,0xbf353f80bf350000,0x3f35bf803f350000,0x3f350000bf353f80
.quad 0xbf6d3f353ec4bf80,0xbec4bf353f6d0000,0x3ec43f35bf6d0000,0xbf6d3f353ec4bf80
.quad 0xbf8000003f80,0x3f800000bf800000,0xbf8000003f800000,0xbf8000003f80
.quad 0x3f6d3f35bec4bf80,0xbec43f353f6d0000,0x3ec4bf35bf6d0000,0x3f6d3f35bec4bf80
.quad 0xbf3500003f353f80,0xbf35bf80bf350000,0x3f353f803f350000,0xbf3500003f353f80
.quad 0xbec4bf35bf6dbf80,0x3f6d3f353ec40000,0xbf6dbf35bec40000,0xbec4bf35bf6dbf80
.quad 0x3f803f803f803f80,0x0,0x0,0x3f803f803f803f80
.quad 0x3f6d3f353ec40000,0xbec4bf35bf6dbf80,0x3ec43f353f6d3f80,0x3f6d3f353ec40000
.quad 0x3f350000bf35bf80,0xbf35bf80bf350000,0x3f353f803f350000,0x3f350000bf35bf80
.quad 0x3ec4bf35bf6d0000,0xbf6dbf353ec43f80,0x3f6d3f35bec4bf80,0x3ec4bf35bf6d0000
.quad 0xbf8000003f80,0xbf8000003f800000,0x3f800000bf800000,0xbf8000003f80
.quad 0xbec4bf353f6d0000,0xbf6d3f353ec4bf80,0x3f6dbf35bec43f80,0xbec4bf353f6d0000
.quad 0xbf3500003f35bf80,0xbf353f80bf350000,0x3f35bf803f350000,0xbf3500003f35bf80
.quad 0xbf6d3f35bec40000,0xbec43f35bf6d3f80,0x3ec4bf353f6dbf80,0xbf6d3f35bec40000
.quad 0xbf803f80bf803f80,0x0,0x0,0xbf803f80bf803f80
.quad 0xbf6d3f35bec40000,0x3ec4bf353f6dbf80,0xbec43f35bf6d3f80,0xbf6d3f35bec40000
.quad 0xbf3500003f35bf80,0x3f35bf803f350000,0xbf353f80bf350000,0xbf3500003f35bf80
.quad 0xbec4bf353f6d0000,0x3f6dbf35bec43f80,0xbf6d3f353ec4bf80,0xbec4bf353f6d0000
.quad 0xbf8000003f80,0x3f800000bf800000,0xbf8000003f800000,0xbf8000003f80
.quad 0x3ec4bf35bf6d0000,0x3f6d3f35bec4bf80,0xbf6dbf353ec43f80,0x3ec4bf35bf6d0000
.quad 0x3f350000bf35bf80,0x3f353f803f350000,0xbf35bf80bf350000,0x3f350000bf35bf80
.quad 0x3f6d3f353ec40000,0x3ec43f353f6d3f80,0xbec4bf35bf6dbf80,0x3f6d3f353ec40000
.quad 0x3f803f803f803f80,0x3f803f803f803f80,0x3f553f6d3f7b3f80,0xbf55bf6dbf7bbf80
.quad 0x3ec43f353f6d3f80,0x3ec43f353f6d3f80,0xbe483ec43f553f80,0x3e48bec4bf55bf80
.quad 0xbf3500003f353f80,0xbf3500003f353f80,0xbf7bbec43f0e3f80,0x3f7b3ec4bf0ebf80
.quad 0xbf6dbf353ec43f80,0xbf6dbf353ec43f80,0xbf0ebf6d3e483f80,0x3f0e3f6dbe48bf80
.quad 0xbf8000003f80,0xbf8000003f80,0x3f0ebf6dbe483f80,0xbf0e3f6d3e48bf80
.quad 0x3f6dbf35bec43f80,0x3f6dbf35bec43f80,0x3f7bbec4bf0e3f80,0xbf7b3ec43f0ebf80
.quad 0x3f350000bf353f80,0x3f350000bf353f80,0x3e483ec4bf553f80,0xbe48bec43f55bf80
.quad 0xbec43f35bf6d3f80,0xbec43f35bf6d3f80,0xbf553f6dbf7b3f80,0x3f55bf6d3f7bbf80
.quad 0x3f803f803f803f80,0x3f803f803f803f80,0x3e483ec43f0e3f35,0xbe48bec4bf0ebf35
.quad 0xbf6dbf35bec40000,0xbf6dbf35bec40000,0xbf0ebf6dbf7bbf35,0x3f0e3f6d3f7b3f35
.quad 0x3f350000bf35bf80,0x3f350000bf35bf80,0x3f553f6d3e48bf35,0xbf55bf6dbe483f35
.quad 0xbec43f353f6d0000,0xbec43f353f6d0000,0xbf7bbec43f553f35,0x3f7b3ec4bf55bf35
.quad 0xbf8000003f80,0xbf8000003f80,0x3f7bbec4bf553f35,0xbf7b3ec43f55bf35
.quad 0x3ec43f35bf6d0000,0x3ec43f35bf6d0000,0xbf553f6dbe48bf35,0x3f55bf6d3e483f35
.quad 0xbf3500003f35bf80,0xbf3500003f35bf80,0x3f0ebf6d3f7bbf35,0xbf0e3f6dbf7b3f35
.quad 0x3f6dbf353ec40000,0x3f6dbf353ec40000,0xbe483ec4bf0e3f35,0x3e48bec43f0ebf35
.quad 0x3f803f803f803f80,0x3f803f803f803f80,0xbf0ebec4be480000,0x3f0e3ec43e480000
.quad 0xbec4bf35bf6dbf80,0xbec4bf35bf6dbf80,0x3f7b3f6d3f0e0000,0xbf7bbf6dbf0e0000
.quad 0xbf3500003f353f80,0xbf3500003f353f80,0xbe48bf6dbf550000,0x3e483f6d3f550000
.quad 0x3f6d3f35bec4bf80,0x3f6d3f35bec4bf80,0xbf553ec43f7b0000,0x3f55bec4bf7b0000
.quad 0xbf8000003f80,0xbf8000003f80,0x3f553ec4bf7b0000,0xbf55bec43f7b0000
.quad 0xbf6d3f353ec4bf80,0xbf6d3f353ec4bf80,0x3e48bf6d3f550000,0xbe483f6dbf550000
.quad 0x3f350000bf353f80,0x3f350000bf353f80,0xbf7b3f6dbf0e0000,0x3f7bbf6d3f0e0000
.quad 0x3ec4bf353f6dbf80,0x3ec4bf353f6dbf80,0x3f0ebec43e480000,0xbf0e3ec4be480000
.quad 0x3f803f803f803f80,0x3f803f803f803f80,0xbf7bbf6dbf55bf35,0x3f7b3f6d3f553f35
.quad 0x3f6d3f353ec40000,0x3f6d3f353ec40000,0xbf55bec43e483f35,0x3f553ec4be48bf35
.quad 0x3f350000bf35bf80,0x3f350000bf35bf80,0xbf0e3ec43f7b3f35,0x3f0ebec4bf7bbf35
.quad 0x3ec4bf35bf6d0000,0x3ec4bf35bf6d0000,0xbe483f6d3f0ebf35,0x3e48bf6dbf0e3f35
.quad 0xbf8000003f80,0xbf8000003f80,0x3e483f6dbf0ebf35,0xbe48bf6d3f0e3f35
.quad 0xbec4bf353f6d0000,0xbec4bf353f6d0000,0x3f0e3ec4bf7b3f35,0xbf0ebec43f7bbf35
.quad 0xbf3500003f35bf80,0xbf3500003f35bf80,0x3f55bec4be483f35,0xbf553ec43e48bf35
.quad 0xbf6d3f35bec40000,0xbf6d3f35bec40000,0x3f7bbf6d3f55bf35,0xbf7b3f6dbf553f35
.quad 0xbf803f80bf803f80,0xbf803f80bf803f80,0xbf553f6dbf7b3f80,0x3f55bf6d3f7bbf80
.quad 0xbec43f35bf6d3f80,0xbec43f35bf6d3f80,0x3e483ec4bf553f80,0xbe48bec43f55bf80
.quad 0x3f350000bf353f80,0x3f350000bf353f80,0x3f7bbec4bf0e3f80,0xbf7b3ec43f0ebf80
.quad 0x3f6dbf35bec43f80,0x3f6dbf35bec43f80,0x3f0ebf6dbe483f80,0xbf0e3f6d3e48bf80
.quad 0xbf8000003f80,0xbf8000003f80,0xbf0ebf6d3e483f80,0x3f0e3f6dbe48bf80
.quad 0xbf6dbf353ec43f80,0xbf6dbf353ec43f80,0xbf7bbec43f0e3f80,0x3f7b3ec4bf0ebf80
.quad 0xbf3500003f353f80,0xbf3500003f353f80,0xbe483ec43f553f80,0x3e48bec4bf55bf80
.quad 0x3ec43f353f6d3f80,0x3ec43f353f6d3f80,0x3f553f6d3f7b3f80,0xbf55bf6dbf7bbf80
.quad 0xbf803f80bf803f80,0xbf803f80bf803f80,0xbe483ec4bf0e3f35,0x3e48bec43f0ebf35
.quad 0x3f6dbf353ec40000,0x3f6dbf353ec40000,0x3f0ebf6d3f7bbf35,0xbf0e3f6dbf7b3f35
.quad 0xbf3500003f35bf80,0xbf3500003f35bf80,0xbf553f6dbe48bf35,0x3f55bf6d3e483f35
.quad 0x3ec43f35bf6d0000,0x3ec43f35bf6d0000,0x3f7bbec4bf553f35,0xbf7b3ec43f55bf35
.quad 0xbf8000003f80,0xbf8000003f80,0xbf7bbec43f553f35,0x3f7b3ec4bf55bf35
.quad 0xbec43f353f6d0000,0xbec43f353f6d0000,0x3f553f6d3e48bf35,0xbf55bf6dbe483f35
.quad 0x3f350000bf35bf80,0x3f350000bf35bf80,0xbf0ebf6dbf7bbf35,0x3f0e3f6d3f7b3f35
.quad 0xbf6dbf35bec40000,0xbf6dbf35bec40000,0x3e483ec43f0e3f35,0xbe48bec4bf0ebf35
.quad 0xbf803f80bf803f80,0xbf803f80bf803f80,0x3f0ebec43e480000,0xbf0e3ec4be480000
.quad 0x3ec4bf353f6dbf80,0x3ec4bf353f6dbf80,0xbf7b3f6dbf0e0000,0x3f7bbf6d3f0e0000
.quad 0x3f350000bf353f80,0x3f350000bf353f80,0x3e48bf6d3f550000,0xbe483f6dbf550000
.quad 0xbf6d3f353ec4bf80,0xbf6d3f353ec4bf80,0x3f553ec4bf7b0000,0xbf55bec43f7b0000
.quad 0xbf8000003f80,0xbf8000003f80,0xbf553ec43f7b0000,0x3f55bec4bf7b0000
.quad 0x3f6d3f35bec4bf80,0x3f6d3f35bec4bf80,0xbe48bf6dbf550000,0x3e483f6d3f550000
.quad 0xbf3500003f353f80,0xbf3500003f353f80,0x3f7b3f6d3f0e0000,0xbf7bbf6dbf0e0000
.quad 0xbec4bf35bf6dbf80,0xbec4bf35bf6dbf80,0xbf0ebec4be480000,0x3f0e3ec43e480000
.quad 0xbf803f80bf803f80,0xbf803f80bf803f80,0x3f7bbf6d3f55bf35,0xbf7b3f6dbf553f35
.quad 0xbf6d3f35bec40000,0xbf6d3f35bec40000,0x3f55bec4be483f35,0xbf553ec43e48bf35
.quad 0xbf3500003f35bf80,0xbf3500003f35bf80,0x3f0e3ec4bf7b3f35,0xbf0ebec43f7bbf35
.quad 0xbec4bf353f6d0000,0xbec4bf353f6d0000,0x3e483f6dbf0ebf35,0xbe48bf6d3f0e3f35
.quad 0xbf8000003f80,0xbf8000003f80,0xbe483f6d3f0ebf35,0x3e48bf6dbf0e3f35
.quad 0x3ec4bf35bf6d0000,0x3ec4bf35bf6d0000,0xbf0e3ec43f7b3f35,0x3f0ebec4bf7bbf35
.quad 0x3f350000bf35bf80,0x3f350000bf35bf80,0xbf55bec43e483f35,0x3f553ec4be48bf35
.quad 0x3f6d3f353ec40000,0x3f6d3f353ec40000,0xbf7bbf6dbf55bf35,0x3f7b3f6d3f553f35
.quad 0x8000800080008000,0x8000800080008000,0xbf0ebec4be488000,0x3f0e3ec43e488000
.quad 0xbf6dbf35bec48000,0xbf6dbf35bec48000,0xbf7bbf6dbf0e8000,0x3f7b3f6d3f0e8000
.quad 0xbf35bf80bf358000,0xbf35bf80bf358000,0xbe48bf6dbf558000,0x3e483f6d3f558000
.quad 0x3ec4bf35bf6d8000,0x3ec4bf35bf6d8000,0x3f55bec4bf7b8000,0xbf553ec43f7b8000
.quad 0x3f808000bf808000,0x3f808000bf808000,0x3f553ec4bf7b8000,0xbf55bec43f7b8000
.quad 0x3ec43f35bf6d8000,0x3ec43f35bf6d8000,0xbe483f6dbf558000,0x3e48bf6d3f558000
.quad 0xbf353f80bf358000,0xbf353f80bf358000,0xbf7b3f6dbf0e8000,0x3f7bbf6d3f0e8000
.quad 0xbf6d3f35bec48000,0xbf6d3f35bec48000,0xbf0e3ec4be488000,0x3f0ebec43e488000
.quad 0x8000800080008000,0x8000800080008000,0xbf7bbf6dbf55bf35,0x3f7b3f6d3f553f35
.quad 0xbec4bf35bf6dbf80,0xbec4bf35bf6dbf80,0x3f553ec4be48bf35,0xbf55bec43e483f35
.quad 0x3f353f803f358000,0x3f353f803f358000,0xbf0e3ec43f7b3f35,0x3f0ebec4bf7bbf35
.quad 0xbf6dbf353ec43f80,0xbf6dbf353ec43f80,0x3e48bf6dbf0e3f35,0xbe483f6d3f0ebf35
.quad 0x3f808000bf808000,0x3f808000bf808000,0x3e483f6dbf0ebf35,0xbe48bf6d3f0e3f35
.quad 0xbf6d3f353ec4bf80,0xbf6d3f353ec4bf80,0xbf0ebec43f7bbf35,0x3f0e3ec4bf7b3f35
.quad 0x3f35bf803f358000,0x3f35bf803f358000,0x3f55bec4be483f35,0xbf553ec43e48bf35
.quad 0xbec43f35bf6d3f80,0xbec43f35bf6d3f80,0xbf7b3f6dbf553f35,0x3f7bbf6d3f55bf35
.quad 0x8000800080008000,0x8000800080008000,0xbf55bf6dbf7bbf80,0x3f553f6d3f7b3f80
.quad 0x3f6d3f353ec48000,0x3f6d3f353ec48000,0xbe483ec43f553f80,0x3e48bec4bf55bf80
.quad 0xbf35bf80bf358000,0xbf35bf80bf358000,0x3f7b3ec4bf0ebf80,0xbf7bbec43f0e3f80
.quad 0xbec43f353f6d8000,0xbec43f353f6d8000,0xbf0ebf6d3e483f80,0x3f0e3f6dbe48bf80
.quad 0x3f808000bf808000,0x3f808000bf808000,0xbf0e3f6d3e48bf80,0x3f0ebf6dbe483f80
.quad 0xbec4bf353f6d8000,0xbec4bf353f6d8000,0x3f7bbec4bf0e3f80,0xbf7b3ec43f0ebf80
.quad 0xbf353f80bf358000,0xbf353f80bf358000,0xbe48bec43f55bf80,0x3e483ec4bf553f80
.quad 0x3f6dbf353ec48000,0x3f6dbf353ec48000,0xbf553f6dbf7b3f80,0x3f55bf6d3f7bbf80
.quad 0x8000800080008000,0x8000800080008000,0xbe48bec4bf0ebf35,0x3e483ec43f0e3f35
.quad 0x3ec43f353f6d3f80,0x3ec43f353f6d3f80,0xbf0ebf6dbf7bbf35,0x3f0e3f6d3f7b3f35
.quad 0x3f353f803f358000,0x3f353f803f358000,0xbf55bf6dbe483f35,0x3f553f6d3e48bf35
.quad 0x3f6d3f35bec4bf80,0x3f6d3f35bec4bf80,0xbf7bbec43f553f35,0x3f7b3ec4bf55bf35
.quad 0x3f808000bf808000,0x3f808000bf808000,0xbf7b3ec43f55bf35,0x3f7bbec4bf553f35
.quad 0x3f6dbf35bec43f80,0x3f6dbf35bec43f80,0xbf553f6dbe48bf35,0x3f55bf6d3e483f35
.quad 0x3f35bf803f358000,0x3f35bf803f358000,0xbf0e3f6dbf7b3f35,0x3f0ebf6d3f7bbf35
.quad 0x3ec4bf353f6dbf80,0x3ec4bf353f6dbf80,0xbe483ec4bf0e3f35,0x3e48bec43f0ebf35
.quad 0x8000800080008000,0x8000800080008000,0x3f0ebec43e488000,0xbf0e3ec4be488000
.quad 0x3f6dbf353ec48000,0x3f6dbf353ec48000,0x3f7bbf6d3f0e8000,0xbf7b3f6dbf0e8000
.quad 0x3f35bf803f358000,0x3f35bf803f358000,0x3e48bf6d3f558000,0xbe483f6dbf558000
.quad 0xbec4bf353f6d8000,0xbec4bf353f6d8000,0xbf55bec43f7b8000,0x3f553ec4bf7b8000
.quad 0xbf8080003f808000,0xbf8080003f808000,0xbf553ec43f7b8000,0x3f55bec4bf7b8000
.quad 0xbec43f353f6d8000,0xbec43f353f6d8000,0x3e483f6d3f558000,0xbe48bf6dbf558000
.quad 0x3f353f803f358000,0x3f353f803f358000,0x3f7b3f6d3f0e8000,0xbf7bbf6dbf0e8000
.quad 0x3f6d3f353ec48000,0x3f6d3f353ec48000,0x3f0e3ec43e488000,0xbf0ebec4be488000
.quad 0x8000800080008000,0x8000800080008000,0x3f7bbf6d3f55bf35,0xbf7b3f6dbf553f35
.quad 0x3ec4bf353f6dbf80,0x3ec4bf353f6dbf80,0xbf553ec43e48bf35,0x3f55bec4be483f35
.quad 0xbf353f80bf358000,0xbf353f80bf358000,0x3f0e3ec4bf7b3f35,0xbf0ebec43f7bbf35
.quad 0x3f6dbf35bec43f80,0x3f6dbf35bec43f80,0xbe48bf6d3f0e3f35,0x3e483f6dbf0ebf35
.quad 0xbf8080003f808000,0xbf8080003f808000,0xbe483f6d3f0ebf35,0x3e48bf6dbf0e3f35
.quad 0x3f6d3f35bec4bf80,0x3f6d3f35bec4bf80,0x3f0ebec4bf7bbf35,0xbf0e3ec43f7b3f35
.quad 0xbf35bf80bf358000,0xbf35bf80bf358000,0xbf55bec43e483f35,0x3f553ec4be48bf35
.quad 0x3ec43f353f6d3f80,0x3ec43f353f6d3f80,0x3f7b3f6d3f553f35,0xbf7bbf6dbf55bf35
.quad 0x8000800080008000,0x8000800080008000,0x3f55bf6d3f7bbf80,0xbf553f6dbf7b3f80
.quad 0xbf6d3f35bec48000,0xbf6d3f35bec48000,0x3e483ec4bf553f80,0xbe48bec43f55bf80
.quad 0x3f35bf803f358000,0x3f35bf803f358000,0xbf7b3ec43f0ebf80,0x3f7bbec4bf0e3f80
.quad 0x3ec43f35bf6d8000,0x3ec43f35bf6d8000,0x3f0ebf6dbe483f80,0xbf0e3f6d3e48bf80
.quad 0xbf8080003f808000,0xbf8080003f808000,0x3f0e3f6dbe48bf80,0xbf0ebf6d3e483f80
.quad 0x3ec4bf35bf6d8000,0x3ec4bf35bf6d8000,0xbf7bbec43f0e3f80,0x3f7b3ec4bf0ebf80
.quad 0x3f353f803f358000,0x3f353f803f358000,0x3e48bec4bf55bf80,0xbe483ec43f553f80
.quad 0xbf6dbf35bec48000,0xbf6dbf35bec48000,0x3f553f6d3f7b3f80,0xbf55bf6dbf7bbf80
.quad 0x8000800080008000,0x8000800080008000,0x3e48bec43f0ebf35,0xbe483ec4bf0e3f35
.quad 0xbec43f35bf6d3f80,0xbec43f35bf6d3f80,0x3f0ebf6d3f7bbf35,0xbf0e3f6dbf7b3f35
.quad 0xbf353f80bf358000,0xbf353f80bf358000,0x3f55bf6d3e483f35,0xbf553f6dbe48bf35
.quad 0xbf6d3f353ec4bf80,0xbf6d3f353ec4bf80,0x3f7bbec4bf553f35,0xbf7b3ec43f55bf35
.quad 0xbf8080003f808000,0xbf8080003f808000,0x3f7b3ec4bf55bf35,0xbf7bbec43f553f35
.quad 0xbf6dbf353ec43f80,0xbf6dbf353ec43f80,0x3f553f6d3e48bf35,0xbf55bf6dbe483f35
.quad 0xbf35bf80bf358000,0xbf35bf80bf358000,0x3f0e3f6d3f7b3f35,0xbf0ebf6dbf7bbf35
.quad 0xbec4bf35bf6dbf80,0xbec4bf35bf6dbf80,0x3e483ec43f0e3f35,0xbe48bec4bf0ebf35
.quad 0x0,0x0,0x3f0e3ec43e480000,0xbf0ebec4be480000
.quad 0x3f6d3f353ec40000,0x3f6d3f353ec40000,0x3f7b3f6d3f0e0000,0xbf7bbf6dbf0e0000
.quad 0x3f353f803f350000,0x3f353f803f350000,0x3e483f6d3f550000,0xbe48bf6dbf550000
.quad 0xbec43f353f6d0000,0xbec43f353f6d0000,0xbf553ec43f7b0000,0x3f55bec4bf7b0000
.quad 0xbf8000003f800000,0xbf8000003f800000,0xbf55bec43f7b0000,0x3f553ec4bf7b0000
.quad 0xbec4bf353f6d0000,0xbec4bf353f6d0000,0x3e48bf6d3f550000,0xbe483f6dbf550000
.quad 0x3f35bf803f350000,0x3f35bf803f350000,0x3f7bbf6d3f0e0000,0xbf7b3f6dbf0e0000
.quad 0x3f6dbf353ec40000,0x3f6dbf353ec40000,0x3f0ebec43e480000,0xbf0e3ec4be480000
.quad 0x0,0x0,0x3f7b3f6d3f553f35,0xbf7bbf6dbf55bf35
.quad 0x3ec43f353f6d3f80,0x3ec43f353f6d3f80,0xbf55bec43e483f35,0x3f553ec4be48bf35
.quad 0xbf35bf80bf350000,0xbf35bf80bf350000,0x3f0ebec4bf7bbf35,0xbf0e3ec43f7b3f35
.quad 0x3f6d3f35bec4bf80,0x3f6d3f35bec4bf80,0xbe483f6d3f0ebf35,0x3e48bf6dbf0e3f35
.quad 0xbf8000003f800000,0xbf8000003f800000,0xbe48bf6d3f0e3f35,0x3e483f6dbf0ebf35
.quad 0x3f6dbf35bec43f80,0x3f6dbf35bec43f80,0x3f0e3ec4bf7b3f35,0xbf0ebec43f7bbf35
.quad 0xbf353f80bf350000,0xbf353f80bf350000,0xbf553ec43e48bf35,0x3f55bec4be483f35
.quad 0x3ec4bf353f6dbf80,0x3ec4bf353f6dbf80,0x3f7bbf6d3f55bf35,0xbf7b3f6dbf553f35
.quad 0x0,0x0,0x3f553f6d3f7b3f80,0xbf55bf6dbf7bbf80
.quad 0xbf6dbf35bec40000,0xbf6dbf35bec40000,0x3e48bec4bf55bf80,0xbe483ec43f553f80
.quad 0x3f353f803f350000,0x3f353f803f350000,0xbf7bbec43f0e3f80,0x3f7b3ec4bf0ebf80
.quad 0x3ec4bf35bf6d0000,0x3ec4bf35bf6d0000,0x3f0e3f6dbe48bf80,0xbf0ebf6d3e483f80
.quad 0xbf8000003f800000,0xbf8000003f800000,0x3f0ebf6dbe483f80,0xbf0e3f6d3e48bf80
.quad 0x3ec43f35bf6d0000,0x3ec43f35bf6d0000,0xbf7b3ec43f0ebf80,0x3f7bbec4bf0e3f80
.quad 0x3f35bf803f350000,0x3f35bf803f350000,0x3e483ec4bf553f80,0xbe48bec43f55bf80
.quad 0xbf6d3f35bec40000,0xbf6d3f35bec40000,0x3f55bf6d3f7bbf80,0xbf553f6dbf7b3f80
.quad 0x0,0x0,0x3e483ec43f0e3f35,0xbe48bec4bf0ebf35
.quad 0xbec4bf35bf6dbf80,0xbec4bf35bf6dbf80,0x3f0e3f6d3f7b3f35,0xbf0ebf6dbf7bbf35
.quad 0xbf35bf80bf350000,0xbf35bf80bf350000,0x3f553f6d3e48bf35,0xbf55bf6dbe483f35
.quad 0xbf6dbf353ec43f80,0xbf6dbf353ec43f80,0x3f7b3ec4bf55bf35,0xbf7bbec43f553f35
.quad 0xbf8000003f800000,0xbf8000003f800000,0x3f7bbec4bf553f35,0xbf7b3ec43f55bf35
.quad 0xbf6d3f353ec4bf80,0xbf6d3f353ec4bf80,0x3f55bf6d3e483f35,0xbf553f6dbe48bf35
.quad 0xbf353f80bf350000,0xbf353f80bf350000,0x3f0ebf6d3f7bbf35,0xbf0e3f6dbf7b3f35
.quad 0xbec43f35bf6d3f80,0xbec43f35bf6d3f80,0x3e48bec43f0ebf35,0xbe483ec4bf0e3f35
.quad 0x0,0x0,0xbf0e3ec4be480000,0x3f0ebec43e480000
.quad 0xbf6d3f35bec40000,0xbf6d3f35bec40000,0xbf7b3f6dbf0e0000,0x3f7bbf6d3f0e0000
.quad 0xbf353f80bf350000,0xbf353f80bf350000,0xbe483f6dbf550000,0x3e48bf6d3f550000
.quad 0x3ec43f35bf6d0000,0x3ec43f35bf6d0000,0x3f553ec4bf7b0000,0xbf55bec43f7b0000
.quad 0x3f800000bf800000,0x3f800000bf800000,0x3f55bec4bf7b0000,0xbf553ec43f7b0000
.quad 0x3ec4bf35bf6d0000,0x3ec4bf35bf6d0000,0xbe48bf6dbf550000,0x3e483f6d3f550000
.quad 0xbf35bf80bf350000,0xbf35bf80bf350000,0xbf7bbf6dbf0e0000,0x3f7b3f6d3f0e0000
.quad 0xbf6dbf35bec40000,0xbf6dbf35bec40000,0xbf0ebec4be480000,0x3f0e3ec43e480000
.quad 0x0,0x0,0xbf7b3f6dbf553f35,0x3f7bbf6d3f55bf35
.quad 0xbec43f35bf6d3f80,0xbec43f35bf6d3f80,0x3f55bec4be483f35,0xbf553ec43e48bf35
.quad 0x3f35bf803f350000,0x3f35bf803f350000,0xbf0ebec43f7bbf35,0x3f0e3ec4bf7b3f35
.quad 0xbf6d3f353ec4bf80,0xbf6d3f353ec4bf80,0x3e483f6dbf0ebf35,0xbe48bf6d3f0e3f35
.quad 0x3f800000bf800000,0x3f800000bf800000,0x3e48bf6dbf0e3f35,0xbe483f6d3f0ebf35
.quad 0xbf6dbf353ec43f80,0xbf6dbf353ec43f80,0xbf0e3ec43f7b3f35,0x3f0ebec4bf7bbf35
.quad 0x3f353f803f350000,0x3f353f803f350000,0x3f553ec4be48bf35,0xbf55bec43e483f35
.quad 0xbec4bf35bf6dbf80,0xbec4bf35bf6dbf80,0xbf7bbf6dbf55bf35,0x3f7b3f6d3f553f35
.quad 0x0,0x0,0xbf553f6dbf7b3f80,0x3f55bf6d3f7bbf80
.quad 0x3f6dbf353ec40000,0x3f6dbf353ec40000,0xbe48bec43f55bf80,0x3e483ec4bf553f80
.quad 0xbf353f80bf350000,0xbf353f80bf350000,0x3f7bbec4bf0e3f80,0xbf7b3ec43f0ebf80
.quad 0xbec4bf353f6d0000,0xbec4bf353f6d0000,0xbf0e3f6d3e48bf80,0x3f0ebf6dbe483f80
.quad 0x3f800000bf800000,0x3f800000bf800000,0xbf0ebf6d3e483f80,0x3f0e3f6dbe48bf80
.quad 0xbec43f353f6d0000,0xbec43f353f6d0000,0x3f7b3ec4bf0ebf80,0xbf7bbec43f0e3f80
.quad 0xbf35bf80bf350000,0xbf35bf80bf350000,0xbe483ec43f553f80,0x3e48bec4bf55bf80
.quad 0x3f6d3f353ec40000,0x3f6d3f353ec40000,0xbf55bf6dbf7bbf80,0x3f553f6d3f7b3f80
.quad 0x0,0x0,0xbe483ec4bf0e3f35,0x3e48bec43f0ebf35
.quad 0x3ec4bf353f6dbf80,0x3ec4bf353f6dbf80,0xbf0e3f6dbf7b3f35,0x3f0ebf6d3f7bbf35
.quad 0x3f35bf803f350000,0x3f35bf803f350000,0xbf553f6dbe48bf35,0x3f55bf6d3e483f35
.quad 0x3f6dbf35bec43f80,0x3f6dbf35bec43f80,0xbf7b3ec43f55bf35,0x3f7bbec4bf553f35
.quad 0x3f800000bf800000,0x3f800000bf800000,0xbf7bbec43f553f35,0x3f7b3ec4bf55bf35
.quad 0x3f6d3f35bec4bf80,0x3f6d3f35bec4bf80,0xbf55bf6dbe483f35,0x3f553f6d3e48bf35
.quad 0x3f353f803f350000,0x3f353f803f350000,0xbf0ebf6dbf7bbf35,0x3f0e3f6d3f7b3f35
.quad 0x3ec43f353f6d3f80,0x3ec43f353f6d3f80,0xbe48bec4bf0ebf35,0x3e483ec43f0e3f35
.quad 0x80003f80,0x80003f80,0x80003f80,0xbec43f6d
.quad 0x80003f80,0xbf353f35,0x80003f80,0xbf6d3ec4
.quad 0x80003f80,0xbf800000,0x80003f80,0xbf6dbec4
.quad 0x80003f80,0xbf35bf35,0x80003f80,0xbec4bf6d
.quad 0x80003f80,0x8000bf80,0x80003f80,0x3ec4bf6d
.quad 0x80003f80,0x3f35bf35,0x80003f80,0x3f6dbec4
.quad 0x80003f80,0x3f800000,0x80003f80,0x3f6d3ec4
.quad 0x80003f80,0x3f353f35,0x80003f80,0x3ec43f6d
.quad 0x80003f8000000000,0x80003f8000000000,0x80003f8000000000,0xbec43f6d00000000
.quad 0x80003f8000000000,0xbf353f3500000000,0x80003f8000000000,0xbf6d3ec400000000
.quad 0x80003f8000000000,0xbf80000000000000,0x80003f8000000000,0xbf6dbec400000000
.quad 0x80003f8000000000,0xbf35bf3500000000,0x80003f8000000000,0xbec4bf6d00000000
.quad 0x80003f8000000000,0x8000bf8000000000,0x80003f8000000000,0x3ec4bf6d00000000
.quad 0x80003f8000000000,0x3f35bf3500000000,0x80003f8000000000,0x3f6dbec400000000
.quad 0x80003f8000000000,0x3f80000000000000,0x80003f8000000000,0x3f6d3ec400000000
.quad 0x80003f8000000000,0x3f353f3500000000,0x80003f8000000000,0x3ec43f6d00000000
.quad 0x80003f80,0x80003f80,0xbf353f35,0xbf6d3ec4
.quad 0xbf800000,0xbf35bf35,0xbf35bf35,0x3ec4bf6d
.quad 0x8000bf80,0x3f800000,0x3f35bf35,0x3ec43f6d
.quad 0x3f800000,0xbf353f35,0x3f353f35,0xbf6dbec4
.quad 0x80003f80,0x8000bf80,0xbf353f35,0x3f6dbec4
.quad 0xbf800000,0x3f353f35,0xbf35bf35,0xbec43f6d
.quad 0x8000bf80,0xbf800000,0x3f35bf35,0xbec4bf6d
.quad 0x3f800000,0x3f35bf35,0x3f353f35,0x3f6d3ec4
.quad 0x80003f8000000000,0x80003f8000000000,0xbf353f3500000000,0xbf6d3ec400000000
.quad 0xbf80000000000000,0xbf35bf3500000000,0xbf35bf3500000000,0x3ec4bf6d00000000
.quad 0x8000bf8000000000,0x3f80000000000000,0x3f35bf3500000000,0x3ec43f6d00000000
.quad 0x3f80000000000000,0xbf353f3500000000,0x3f353f3500000000,0xbf6dbec400000000
.quad 0x80003f8000000000,0x8000bf8000000000,0xbf353f3500000000,0x3f6dbec400000000
.quad 0xbf80000000000000,0x3f353f3500000000,0xbf35bf3500000000,0xbec43f6d00000000
.quad 0x8000bf8000000000,0xbf80000000000000,0x3f35bf3500000000,0xbec4bf6d00000000
.quad 0x3f80000000000000,0x3f35bf3500000000,0x3f353f3500000000,0x3f6d3ec400000000
.quad 0x80003f80,0x80003f80,0xbf800000,0xbf6dbec4
.quad 0x8000bf80,0x3f35bf35,0x3f800000,0x3ec43f6d
.quad 0x80003f80,0xbf800000,0xbf800000,0x3ec4bf6d
.quad 0x8000bf80,0x3f353f35,0x3f800000,0xbf6d3ec4
.quad 0x80003f80,0x8000bf80,0xbf800000,0x3f6d3ec4
.quad 0x8000bf80,0xbf353f35,0x3f800000,0xbec4bf6d
.quad 0x80003f80,0x3f800000,0xbf800000,0xbec43f6d
.quad 0x8000bf80,0xbf35bf35,0x3f800000,0x3f6dbec4
.quad 0x80003f8000000000,0x80003f8000000000,0xbf80000000000000,0xbf6dbec400000000
.quad 0x8000bf8000000000,0x3f35bf3500000000,0x3f80000000000000,0x3ec43f6d00000000
.quad 0x80003f8000000000,0xbf80000000000000,0xbf80000000000000,0x3ec4bf6d00000000
.quad 0x8000bf8000000000,0x3f353f3500000000,0x3f80000000000000,0xbf6d3ec400000000
.quad 0x80003f8000000000,0x8000bf8000000000,0xbf80000000000000,0x3f6d3ec400000000
.quad 0x8000bf8000000000,0xbf353f3500000000,0x3f80000000000000,0xbec4bf6d00000000
.quad 0x80003f8000000000,0x3f80000000000000,0xbf80000000000000,0xbec43f6d00000000
.quad 0x8000bf8000000000,0xbf35bf3500000000,0x3f80000000000000,0x3f6dbec400000000
.quad 0x80003f80,0x80003f80,0xbf35bf35,0xbec4bf6d
.quad 0x3f800000,0x3f353f35,0xbf353f35,0xbf6dbec4
.quad 0x8000bf80,0x3f800000,0x3f353f35,0xbf6d3ec4
.quad 0xbf800000,0x3f35bf35,0x3f35bf35,0xbec43f6d
.quad 0x80003f80,0x8000bf80,0xbf35bf35,0x3ec43f6d
.quad 0x3f800000,0xbf35bf35,0xbf353f35,0x3f6d3ec4
.quad 0x8000bf80,0xbf800000,0x3f353f35,0x3f6dbec4
.quad 0xbf800000,0xbf353f35,0x3f35bf35,0x3ec4bf6d
.quad 0x80003f8000000000,0x80003f8000000000,0xbf35bf3500000000,0xbec4bf6d00000000
.quad 0x3f80000000000000,0x3f353f3500000000,0xbf353f3500000000,0xbf6dbec400000000
.quad 0x8000bf8000000000,0x3f80000000000000,0x3f353f3500000000,0xbf6d3ec400000000
.quad 0xbf80000000000000,0x3f35bf3500000000,0x3f35bf3500000000,0xbec43f6d00000000
.quad 0x80003f8000000000,0x8000bf8000000000,0xbf35bf3500000000,0x3ec43f6d00000000
.quad 0x3f80000000000000,0xbf35bf3500000000,0xbf353f3500000000,0x3f6d3ec400000000
.quad 0x8000bf8000000000,0xbf80000000000000,0x3f353f3500000000,0x3f6dbec400000000
.quad 0xbf80000000000000,0xbf353f3500000000,0x3f35bf3500000000,0x3ec4bf6d00000000
.quad 0x3f800000,0x3f800000,0x3f800000,0x3f6d3ec4
.quad 0x3f800000,0x3f353f35,0x3f800000,0x3ec43f6d
.quad 0x3f800000,0x3f80,0x3f800000,0xbec43f6d
.quad 0x3f800000,0xbf353f35,0x3f800000,0xbf6d3ec4
.quad 0x3f800000,0xbf800000,0x3f800000,0xbf6dbec4
.quad 0x3f800000,0xbf35bf35,0x3f800000,0xbec4bf6d
.quad 0x3f800000,0xbf80,0x3f800000,0x3ec4bf6d
.quad 0x3f800000,0x3f35bf35,0x3f800000,0x3f6dbec4
.quad 0x3f80000000000000,0x3f80000000000000,0x3f80000000000000,0x3f6d3ec400000000
.quad 0x3f80000000000000,0x3f353f3500000000,0x3f80000000000000,0x3ec43f6d00000000
.quad 0x3f80000000000000,0x3f8000000000,0x3f80000000000000,0xbec43f6d00000000
.quad 0x3f80000000000000,0xbf353f3500000000,0x3f80000000000000,0xbf6d3ec400000000
.quad 0x3f80000000000000,0xbf80000000000000,0x3f80000000000000,0xbf6dbec400000000
.quad 0x3f80000000000000,0xbf35bf3500000000,0x3f80000000000000,0xbec4bf6d00000000
.quad 0x3f80000000000000,0xbf8000000000,0x3f80000000000000,0x3ec4bf6d00000000
.quad 0x3f80000000000000,0x3f35bf3500000000,0x3f80000000000000,0x3f6dbec400000000
.quad 0x3f800000,0x3f800000,0x3f353f35,0x3ec43f6d
.quad 0x3f80,0xbf353f35,0xbf353f35,0xbf6dbec4
.quad 0xbf800000,0xbf80,0xbf35bf35,0x3f6dbec4
.quad 0xbf80,0x3f353f35,0x3f35bf35,0xbec43f6d
.quad 0x3f800000,0xbf800000,0x3f353f35,0xbec4bf6d
.quad 0x3f80,0x3f35bf35,0xbf353f35,0x3f6d3ec4
.quad 0xbf800000,0x3f80,0xbf35bf35,0xbf6d3ec4
.quad 0xbf80,0xbf35bf35,0x3f35bf35,0x3ec4bf6d
.quad 0x3f80000000000000,0x3f80000000000000,0x3f353f3500000000,0x3ec43f6d00000000
.quad 0x3f8000000000,0xbf353f3500000000,0xbf353f3500000000,0xbf6dbec400000000
.quad 0xbf80000000000000,0xbf8000000000,0xbf35bf3500000000,0x3f6dbec400000000
.quad 0xbf8000000000,0x3f353f3500000000,0x3f35bf3500000000,0xbec43f6d00000000
.quad 0x3f80000000000000,0xbf80000000000000,0x3f353f3500000000,0xbec4bf6d00000000
.quad 0x3f8000000000,0x3f35bf3500000000,0xbf353f3500000000,0x3f6d3ec400000000
.quad 0xbf80000000000000,0x3f8000000000,0xbf35bf3500000000,0xbf6d3ec400000000
.quad 0xbf8000000000,0xbf35bf3500000000,0x3f35bf3500000000,0x3ec4bf6d00000000
.quad 0x3f800000,0x3f800000,0x3f80,0xbec43f6d
.quad 0xbf800000,0xbf35bf35,0xbf80,0x3f6dbec4
.quad 0x3f800000,0x3f80,0x3f80,0xbf6dbec4
.quad 0xbf800000,0x3f35bf35,0xbf80,0x3ec43f6d
.quad 0x3f800000,0xbf800000,0x3f80,0x3ec4bf6d
.quad 0xbf800000,0x3f353f35,0xbf80,0xbf6d3ec4
.quad 0x3f800000,0xbf80,0x3f80,0x3f6d3ec4
.quad 0xbf800000,0xbf353f35,0xbf80,0xbec4bf6d
.quad 0x3f80000000000000,0x3f80000000000000,0x3f8000000000,0xbec43f6d00000000
.quad 0xbf80000000000000,0xbf35bf3500000000,0xbf8000000000,0x3f6dbec400000000
.quad 0x3f80000000000000,0x3f8000000000,0x3f8000000000,0xbf6dbec400000000
.quad 0xbf80000000000000,0x3f35bf3500000000,0xbf8000000000,0x3ec43f6d00000000
.quad 0x3f80000000000000,0xbf80000000000000,0x3f8000000000,0x3ec4bf6d00000000
.quad 0xbf80000000000000,0x3f353f3500000000,0xbf8000000000,0xbf6d3ec400000000
.quad 0x3f80000000000000,0xbf8000000000,0x3f8000000000,0x3f6d3ec400000000
.quad 0xbf80000000000000,0xbf353f3500000000,0xbf8000000000,0xbec4bf6d00000000
.quad 0x3f800000,0x3f800000,0xbf353f35,0xbf6d3ec4
.quad 0xbf80,0x3f35bf35,0x3f353f35,0xbec43f6d
.quad 0xbf800000,0xbf80,0x3f35bf35,0x3ec43f6d
.quad 0x3f80,0xbf35bf35,0xbf35bf35,0x3f6d3ec4
.quad 0x3f800000,0xbf800000,0xbf353f35,0x3f6dbec4
.quad 0xbf80,0xbf353f35,0x3f353f35,0x3ec4bf6d
.quad 0xbf800000,0x3f80,0x3f35bf35,0xbec4bf6d
.quad 0x3f80,0x3f353f35,0xbf35bf35,0xbf6dbec4
.quad 0x3f80000000000000,0x3f80000000000000,0xbf353f3500000000,0xbf6d3ec400000000
.quad 0xbf8000000000,0x3f35bf3500000000,0x3f353f3500000000,0xbec43f6d00000000
.quad 0xbf80000000000000,0xbf8000000000,0x3f35bf3500000000,0x3ec43f6d00000000
.quad 0x3f8000000000,0xbf35bf3500000000,0xbf35bf3500000000,0x3f6d3ec400000000
.quad 0x3f80000000000000,0xbf80000000000000,0xbf353f3500000000,0x3f6dbec400000000
.quad 0xbf8000000000,0xbf353f3500000000,0x3f353f3500000000,0x3ec4bf6d00000000
.quad 0xbf80000000000000,0x3f8000000000,0x3f35bf3500000000,0xbec4bf6d00000000
.quad 0x3f8000000000,0x3f353f3500000000,0xbf35bf3500000000,0xbf6dbec400000000
.quad 0x3f803f803f803f80,0x8000800080008000,0x3f553f6d3f7b3f80,0xbf0ebec4be488000
.quad 0x3ec43f353f6d3f80,0xbf6dbf35bec48000,0xbe483ec43f553f80,0xbf7bbf6dbf0e8000
.quad 0xbf3500003f353f80,0xbf35bf80bf358000,0xbf7bbec43f0e3f80,0xbe48bf6dbf558000
.quad 0xbf6dbf353ec43f80,0x3ec4bf35bf6d8000,0xbf0ebf6d3e483f80,0x3f55bec4bf7b8000
.quad 0xbf8000003f80,0x3f808000bf808000,0x3f0ebf6dbe483f80,0x3f553ec4bf7b8000
.quad 0x3f6dbf35bec43f80,0x3ec43f35bf6d8000,0x3f7bbec4bf0e3f80,0xbe483f6dbf558000
.quad 0x3f350000bf353f80,0xbf353f80bf358000,0x3e483ec4bf553f80,0xbf7b3f6dbf0e8000
.quad 0xbec43f35bf6d3f80,0xbf6d3f35bec48000,0xbf553f6dbf7b3f80,0xbf0e3ec4be488000
.quad 0xbf803f80bf803f80,0x8000800080008000,0xbf553f6dbf7b3f80,0x3f0ebec43e488000
.quad 0xbec43f35bf6d3f80,0x3f6dbf353ec48000,0x3e483ec4bf553f80,0x3f7bbf6d3f0e8000
.quad 0x3f350000bf353f80,0x3f35bf803f358000,0x3f7bbec4bf0e3f80,0x3e48bf6d3f558000
.quad 0x3f6dbf35bec43f80,0xbec4bf353f6d8000,0x3f0ebf6dbe483f80,0xbf55bec43f7b8000
.quad 0xbf8000003f80,0xbf8080003f808000,0xbf0ebf6d3e483f80,0xbf553ec43f7b8000
.quad 0xbf6dbf353ec43f80,0xbec43f353f6d8000,0xbf7bbec43f0e3f80,0x3e483f6d3f558000
.quad 0xbf3500003f353f80,0x3f353f803f358000,0xbe483ec43f553f80,0x3f7b3f6d3f0e8000
.quad 0x3ec43f353f6d3f80,0x3f6d3f353ec48000,0x3f553f6d3f7b3f80,0x3f0e3ec43e488000
.quad 0x3f803f803f803f80,0x8000800080008000,0x3e483ec43f0e3f35,0xbf7bbf6dbf55bf35
.quad 0xbf6dbf35bec40000,0xbec4bf35bf6dbf80,0xbf0ebf6dbf7bbf35,0x3f553ec4be48bf35
.quad 0x3f350000bf35bf80,0x3f353f803f358000,0x3f553f6d3e48bf35,0xbf0e3ec43f7b3f35
.quad 0xbec43f353f6d0000,0xbf6dbf353ec43f80,0xbf7bbec43f553f35,0x3e48bf6dbf0e3f35
.quad 0xbf8000003f80,0x3f808000bf808000,0x3f7bbec4bf553f35,0x3e483f6dbf0ebf35
.quad 0x3ec43f35bf6d0000,0xbf6d3f353ec4bf80,0xbf553f6dbe48bf35,0xbf0ebec43f7bbf35
.quad 0xbf3500003f35bf80,0x3f35bf803f358000,0x3f0ebf6d3f7bbf35,0x3f55bec4be483f35
.quad 0x3f6dbf353ec40000,0xbec43f35bf6d3f80,0xbe483ec4bf0e3f35,0xbf7b3f6dbf553f35
.quad 0xbf803f80bf803f80,0x8000800080008000,0xbe483ec4bf0e3f35,0x3f7bbf6d3f55bf35
.quad 0x3f6dbf353ec40000,0x3ec4bf353f6dbf80,0x3f0ebf6d3f7bbf35,0xbf553ec43e48bf35
.quad 0xbf3500003f35bf80,0xbf353f80bf358000,0xbf553f6dbe48bf35,0x3f0e3ec4bf7b3f35
.quad 0x3ec43f35bf6d0000,0x3f6dbf35bec43f80,0x3f7bbec4bf553f35,0xbe48bf6d3f0e3f35
.quad 0xbf8000003f80,0xbf8080003f808000,0xbf7bbec43f553f35,0xbe483f6d3f0ebf35
.quad 0xbec43f353f6d0000,0x3f6d3f35bec4bf80,0x3f553f6d3e48bf35,0x3f0ebec4bf7bbf35
.quad 0x3f350000bf35bf80,0xbf35bf80bf358000,0xbf0ebf6dbf7bbf35,0xbf55bec43e483f35
.quad 0xbf6dbf35bec40000,0x3ec43f353f6d3f80,0x3e483ec43f0e3f35,0x3f7b3f6d3f553f35
.quad 0x3f803f803f803f80,0x8000800080008000,0xbf0ebec4be480000,0xbf55bf6dbf7bbf80
.quad 0xbec4bf35bf6dbf80,0x3f6d3f353ec48000,0x3f7b3f6d3f0e0000,0xbe483ec43f553f80
.quad 0xbf3500003f353f80,0xbf35bf80bf358000,0xbe48bf6dbf550000,0x3f7b3ec4bf0ebf80
.quad 0x3f6d3f35bec4bf80,0xbec43f353f6d8000,0xbf553ec43f7b0000,0xbf0ebf6d3e483f80
.quad 0xbf8000003f80,0x3f808000bf808000,0x3f553ec4bf7b0000,0xbf0e3f6d3e48bf80
.quad 0xbf6d3f353ec4bf80,0xbec4bf353f6d8000,0x3e48bf6d3f550000,0x3f7bbec4bf0e3f80
.quad 0x3f350000bf353f80,0xbf353f80bf358000,0xbf7b3f6dbf0e0000,0xbe48bec43f55bf80
.quad 0x3ec4bf353f6dbf80,0x3f6dbf353ec48000,0x3f0ebec43e480000,0xbf553f6dbf7b3f80
.quad 0xbf803f80bf803f80,0x8000800080008000,0x3f0ebec43e480000,0x3f55bf6d3f7bbf80
.quad 0x3ec4bf353f6dbf80,0xbf6d3f35bec48000,0xbf7b3f6dbf0e0000,0x3e483ec4bf553f80
.quad 0x3f350000bf353f80,0x3f35bf803f358000,0x3e48bf6d3f550000,0xbf7b3ec43f0ebf80
.quad 0xbf6d3f353ec4bf80,0x3ec43f35bf6d8000,0x3f553ec4bf7b0000,0x3f0ebf6dbe483f80
.quad 0xbf8000003f80,0xbf8080003f808000,0xbf553ec43f7b0000,0x3f0e3f6dbe48bf80
.quad 0x3f6d3f35bec4bf80,0x3ec4bf35bf6d8000,0xbe48bf6dbf550000,0xbf7bbec43f0e3f80
.quad 0xbf3500003f353f80,0x3f353f803f358000,0x3f7b3f6d3f0e0000,0x3e48bec4bf55bf80
.quad 0xbec4bf35bf6dbf80,0xbf6dbf35bec48000,0xbf0ebec4be480000,0x3f553f6d3f7b3f80
.quad 0x3f803f803f803f80,0x8000800080008000,0xbf7bbf6dbf55bf35,0xbe48bec4bf0ebf35
.quad 0x3f6d3f353ec40000,0x3ec43f353f6d3f80,0xbf55bec43e483f35,0xbf0ebf6dbf7bbf35
.quad 0x3f350000bf35bf80,0x3f353f803f358000,0xbf0e3ec43f7b3f35,0xbf55bf6dbe483f35
.quad 0x3ec4bf35bf6d0000,0x3f6d3f35bec4bf80,0xbe483f6d3f0ebf35,0xbf7bbec43f553f35
.quad 0xbf8000003f80,0x3f808000bf808000,0x3e483f6dbf0ebf35,0xbf7b3ec43f55bf35
.quad 0xbec4bf353f6d0000,0x3f6dbf35bec43f80,0x3f0e3ec4bf7b3f35,0xbf553f6dbe48bf35
.quad 0xbf3500003f35bf80,0x3f35bf803f358000,0x3f55bec4be483f35,0xbf0e3f6dbf7b3f35
.quad 0xbf6d3f35bec40000,0x3ec4bf353f6dbf80,0x3f7bbf6d3f55bf35,0xbe483ec4bf0e3f35
.quad 0xbf803f80bf803f80,0x8000800080008000,0x3f7bbf6d3f55bf35,0x3e48bec43f0ebf35
.quad 0xbf6d3f35bec40000,0xbec43f35bf6d3f80,0x3f55bec4be483f35,0x3f0ebf6d3f7bbf35
.quad 0xbf3500003f35bf80,0xbf353f80bf358000,0x3f0e3ec4bf7b3f35,0x3f55bf6d3e483f35
.quad 0xbec4bf353f6d0000,0xbf6d3f353ec4bf80,0x3e483f6dbf0ebf35,0x3f7bbec4bf553f35
.quad 0xbf8000003f80,0xbf8080003f808000,0xbe483f6d3f0ebf35,0x3f7b3ec4bf55bf35
.quad 0x3ec4bf35bf6d0000,0xbf6dbf353ec43f80,0xbf0e3ec43f7b3f35,0x3f553f6d3e48bf35
.quad 0x3f350000bf35bf80,0xbf35bf80bf358000,0xbf55bec43e483f35,0x3f0e3f6d3f7b3f35
.quad 0x3f6d3f353ec40000,0xbec4bf35bf6dbf80,0xbf7bbf6dbf55bf35,0x3e483ec43f0e3f35
.quad 0x3f803f803f803f80,0x8000800080008000,0xbf55bf6dbf7bbf80,0x3f0e3ec43e488000
.quad 0x3ec43f353f6d3f80,0xbf6dbf35bec48000,0x3e48bec4bf55bf80,0x3f7b3f6d3f0e8000
.quad 0xbf3500003f353f80,0xbf35bf80bf358000,0x3f7b3ec4bf0ebf80,0x3e483f6d3f558000
.quad 0xbf6dbf353ec43f80,0x3ec4bf35bf6d8000,0x3f0e3f6dbe48bf80,0xbf553ec43f7b8000
.quad 0xbf8000003f80,0x3f808000bf808000,0xbf0e3f6d3e48bf80,0xbf55bec43f7b8000
.quad 0x3f6dbf35bec43f80,0x3ec43f35bf6d8000,0xbf7b3ec43f0ebf80,0x3e48bf6d3f558000
.quad 0x3f350000bf353f80,0xbf353f80bf358000,0xbe48bec43f55bf80,0x3f7bbf6d3f0e8000
.quad 0xbec43f35bf6d3f80,0xbf6d3f35bec48000,0x3f55bf6d3f7bbf80,0x3f0ebec43e488000
.quad 0xbf803f80bf803f80,0x8000800080008000,0x3f55bf6d3f7bbf80,0xbf0e3ec4be488000
.quad 0xbec43f35bf6d3f80,0x3f6dbf353ec48000,0xbe48bec43f55bf80,0xbf7b3f6dbf0e8000
.quad 0x3f350000bf353f80,0x3f35bf803f358000,0xbf7b3ec43f0ebf80,0xbe483f6dbf558000
.quad 0x3f6dbf35bec43f80,0xbec4bf353f6d8000,0xbf0e3f6d3e48bf80,0x3f553ec4bf7b8000
.quad 0xbf8000003f80,0xbf8080003f808000,0x3f0e3f6dbe48bf80,0x3f55bec4bf7b8000
.quad 0xbf6dbf353ec43f80,0xbec43f353f6d8000,0x3f7b3ec4bf0ebf80,0xbe48bf6dbf558000
.quad 0xbf3500003f353f80,0x3f353f803f358000,0x3e48bec4bf55bf80,0xbf7bbf6dbf0e8000
.quad 0x3ec43f353f6d3f80,0x3f6d3f353ec48000,0xbf55bf6dbf7bbf80,0xbf0ebec4be488000
.quad 0x3f803f803f803f80,0x8000800080008000,0xbe48bec4bf0ebf35,0x3f7b3f6d3f553f35
.quad 0xbf6dbf35bec40000,0xbec4bf35bf6dbf80,0x3f0e3f6d3f7b3f35,0xbf55bec43e483f35
.quad 0x3f350000bf35bf80,0x3f353f803f358000,0xbf55bf6dbe483f35,0x3f0ebec4bf7bbf35
.quad 0xbec43f353f6d0000,0xbf6dbf353ec43f80,0x3f7b3ec4bf55bf35,0xbe483f6d3f0ebf35
.quad 0xbf8000003f80,0x3f808000bf808000,0xbf7b3ec43f55bf35,0xbe48bf6d3f0e3f35
.quad 0x3ec43f35bf6d0000,0xbf6d3f353ec4bf80,0x3f55bf6d3e483f35,0x3f0e3ec4bf7b3f35
.quad 0xbf3500003f35bf80,0x3f35bf803f358000,0xbf0e3f6dbf7b3f35,0xbf553ec43e48bf35
.quad 0x3f6dbf353ec40000,0xbec43f35bf6d3f80,0x3e48bec43f0ebf35,0x3f7bbf6d3f55bf35
.quad 0xbf803f80bf803f80,0x8000800080008000,0x3e48bec43f0ebf35,0xbf7b3f6dbf553f35
.quad 0x3f6dbf353ec40000,0x3ec4bf353f6dbf80,0xbf0e3f6dbf7b3f35,0x3f55bec4be483f35
.quad 0xbf3500003f35bf80,0xbf353f80bf358000,0x3f55bf6d3e483f35,0xbf0ebec43f7bbf35
.quad 0x3ec43f35bf6d0000,0x3f6dbf35bec43f80,0xbf7b3ec43f55bf35,0x3e483f6dbf0ebf35
.quad 0xbf8000003f80,0xbf8080003f808000,0x3f7b3ec4bf55bf35,0x3e48bf6dbf0e3f35
.quad 0xbec43f353f6d0000,0x3f6d3f35bec4bf80,0xbf55bf6dbe483f35,0xbf0e3ec43f7b3f35
.quad 0x3f350000bf35bf80,0xbf35bf80bf358000,0x3f0e3f6d3f7b3f35,0x3f553ec4be48bf35
.quad 0xbf6dbf35bec40000,0x3ec43f353f6d3f80,0xbe48bec4bf0ebf35,0xbf7bbf6dbf55bf35
.quad 0x3f803f803f803f80,0x8000800080008000,0x3f0e3ec43e480000,0x3f553f6d3f7b3f80
.quad 0xbec4bf35bf6dbf80,0x3f6d3f353ec48000,0xbf7bbf6dbf0e0000,0x3e48bec4bf55bf80
.quad 0xbf3500003f353f80,0xbf35bf80bf358000,0x3e483f6d3f550000,0xbf7bbec43f0e3f80
.quad 0x3f6d3f35bec4bf80,0xbec43f353f6d8000,0x3f55bec4bf7b0000,0x3f0e3f6dbe48bf80
.quad 0xbf8000003f80,0x3f808000bf808000,0xbf55bec43f7b0000,0x3f0ebf6dbe483f80
.quad 0xbf6d3f353ec4bf80,0xbec4bf353f6d8000,0xbe483f6dbf550000,0xbf7b3ec43f0ebf80
.quad 0x3f350000bf353f80,0xbf353f80bf358000,0x3f7bbf6d3f0e0000,0x3e483ec4bf553f80
.quad 0x3ec4bf353f6dbf80,0x3f6dbf353ec48000,0xbf0e3ec4be480000,0x3f55bf6d3f7bbf80
.quad 0xbf803f80bf803f80,0x8000800080008000,0xbf0e3ec4be480000,0xbf553f6dbf7b3f80
.quad 0x3ec4bf353f6dbf80,0xbf6d3f35bec48000,0x3f7bbf6d3f0e0000,0xbe48bec43f55bf80
.quad 0x3f350000bf353f80,0x3f35bf803f358000,0xbe483f6dbf550000,0x3f7bbec4bf0e3f80
.quad 0xbf6d3f353ec4bf80,0x3ec43f35bf6d8000,0xbf55bec43f7b0000,0xbf0e3f6d3e48bf80
.quad 0xbf8000003f80,0xbf8080003f808000,0x3f55bec4bf7b0000,0xbf0ebf6d3e483f80
.quad 0x3f6d3f35bec4bf80,0x3ec4bf35bf6d8000,0x3e483f6d3f550000,0x3f7b3ec4bf0ebf80
.quad 0xbf3500003f353f80,0x3f353f803f358000,0xbf7bbf6dbf0e0000,0xbe483ec43f553f80
.quad 0xbec4bf35bf6dbf80,0xbf6dbf35bec48000,0x3f0e3ec43e480000,0xbf55bf6dbf7bbf80
.quad 0x3f803f803f803f80,0x8000800080008000,0x3f7b3f6d3f553f35,0x3e483ec43f0e3f35
.quad 0x3f6d3f353ec40000,0x3ec43f353f6d3f80,0x3f553ec4be48bf35,0x3f0e3f6d3f7b3f35
.quad 0x3f350000bf35bf80,0x3f353f803f358000,0x3f0ebec4bf7bbf35,0x3f553f6d3e48bf35
.quad 0x3ec4bf35bf6d0000,0x3f6d3f35bec4bf80,0x3e48bf6dbf0e3f35,0x3f7b3ec4bf55bf35
.quad 0xbf8000003f80,0x3f808000bf808000,0xbe48bf6d3f0e3f35,0x3f7bbec4bf553f35
.quad 0xbec4bf353f6d0000,0x3f6dbf35bec43f80,0xbf0ebec43f7bbf35,0x3f55bf6d3e483f35
.quad 0xbf3500003f35bf80,0x3f35bf803f358000,0xbf553ec43e48bf35,0x3f0ebf6d3f7bbf35
.quad 0xbf6d3f35bec40000,0x3ec4bf353f6dbf80,0xbf7b3f6dbf553f35,0x3e48bec43f0ebf35
.quad 0xbf803f80bf803f80,0x8000800080008000,0xbf7b3f6dbf553f35,0xbe483ec4bf0e3f35
.quad 0xbf6d3f35bec40000,0xbec43f35bf6d3f80,0xbf553ec43e48bf35,0xbf0e3f6dbf7b3f35
.quad 0xbf3500003f35bf80,0xbf353f80bf358000,0xbf0ebec43f7bbf35,0xbf553f6dbe48bf35
.quad 0xbec4bf353f6d0000,0xbf6d3f353ec4bf80,0xbe48bf6d3f0e3f35,0xbf7b3ec43f55bf35
.quad 0xbf8000003f80,0xbf8080003f808000,0x3e48bf6dbf0e3f35,0xbf7bbec43f553f35
.quad 0x3ec4bf35bf6d0000,0xbf6dbf353ec43f80,0x3f0ebec4bf7bbf35,0xbf55bf6dbe483f35
.quad 0x3f350000bf35bf80,0xbf35bf80bf358000,0x3f553ec4be48bf35,0xbf0ebf6dbf7bbf35
.quad 0x3f6d3f353ec40000,0xbec4bf35bf6dbf80,0x3f7b3f6d3f553f35,0xbe48bec4bf0ebf35
.quad 0x3f8000003f800000,0x3f8000003f800000,0x3f7ffb113f800000,0x3f7fd3973f7fec43
.quad 0x3f7fec433f800000,0x3f7f4e6d3f7fb10f,0x3f7fd3973f800000,0x3f7e70b03f7f4e6d
.quad 0x3f7fb10f3f800000,0x3f7d3aac3f7ec46d,0x3f7f84ab3f800000,0x3f7baccd3f7e1324
.quad 0x3f7f4e6d3f800000,0x3f79c79d3f7d3aac,0x3f7f0e583f800000,0x3f778bc53f7c3b28
.quad 0x3f7ec46d3f800000,0x3f74fa0b3f7b14be,0x3f7e70b03f800000,0x3f7213523f79c79d
.quad 0x3f7e13243f800000,0x3f6ed89e3f7853f8,0x3f7dabcc3f800000,0x3f6b4b0c3f76ba07
.quad 0x3f7d3aac3f800000,0x3f676bd83f74fa0b,0x3f7cbfc93f800000,0x3f633c5a3f731447
.quad 0x3f7c3b283f800000,0x3f5ebe053f710908,0x3f7baccd3f800000,0x3f59f26a3f6ed89e
.quad 0x3f8000003f800000,0x3f8000003f800000,0x3f7ffb113f800000,0x3f7fd3973f7fec43
.quad 0x3f7fec433f800000,0x3f7f4e6d3f7fb10f,0x3f7fd3973f800000,0x3f7e70b03f7f4e6d
.quad 0x3f7fb10f3f800000,0x3f7d3aac3f7ec46d,0x3f7f84ab3f800000,0x3f7baccd3f7e1324
.quad 0x3f7f4e6d3f800000,0x3f79c79d3f7d3aac,0x3f7f0e583f800000,0x3f778bc53f7c3b28
.quad 0x3f7ec46d3f800000,0x3f74fa0b3f7b14be,0x3f7e70b03f800000,0x3f7213523f79c79d
.quad 0x3f7e13243f800000,0x3f6ed89e3f7853f8,0x3f7dabcc3f800000,0x3f6b4b0c3f76ba07
.quad 0x3f7d3aac3f800000,0x3f676bd83f74fa0b,0x3f7cbfc93f800000,0x3f633c5a3f731447
.quad 0x3f7c3b283f800000,0x3f5ebe053f710908,0x3f7baccd3f800000,0x3f59f26a3f6ed89e
.quad 0x3f8000003f800000,0x3f8000003f800000,0x3f7f84ab3f7fb10f,0x3f7f0e583f7f4e6d
.quad 0x3f7e13243f7ec46d,0x3f7c3b283f7d3aac,0x3f7baccd3f7d3aac,0x3f778bc53f79c79d
.quad 0x3f7853f83f7b14be,0x3f7109083f74fa0b,0x3f740bdd3f7853f8,0x3f68bf3c3f6ed89e
.quad 0x3f6ed89e3f74fa0b,0x3f5ebe053f676bd8,0x3f68bf3c3f710908,0x3f5318493f5ebe05
.quad 0x3f61c5983f6c835e,0x3f45e4033f54db31,0x3f59f26a3f676bd8,0x3f373a233f49d112
.quad 0x3f514d3d3f61c598,0x3f2736563f3daef9,0x3f47de653f5b941a,0x3f15f6d93f3085bb
.quad 0x3f3daef93f54db31,0x3f039c3d3f226799,0x3f32c8c93f4d9f02,0x3ee0924f3f13682a
.quad 0x3f2736563f45e403,0x3eb8442a3f039c3d,0x3f1b02c63f3daef9,0x3e8e9a223ee63375
.quad 0x3f8000003f800000,0x3f8000003f800000,0x3f7f84ab3f7fb10f,0x3f7f0e583f7f4e6d
.quad 0x3f7e13243f7ec46d,0x3f7c3b283f7d3aac,0x3f7baccd3f7d3aac,0x3f778bc53f79c79d
.quad 0x3f7853f83f7b14be,0x3f7109083f74fa0b,0x3f740bdd3f7853f8,0x3f68bf3c3f6ed89e
.quad 0x3f6ed89e3f74fa0b,0x3f5ebe053f676bd8,0x3f68bf3c3f710908,0x3f5318493f5ebe05
.quad 0x3f61c5983f6c835e,0x3f45e4033f54db31,0x3f59f26a3f676bd8,0x3f373a233f49d112
.quad 0x3f514d3d3f61c598,0x3f2736563f3daef9,0x3f47de653f5b941a,0x3f15f6d93f3085bb
.quad 0x3f3daef93f54db31,0x3f039c3d3f226799,0x3f32c8c93f4d9f02,0x3ee0924f3f13682a
.quad 0x3f2736563f45e403,0x3eb8442a3f039c3d,0x3f1b02c63f3daef9,0x3e8e9a223ee63375
.quad 0x3f8000003f800000,0x3f8000003f800000,0x3f7e70b03f7ec46d,0x3f7dabcc3f7e1324
.quad 0x3f79c79d3f7b14be,0x3f76ba073f7853f8,0x3f7213523f74fa0b,0x3f6b4b0c3f6ed89e
.quad 0x3f676bd83f6c835e,0x3f5b941a3f61c598,0x3f59f26a3f61c598,0x3f47de653f514d3d
.quad 0x3f49d1123f54db31,0x3f3085bb3f3daef9,0x3f373a233f45e403,0x3f15f6d93f273656
.quad 0x3f2267993f3504f3,0x3ef15aea3f0e39da,0x3f0b9a6b3f226799,0x3eb263ef3ee63375
.quad 0x3ee633753f0e39da,0x3e605c133eac7cd4,0x3eb263ef3ef15aea,0x3dafb6803e605c13
.quad 0x3e78cfcc3ec3ef15,0xbd48fb303dc8bd36,0x3e09cf863e94a031,0xbe3b6ecfbcc90ab0
.quad 0x3cc90ab03e47c5c2,0xbea09ae5be164083,0xbdafb6803dc8bd36,0xbee0924fbe888e93
.quad 0x3f8000003f800000,0x3f8000003f800000,0x3f7e70b03f7ec46d,0x3f7dabcc3f7e1324
.quad 0x3f79c79d3f7b14be,0x3f76ba073f7853f8,0x3f7213523f74fa0b,0x3f6b4b0c3f6ed89e
.quad 0x3f676bd83f6c835e,0x3f5b941a3f61c598,0x3f59f26a3f61c598,0x3f47de653f514d3d
.quad 0x3f49d1123f54db31,0x3f3085bb3f3daef9,0x3f373a233f45e403,0x3f15f6d93f273656
.quad 0x3f2267993f3504f3,0x3ef15aea3f0e39da,0x3f0b9a6b3f226799,0x3eb263ef3ee63375
.quad 0x3ee633753f0e39da,0x3e605c133eac7cd4,0x3eb263ef3ef15aea,0x3dafb6803e605c13
.quad 0x3e78cfcc3ec3ef15,0xbd48fb303dc8bd36,0x3e09cf863e94a031,0xbe3b6ecfbcc90ab0
.quad 0x3cc90ab03e47c5c2,0xbea09ae5be164083,0xbdafb6803dc8bd36,0xbee0924fbe888e93
.quad 0x3f8000003f800000,0x3f8000003f800000,0x3f7cbfc93f7d3aac,0x3f7baccd3f7c3b28
.quad 0x3f7314473f74fa0b,0x3f6ed89e3f710908,0x3f633c5a3f676bd8,0x3f59f26a3f5ebe05
.quad 0x3f4d9f023f54db31,0x3f3daef93f45e403,0x3f32c8c93f3daef9,0x3f1b02c63f273656
.quad 0x3f13682a3f226799,0x3ee633753f039c3d,0x3ee0924f3f039c3d,0x3e8e9a223eb8442a
.quad 0x3e94a0313ec3ef15,0x3dc8bd363e47c5c2,0x3e09cf863e78cfcc,0xbdafb6803cc90ab0
.quad 0xbcc90ab03dc8bd36,0xbe888e93be164083,0xbe3b6ecfbd48fb30,0xbee0924fbea09ae5
.quad 0xbeac7cd4be47c5c2,0xbf187fc0bef15aea,0xbef6e0cbbeac7cd4,0xbf3b8f3bbf1d7fd1
.quad 0xbf1d7fd1bef15aea,0xbf584853bf3daef9,0xbf3b8f3bbf187fc0,0xbf6db293bf584853
.quad 0x3f8000003f800000,0x3f8000003f800000,0x3f7cbfc93f7d3aac,0x3f7baccd3f7c3b28
.quad 0x3f7314473f74fa0b,0x3f6ed89e3f710908,0x3f633c5a3f676bd8,0x3f59f26a3f5ebe05
.quad 0x3f4d9f023f54db31,0x3f3daef93f45e403,0x3f32c8c93f3daef9,0x3f1b02c63f273656
.quad 0x3f13682a3f226799,0x3ee633753f039c3d,0x3ee0924f3f039c3d,0x3e8e9a223eb8442a
.quad 0x3e94a0313ec3ef15,0x3dc8bd363e47c5c2,0x3e09cf863e78cfcc,0xbdafb6803cc90ab0
.quad 0xbcc90ab03dc8bd36,0xbe888e93be164083,0xbe3b6ecfbd48fb30,0xbee0924fbea09ae5
.quad 0xbeac7cd4be47c5c2,0xbf187fc0bef15aea,0xbef6e0cbbeac7cd4,0xbf3b8f3bbf1d7fd1
.quad 0xbf1d7fd1bef15aea,0xbf584853bf3daef9,0xbf3b8f3bbf187fc0,0xbf6db293bf584853
.quad 0x3f8000003f800000,0x3f8000003f800000,0x3f7a73023f7b14be,0x3f7912983f79c79d
.quad 0x3f6a09a73f6c835e,0x3f64aa593f676bd8,0x3f4f7a1f3f54db31,0x3f43e2003f49d112
.quad 0x3f2beb4a3f3504f3,0x3f187fc03f226799,0x3f00e7e43f0e39da,0x3ec9b9533ee63375
.quad 0x3ea09ae53ec3ef15,0x3e2f10a23e78cfcc,0x3de1bc2e3e47c5c2,0xbd7b2b743cc90ab0
.quad 0xbdc8bd3600000000,0xbe94a031be47c5c2,0xbe9aa086be47c5c2,0xbf00e7e4becf7bca
.quad 0xbefc5d27bec3ef15,0xbf3085bbbf187fc0,0xbf299415bf0e39da,0xbf5695e5bf41d870
.quad 0xbf4d9f02bf3504f3,0xbf710908bf61c598,0xbf68bf3cbf54db31,0xbf7e70b0bf76ba07
.quad 0xbf79c79dbf6c835e,0xbf7e1324bf7fb10f,0xbf7ffb11bf7b14be,0xbf6ff573bf7c3b28
.quad 0x3f8000003f800000,0x3f8000003f800000,0x3f7a73023f7b14be,0x3f7912983f79c79d
.quad 0x3f6a09a73f6c835e,0x3f64aa593f676bd8,0x3f4f7a1f3f54db31,0x3f43e2003f49d112
.quad 0x3f2beb4a3f3504f3,0x3f187fc03f226799,0x3f00e7e43f0e39da,0x3ec9b9533ee63375
.quad 0x3ea09ae53ec3ef15,0x3e2f10a23e78cfcc,0x3de1bc2e3e47c5c2,0xbd7b2b743cc90ab0
.quad 0xbdc8bd3600000000,0xbe94a031be47c5c2,0xbe9aa086be47c5c2,0xbf00e7e4becf7bca
.quad 0xbefc5d27bec3ef15,0xbf3085bbbf187fc0,0xbf299415bf0e39da,0xbf5695e5bf41d870
.quad 0xbf4d9f02bf3504f3,0xbf710908bf61c598,0xbf68bf3cbf54db31,0xbf7e70b0bf76ba07
.quad 0xbf79c79dbf6c835e,0xbf7e1324bf7fb10f,0xbf7ffb11bf7b14be,0xbf6ff573bf7c3b28
.quad 0x3f8000003f800000,0x3f8000003f800000,0x3f778bc53f7853f8,0x3f75dec63f76ba07
.quad 0x3f5ebe053f61c598,0x3f5848533f5b941a,0x3f373a233f3daef9,0x3f2994153f3085bb
.quad 0x3f039c3d3f0e39da,0x3edae8803ef15aea,0x3e8e9a223eac7cd4,0x3e22abb63e605c13
.quad 0x3cc90ab03dc8bd36,0xbdfab273bd48fb30,0xbe6c9a7fbe164083,0xbec9b953bea09ae5
.quad 0xbef15aeabec3ef15,0xbf226799bf0e39da,0xbf2e3bdebf187fc0,0xbf531849bf41d870
.quad 0xbf584853bf45e403,0xbf731447bf676bd8,0xbf740bddbf676bd8,0xbf7fd397bf7c3b28
.quad 0xbf7fb10fbf7b14be,0xbf7853f8bf7ec46d,0xbf7a7302bf7fb10f,0xbf5d2d53bf6ed89e
.quad 0xbf64aa59bf74fa0b,0xbf3085bbbf4d9f02,0xbf3fc767bf5b941a,0xbeebcbbbbf1d7fd1
.quad 0x3f8000003f800000,0x3f8000003f800000,0x3f778bc53f7853f8,0x3f75dec63f76ba07
.quad 0x3f5ebe053f61c598,0x3f5848533f5b941a,0x3f373a233f3daef9,0x3f2994153f3085bb
.quad 0x3f039c3d3f0e39da,0x3edae8803ef15aea,0x3e8e9a223eac7cd4,0x3e22abb63e605c13
.quad 0x3cc90ab03dc8bd36,0xbdfab273bd48fb30,0xbe6c9a7fbe164083,0xbec9b953bea09ae5
.quad 0xbef15aeabec3ef15,0xbf226799bf0e39da,0xbf2e3bdebf187fc0,0xbf531849bf41d870
.quad 0xbf584853bf45e403,0xbf731447bf676bd8,0xbf740bddbf676bd8,0xbf7fd397bf7c3b28
.quad 0xbf7fb10fbf7b14be,0xbf7853f8bf7ec46d,0xbf7a7302bf7fb10f,0xbf5d2d53bf6ed89e
.quad 0xbf64aa59bf74fa0b,0xbf3085bbbf4d9f02,0xbf3fc767bf5b941a,0xbeebcbbbbf1d7fd1
.quad 0x3f8000003f800000,0x3f8000003f800000,0x3f740bdd3f74fa0b,0x3f7213523f731447
.quad 0x3f514d3d3f54db31,0x3f49d1123f4d9f02,0x3f1b02c63f226799,0x3f0b9a6b3f13682a
.quad 0x3eac7cd43ec3ef15,0x3e78cfcc3e94a031,0x3d16c32c3dc8bd36,0xbdafb680bcc90ab0
.quad 0xbe888e93be47c5c2,0xbecf7bcabeac7cd4,0xbf0b9a6bbef15aea,0xbf2e3bdebf1d7fd1
.quad 0xbf45e403bf3504f3,0xbf61c598bf54db31,0xbf6db293bf61c598,0xbf7cbfc9bf76ba07
.quad 0xbf7f4e6dbf7b14be,0xbf7c3b28bf7fb10f,0xbf791298bf7ec46d,0xbf604621bf6ed89e
.quad 0xbf5b941abf6c835e,0xbf2beb4abf45e403,0xbf299415bf45e403,0xbec9b953bf08f59b
.quad 0xbecf7bcabf0e39da,0xbd96a905be78cfcc,0xbde1bc2ebe94a031,0x3e827dc03d96a905
.quad 0x3f8000003f800000,0x3f8000003f800000,0x3f740bdd3f74fa0b,0x3f7213523f731447
.quad 0x3f514d3d3f54db31,0x3f49d1123f4d9f02,0x3f1b02c63f226799,0x3f0b9a6b3f13682a
.quad 0x3eac7cd43ec3ef15,0x3e78cfcc3e94a031,0x3d16c32c3dc8bd36,0xbdafb680bcc90ab0
.quad 0xbe888e93be47c5c2,0xbecf7bcabeac7cd4,0xbf0b9a6bbef15aea,0xbf2e3bdebf1d7fd1
.quad 0xbf45e403bf3504f3,0xbf61c598bf54db31,0xbf6db293bf61c598,0xbf7cbfc9bf76ba07
.quad 0xbf7f4e6dbf7b14be,0xbf7c3b28bf7fb10f,0xbf791298bf7ec46d,0xbf604621bf6ed89e
.quad 0xbf5b941abf6c835e,0xbf2beb4abf45e403,0xbf299415bf45e403,0xbec9b953bf08f59b
.quad 0xbecf7bcabf0e39da,0xbd96a905be78cfcc,0xbde1bc2ebe94a031,0x3e827dc03d96a905
.quad 0x3f8000003f800000,0x3f8000003f800000,0x3f6ff5733f710908,0x3f6db2933f6ed89e
.quad 0x3f41d8703f45e403,0x3f3968423f3daef9,0x3ef6e0cb3f039c3d,0x3ed536413ee63375
.quad 0x3e1640833e47c5c2,0x3d48fb303dc8bd36,0xbe541501be164083,0xbea68f12be888e93
.quad 0xbf08f59bbef15aea,0xbf273656bf187fc0,0xbf4bbbf8bf3daef9,0xbf633c5abf584853
.quad 0xbf74fa0bbf6c835e,0xbf7ec46dbf7b14be,0xbf7f84abbf7fb10f,0xbf75dec6bf7c3b28
.quad 0xbf6a09a7bf74fa0b,0xbf49d112bf5b941a,0xbf373a23bf4d9f02,0xbf00e7e4bf1d7fd1
.quad 0xbedae880bf0e39da,0xbe164083be94a031,0xbdafb680be78cfcc,0x3e6c9a7f3d96a905
.quad 0x3e888e933dc8bd36,0x3f13682a3edae880,0x3f15f6d93edae880,0x3f5695e53f396842
.quad 0x3f8000003f800000,0x3f8000003f800000,0x3f6ff5733f710908,0x3f6db2933f6ed89e
.quad 0x3f41d8703f45e403,0x3f3968423f3daef9,0x3ef6e0cb3f039c3d,0x3ed536413ee63375
.quad 0x3e1640833e47c5c2,0x3d48fb303dc8bd36,0xbe541501be164083,0xbea68f12be888e93
.quad 0xbf08f59bbef15aea,0xbf273656bf187fc0,0xbf4bbbf8bf3daef9,0xbf633c5abf584853
.quad 0xbf74fa0bbf6c835e,0xbf7ec46dbf7b14be,0xbf7f84abbf7fb10f,0xbf75dec6bf7c3b28
.quad 0xbf6a09a7bf74fa0b,0xbf49d112bf5b941a,0xbf373a23bf4d9f02,0xbf00e7e4bf1d7fd1
.quad 0xbedae880bf0e39da,0xbe164083be94a031,0xbdafb680be78cfcc,0x3e6c9a7f3d96a905
.quad 0x3e888e933dc8bd36,0x3f13682a3edae880,0x3f15f6d93edae880,0x3f5695e53f396842
.quad 0x0,0x0,0x3c490e9000000000,0x3d16c32c3cc90ab0
.quad 0x3cc90ab000000000,0x3d96a9053d48fb30,0x3d16c32c00000000,0x3de1bc2e3d96a905
.quad 0x3d48fb3000000000,0x3e1640833dc8bd36,0x3d7b2b7400000000,0x3e3b6ecf3dfab273
.quad 0x3d96a90500000000,0x3e605c133e164083,0x3dafb68000000000,0x3e827dc03e2f10a2
.quad 0x3dc8bd3600000000,0x3e94a0313e47c5c2,0x3de1bc2e00000000,0x3ea68f123e605c13
.quad 0x3dfab27300000000,0x3eb8442a3e78cfcc,0x3e09cf8600000000,0x3ec9b9533e888e93
.quad 0x3e16408300000000,0x3edae8803e94a031,0x3e22abb600000000,0x3eebcbbb3ea09ae5
.quad 0x3e2f10a200000000,0x3efc5d273eac7cd4,0x3e3b6ecf00000000,0x3f064b823eb8442a
.quad 0x0,0x0,0x3c490e9000000000,0x3d16c32c3cc90ab0
.quad 0x3cc90ab000000000,0x3d96a9053d48fb30,0x3d16c32c00000000,0x3de1bc2e3d96a905
.quad 0x3d48fb3000000000,0x3e1640833dc8bd36,0x3d7b2b7400000000,0x3e3b6ecf3dfab273
.quad 0x3d96a90500000000,0x3e605c133e164083,0x3dafb68000000000,0x3e827dc03e2f10a2
.quad 0x3dc8bd3600000000,0x3e94a0313e47c5c2,0x3de1bc2e00000000,0x3ea68f123e605c13
.quad 0x3dfab27300000000,0x3eb8442a3e78cfcc,0x3e09cf8600000000,0x3ec9b9533e888e93
.quad 0x3e16408300000000,0x3edae8803e94a031,0x3e22abb600000000,0x3eebcbbb3ea09ae5
.quad 0x3e2f10a200000000,0x3efc5d273eac7cd4,0x3e3b6ecf00000000,0x3f064b823eb8442a
.quad 0x0,0x0,0x3d7b2b743d48fb30,0x3dafb6803d96a905
.quad 0x3dfab2733dc8bd36,0x3e2f10a23e164083,0x3e3b6ecf3e164083,0x3e827dc03e605c13
.quad 0x3e78cfcc3e47c5c2,0x3eac7cd43e94a031,0x3e9aa0863e78cfcc,0x3ed536413eb8442a
.quad 0x3eb8442a3e94a031,0x3efc5d273edae880,0x3ed536413eac7cd4,0x3f10d3cd3efc5d27
.quad 0x3ef15aea3ec3ef15,0x3f2267993f0e39da,0x3f064b823edae880,0x3f32c8c93f1d7fd1
.quad 0x3f13682a3ef15aea,0x3f41d8703f2beb4a,0x3f1ff6cb3f039c3d,0x3f4f7a1f3f396842
.quad 0x3f2beb4a3f0e39da,0x3f5b941a3f45e403,0x3f373a233f187fc0,0x3f660f883f514d3d
.quad 0x3f41d8703f226799,0x3f6ed89e3f5b941a,0x3f4bbbf83f2beb4a,0x3f75dec63f64aa59
.quad 0x0,0x0,0x3d7b2b743d48fb30,0x3dafb6803d96a905
.quad 0x3dfab2733dc8bd36,0x3e2f10a23e164083,0x3e3b6ecf3e164083,0x3e827dc03e605c13
.quad 0x3e78cfcc3e47c5c2,0x3eac7cd43e94a031,0x3e9aa0863e78cfcc,0x3ed536413eb8442a
.quad 0x3eb8442a3e94a031,0x3efc5d273edae880,0x3ed536413eac7cd4,0x3f10d3cd3efc5d27
.quad 0x3ef15aea3ec3ef15,0x3f2267993f0e39da,0x3f064b823edae880,0x3f32c8c93f1d7fd1
.quad 0x3f13682a3ef15aea,0x3f41d8703f2beb4a,0x3f1ff6cb3f039c3d,0x3f4f7a1f3f396842
.quad 0x3f2beb4a3f0e39da,0x3f5b941a3f45e403,0x3f373a233f187fc0,0x3f660f883f514d3d
.quad 0x3f41d8703f226799,0x3f6ed89e3f5b941a,0x3f4bbbf83f2beb4a,0x3f75dec63f64aa59
.quad 0x0,0x0,0x3de1bc2e3dc8bd36,0x3e09cf863dfab273
.quad 0x3e605c133e47c5c2,0x3e888e933e78cfcc,0x3ea68f123e94a031,0x3ec9b9533eb8442a
.quad 0x3edae8803ec3ef15,0x3f039c3d3ef15aea,0x3f064b823ef15aea,0x3f1ff6cb3f13682a
.quad 0x3f1d7fd13f0e39da,0x3f3968423f2beb4a,0x3f32c8c93f226799,0x3f4f7a1f3f41d870
.quad 0x3f45e4033f3504f3,0x3f61c5983f54db31,0x3f5695e53f45e403,0x3f6ff5733f64aa59
.quad 0x3f64aa593f54db31,0x3f79c79d3f710908,0x3f6ff5733f61c598,0x3f7f0e583f79c79d
.quad 0x3f7853f83f6c835e,0x3f7fb10f3f7ec46d,0x3f7dabcc3f74fa0b,0x3f7baccd3f7fec43
.quad 0x3f7fec433f7b14be,0x3f7314473f7d3aac,0x3f7f0e583f7ec46d,0x3f660f883f76ba07
.quad 0x0,0x0,0x3de1bc2e3dc8bd36,0x3e09cf863dfab273
.quad 0x3e605c133e47c5c2,0x3e888e933e78cfcc,0x3ea68f123e94a031,0x3ec9b9533eb8442a
.quad 0x3edae8803ec3ef15,0x3f039c3d3ef15aea,0x3f064b823ef15aea,0x3f1ff6cb3f13682a
.quad 0x3f1d7fd13f0e39da,0x3f3968423f2beb4a,0x3f32c8c93f226799,0x3f4f7a1f3f41d870
.quad 0x3f45e4033f3504f3,0x3f61c5983f54db31,0x3f5695e53f45e403,0x3f6ff5733f64aa59
.quad 0x3f64aa593f54db31,0x3f79c79d3f710908,0x3f6ff5733f61c598,0x3f7f0e583f79c79d
.quad 0x3f7853f83f6c835e,0x3f7fb10f3f7ec46d,0x3f7dabcc3f74fa0b,0x3f7baccd3f7fec43
.quad 0x3f7fec433f7b14be,0x3f7314473f7d3aac,0x3f7f0e583f7ec46d,0x3f660f883f76ba07
.quad 0x0,0x0,0x3e22abb63e164083,0x3e3b6ecf3e2f10a2
.quad 0x3ea09ae53e94a031,0x3eb8442a3eac7cd4,0x3eebcbbb3edae880,0x3f064b823efc5d27
.quad 0x3f187fc03f0e39da,0x3f2beb4a3f226799,0x3f373a233f2beb4a,0x3f4bbbf83f41d870
.quad 0x3f514d3d3f45e403,0x3f64aa593f5b941a,0x3f660f883f5b941a,0x3f75dec63f6ed89e
.quad 0x3f74fa0b3f6c835e,0x3f7ec46d3f7b14be,0x3f7dabcc3f7853f8,0x3f7f0e583f7fec43
.quad 0x3f7fec433f7ec46d,0x3f76ba073f7d3aac,0x3f7baccd3f7fb10f,0x3f660f883f731447
.quad 0x3f7109083f7b14be,0x3f4d9f023f61c598,0x3f6046213f710908,0x3f2e3bde3f49d112
.quad 0x3f49d1123f61c598,0x3f08f59b3f2beb4a,0x3f2e3bde3f4d9f02,0x3ebe1d4a3f08f59b
.quad 0x0,0x0,0x3e22abb63e164083,0x3e3b6ecf3e2f10a2
.quad 0x3ea09ae53e94a031,0x3eb8442a3eac7cd4,0x3eebcbbb3edae880,0x3f064b823efc5d27
.quad 0x3f187fc03f0e39da,0x3f2beb4a3f226799,0x3f373a233f2beb4a,0x3f4bbbf83f41d870
.quad 0x3f514d3d3f45e403,0x3f64aa593f5b941a,0x3f660f883f5b941a,0x3f75dec63f6ed89e
.quad 0x3f74fa0b3f6c835e,0x3f7ec46d3f7b14be,0x3f7dabcc3f7853f8,0x3f7f0e583f7fec43
.quad 0x3f7fec433f7ec46d,0x3f76ba073f7d3aac,0x3f7baccd3f7fb10f,0x3f660f883f731447
.quad 0x3f7109083f7b14be,0x3f4d9f023f61c598,0x3f6046213f710908,0x3f2e3bde3f49d112
.quad 0x3f49d1123f61c598,0x3f08f59b3f2beb4a,0x3f2e3bde3f4d9f02,0x3ebe1d4a3f08f59b
.quad 0x0,0x0,0x3e5415013e47c5c2,0x3e6c9a7f3e605c13
.quad 0x3ecf7bca3ec3ef15,0x3ee633753edae880,0x3f15f6d93f0e39da,0x3f24d2253f1d7fd1
.quad 0x3f3daef93f3504f3,0x3f4d9f023f45e403,0x3f5d2d533f54db31,0x3f6b4b0c3f64aa59
.quad 0x3f7314473f6c835e,0x3f7c3b283f7853f8,0x3f7e70b03f7b14be,0x3f7f84ab3f7fec43
.quad 0x3f7ec46d3f800000,0x3f74fa0b3f7b14be,0x3f740bdd3f7b14be,0x3f5d2d533f6a09a7
.quad 0x3f5ebe053f6c835e,0x3f3968423f4d9f02,0x3f3fc7673f54db31,0x3f0b9a6b3f273656
.quad 0x3f187fc03f3504f3,0x3eac7cd43ef15aea,0x3ed536413f0e39da,0x3de1bc2e3e888e93
.quad 0x3e605c133ec3ef15,0xbdfab2733d48fb30,0x3c490e903e47c5c2,0xbeb263efbe2f10a2
.quad 0x0,0x0,0x3e5415013e47c5c2,0x3e6c9a7f3e605c13
.quad 0x3ecf7bca3ec3ef15,0x3ee633753edae880,0x3f15f6d93f0e39da,0x3f24d2253f1d7fd1
.quad 0x3f3daef93f3504f3,0x3f4d9f023f45e403,0x3f5d2d533f54db31,0x3f6b4b0c3f64aa59
.quad 0x3f7314473f6c835e,0x3f7c3b283f7853f8,0x3f7e70b03f7b14be,0x3f7f84ab3f7fec43
.quad 0x3f7ec46d3f800000,0x3f74fa0b3f7b14be,0x3f740bdd3f7b14be,0x3f5d2d533f6a09a7
.quad 0x3f5ebe053f6c835e,0x3f3968423f4d9f02,0x3f3fc7673f54db31,0x3f0b9a6b3f273656
.quad 0x3f187fc03f3504f3,0x3eac7cd43ef15aea,0x3ed536413f0e39da,0x3de1bc2e3e888e93
.quad 0x3e605c133ec3ef15,0xbdfab2733d48fb30,0x3c490e903e47c5c2,0xbeb263efbe2f10a2
.quad 0x0,0x0,0x3e827dc03e78cfcc,0x3e8e9a223e888e93
.quad 0x3efc5d273ef15aea,0x3f08f59b3f039c3d,0x3f32c8c93f2beb4a,0x3f3fc7673f396842
.quad 0x3f5b941a3f54db31,0x3f676bd83f61c598,0x3f75dec63f710908,0x3f7cbfc93f79c79d
.quad 0x3f7fec433f7ec46d,0x3f7e13243f7fb10f,0x3f7912983f7d3aac,0x3f6b4b0c3f731447
.quad 0x3f61c5983f6c835e,0x3f45e4033f54db31,0x3f3b8f3b3f4d9f02,0x3f10d3cd3f273656
.quad 0x3f08f59b3f226799,0x3ea09ae53edae880,0x3e9aa0863edae880,0x3d16c32c3e2f10a2
.quad 0x3d48fb303e47c5c2,0xbe78cfccbdc8bd36,0xbe541501bd48fb30,0xbf00e7e4beb8442a
.quad 0xbee63375be94a031,0xbf396842bf187fc0,0xbf299415bf039c3d,0xbf633c5abf49d112
.quad 0x0,0x0,0x3e827dc03e78cfcc,0x3e8e9a223e888e93
.quad 0x3efc5d273ef15aea,0x3f08f59b3f039c3d,0x3f32c8c93f2beb4a,0x3f3fc7673f396842
.quad 0x3f5b941a3f54db31,0x3f676bd83f61c598,0x3f75dec63f710908,0x3f7cbfc93f79c79d
.quad 0x3f7fec433f7ec46d,0x3f7e13243f7fb10f,0x3f7912983f7d3aac,0x3f6b4b0c3f731447
.quad 0x3f61c5983f6c835e,0x3f45e4033f54db31,0x3f3b8f3b3f4d9f02,0x3f10d3cd3f273656
.quad 0x3f08f59b3f226799,0x3ea09ae53edae880,0x3e9aa0863edae880,0x3d16c32c3e2f10a2
.quad 0x3d48fb303e47c5c2,0xbe78cfccbdc8bd36,0xbe541501bd48fb30,0xbf00e7e4beb8442a
.quad 0xbee63375be94a031,0xbf396842bf187fc0,0xbf299415bf039c3d,0xbf633c5abf49d112
.quad 0x0,0x0,0x3e9aa0863e94a031,0x3ea68f123ea09ae5
.quad 0x3f13682a3f0e39da,0x3f1d7fd13f187fc0,0x3f4bbbf83f45e403,0x3f5695e53f514d3d
.quad 0x3f7109083f6c835e,0x3f7853f83f74fa0b,0x3f7fd3973f7ec46d,0x3f7f0e583f7fec43
.quad 0x3f76ba073f7b14be,0x3f6a09a73f710908,0x3f5695e53f61c598,0x3f3b8f3b3f49d112
.quad 0x3f2267993f3504f3,0x3ef15aea3f0e39da,0x3ebe1d4a3ef15aea,0x3e22abb63e888e93
.quad 0x3d96a9053e47c5c2,0xbe2f10a2bd48fb30,0xbe6c9a7fbdc8bd36,0xbef6e0cbbeb8442a
.quad 0xbf039c3dbec3ef15,0xbf3daef9bf226799,0xbf3fc767bf226799,0xbf6b4b0cbf584853
.quad 0xbf6a09a7bf54db31,0xbf7f4e6dbf7853f8,0xbf7e70b0bf74fa0b,0xbf778bc5bf7f4e6d
.quad 0x0,0x0,0x3e9aa0863e94a031,0x3ea68f123ea09ae5
.quad 0x3f13682a3f0e39da,0x3f1d7fd13f187fc0,0x3f4bbbf83f45e403,0x3f5695e53f514d3d
.quad 0x3f7109083f6c835e,0x3f7853f83f74fa0b,0x3f7fd3973f7ec46d,0x3f7f0e583f7fec43
.quad 0x3f76ba073f7b14be,0x3f6a09a73f710908,0x3f5695e53f61c598,0x3f3b8f3b3f49d112
.quad 0x3f2267993f3504f3,0x3ef15aea3f0e39da,0x3ebe1d4a3ef15aea,0x3e22abb63e888e93
.quad 0x3d96a9053e47c5c2,0xbe2f10a2bd48fb30,0xbe6c9a7fbdc8bd36,0xbef6e0cbbeb8442a
.quad 0xbf039c3dbec3ef15,0xbf3daef9bf226799,0xbf3fc767bf226799,0xbf6b4b0cbf584853
.quad 0xbf6a09a7bf54db31,0xbf7f4e6dbf7853f8,0xbf7e70b0bf74fa0b,0xbf778bc5bf7f4e6d
.quad 0x0,0x0,0x3eb263ef3eac7cd4,0x3ebe1d4a3eb8442a
.quad 0x3f2736563f226799,0x3f3085bb3f2beb4a,0x3f6046213f5b941a,0x3f68bf3c3f64aa59
.quad 0x3f7d3aac3f7b14be,0x3f7fb10f3f7ec46d,0x3f7a73023f7d3aac,0x3f7213523f76ba07
.quad 0x3f5848533f61c598,0x3f41d8703f4d9f02,0x3f1b02c63f2beb4a,0x3eebcbbb3f08f59b
.quad 0x3e94a0313ec3ef15,0x3dc8bd363e47c5c2,0xbd7b2b743d48fb30,0xbe8e9a22be2f10a2
.quad 0xbecf7bcabe94a031,0xbf1d7fd1bf039c3d,0xbf32c8c9bf187fc0,0xbf5d2d53bf49d112
.quad 0xbf676bd8bf54db31,0xbf7d3aacbf74fa0b,0xbf7f0e58bf7853f8,0xbf791298bf7f4e6d
.quad 0xbf76ba07bf7ec46d,0xbf514d3dbf676bd8,0xbf4f7a1fbf676bd8,0xbf0b9a6bbf3085bb
.quad 0x0,0x0,0x3eb263ef3eac7cd4,0x3ebe1d4a3eb8442a
.quad 0x3f2736563f226799,0x3f3085bb3f2beb4a,0x3f6046213f5b941a,0x3f68bf3c3f64aa59
.quad 0x3f7d3aac3f7b14be,0x3f7fb10f3f7ec46d,0x3f7a73023f7d3aac,0x3f7213523f76ba07
.quad 0x3f5848533f61c598,0x3f41d8703f4d9f02,0x3f1b02c63f2beb4a,0x3eebcbbb3f08f59b
.quad 0x3e94a0313ec3ef15,0x3dc8bd363e47c5c2,0xbd7b2b743d48fb30,0xbe8e9a22be2f10a2
.quad 0xbecf7bcabe94a031,0xbf1d7fd1bf039c3d,0xbf32c8c9bf187fc0,0xbf5d2d53bf49d112
.quad 0xbf676bd8bf54db31,0xbf7d3aacbf74fa0b,0xbf7f0e58bf7853f8,0xbf791298bf7f4e6d
.quad 0xbf76ba07bf7ec46d,0xbf514d3dbf676bd8,0xbf4f7a1fbf676bd8,0xbf0b9a6bbf3085bb
.Ltabw:
.quad 0x1a4000001a400,0x1c6000001c600,0x1a4900001a640,0x1d6400001c604
.quad 0x1a5200001a880,0x1c6040001c608,0x1a5b00001aac0,0x1d6440001c60c
.quad 0x1a6400001a404,0x1c6080001c610,0x1a6d00001a644,0x1d6480001c614
.quad 0x1a7600001a884,0x1c60c0001c618,0x1a7f00001aac4,0x1d64c0001c61c
.quad 0x1a8800001a408,0x1c6100001c620,0x1a9100001a648,0x1d6500001c624
.quad 0x1a9a00001a888,0x1c6140001c628,0x1aa300001aac8,0x1d6540001c62c
.quad 0x1aac00001a40c,0x1c6180001c630,0x1ab500001a64c,0x1d6580001c634
.quad 0x1abe00001a88c,0x1c61c0001c638,0x1ac700001aacc,0x1d65c0001c63c
.quad 0x1a4000001a410,0x1c6200001c640,0x1a4900001a650,0x1d6600001c644
.quad 0x1a5200001a890,0x1c6240001c648,0x1a5b00001aad0,0x1d6640001c64c
.quad 0x1a6400001a414,0x1c6280001c650,0x1a6d00001a654,0x1d6680001c654
.quad 0x1a7600001a894,0x1c62c0001c658,0x1a7f00001aad4,0x1d66c0001c65c
.quad 0x1a8800001a418,0x1c6300001c660,0x1a9100001a658,0x1d6700001c664
.quad 0x1a9a00001a898,0x1c6340001c668,0x1aa300001aad8,0x1d6740001c66c
.quad 0x1aac00001a41c,0x1c6380001c670,0x1ab500001a65c,0x1d6780001c674
.quad 0x1abe00001a89c,0x1c63c0001c678,0x1ac700001aadc,0x1d67c0001c67c
.quad 0x1a4200001a420,0x1c6400001ca00,0x1a4b00001a660,0x1d6800001ca04
.quad 0x1a5400001a8a0,0x1c6440001ca08,0x1a5d00001aae0,0x1d6840001ca0c
.quad 0x1a6600001a424,0x1c6480001ca10,0x1a6f00001a664,0x1d6880001ca14
.quad 0x1a7800001a8a4,0x1c64c0001ca18,0x1a8100001aae4,0x1d68c0001ca1c
.quad 0x1a8a00001a428,0x1c6500001ca20,0x1a9300001a668,0x1d6900001ca24
.quad 0x1a9c00001a8a8,0x1c6540001ca28,0x1aa500001aae8,0x1d6940001ca2c
.quad 0x1aae00001a42c,0x1c6580001ca30,0x1ab700001a66c,0x1d6980001ca34
.quad 0x1ac000001a8ac,0x1c65c0001ca38,0x1ac900001aaec,0x1d69c0001ca3c
.quad 0x1a4200001a430,0x1c6600001ca40,0x1a4b00001a670,0x1d6a00001ca44
.quad 0x1a5400001a8b0,0x1c6640001ca48,0x1a5d00001aaf0,0x1d6a40001ca4c
.quad 0x1a6600001a434,0x1c6680001ca50,0x1a6f00001a674,0x1d6a80001ca54
.quad 0x1a7800001a8b4,0x1c66c0001ca58,0x1a8100001aaf4,0x1d6ac0001ca5c
.quad 0x1a8a00001a438,0x1c6700001ca60,0x1a9300001a678,0x1d6b00001ca64
.quad 0x1a9c00001a8b8,0x1c6740001ca68,0x1aa500001aaf8,0x1d6b40001ca6c
.quad 0x1aae00001a43c,0x1c6780001ca70,0x1ab700001a67c,0x1d6b80001ca74
.quad 0x1ac000001a8bc,0x1c67c0001ca78,0x1ac900001aafc,0x1d6bc0001ca7c
.quad 0x2120000000000,0x0,0x2161000000010,0x1000000010
.quad 0x21a2000000020,0x20000000000020,0x21e3000000030,0x20001000000030
.quad 0x2224000000040,0x40,0x2265000000050,0x1000000050
.quad 0x22a6000000060,0x20000000000060,0x22e7000000070,0x20001000000070
.quad 0x2120200000080,0x2000,0x2161200000090,0x1000002010
.quad 0x21a22000000a0,0x20000000002020,0x21e32000000b0,0x20001000002030
.quad 0x22242000000c0,0x2040,0x22652000000d0,0x1000002050
.quad 0x22a62000000e0,0x20000000002060,0x22e72000000f0,0x20001000002070
.quad 0x2120400000100,0x4000,0x2161400000110,0x1000004010
.quad 0x21a2400000120,0x20000000004020,0x21e3400000130,0x20001000004030
.quad 0x2224400000140,0x4040,0x2265400000150,0x1000004050
.quad 0x22a6400000160,0x20000000004060,0x22e7400000170,0x20001000004070
.quad 0x2120600000180,0x6000,0x2161600000190,0x1000006010
.quad 0x21a26000001a0,0x20000000006020,0x21e36000001b0,0x20001000006030
.quad 0x22246000001c0,0x6040,0x22656000001d0,0x1000006050
.quad 0x22a66000001e0,0x20000000006060,0x22e76000001f0,0x20001000006070
.quad 0x2120800000200,0x8000,0x2161800000210,0x1000008010
.quad 0x21a2800000220,0x20000000008020,0x21e3800000230,0x20001000008030
.quad 0x2224800000240,0x8040,0x2265800000250,0x1000008050
.quad 0x22a6800000260,0x20000000008060,0x22e7800000270,0x20001000008070
.quad 0x2120a00000280,0xa000,0x2161a00000290,0x100000a010
.quad 0x21a2a000002a0,0x2000000000a020,0x21e3a000002b0,0x2000100000a030
.quad 0x2224a000002c0,0xa040,0x2265a000002d0,0x100000a050
.quad 0x22a6a000002e0,0x2000000000a060,0x22e7a000002f0,0x2000100000a070
.quad 0x2120c00000300,0xc000,0x2161c00000310,0x100000c010
.quad 0x21a2c00000320,0x2000000000c020,0x21e3c00000330,0x2000100000c030
.quad 0x2224c00000340,0xc040,0x2265c00000350,0x100000c050
.quad 0x22a6c00000360,0x2000000000c060,0x22e7c00000370,0x2000100000c070
.quad 0x2120e00000380,0xe000,0x2161e00000390,0x100000e010
.quad 0x21a2e000003a0,0x2000000000e020,0x21e3e000003b0,0x2000100000e030
.quad 0x2224e000003c0,0xe040,0x2265e000003d0,0x100000e050
.quad 0x22a6e000003e0,0x2000000000e060,0x22e7e000003f0,0x2000100000e070
.quad 0x1ef00,0x1f10000025300,0x100001ef40,0x1f10000025308
.quad 0x200001ef00,0x1f10000025310,0x300001ef40,0x1f10000025318
.quad 0x400001ef00,0x1f10000025380,0x500001ef40,0x1f10000025388
.quad 0x600001ef00,0x1f10000025390,0x700001ef40,0x1f10000025398
.quad 0x4000001ef00,0x1f10000025400,0x4100001ef40,0x1f10000025408
.quad 0x4200001ef00,0x1f10000025410,0x4300001ef40,0x1f10000025418
.quad 0x4400001ef00,0x1f10000025480,0x4500001ef40,0x1f10000025488
.quad 0x4600001ef00,0x1f10000025490,0x4700001ef40,0x1f10000025498
.quad 0x8000001ef20,0x1f10000025320,0x8100001ef60,0x1f10000025328
.quad 0x8200001ef20,0x1f10000025330,0x8300001ef60,0x1f10000025338
.quad 0x8400001ef20,0x1f100000253a0,0x8500001ef60,0x1f100000253a8
.quad 0x8600001ef20,0x1f100000253b0,0x8700001ef60,0x1f100000253b8
.quad 0xc000001ef20,0x1f10000025420,0xc100001ef60,0x1f10000025428
.quad 0xc200001ef20,0x1f10000025430,0xc300001ef60,0x1f10000025438
.quad 0xc400001ef20,0x1f100000254a0,0xc500001ef60,0x1f100000254a8
.quad 0xc600001ef20,0x1f100000254b0,0xc700001ef60,0x1f100000254b8
.quad 0x10000001ef10,0x1f10000025500,0x10100001ef50,0x1f10000025508
.quad 0x10200001ef10,0x1f10000025510,0x10300001ef50,0x1f10000025518
.quad 0x10400001ef10,0x1f10000025580,0x10500001ef50,0x1f10000025588
.quad 0x10600001ef10,0x1f10000025590,0x10700001ef50,0x1f10000025598
.quad 0x14000001ef10,0x1f10000025600,0x14100001ef50,0x1f10000025608
.quad 0x14200001ef10,0x1f10000025610,0x14300001ef50,0x1f10000025618
.quad 0x14400001ef10,0x1f10000025680,0x14500001ef50,0x1f10000025688
.quad 0x14600001ef10,0x1f10000025690,0x14700001ef50,0x1f10000025698
.quad 0x18000001ef30,0x1f10000025520,0x18100001ef70,0x1f10000025528
.quad 0x18200001ef30,0x1f10000025530,0x18300001ef70,0x1f10000025538
.quad 0x18400001ef30,0x1f100000255a0,0x18500001ef70,0x1f100000255a8
.quad 0x18600001ef30,0x1f100000255b0,0x18700001ef70,0x1f100000255b8
.quad 0x1c000001ef30,0x1f10000025620,0x1c100001ef70,0x1f10000025628
.quad 0x1c200001ef30,0x1f10000025630,0x1c300001ef70,0x1f10000025638
.quad 0x1c400001ef30,0x1f100000256a0,0x1c500001ef70,0x1f100000256a8
.quad 0x1c600001ef30,0x1f100000256b0,0x1c700001ef70,0x1f100000256b8
.quad 0x360000000000,0x6c00,0x361000000010,0x800006c10
.quad 0x362000000020,0x1000006c20,0x363000000030,0x1800006c30
.quad 0x364000000040,0xc000007640,0x365000000050,0xc800007650
.quad 0x366000000060,0xd000007660,0x367000000070,0xd800007670
.quad 0x408000000080,0x18000007680,0x409000000090,0x18800007690
.quad 0x40a0000000a0,0x190000076a0,0x40b0000000b0,0x198000076b0
.quad 0x40c000000ac0,0x240000076c0,0x40d000000ad0,0x248000076d0
.quad 0x40e000000ae0,0x250000076e0,0x40f000000af0,0x258000076f0
.quad 0x410000000b00,0x2000008100,0x411000000b10,0x2800008110
.quad 0x412000000b20,0x3000008120,0x413000000b30,0x3800008130
.quad 0x4b4000000b40,0xe000008140,0x4b5000000b50,0xe800008150
.quad 0x4b6000000b60,0xf000008160,0x4b7000000b70,0xf800008170
.quad 0x4b8000001580,0x1a000008180,0x4b9000001590,0x1a800008190
.quad 0x4ba0000015a0,0x1b0000081a0,0x4bb0000015b0,0x1b8000081b0
.quad 0x4bc0000015c0,0x26000008bc0,0x4bd0000015d0,0x26800008bd0
.quad 0x4be0000015e0,0x27000008be0,0x4bf0000015f0,0x27800008bf0
.quad 0x560000001600,0x30000008c00,0x561000001610,0x30800008c10
.quad 0x562000001620,0x31000008c20,0x563000001630,0x31800008c30
.quad 0x564000002040,0x3c000008c40,0x565000002050,0x3c800008c50
.quad 0x566000002060,0x3d000008c60,0x567000002070,0x3d800008c70
.quad 0x568000002080,0x48000009680,0x569000002090,0x48800009690
.quad 0x56a0000020a0,0x490000096a0,0x56b0000020b0,0x498000096b0
.quad 0x60c0000020c0,0x540000096c0,0x60d0000020d0,0x548000096d0
.quad 0x60e0000020e0,0x550000096e0,0x60f0000020f0,0x558000096f0
.quad 0x610000002b00,0x32000009700,0x611000002b10,0x32800009710
.quad 0x612000002b20,0x33000009720,0x613000002b30,0x33800009730
.quad 0x614000002b40,0x3e00000a140,0x615000002b50,0x3e80000a150
.quad 0x616000002b60,0x3f00000a160,0x617000002b70,0x3f80000a170
.quad 0x6b8000002b80,0x4a00000a180,0x6b9000002b90,0x4a80000a190
.quad 0x6ba000002ba0,0x4b00000a1a0,0x6bb000002bb0,0x4b80000a1b0
.quad 0x6bc0000035c0,0x5600000a1c0,0x6bd0000035d0,0x5680000a1d0
.quad 0x6be0000035e0,0x5700000a1e0,0x6bf0000035f0,0x5780000a1f0
.quad 0x0,0x0,0x1000000010,0x1000000080
.quad 0x2000000020,0x2000000100,0x3000000030,0x3000000180
.quad 0x4000000040,0x4000000200,0x5000000050,0x5000000280
.quad 0x6000000060,0x6000000300,0x7000000070,0x7000000380
.quad 0x8000000200,0x8000000400,0x9000000210,0x9000000480
.quad 0xa000000220,0xa000000500,0xb000000230,0xb000000580
.quad 0xc000000240,0xc000000600,0xd000000250,0xd000000680
.quad 0xe000000260,0xe000000700,0xf000000270,0xf000000780
.quad 0x10000000400,0x10000000800,0x11000000410,0x11000000880
.quad 0x12000000420,0x12000000900,0x13000000430,0x13000000980
.quad 0x14000000440,0x14000000a00,0x15000000450,0x15000000a80
.quad 0x16000000460,0x16000000b00,0x17000000470,0x17000000b80
.quad 0x18000000600,0x18000000c00,0x19000000610,0x19000000c80
.quad 0x1a000000620,0x1a000000d00,0x1b000000630,0x1b000000d80
.quad 0x1c000000640,0x1c000000e00,0x1d000000650,0x1d000000e80
.quad 0x1e000000660,0x1e000000f00,0x1f000000670,0x1f000000f80
.quad 0x20000000800,0x20000001000,0x21000000810,0x21000001080
.quad 0x22000000820,0x22000001100,0x23000000830,0x23000001180
.quad 0x24000000840,0x24000001200,0x25000000850,0x25000001280
.quad 0x26000000860,0x26000001300,0x27000000870,0x27000001380
.quad 0x28000000a00,0x28000001400,0x29000000a10,0x29000001480
.quad 0x2a000000a20,0x2a000001500,0x2b000000a30,0x2b000001580
.quad 0x2c000000a40,0x2c000001600,0x2d000000a50,0x2d000001680
.quad 0x2e000000a60,0x2e000001700,0x2f000000a70,0x2f000001780
.quad 0x30000000c00,0x30000001800,0x31000000c10,0x31000001880
.quad 0x32000000c20,0x32000001900,0x33000000c30,0x33000001980
.quad 0x34000000c40,0x34000001a00,0x35000000c50,0x35000001a80
.quad 0x36000000c60,0x36000001b00,0x37000000c70,0x37000001b80
.quad 0x38000000e00,0x38000001c00,0x39000000e10,0x39000001c80
.quad 0x3a000000e20,0x3a000001d00,0x3b000000e30,0x3b000001d80
.quad 0x3c000000e40,0x3c000001e00,0x3d000000e50,0x3d000001e80
.quad 0x3e000000e60,0x3e000001f00,0x3f000000e70,0x3f000001f80
.quad 0x1a40000000000,0x1a400,0x1a84000000010,0x800001a410
.quad 0x1a41000010000,0x1000001a420,0x1a85000010010,0x1800001a430
.quad 0x1a42000020000,0x2000001a440,0x1a86000020010,0x2800001a450
.quad 0x1a43000030000,0x3000001a460,0x1a87000030010,0x3800001a470
.quad 0x1a44000040000,0x4000001a480,0x1a88000040010,0x4800001a490
.quad 0x1a45000050000,0x5000001a4a0,0x1a89000050010,0x5800001a4b0
.quad 0x1a46000060000,0x6000001a4c0,0x1a8a000060010,0x6800001a4d0
.quad 0x1a47000070000,0x7000001a4e0,0x1a8b000070010,0x7800001a4f0
.quad 0x1a48000080000,0x100001a500,0x1a8c000080010,0x900001a510
.quad 0x1a49000090000,0x1100001a520,0x1a8d000090010,0x1900001a530
.quad 0x1a4a0000a0000,0x2100001a540,0x1a8e0000a0010,0x2900001a550
.quad 0x1a4b0000b0000,0x3100001a560,0x1a8f0000b0010,0x3900001a570
.quad 0x1a4c0000c0000,0x4100001a580,0x1a900000c0010,0x4900001a590
.quad 0x1a4d0000d0000,0x5100001a5a0,0x1a910000d0010,0x5900001a5b0
.quad 0x1a4e0000e0000,0x6100001a5c0,0x1a920000e0010,0x6900001a5d0
.quad 0x1a4f0000f0000,0x7100001a5e0,0x1a930000f0010,0x7900001a5f0
.quad 0x1a50000002000,0x200001a600,0x1a94000002010,0xa00001a610
.quad 0x1a51000012000,0x1200001a620,0x1a95000012010,0x1a00001a630
.quad 0x1a52000022000,0x2200001a640,0x1a96000022010,0x2a00001a650
.quad 0x1a53000032000,0x3200001a660,0x1a97000032010,0x3a00001a670
.quad 0x1a54000042000,0x4200001a680,0x1a98000042010,0x4a00001a690
.quad 0x1a55000052000,0x5200001a6a0,0x1a99000052010,0x5a00001a6b0
.quad 0x1a56000062000,0x6200001a6c0,0x1a9a000062010,0x6a00001a6d0
.quad 0x1a57000072000,0x7200001a6e0,0x1a9b000072010,0x7a00001a6f0
.quad 0x1a58000082000,0x300001a700,0x1a9c000082010,0xb00001a710
.quad 0x1a59000092000,0x1300001a720,0x1a9d000092010,0x1b00001a730
.quad 0x1a5a0000a2000,0x2300001a740,0x1a9e0000a2010,0x2b00001a750
.quad 0x1a5b0000b2000,0x3300001a760,0x1a9f0000b2010,0x3b00001a770
.quad 0x1a5c0000c2000,0x4300001a780,0x1aa00000c2010,0x4b00001a790
.quad 0x1a5d0000d2000,0x5300001a7a0,0x1aa10000d2010,0x5b00001a7b0
.quad 0x1a5e0000e2000,0x6300001a7c0,0x1aa20000e2010,0x6b00001a7d0
.quad 0x1a5f0000f2000,0x7300001a7e0,0x1aa30000f2010,0x7b00001a7f0
.quad 0x1c6000001c600,0x0,0x1c6a00001c6a0,0x100
.quad 0x1c7400001c740,0x200,0x1c7e00001c7e0,0x300
.quad 0x1c8800001c880,0x400,0x1c9200001c920,0x500
.quad 0x1c9c00001c9c0,0x600,0x1ca600001ca60,0x700
.quad 0x1cb000001cb00,0x800,0x1cba00001cba0,0x900
.quad 0x1cc400001cc40,0xa00,0x1cce00001cce0,0xb00
.quad 0x1cd800001cd80,0xc00,0x1ce200001ce20,0xd00
.quad 0x1cec00001cec0,0xe00,0x1cf600001cf60,0xf00
.quad 0x1c6100001c608,0x10,0x1c6b00001c6a8,0x110
.quad 0x1c7500001c748,0x210,0x1c7f00001c7e8,0x310
.quad 0x1c8900001c888,0x410,0x1c9300001c928,0x510
.quad 0x1c9d00001c9c8,0x610,0x1ca700001ca68,0x710
.quad 0x1cb100001cb08,0x810,0x1cbb00001cba8,0x910
.quad 0x1cc500001cc48,0xa10,0x1ccf00001cce8,0xb10
.quad 0x1cd900001cd88,0xc10,0x1ce300001ce28,0xd10
.quad 0x1ced00001cec8,0xe10,0x1cf700001cf68,0xf10
.quad 0x1c6200001c610,0x20,0x1c6c00001c6b0,0x120
.quad 0x1c7600001c750,0x220,0x1c8000001c7f0,0x320
.quad 0x1c8a00001c890,0x420,0x1c9400001c930,0x520
.quad 0x1c9e00001c9d0,0x620,0x1ca800001ca70,0x720
.quad 0x1cb200001cb10,0x820,0x1cbc00001cbb0,0x920
.quad 0x1cc600001cc50,0xa20,0x1cd000001ccf0,0xb20
.quad 0x1cda00001cd90,0xc20,0x1ce400001ce30,0xd20
.quad 0x1cee00001ced0,0xe20,0x1cf800001cf70,0xf20
.quad 0x1c6300001c618,0x30,0x1c6d00001c6b8,0x130
.quad 0x1c7700001c758,0x230,0x1c8100001c7f8,0x330
.quad 0x1c8b00001c898,0x430,0x1c9500001c938,0x530
.quad 0x1c9f00001c9d8,0x630,0x1ca900001ca78,0x730
.quad 0x1cb300001cb18,0x830,0x1cbd00001cbb8,0x930
.quad 0x1cc700001cc58,0xa30,0x1cd100001ccf8,0xb30
.quad 0x1cdb00001cd98,0xc30,0x1ce500001ce38,0xd30
.quad 0x1cef00001ced8,0xe30,0x1cf900001cf78,0xf30
.quad 0x3f800000,0x1a4000001a400,0x10bf800000,0x1a4100001b440
.quad 0x20003f800000,0x1a4200001a410,0x2010bf800000,0x1a4300001b450
.quad 0x40003f800000,0x1a4400001a420,0x4010bf800000,0x1a4500001b460
.quad 0x60003f800000,0x1a4600001a430,0x6010bf800000,0x1a4700001b470
.quad 0x80003f800000,0x1a4800001a440,0x8010bf800000,0x1a4900001b480
.quad 0xa0003f800000,0x1a4a00001a450,0xa010bf800000,0x1a4b00001b490
.quad 0xc0003f800000,0x1a4c00001a460,0xc010bf800000,0x1a4d00001b4a0
.quad 0xe0003f800000,0x1a4e00001a470,0xe010bf800000,0x1a4f00001b4b0
.quad 0x100003f800000,0x1a5000001a480,0x10010bf800000,0x1a5100001b4c0
.quad 0x120003f800000,0x1a5200001a490,0x12010bf800000,0x1a5300001b4d0
.quad 0x140003f800000,0x1a5400001a4a0,0x14010bf800000,0x1a5500001b4e0
.quad 0x160003f800000,0x1a5600001a4b0,0x16010bf800000,0x1a5700001b4f0
.quad 0x180003f800000,0x1a5800001a4c0,0x18010bf800000,0x1a5900001b500
.quad 0x1a0003f800000,0x1a5a00001a4d0,0x1a010bf800000,0x1a5b00001b510
.quad 0x1c0003f800000,0x1a5c00001a4e0,0x1c010bf800000,0x1a5d00001b520
.quad 0x1e0003f800000,0x1a5e00001a4f0,0x1e010bf800000,0x1a5f00001b530
.quad 0x2000000000000,0x1a8000001a500,0x2001000000000,0x1a8100001b540
.quad 0x2200000000000,0x1a8200001a510,0x2201000000000,0x1a8300001b550
.quad 0x2400000000000,0x1a8400001a520,0x2401000000000,0x1a8500001b560
.quad 0x2600000000000,0x1a8600001a530,0x2601000000000,0x1a8700001b570
.quad 0x2800000000000,0x1a8800001a540,0x2801000000000,0x1a8900001b580
.quad 0x2a00000000000,0x1a8a00001a550,0x2a01000000000,0x1a8b00001b590
.quad 0x2c00000000000,0x1a8c00001a560,0x2c01000000000,0x1a8d00001b5a0
.quad 0x2e00000000000,0x1a8e00001a570,0x2e01000000000,0x1a8f00001b5b0
.quad 0x3000000000000,0x1a9000001a580,0x3001000000000,0x1a9100001b5c0
.quad 0x3200000000000,0x1a9200001a590,0x3201000000000,0x1a9300001b5d0
.quad 0x3400000000000,0x1a9400001a5a0,0x3401000000000,0x1a9500001b5e0
.quad 0x3600000000000,0x1a9600001a5b0,0x3601000000000,0x1a9700001b5f0
.quad 0x3800000000000,0x1a9800001a5c0,0x3801000000000,0x1a9900001b600
.quad 0x3a00000000000,0x1a9a00001a5d0,0x3a01000000000,0x1a9b00001b610
.quad 0x3c00000000000,0x1a9c00001a5e0,0x3c01000000000,0x1a9d00001b620
.quad 0x3e00000000000,0x1a9e00001a5f0,0x3e01000000000,0x1a9f00001b630
.quad 0x1a400,0x1c6100001c600,0x200001a400,0x1c7200001c710
.quad 0x400001a400,0x1c8300001c820,0x600001a400,0x1c9400001c930
.quad 0x800001a400,0x1ca500001ca40,0xa00001a400,0x1cb600001cb50
.quad 0xc00001a400,0x1cc700001cc60,0xe00001a400,0x1cd000001cd70
.quad 0x1000001a400,0x1ce100001ce00,0x1200001a400,0x1cf200001cf10
.quad 0x1400001a400,0x1d0300001d020,0x1600001a400,0x1d1400001d130
.quad 0x1800001a400,0x1d2500001d240,0x1a00001a400,0x1d3600001d350
.quad 0x1c00001a400,0x1d4700001d460,0x1e00001a400,0x1d5000001d570
.quad 0x2000001a404,0x1d6100001d600,0x2200001a404,0x1d7200001d710
.quad 0x2400001a404,0x1d8300001d820,0x2600001a404,0x1d9400001d930
.quad 0x2800001a404,0x1da500001da40,0x2a00001a404,0x1db600001db50
.quad 0x2c00001a404,0x1dc700001dc60,0x2e00001a404,0x1dd000001dd70
.quad 0x3000001a404,0x1de100001de00,0x3200001a404,0x1df200001df10
.quad 0x3400001a404,0x1e0300001e020,0x3600001a404,0x1e1400001e130
.quad 0x3800001a404,0x1e2500001e240,0x3a00001a404,0x1e3600001e350
.quad 0x3c00001a404,0x1e4700001e460,0x3e00001a404,0x1e5000001e570
.quad 0x100001a400,0x1c6900001c680,0x300001a400,0x1c7a00001c790
.quad 0x500001a400,0x1c8b00001c8a0,0x700001a400,0x1c9c00001c9b0
.quad 0x900001a400,0x1cad00001cac0,0xb00001a400,0x1cbe00001cbd0
.quad 0xd00001a400,0x1ccf00001cce0,0xf00001a400,0x1cd800001cdf0
.quad 0x1100001a400,0x1ce900001ce80,0x1300001a400,0x1cfa00001cf90
.quad 0x1500001a400,0x1d0b00001d0a0,0x1700001a400,0x1d1c00001d1b0
.quad 0x1900001a400,0x1d2d00001d2c0,0x1b00001a400,0x1d3e00001d3d0
.quad 0x1d00001a400,0x1d4f00001d4e0,0x1f00001a400,0x1d5800001d5f0
.quad 0x2100001a404,0x1d6900001d680,0x2300001a404,0x1d7a00001d790
.quad 0x2500001a404,0x1d8b00001d8a0,0x2700001a404,0x1d9c00001d9b0
.quad 0x2900001a404,0x1dad00001dac0,0x2b00001a404,0x1dbe00001dbd0
.quad 0x2d00001a404,0x1dcf00001dce0,0x2f00001a404,0x1dd800001ddf0
.quad 0x3100001a404,0x1de900001de80,0x3300001a404,0x1dfa00001df90
.quad 0x3500001a404,0x1e0b00001e0a0,0x3700001a404,0x1e1c00001e1b0
.quad 0x3900001a404,0x1e2d00001e2c0,0x3b00001a404,0x1e3e00001e3d0
.quad 0x3d00001a404,0x1e4f00001e4e0,0x3f00001a404,0x1e5800001e5f0
.quad 0x1c6400001c600,0x1f20000018000,0x1c6500001c610,0x1f24000018020
.quad 0x1c6600001c620,0x1f28000018040,0x1c6700001c630,0x1f2c000018060
.quad 0x1c6000001c640,0x1f30000018080,0x1c6100001c650,0x1f340000180a0
.quad 0x1c6200001c660,0x1f380000180c0,0x1c6300001c670,0x1f3c0000180e0
.quad 0x1c6c00001c680,0x1f40000018100,0x1c6d00001c690,0x1f44000018120
.quad 0x1c6e00001c6a0,0x1f48000018140,0x1c6f00001c6b0,0x1f4c000018160
.quad 0x1c6800001c6c0,0x1f50000018180,0x1c6900001c6d0,0x1f540000181a0
.quad 0x1c6a00001c6e0,0x1f580000181c0,0x1c6b00001c6f0,0x1f5c0000181e0
.quad 0x1c7500001c710,0x1f60000018200,0x1c7600001c720,0x1f64000018220
.quad 0x1c7700001c730,0x1f68000018240,0x1c7000001c740,0x1f6c000018260
.quad 0x1c7100001c750,0x1f70000018280,0x1c7200001c760,0x1f740000182a0
.quad 0x1c7300001c770,0x1f780000182c0,0x1c7400001c700,0x1f7c0000182e0
.quad 0x1c7d00001c790,0x1f80000018300,0x1c7e00001c7a0,0x1f84000018320
.quad 0x1c7f00001c7b0,0x1f88000018340,0x1c7800001c7c0,0x1f8c000018360
.quad 0x1c7900001c7d0,0x1f90000018380,0x1c7a00001c7e0,0x1f940000183a0
.quad 0x1c7b00001c7f0,0x1f980000183c0,0x1c7c00001c780,0x1f9c0000183e0
.quad 0x1c8600001c820,0x1f21000018008,0x1c8700001c830,0x1f25000018028
.quad 0x1c8000001c840,0x1f29000018048,0x1c8100001c850,0x1f2d000018068
.quad 0x1c8200001c860,0x1f31000018088,0x1c8300001c870,0x1f350000180a8
.quad 0x1c8400001c800,0x1f390000180c8,0x1c8500001c810,0x1f3d0000180e8
.quad 0x1c8e00001c8a0,0x1f41000018108,0x1c8f00001c8b0,0x1f45000018128
.quad 0x1c8800001c8c0,0x1f49000018148,0x1c8900001c8d0,0x1f4d000018168
.quad 0x1c8a00001c8e0,0x1f51000018188,0x1c8b00001c8f0,0x1f550000181a8
.quad 0x1c8c00001c880,0x1f590000181c8,0x1c8d00001c890,0x1f5d0000181e8
.quad 0x1c9700001c930,0x1f61000018208,0x1c9000001c940,0x1f65000018228
.quad 0x1c9100001c950,0x1f69000018248,0x1c9200001c960,0x1f6d000018268
.quad 0x1c9300001c970,0x1f71000018288,0x1c9400001c900,0x1f750000182a8
.quad 0x1c9500001c910,0x1f790000182c8,0x1c9600001c920,0x1f7d0000182e8
.quad 0x1c9f00001c9b0,0x1f81000018308,0x1c9800001c9c0,0x1f85000018328
.quad 0x1c9900001c9d0,0x1f89000018348,0x1c9a00001c9e0,0x1f8d000018368
.quad 0x1c9b00001c9f0,0x1f91000018388,0x1c9c00001c980,0x1f950000183a8
.quad 0x1c9d00001c990,0x1f990000183c8,0x1c9e00001c9a0,0x1f9d0000183e8
.quad 0x1f20000001000,0x40000000000,0x1f21000001010,0x41000000010
.quad 0x1f22000001020,0x42000000020,0x1f23000001030,0x43000000030
.quad 0x1f24000001040,0x44000000040,0x1f25000001050,0x45000000050
.quad 0x1f26000001060,0x46000000060,0x1f27000001070,0x47000000070
.quad 0x1f28000001080,0x48000000080,0x1f29000001090,0x49000000090
.quad 0x1f2a0000010a0,0x4a0000000a0,0x1f2b0000010b0,0x4b0000000b0
.quad 0x1f2c0000010c0,0x4c0000000c0,0x1f2d0000010d0,0x4d0000000d0
.quad 0x1f2e0000010e0,0x4e0000000e0,0x1f2f0000010f0,0x4f0000000f0
.quad 0x1f30000001100,0x50000000100,0x1f31000001110,0x51000000110
.quad 0x1f32000001120,0x52000000120,0x1f33000001130,0x53000000130
.quad 0x1f34000001140,0x54000000140,0x1f35000001150,0x55000000150
.quad 0x1f36000001160,0x56000000160,0x1f37000001170,0x57000000170
.quad 0x1f38000001180,0x58000000180,0x1f39000001190,0x59000000190
.quad 0x1f3a0000011a0,0x5a0000001a0,0x1f3b0000011b0,0x5b0000001b0
.quad 0x1f3c0000011c0,0x5c0000001c0,0x1f3d0000011d0,0x5d0000001d0
.quad 0x1f3e0000011e0,0x5e0000001e0,0x1f3f0000011f0,0x5f0000001f0
.quad 0x1f40000001200,0x60000000200,0x1f41000001210,0x61000000210
.quad 0x1f42000001220,0x62000000220,0x1f43000001230,0x63000000230
.quad 0x1f44000001240,0x64000000240,0x1f45000001250,0x65000000250
.quad 0x1f46000001260,0x66000000260,0x1f47000001270,0x67000000270
.quad 0x1f48000001280,0x68000000280,0x1f49000001290,0x69000000290
.quad 0x1f4a0000012a0,0x6a0000002a0,0x1f4b0000012b0,0x6b0000002b0
.quad 0x1f4c0000012c0,0x6c0000002c0,0x1f4d0000012d0,0x6d0000002d0
.quad 0x1f4e0000012e0,0x6e0000002e0,0x1f4f0000012f0,0x6f0000002f0
.quad 0x1f50000001300,0x70000000300,0x1f51000001310,0x71000000310
.quad 0x1f52000001320,0x72000000320,0x1f53000001330,0x73000000330
.quad 0x1f54000001340,0x74000000340,0x1f55000001350,0x75000000350
.quad 0x1f56000001360,0x76000000360,0x1f57000001370,0x77000000370
.quad 0x1f58000001380,0x78000000380,0x1f59000001390,0x79000000390
.quad 0x1f5a0000013a0,0x7a0000003a0,0x1f5b0000013b0,0x7b0000003b0
.quad 0x1f5c0000013c0,0x7c0000003c0,0x1f5d0000013d0,0x7d0000003d0
.quad 0x1f5e0000013e0,0x7e0000003e0,0x1f5f0000013f0,0x7f0000003f0
.quad 0x1580000000000,0x20a0000000000,0x1581000000010,0x20a0000000400
.quad 0x1582000000020,0x20a0000000800,0x1583000000030,0x20a0000000c00
.quad 0x1584000000040,0x20a0000001000,0x1585000000050,0x20a0000001400
.quad 0x1586000000060,0x20a0000001800,0x1587000000070,0x20a0000001c00
.quad 0x1588000000080,0x20a0000002000,0x1589000000090,0x20a0000002400
.quad 0x158a0000000a0,0x20a0000002800,0x158b0000000b0,0x20a0000002c00
.quad 0x158c0000000c0,0x20a0000003000,0x158d0000000d0,0x20a0000003400
.quad 0x158e0000000e0,0x20a0000003800,0x158f0000000f0,0x20a0000003c00
.quad 0x1590000000100,0x20a0000004000,0x1591000000110,0x20a0000004400
.quad 0x1592000000120,0x20a0000004800,0x1593000000130,0x20a0000004c00
.quad 0x1594000000140,0x20a0000005000,0x1595000000150,0x20a0000005400
.quad 0x1596000000160,0x20a0000005800,0x1597000000170,0x20a0000005c00
.quad 0x1598000000180,0x20a0000006000,0x1599000000190,0x20a0000006400
.quad 0x159a0000001a0,0x20a0000006800,0x159b0000001b0,0x20a0000006c00
.quad 0x159c0000001c0,0x20a0000007000,0x159d0000001d0,0x20a0000007400
.quad 0x159e0000001e0,0x20a0000007800,0x159f0000001f0,0x20a0000007c00
.quad 0x15a0000000200,0x20a1000000010,0x15a1000000210,0x20a1000000410
.quad 0x15a2000000220,0x20a1000000810,0x15a3000000230,0x20a1000000c10
.quad 0x15a4000000240,0x20a1000001010,0x15a5000000250,0x20a1000001410
.quad 0x15a6000000260,0x20a1000001810,0x15a7000000270,0x20a1000001c10
.quad 0x15a8000000280,0x20a1000002010,0x15a9000000290,0x20a1000002410
.quad 0x15aa0000002a0,0x20a1000002810,0x15ab0000002b0,0x20a1000002c10
.quad 0x15ac0000002c0,0x20a1000003010,0x15ad0000002d0,0x20a1000003410
.quad 0x15ae0000002e0,0x20a1000003810,0x15af0000002f0,0x20a1000003c10
.quad 0x15b0000000300,0x20a1000004010,0x15b1000000310,0x20a1000004410
.quad 0x15b2000000320,0x20a1000004810,0x15b3000000330,0x20a1000004c10
.quad 0x15b4000000340,0x20a1000005010,0x15b5000000350,0x20a1000005410
.quad 0x15b6000000360,0x20a1000005810,0x15b7000000370,0x20a1000005c10
.quad 0x15b8000000380,0x20a1000006010,0x15b9000000390,0x20a1000006410
.quad 0x15ba0000003a0,0x20a1000006810,0x15bb0000003b0,0x20a1000006c10
.quad 0x15bc0000003c0,0x20a1000007010,0x15bd0000003d0,0x20a1000007410
.quad 0x15be0000003e0,0x20a1000007810,0x15bf0000003f0,0x20a1000007c10
.quad 0x300000000000,0xb00000007000,0x301000008000,0xb01000007010
.quad 0x302000010000,0xb02000007020,0x303000018000,0xb03000007030
.quad 0x304000020000,0xb04000007040,0x305000028000,0xb05000007050
.quad 0x306000030000,0xb06000007060,0x307000038000,0xb07000007070
.quad 0x308000040000,0xb08000007080,0x309000048000,0xb09000007090
.quad 0x30a000050000,0xb0a0000070a0,0x30b000058000,0xb0b0000070b0
.quad 0x30c000060000,0xb0c0000070c0,0x30d000068000,0xb0d0000070d0
.quad 0x30e000070000,0xb0e0000070e0,0x30f000078000,0xb0f0000070f0
.quad 0x310000080000,0xb10000007100,0x311000088000,0xb11000007110
.quad 0x312000090000,0xb12000007120,0x313000098000,0xb13000007130
.quad 0x3140000a0000,0xb14000007140,0x3150000a8000,0xb15000007150
.quad 0x3160000b0000,0xb16000007160,0x3170000b8000,0xb17000007170
.quad 0x3180000c0000,0xb18000007180,0x3190000c8000,0xb19000007190
.quad 0x31a0000d0000,0xb1a0000071a0,0x31b0000d8000,0xb1b0000071b0
.quad 0x31c0000e0000,0xb1c0000071c0,0x31d0000e8000,0xb1d0000071d0
.quad 0x31e0000f0000,0xb1e0000071e0,0x31f0000f8000,0xb1f0000071f0
.quad 0x320000000010,0xb20000007200,0x321000008010,0xb21000007210
.quad 0x322000010010,0xb22000007220,0x323000018010,0xb23000007230
.quad 0x324000020010,0xb24000007240,0x325000028010,0xb25000007250
.quad 0x326000030010,0xb26000007260,0x327000038010,0xb27000007270
.quad 0x328000040010,0xb28000007280,0x329000048010,0xb29000007290
.quad 0x32a000050010,0xb2a0000072a0,0x32b000058010,0xb2b0000072b0
.quad 0x32c000060010,0xb2c0000072c0,0x32d000068010,0xb2d0000072d0
.quad 0x32e000070010,0xb2e0000072e0,0x32f000078010,0xb2f0000072f0
.quad 0x330000080010,0xb30000007300,0x331000088010,0xb31000007310
.quad 0x332000090010,0xb32000007320,0x333000098010,0xb33000007330
.quad 0x3340000a0010,0xb34000007340,0x3350000a8010,0xb35000007350
.quad 0x3360000b0010,0xb36000007360,0x3370000b8010,0xb37000007370
.quad 0x3380000c0010,0xb38000007380,0x3390000c8010,0xb39000007390
.quad 0x33a0000d0010,0xb3a0000073a0,0x33b0000d8010,0xb3b0000073b0
.quad 0x33c0000e0010,0xb3c0000073c0,0x33d0000e8010,0xb3d0000073d0
.quad 0x33e0000f0010,0xb3e0000073e0,0x33f0000f8010,0xb3f0000073f0
.Ltabw1:
.quad 0x1a4000001a440,0x1ca000001c680,0x1a4900001a680,0x1da400001c684
.quad 0x1a5200001a8c0,0x1ca040001c688,0x1a5b00001ab00,0x1da440001c68c
.quad 0x1a6400001a444,0x1ca080001c690,0x1a6d00001a684,0x1da480001c694
.quad 0x1a7600001a8c4,0x1ca0c0001c698,0x1a7f00001ab04,0x1da4c0001c69c
.quad 0x1a8800001a448,0x1ca100001c6a0,0x1a9100001a688,0x1da500001c6a4
.quad 0x1a9a00001a8c8,0x1ca140001c6a8,0x1aa300001ab08,0x1da540001c6ac
.quad 0x1aac00001a44c,0x1ca180001c6b0,0x1ab500001a68c,0x1da580001c6b4
.quad 0x1abe00001a8cc,0x1ca1c0001c6b8,0x1ac700001ab0c,0x1da5c0001c6bc
.quad 0x1a4000001a450,0x1ca200001c6c0,0x1a4900001a690,0x1da600001c6c4
.quad 0x1a5200001a8d0,0x1ca240001c6c8,0x1a5b00001ab10,0x1da640001c6cc
.quad 0x1a6400001a454,0x1ca280001c6d0,0x1a6d00001a694,0x1da680001c6d4
.quad 0x1a7600001a8d4,0x1ca2c0001c6d8,0x1a7f00001ab14,0x1da6c0001c6dc
.quad 0x1a8800001a458,0x1ca300001c6e0,0x1a9100001a698,0x1da700001c6e4
.quad 0x1a9a00001a8d8,0x1ca340001c6e8,0x1aa300001ab18,0x1da740001c6ec
.quad 0x1aac00001a45c,0x1ca380001c6f0,0x1ab500001a69c,0x1da780001c6f4
.quad 0x1abe00001a8dc,0x1ca3c0001c6f8,0x1ac700001ab1c,0x1da7c0001c6fc
.quad 0x1a4200001a460,0x1ca400001ca80,0x1a4b00001a6a0,0x1da800001ca84
.quad 0x1a5400001a8e0,0x1ca440001ca88,0x1a5d00001ab20,0x1da840001ca8c
.quad 0x1a6600001a464,0x1ca480001ca90,0x1a6f00001a6a4,0x1da880001ca94
.quad 0x1a7800001a8e4,0x1ca4c0001ca98,0x1a8100001ab24,0x1da8c0001ca9c
.quad 0x1a8a00001a468,0x1ca500001caa0,0x1a9300001a6a8,0x1da900001caa4
.quad 0x1a9c00001a8e8,0x1ca540001caa8,0x1aa500001ab28,0x1da940001caac
.quad 0x1aae00001a46c,0x1ca580001cab0,0x1ab700001a6ac,0x1da980001cab4
.quad 0x1ac000001a8ec,0x1ca5c0001cab8,0x1ac900001ab2c,0x1da9c0001cabc
.quad 0x1a4200001a470,0x1ca600001cac0,0x1a4b00001a6b0,0x1daa00001cac4
.quad 0x1a5400001a8f0,0x1ca640001cac8,0x1a5d00001ab30,0x1daa40001cacc
.quad 0x1a6600001a474,0x1ca680001cad0,0x1a6f00001a6b4,0x1daa80001cad4
.quad 0x1a7800001a8f4,0x1ca6c0001cad8,0x1a8100001ab34,0x1daac0001cadc
.quad 0x1a8a00001a478,0x1ca700001cae0,0x1a9300001a6b8,0x1dab00001cae4
.quad 0x1a9c00001a8f8,0x1ca740001cae8,0x1aa500001ab38,0x1dab40001caec
.quad 0x1aae00001a47c,0x1ca780001caf0,0x1ab700001a6bc,0x1dab80001caf4
.quad 0x1ac000001a8fc,0x1ca7c0001caf8,0x1ac900001ab3c,0x1dabc0001cafc
.quad 0x2122000000800,0x400020000,0x2163000000810,0x1400020010
.quad 0x21a4000000820,0x20000400020020,0x21e5000000830,0x20001400020030
.quad 0x2226000000840,0x400020040,0x2267000000850,0x1400020050
.quad 0x22a8000000860,0x20000400020060,0x22e9000000870,0x20001400020070
.quad 0x2122200000880,0x400022000,0x2163200000890,0x1400022010
.quad 0x21a42000008a0,0x20000400022020,0x21e52000008b0,0x20001400022030
.quad 0x22262000008c0,0x400022040,0x22672000008d0,0x1400022050
.quad 0x22a82000008e0,0x20000400022060,0x22e92000008f0,0x20001400022070
.quad 0x2122400000900,0x400024000,0x2163400000910,0x1400024010
.quad 0x21a4400000920,0x20000400024020,0x21e5400000930,0x20001400024030
.quad 0x2226400000940,0x400024040,0x2267400000950,0x1400024050
.quad 0x22a8400000960,0x20000400024060,0x22e9400000970,0x20001400024070
.quad 0x2122600000980,0x400026000,0x2163600000990,0x1400026010
.quad 0x21a46000009a0,0x20000400026020,0x21e56000009b0,0x20001400026030
.quad 0x22266000009c0,0x400026040,0x22676000009d0,0x1400026050
.quad 0x22a86000009e0,0x20000400026060,0x22e96000009f0,0x20001400026070
.quad 0x2122800000a00,0x400028000,0x2163800000a10,0x1400028010
.quad 0x21a4800000a20,0x20000400028020,0x21e5800000a30,0x20001400028030
.quad 0x2226800000a40,0x400028040,0x2267800000a50,0x1400028050
.quad 0x22a8800000a60,0x20000400028060,0x22e9800000a70,0x20001400028070
.quad 0x2122a00000a80,0x40002a000,0x2163a00000a90,0x140002a010
.quad 0x21a4a00000aa0,0x2000040002a020,0x21e5a00000ab0,0x2000140002a030
.quad 0x2226a00000ac0,0x40002a040,0x2267a00000ad0,0x140002a050
.quad 0x22a8a00000ae0,0x2000040002a060,0x22e9a00000af0,0x2000140002a070
.quad 0x2122c00000b00,0x40002c000,0x2163c00000b10,0x140002c010
.quad 0x21a4c00000b20,0x2000040002c020,0x21e5c00000b30,0x2000140002c030
.quad 0x2226c00000b40,0x40002c040,0x2267c00000b50,0x140002c050
.quad 0x22a8c00000b60,0x2000040002c060,0x22e9c00000b70,0x2000140002c070
.quad 0x2122e00000b80,0x40002e000,0x2163e00000b90,0x140002e010
.quad 0x21a4e00000ba0,0x2000040002e020,0x21e5e00000bb0,0x2000140002e030
.quad 0x2226e00000bc0,0x40002e040,0x2267e00000bd0,0x140002e050
.quad 0x22a8e00000be0,0x2000040002e060,0x22e9e00000bf0,0x2000140002e070
.quad 0x800001ef80,0x1f10000025b00,0x900001efc0,0x1f10000025b08
.quad 0xa00001ef80,0x1f10000025b10,0xb00001efc0,0x1f10000025b18
.quad 0xc00001ef80,0x1f10000025b80,0xd00001efc0,0x1f10000025b88
.quad 0xe00001ef80,0x1f10000025b90,0xf00001efc0,0x1f10000025b98
.quad 0x4800001ef80,0x1f10000025c00,0x4900001efc0,0x1f10000025c08
.quad 0x4a00001ef80,0x1f10000025c10,0x4b00001efc0,0x1f10000025c18
.quad 0x4c00001ef80,0x1f10000025c80,0x4d00001efc0,0x1f10000025c88
.quad 0x4e00001ef80,0x1f10000025c90,0x4f00001efc0,0x1f10000025c98
.quad 0x8800001efa0,0x1f10000025b20,0x8900001efe0,0x1f10000025b28
.quad 0x8a00001efa0,0x1f10000025b30,0x8b00001efe0,0x1f10000025b38
.quad 0x8c00001efa0,0x1f10000025ba0,0x8d00001efe0,0x1f10000025ba8
.quad 0x8e00001efa0,0x1f10000025bb0,0x8f00001efe0,0x1f10000025bb8
.quad 0xc800001efa0,0x1f10000025c20,0xc900001efe0,0x1f10000025c28
.quad 0xca00001efa0,0x1f10000025c30,0xcb00001efe0,0x1f10000025c38
.quad 0xcc00001efa0,0x1f10000025ca0,0xcd00001efe0,0x1f10000025ca8
.quad 0xce00001efa0,0x1f10000025cb0,0xcf00001efe0,0x1f10000025cb8
.quad 0x10800001ef90,0x1f10000025d00,0x10900001efd0,0x1f10000025d08
.quad 0x10a00001ef90,0x1f10000025d10,0x10b00001efd0,0x1f10000025d18
.quad 0x10c00001ef90,0x1f10000025d80,0x10d00001efd0,0x1f10000025d88
.quad 0x10e00001ef90,0x1f10000025d90,0x10f00001efd0,0x1f10000025d98
.quad 0x14800001ef90,0x1f10000025e00,0x14900001efd0,0x1f10000025e08
.quad 0x14a00001ef90,0x1f10000025e10,0x14b00001efd0,0x1f10000025e18
.quad 0x14c00001ef90,0x1f10000025e80,0x14d00001efd0,0x1f10000025e88
.quad 0x14e00001ef90,0x1f10000025e90,0x14f00001efd0,0x1f10000025e98
.quad 0x18800001efb0,0x1f10000025d20,0x18900001eff0,0x1f10000025d28
.quad 0x18a00001efb0,0x1f10000025d30,0x18b00001eff0,0x1f10000025d38
.quad 0x18c00001efb0,0x1f10000025da0,0x18d00001eff0,0x1f10000025da8
.quad 0x18e00001efb0,0x1f10000025db0,0x18f00001eff0,0x1f10000025db8
.quad 0x1c800001efb0,0x1f10000025e20,0x1c900001eff0,0x1f10000025e28
.quad 0x1ca00001efb0,0x1f10000025e30,0x1cb00001eff0,0x1f10000025e38
.quad 0x1cc00001efb0,0x1f10000025ea0,0x1cd00001eff0,0x1f10000025ea8
.quad 0x1ce00001efb0,0x1f10000025eb0,0x1cf00001eff0,0x1f10000025eb8
.quad 0x5960000056000,0x5cc00,0x5961000056010,0x80005cc10
.quad 0x5962000056020,0x100005cc20,0x5963000056030,0x180005cc30
.quad 0x5964000056040,0xc00005d640,0x5965000056050,0xc80005d650
.quad 0x5966000056060,0xd00005d660,0x5967000056070,0xd80005d670
.quad 0x5a08000056080,0x1800005d680,0x5a09000056090,0x1880005d690
.quad 0x5a0a0000560a0,0x1900005d6a0,0x5a0b0000560b0,0x1980005d6b0
.quad 0x5a0c000056ac0,0x2400005d6c0,0x5a0d000056ad0,0x2480005d6d0
.quad 0x5a0e000056ae0,0x2500005d6e0,0x5a0f000056af0,0x2580005d6f0
.quad 0x5a10000056b00,0x200005e100,0x5a11000056b10,0x280005e110
.quad 0x5a12000056b20,0x300005e120,0x5a13000056b30,0x380005e130
.quad 0x5ab4000056b40,0xe00005e140,0x5ab5000056b50,0xe80005e150
.quad 0x5ab6000056b60,0xf00005e160,0x5ab7000056b70,0xf80005e170
.quad 0x5ab8000057580,0x1a00005e180,0x5ab9000057590,0x1a80005e190
.quad 0x5aba0000575a0,0x1b00005e1a0,0x5abb0000575b0,0x1b80005e1b0
.quad 0x5abc0000575c0,0x2600005ebc0,0x5abd0000575d0,0x2680005ebd0
.quad 0x5abe0000575e0,0x2700005ebe0,0x5abf0000575f0,0x2780005ebf0
.quad 0x5b60000057600,0x3000005ec00,0x5b61000057610,0x3080005ec10
.quad 0x5b62000057620,0x3100005ec20,0x5b63000057630,0x3180005ec30
.quad 0x5b64000058040,0x3c00005ec40,0x5b65000058050,0x3c80005ec50
.quad 0x5b66000058060,0x3d00005ec60,0x5b67000058070,0x3d80005ec70
.quad 0x5b68000058080,0x4800005f680,0x5b69000058090,0x4880005f690
.quad 0x5b6a0000580a0,0x4900005f6a0,0x5b6b0000580b0,0x4980005f6b0
.quad 0x5c0c0000580c0,0x5400005f6c0,0x5c0d0000580d0,0x5480005f6d0
.quad 0x5c0e0000580e0,0x5500005f6e0,0x5c0f0000580f0,0x5580005f6f0
.quad 0x5c10000058b00,0x3200005f700,0x5c11000058b10,0x3280005f710
.quad 0x5c12000058b20,0x3300005f720,0x5c13000058b30,0x3380005f730
.quad 0x5c14000058b40,0x3e000060140,0x5c15000058b50,0x3e800060150
.quad 0x5c16000058b60,0x3f000060160,0x5c17000058b70,0x3f800060170
.quad 0x5cb8000058b80,0x4a000060180,0x5cb9000058b90,0x4a800060190
.quad 0x5cba000058ba0,0x4b0000601a0,0x5cbb000058bb0,0x4b8000601b0
.quad 0x5cbc0000595c0,0x560000601c0,0x5cbd0000595d0,0x568000601d0
.quad 0x5cbe0000595e0,0x570000601e0,0x5cbf0000595f0,0x578000601f0
.quad 0x1580000002000,0x800000000580,0x1581000002010,0x801000000600
.quad 0x1582000002020,0x802000000680,0x1583000002030,0x803000000700
.quad 0x1584000002040,0x804000000780,0x1585000002050,0x805000000800
.quad 0x1586000002060,0x806000000880,0x1587000002070,0x807000000900
.quad 0x1588000002200,0x808000000980,0x1589000002210,0x809000000a00
.quad 0x158a000002220,0x80a000000a80,0x158b000002230,0x80b000000b00
.quad 0x158c000002240,0x80c000000b80,0x158d000002250,0x80d000000c00
.quad 0x158e000002260,0x80e000000c80,0x158f000002270,0x80f000000d00
.quad 0x1590000002400,0x810000000d80,0x1591000002410,0x811000000e00
.quad 0x1592000002420,0x812000000e80,0x1593000002430,0x813000000f00
.quad 0x1594000002440,0x814000000f80,0x1595000002450,0x815000001000
.quad 0x1596000002460,0x816000001080,0x1597000002470,0x817000001100
.quad 0x1598000002600,0x818000001180,0x1599000002610,0x819000001200
.quad 0x159a000002620,0x81a000001280,0x159b000002630,0x81b000001300
.quad 0x159c000002640,0x81c000001380,0x159d000002650,0x81d000001400
.quad 0x159e000002660,0x81e000001480,0x159f000002670,0x81f000001500
.quad 0x15a0000002800,0x820000001580,0x15a1000002810,0x821000001600
.quad 0x15a2000002820,0x822000001680,0x15a3000002830,0x823000001700
.quad 0x15a4000002840,0x824000001780,0x15a5000002850,0x825000001800
.quad 0x15a6000002860,0x826000001880,0x15a7000002870,0x827000001900
.quad 0x15a8000002a00,0x828000001980,0x15a9000002a10,0x829000001a00
.quad 0x15aa000002a20,0x82a000001a80,0x15ab000002a30,0x82b000001b00
.quad 0x15ac000002a40,0x82c000001b80,0x15ad000002a50,0x82d000001c00
.quad 0x15ae000002a60,0x82e000001c80,0x15af000002a70,0x82f000001d00
.quad 0x15b0000002c00,0x830000001d80,0x15b1000002c10,0x831000001e00
.quad 0x15b2000002c20,0x832000001e80,0x15b3000002c30,0x833000001f00
.quad 0x15b4000002c40,0x834000001f80,0x15b5000002c50,0x835000002000
.quad 0x15b6000002c60,0x836000002080,0x15b7000002c70,0x837000002100
.quad 0x15b8000002e00,0x838000002180,0x15b9000002e10,0x839000002200
.quad 0x15ba000002e20,0x83a000002280,0x15bb000002e30,0x83b000002300
.quad 0x15bc000002e40,0x83c000002380,0x15bd000002e50,0x83d000002400
.quad 0x15be000002e60,0x83e000002480,0x15bf000002e70,0x83f000002500
.quad 0x1ac8000008000,0x8000001a400,0x1b0c000008010,0x8800001a410
.quad 0x1ac9000018000,0x9000001a420,0x1b0d000018010,0x9800001a430
.quad 0x1aca000028000,0xa000001a440,0x1b0e000028010,0xa800001a450
.quad 0x1acb000038000,0xb000001a460,0x1b0f000038010,0xb800001a470
.quad 0x1acc000048000,0xc000001a480,0x1b10000048010,0xc800001a490
.quad 0x1acd000058000,0xd000001a4a0,0x1b11000058010,0xd800001a4b0
.quad 0x1ace000068000,0xe000001a4c0,0x1b12000068010,0xe800001a4d0
.quad 0x1acf000078000,0xf000001a4e0,0x1b13000078010,0xf800001a4f0
.quad 0x1ad0000088000,0x8100001a500,0x1b14000088010,0x8900001a510
.quad 0x1ad1000098000,0x9100001a520,0x1b15000098010,0x9900001a530
.quad 0x1ad20000a8000,0xa100001a540,0x1b160000a8010,0xa900001a550
.quad 0x1ad30000b8000,0xb100001a560,0x1b170000b8010,0xb900001a570
.quad 0x1ad40000c8000,0xc100001a580,0x1b180000c8010,0xc900001a590
.quad 0x1ad50000d8000,0xd100001a5a0,0x1b190000d8010,0xd900001a5b0
.quad 0x1ad60000e8000,0xe100001a5c0,0x1b1a0000e8010,0xe900001a5d0
.quad 0x1ad70000f8000,0xf100001a5e0,0x1b1b0000f8010,0xf900001a5f0
.quad 0x1ad800000a000,0x8200001a600,0x1b1c00000a010,0x8a00001a610
.quad 0x1ad900001a000,0x9200001a620,0x1b1d00001a010,0x9a00001a630
.quad 0x1ada00002a000,0xa200001a640,0x1b1e00002a010,0xaa00001a650
.quad 0x1adb00003a000,0xb200001a660,0x1b1f00003a010,0xba00001a670
.quad 0x1adc00004a000,0xc200001a680,0x1b2000004a010,0xca00001a690
.quad 0x1add00005a000,0xd200001a6a0,0x1b2100005a010,0xda00001a6b0
.quad 0x1ade00006a000,0xe200001a6c0,0x1b2200006a010,0xea00001a6d0
.quad 0x1adf00007a000,0xf200001a6e0,0x1b2300007a010,0xfa00001a6f0
.quad 0x1ae000008a000,0x8300001a700,0x1b2400008a010,0x8b00001a710
.quad 0x1ae100009a000,0x9300001a720,0x1b2500009a010,0x9b00001a730
.quad 0x1ae20000aa000,0xa300001a740,0x1b260000aa010,0xab00001a750
.quad 0x1ae30000ba000,0xb300001a760,0x1b270000ba010,0xbb00001a770
.quad 0x1ae40000ca000,0xc300001a780,0x1b280000ca010,0xcb00001a790
.quad 0x1ae50000da000,0xd300001a7a0,0x1b290000da010,0xdb00001a7b0
.quad 0x1ae60000ea000,0xe300001a7c0,0x1b2a0000ea010,0xeb00001a7d0
.quad 0x1ae70000fa000,0xf300001a7e0,0x1b2b0000fa010,0xfb00001a7f0
.quad 0x1c6000001c620,0x40,0x1c6a00001c6c0,0x140
.quad 0x1c7400001c760,0x240,0x1c7e00001c800,0x340
.quad 0x1c8800001c8a0,0x440,0x1c9200001c940,0x540
.quad 0x1c9c00001c9e0,0x640,0x1ca600001ca80,0x740
.quad 0x1cb000001cb20,0x840,0x1cba00001cbc0,0x940
.quad 0x1cc400001cc60,0xa40,0x1cce00001cd00,0xb40
.quad 0x1cd800001cda0,0xc40,0x1ce200001ce40,0xd40
.quad 0x1cec00001cee0,0xe40,0x1cf600001cf80,0xf40
.quad 0x1c6100001c628,0x50,0x1c6b00001c6c8,0x150
.quad 0x1c7500001c768,0x250,0x1c7f00001c808,0x350
.quad 0x1c8900001c8a8,0x450,0x1c9300001c948,0x550
.quad 0x1c9d00001c9e8,0x650,0x1ca700001ca88,0x750
.quad 0x1cb100001cb28,0x850,0x1cbb00001cbc8,0x950
.quad 0x1cc500001cc68,0xa50,0x1ccf00001cd08,0xb50
.quad 0x1cd900001cda8,0xc50,0x1ce300001ce48,0xd50
.quad 0x1ced00001cee8,0xe50,0x1cf700001cf88,0xf50
.quad 0x1c6200001c630,0x60,0x1c6c00001c6d0,0x160
.quad 0x1c7600001c770,0x260,0x1c8000001c810,0x360
.quad 0x1c8a00001c8b0,0x460,0x1c9400001c950,0x560
.quad 0x1c9e00001c9f0,0x660,0x1ca800001ca90,0x760
.quad 0x1cb200001cb30,0x860,0x1cbc00001cbd0,0x960
.quad 0x1cc600001cc70,0xa60,0x1cd000001cd10,0xb60
.quad 0x1cda00001cdb0,0xc60,0x1ce400001ce50,0xd60
.quad 0x1cee00001cef0,0xe60,0x1cf800001cf90,0xf60
.quad 0x1c6300001c638,0x70,0x1c6d00001c6d8,0x170
.quad 0x1c7700001c778,0x270,0x1c8100001c818,0x370
.quad 0x1c8b00001c8b8,0x470,0x1c9500001c958,0x570
.quad 0x1c9f00001c9f8,0x670,0x1ca900001ca98,0x770
.quad 0x1cb300001cb38,0x870,0x1cbd00001cbd8,0x970
.quad 0x1cc700001cc78,0xa70,0x1cd100001cd18,0xb70
.quad 0x1cdb00001cdb8,0xc70,0x1ce500001ce58,0xd70
.quad 0x1cef00001cef8,0xe70,0x1cf900001cf98,0xf70
.quad 0x800003f800000,0x1a4080001a800,0x80010bf800000,0x1a4180001b840
.quad 0x820003f800000,0x1a4280001a810,0x82010bf800000,0x1a4380001b850
.quad 0x840003f800000,0x1a4480001a820,0x84010bf800000,0x1a4580001b860
.quad 0x860003f800000,0x1a4680001a830,0x86010bf800000,0x1a4780001b870
.quad 0x880003f800000,0x1a4880001a840,0x88010bf800000,0x1a4980001b880
.quad 0x8a0003f800000,0x1a4a80001a850,0x8a010bf800000,0x1a4b80001b890
.quad 0x8c0003f800000,0x1a4c80001a860,0x8c010bf800000,0x1a4d80001b8a0
.quad 0x8e0003f800000,0x1a4e80001a870,0x8e010bf800000,0x1a4f80001b8b0
.quad 0x900003f800000,0x1a5080001a880,0x90010bf800000,0x1a5180001b8c0
.quad 0x920003f800000,0x1a5280001a890,0x92010bf800000,0x1a5380001b8d0
.quad 0x940003f800000,0x1a5480001a8a0,0x94010bf800000,0x1a5580001b8e0
.quad 0x960003f800000,0x1a5680001a8b0,0x96010bf800000,0x1a5780001b8f0
.quad 0x980003f800000,0x1a5880001a8c0,0x98010bf800000,0x1a5980001b900
.quad 0x9a0003f800000,0x1a5a80001a8d0,0x9a010bf800000,0x1a5b80001b910
.quad 0x9c0003f800000,0x1a5c80001a8e0,0x9c010bf800000,0x1a5d80001b920
.quad 0x9e0003f800000,0x1a5e80001a8f0,0x9e010bf800000,0x1a5f80001b930
.quad 0xa000000000000,0x1a8080001a900,0xa001000000000,0x1a8180001b940
.quad 0xa200000000000,0x1a8280001a910,0xa201000000000,0x1a8380001b950
.quad 0xa400000000000,0x1a8480001a920,0xa401000000000,0x1a8580001b960
.quad 0xa600000000000,0x1a8680001a930,0xa601000000000,0x1a8780001b970
.quad 0xa800000000000,0x1a8880001a940,0xa801000000000,0x1a8980001b980
.quad 0xaa00000000000,0x1a8a80001a950,0xaa01000000000,0x1a8b80001b990
.quad 0xac00000000000,0x1a8c80001a960,0xac01000000000,0x1a8d80001b9a0
.quad 0xae00000000000,0x1a8e80001a970,0xae01000000000,0x1a8f80001b9b0
.quad 0xb000000000000,0x1a9080001a980,0xb001000000000,0x1a9180001b9c0
.quad 0xb200000000000,0x1a9280001a990,0xb201000000000,0x1a9380001b9d0
.quad 0xb400000000000,0x1a9480001a9a0,0xb401000000000,0x1a9580001b9e0
.quad 0xb600000000000,0x1a9680001a9b0,0xb601000000000,0x1a9780001b9f0
.quad 0xb800000000000,0x1a9880001a9c0,0xb801000000000,0x1a9980001ba00
.quad 0xba00000000000,0x1a9a80001a9d0,0xba01000000000,0x1a9b80001ba10
.quad 0xbc00000000000,0x1a9c80001a9e0,0xbc01000000000,0x1a9d80001ba20
.quad 0xbe00000000000,0x1a9e80001a9f0,0xbe01000000000,0x1a9f80001ba30
.quad 0x8000001a408,0x1c6300001c620,0x8200001a408,0x1c7400001c730
.quad 0x8400001a408,0x1c8500001c840,0x8600001a408,0x1c9600001c950
.quad 0x8800001a408,0x1ca700001ca60,0x8a00001a408,0x1cb000001cb70
.quad 0x8c00001a408,0x1cc100001cc00,0x8e00001a408,0x1cd200001cd10
.quad 0x9000001a408,0x1ce300001ce20,0x9200001a408,0x1cf400001cf30
.quad 0x9400001a408,0x1d0500001d040,0x9600001a408,0x1d1600001d150
.quad 0x9800001a408,0x1d2700001d260,0x9a00001a408,0x1d3000001d370
.quad 0x9c00001a408,0x1d4100001d400,0x9e00001a408,0x1d5200001d510
.quad 0xa000001a40c,0x1d6300001d620,0xa200001a40c,0x1d7400001d730
.quad 0xa400001a40c,0x1d8500001d840,0xa600001a40c,0x1d9600001d950
.quad 0xa800001a40c,0x1da700001da60,0xaa00001a40c,0x1db000001db70
.quad 0xac00001a40c,0x1dc100001dc00,0xae00001a40c,0x1dd200001dd10
.quad 0xb000001a40c,0x1de300001de20,0xb200001a40c,0x1df400001df30
.quad 0xb400001a40c,0x1e0500001e040,0xb600001a40c,0x1e1600001e150
.quad 0xb800001a40c,0x1e2700001e260,0xba00001a40c,0x1e3000001e370
.quad 0xbc00001a40c,0x1e4100001e400,0xbe00001a40c,0x1e5200001e510
.quad 0x8100001a408,0x1c6b00001c6a0,0x8300001a408,0x1c7c00001c7b0
.quad 0x8500001a408,0x1c8d00001c8c0,0x8700001a408,0x1c9e00001c9d0
.quad 0x8900001a408,0x1caf00001cae0,0x8b00001a408,0x1cb800001cbf0
.quad 0x8d00001a408,0x1cc900001cc80,0x8f00001a408,0x1cda00001cd90
.quad 0x9100001a408,0x1ceb00001cea0,0x9300001a408,0x1cfc00001cfb0
.quad 0x9500001a408,0x1d0d00001d0c0,0x9700001a408,0x1d1e00001d1d0
.quad 0x9900001a408,0x1d2f00001d2e0,0x9b00001a408,0x1d3800001d3f0
.quad 0x9d00001a408,0x1d4900001d480,0x9f00001a408,0x1d5a00001d590
.quad 0xa100001a40c,0x1d6b00001d6a0,0xa300001a40c,0x1d7c00001d7b0
.quad 0xa500001a40c,0x1d8d00001d8c0,0xa700001a40c,0x1d9e00001d9d0
.quad 0xa900001a40c,0x1daf00001dae0,0xab00001a40c,0x1db800001dbf0
.quad 0xad00001a40c,0x1dc900001dc80,0xaf00001a40c,0x1dda00001dd90
.quad 0xb100001a40c,0x1deb00001dea0,0xb300001a40c,0x1dfc00001dfb0
.quad 0xb500001a40c,0x1e0d00001e0c0,0xb700001a40c,0x1e1e00001e1d0
.quad 0xb900001a40c,0x1e2f00001e2e0,0xbb00001a40c,0x1e3800001e3f0
.quad 0xbd00001a40c,0x1e4900001e480,0xbf00001a40c,0x1e5a00001e590
.quad 0x1ce400001ce00,0x1f20000018900,0x1ce500001ce10,0x1f24000018920
.quad 0x1ce600001ce20,0x1f28000018940,0x1ce700001ce30,0x1f2c000018960
.quad 0x1ce000001ce40,0x1f30000018980,0x1ce100001ce50,0x1f340000189a0
.quad 0x1ce200001ce60,0x1f380000189c0,0x1ce300001ce70,0x1f3c0000189e0
.quad 0x1cec00001ce80,0x1f40000018a00,0x1ced00001ce90,0x1f44000018a20
.quad 0x1cee00001cea0,0x1f48000018a40,0x1cef00001ceb0,0x1f4c000018a60
.quad 0x1ce800001cec0,0x1f50000018a80,0x1ce900001ced0,0x1f54000018aa0
.quad 0x1cea00001cee0,0x1f58000018ac0,0x1ceb00001cef0,0x1f5c000018ae0
.quad 0x1cf500001cf10,0x1f60000018b00,0x1cf600001cf20,0x1f64000018b20
.quad 0x1cf700001cf30,0x1f68000018b40,0x1cf000001cf40,0x1f6c000018b60
.quad 0x1cf100001cf50,0x1f70000018b80,0x1cf200001cf60,0x1f74000018ba0
.quad 0x1cf300001cf70,0x1f78000018bc0,0x1cf400001cf00,0x1f7c000018be0
.quad 0x1cfd00001cf90,0x1f80000018c00,0x1cfe00001cfa0,0x1f84000018c20
.quad 0x1cff00001cfb0,0x1f88000018c40,0x1cf800001cfc0,0x1f8c000018c60
.quad 0x1cf900001cfd0,0x1f90000018c80,0x1cfa00001cfe0,0x1f94000018ca0
.quad 0x1cfb00001cff0,0x1f98000018cc0,0x1cfc00001cf80,0x1f9c000018ce0
.quad 0x1d0600001d020,0x1f21000018908,0x1d0700001d030,0x1f25000018928
.quad 0x1d0000001d040,0x1f29000018948,0x1d0100001d050,0x1f2d000018968
.quad 0x1d0200001d060,0x1f31000018988,0x1d0300001d070,0x1f350000189a8
.quad 0x1d0400001d000,0x1f390000189c8,0x1d0500001d010,0x1f3d0000189e8
.quad 0x1d0e00001d0a0,0x1f41000018a08,0x1d0f00001d0b0,0x1f45000018a28
.quad 0x1d0800001d0c0,0x1f49000018a48,0x1d0900001d0d0,0x1f4d000018a68
.quad 0x1d0a00001d0e0,0x1f51000018a88,0x1d0b00001d0f0,0x1f55000018aa8
.quad 0x1d0c00001d080,0x1f59000018ac8,0x1d0d00001d090,0x1f5d000018ae8
.quad 0x1d1700001d130,0x1f61000018b08,0x1d1000001d140,0x1f65000018b28
.quad 0x1d1100001d150,0x1f69000018b48,0x1d1200001d160,0x1f6d000018b68
.quad 0x1d1300001d170,0x1f71000018b88,0x1d1400001d100,0x1f75000018ba8
.quad 0x1d1500001d110,0x1f79000018bc8,0x1d1600001d120,0x1f7d000018be8
.quad 0x1d1f00001d1b0,0x1f81000018c08,0x1d1800001d1c0,0x1f85000018c28
.quad 0x1d1900001d1d0,0x1f89000018c48,0x1d1a00001d1e0,0x1f8d000018c68
.quad 0x1d1b00001d1f0,0x1f91000018c88,0x1d1c00001d180,0x1f95000018ca8
.quad 0x1d1d00001d190,0x1f99000018cc8,0x1d1e00001d1a0,0x1f9d000018ce8
.quad 0x1f60000001400,0x400,0x1f61000001410,0x1000000410
.quad 0x1f62000001420,0x2000000420,0x1f63000001430,0x3000000430
.quad 0x1f64000001440,0x4000000440,0x1f65000001450,0x5000000450
.quad 0x1f66000001460,0x6000000460,0x1f67000001470,0x7000000470
.quad 0x1f68000001480,0x8000000480,0x1f69000001490,0x9000000490
.quad 0x1f6a0000014a0,0xa0000004a0,0x1f6b0000014b0,0xb0000004b0
.quad 0x1f6c0000014c0,0xc0000004c0,0x1f6d0000014d0,0xd0000004d0
.quad 0x1f6e0000014e0,0xe0000004e0,0x1f6f0000014f0,0xf0000004f0
.quad 0x1f70000001500,0x10000000500,0x1f71000001510,0x11000000510
.quad 0x1f72000001520,0x12000000520,0x1f73000001530,0x13000000530
.quad 0x1f74000001540,0x14000000540,0x1f75000001550,0x15000000550
.quad 0x1f76000001560,0x16000000560,0x1f77000001570,0x17000000570
.quad 0x1f78000001580,0x18000000580,0x1f79000001590,0x19000000590
.quad 0x1f7a0000015a0,0x1a0000005a0,0x1f7b0000015b0,0x1b0000005b0
.quad 0x1f7c0000015c0,0x1c0000005c0,0x1f7d0000015d0,0x1d0000005d0
.quad 0x1f7e0000015e0,0x1e0000005e0,0x1f7f0000015f0,0x1f0000005f0
.quad 0x1f80000001600,0x20000000600,0x1f81000001610,0x21000000610
.quad 0x1f82000001620,0x22000000620,0x1f83000001630,0x23000000630
.quad 0x1f84000001640,0x24000000640,0x1f85000001650,0x25000000650
.quad 0x1f86000001660,0x26000000660,0x1f87000001670,0x27000000670
.quad 0x1f88000001680,0x28000000680,0x1f89000001690,0x29000000690
.quad 0x1f8a0000016a0,0x2a0000006a0,0x1f8b0000016b0,0x2b0000006b0
.quad 0x1f8c0000016c0,0x2c0000006c0,0x1f8d0000016d0,0x2d0000006d0
.quad 0x1f8e0000016e0,0x2e0000006e0,0x1f8f0000016f0,0x2f0000006f0
.quad 0x1f90000001700,0x30000000700,0x1f91000001710,0x31000000710
.quad 0x1f92000001720,0x32000000720,0x1f93000001730,0x33000000730
.quad 0x1f94000001740,0x34000000740,0x1f95000001750,0x35000000750
.quad 0x1f96000001760,0x36000000760,0x1f97000001770,0x37000000770
.quad 0x1f98000001780,0x38000000780,0x1f99000001790,0x39000000790
.quad 0x1f9a0000017a0,0x3a0000007a0,0x1f9b0000017b0,0x3b0000007b0
.quad 0x1f9c0000017c0,0x3c0000007c0,0x1f9d0000017d0,0x3d0000007d0
.quad 0x1f9e0000017e0,0x3e0000007e0,0x1f9f0000017f0,0x3f0000007f0
.quad 0x1580000000000,0x20a8000000040,0x1581000000010,0x20a8000000440
.quad 0x1582000000020,0x20a8000000840,0x1583000000030,0x20a8000000c40
.quad 0x1584000000040,0x20a8000001040,0x1585000000050,0x20a8000001440
.quad 0x1586000000060,0x20a8000001840,0x1587000000070,0x20a8000001c40
.quad 0x1588000000080,0x20a8000002040,0x1589000000090,0x20a8000002440
.quad 0x158a0000000a0,0x20a8000002840,0x158b0000000b0,0x20a8000002c40
.quad 0x158c0000000c0,0x20a8000003040,0x158d0000000d0,0x20a8000003440
.quad 0x158e0000000e0,0x20a8000003840,0x158f0000000f0,0x20a8000003c40
.quad 0x1590000000100,0x20a8000004040,0x1591000000110,0x20a8000004440
.quad 0x1592000000120,0x20a8000004840,0x1593000000130,0x20a8000004c40
.quad 0x1594000000140,0x20a8000005040,0x1595000000150,0x20a8000005440
.quad 0x1596000000160,0x20a8000005840,0x1597000000170,0x20a8000005c40
.quad 0x1598000000180,0x20a8000006040,0x1599000000190,0x20a8000006440
.quad 0x159a0000001a0,0x20a8000006840,0x159b0000001b0,0x20a8000006c40
.quad 0x159c0000001c0,0x20a8000007040,0x159d0000001d0,0x20a8000007440
.quad 0x159e0000001e0,0x20a8000007840,0x159f0000001f0,0x20a8000007c40
.quad 0x15a0000000200,0x20a9000000050,0x15a1000000210,0x20a9000000450
.quad 0x15a2000000220,0x20a9000000850,0x15a3000000230,0x20a9000000c50
.quad 0x15a4000000240,0x20a9000001050,0x15a5000000250,0x20a9000001450
.quad 0x15a6000000260,0x20a9000001850,0x15a7000000270,0x20a9000001c50
.quad 0x15a8000000280,0x20a9000002050,0x15a9000000290,0x20a9000002450
.quad 0x15aa0000002a0,0x20a9000002850,0x15ab0000002b0,0x20a9000002c50
.quad 0x15ac0000002c0,0x20a9000003050,0x15ad0000002d0,0x20a9000003450
.quad 0x15ae0000002e0,0x20a9000003850,0x15af0000002f0,0x20a9000003c50
.quad 0x15b0000000300,0x20a9000004050,0x15b1000000310,0x20a9000004450
.quad 0x15b2000000320,0x20a9000004850,0x15b3000000330,0x20a9000004c50
.quad 0x15b4000000340,0x20a9000005050,0x15b5000000350,0x20a9000005450
.quad 0x15b6000000360,0x20a9000005850,0x15b7000000370,0x20a9000005c50
.quad 0x15b8000000380,0x20a9000006050,0x15b9000000390,0x20a9000006450
.quad 0x15ba0000003a0,0x20a9000006850,0x15bb0000003b0,0x20a9000006c50
.quad 0x15bc0000003c0,0x20a9000007050,0x15bd0000003d0,0x20a9000007450
.quad 0x15be0000003e0,0x20a9000007850,0x15bf0000003f0,0x20a9000007c50
.quad 0x40,0x80000000a000,0x1000008040,0x80100000a010
.quad 0x2000010040,0x80200000a020,0x3000018040,0x80300000a030
.quad 0x4000020040,0x80400000a040,0x5000028040,0x80500000a050
.quad 0x6000030040,0x80600000a060,0x7000038040,0x80700000a070
.quad 0x8000040040,0x80800000a080,0x9000048040,0x80900000a090
.quad 0xa000050040,0x80a00000a0a0,0xb000058040,0x80b00000a0b0
.quad 0xc000060040,0x80c00000a0c0,0xd000068040,0x80d00000a0d0
.quad 0xe000070040,0x80e00000a0e0,0xf000078040,0x80f00000a0f0
.quad 0x10000080040,0x81000000a100,0x11000088040,0x81100000a110
.quad 0x12000090040,0x81200000a120,0x13000098040,0x81300000a130
.quad 0x140000a0040,0x81400000a140,0x150000a8040,0x81500000a150
.quad 0x160000b0040,0x81600000a160,0x170000b8040,0x81700000a170
.quad 0x180000c0040,0x81800000a180,0x190000c8040,0x81900000a190
.quad 0x1a0000d0040,0x81a00000a1a0,0x1b0000d8040,0x81b00000a1b0
.quad 0x1c0000e0040,0x81c00000a1c0,0x1d0000e8040,0x81d00000a1d0
.quad 0x1e0000f0040,0x81e00000a1e0,0x1f0000f8040,0x81f00000a1f0
.quad 0x20000000050,0x82000000a200,0x21000008050,0x82100000a210
.quad 0x22000010050,0x82200000a220,0x23000018050,0x82300000a230
.quad 0x24000020050,0x82400000a240,0x25000028050,0x82500000a250
.quad 0x26000030050,0x82600000a260,0x27000038050,0x82700000a270
.quad 0x28000040050,0x82800000a280,0x29000048050,0x82900000a290
.quad 0x2a000050050,0x82a00000a2a0,0x2b000058050,0x82b00000a2b0
.quad 0x2c000060050,0x82c00000a2c0,0x2d000068050,0x82d00000a2d0
.quad 0x2e000070050,0x82e00000a2e0,0x2f000078050,0x82f00000a2f0
.quad 0x30000080050,0x83000000a300,0x31000088050,0x83100000a310
.quad 0x32000090050,0x83200000a320,0x33000098050,0x83300000a330
.quad 0x340000a0050,0x83400000a340,0x350000a8050,0x83500000a350
.quad 0x360000b0050,0x83600000a360,0x370000b8050,0x83700000a370
.quad 0x380000c0050,0x83800000a380,0x390000c8050,0x83900000a390
.quad 0x3a0000d0050,0x83a00000a3a0,0x3b0000d8050,0x83b00000a3b0
.quad 0x3c0000e0050,0x83c00000a3c0,0x3d0000e8050,0x83d00000a3d0
.quad 0x3e0000f0050,0x83e00000a3e0,0x3f0000f8050,0x83f00000a3f0
.Ltabw2:
.quad 0x1a4000001ad00,0x1ce000001c700,0x1a4900001af40,0x1de400001c704
.quad 0x1a5200001b180,0x1ce040001c708,0x1a5b00001b3c0,0x1de440001c70c
.quad 0x1a6400001ad04,0x1ce080001c710,0x1a6d00001af44,0x1de480001c714
.quad 0x1a7600001b184,0x1ce0c0001c718,0x1a7f00001b3c4,0x1de4c0001c71c
.quad 0x1a8800001ad08,0x1ce100001c720,0x1a9100001af48,0x1de500001c724
.quad 0x1a9a00001b188,0x1ce140001c728,0x1aa300001b3c8,0x1de540001c72c
.quad 0x1aac00001ad0c,0x1ce180001c730,0x1ab500001af4c,0x1de580001c734
.quad 0x1abe00001b18c,0x1ce1c0001c738,0x1ac700001b3cc,0x1de5c0001c73c
.quad 0x1a4000001ad10,0x1ce200001c740,0x1a4900001af50,0x1de600001c744
.quad 0x1a5200001b190,0x1ce240001c748,0x1a5b00001b3d0,0x1de640001c74c
.quad 0x1a6400001ad14,0x1ce280001c750,0x1a6d00001af54,0x1de680001c754
.quad 0x1a7600001b194,0x1ce2c0001c758,0x1a7f00001b3d4,0x1de6c0001c75c
.quad 0x1a8800001ad18,0x1ce300001c760,0x1a9100001af58,0x1de700001c764
.quad 0x1a9a00001b198,0x1ce340001c768,0x1aa300001b3d8,0x1de740001c76c
.quad 0x1aac00001ad1c,0x1ce380001c770,0x1ab500001af5c,0x1de780001c774
.quad 0x1abe00001b19c,0x1ce3c0001c778,0x1ac700001b3dc,0x1de7c0001c77c
.quad 0x1a4200001ad20,0x1ce400001cb00,0x1a4b00001af60,0x1de800001cb04
.quad 0x1a5400001b1a0,0x1ce440001cb08,0x1a5d00001b3e0,0x1de840001cb0c
.quad 0x1a6600001ad24,0x1ce480001cb10,0x1a6f00001af64,0x1de880001cb14
.quad 0x1a7800001b1a4,0x1ce4c0001cb18,0x1a8100001b3e4,0x1de8c0001cb1c
.quad 0x1a8a00001ad28,0x1ce500001cb20,0x1a9300001af68,0x1de900001cb24
.quad 0x1a9c00001b1a8,0x1ce540001cb28,0x1aa500001b3e8,0x1de940001cb2c
.quad 0x1aae00001ad2c,0x1ce580001cb30,0x1ab700001af6c,0x1de980001cb34
.quad 0x1ac000001b1ac,0x1ce5c0001cb38,0x1ac900001b3ec,0x1de9c0001cb3c
.quad 0x1a4200001ad30,0x1ce600001cb40,0x1a4b00001af70,0x1dea00001cb44
.quad 0x1a5400001b1b0,0x1ce640001cb48,0x1a5d00001b3f0,0x1dea40001cb4c
.quad 0x1a6600001ad34,0x1ce680001cb50,0x1a6f00001af74,0x1dea80001cb54
.quad 0x1a7800001b1b4,0x1ce6c0001cb58,0x1a8100001b3f4,0x1deac0001cb5c
.quad 0x1a8a00001ad38,0x1ce700001cb60,0x1a9300001af78,0x1deb00001cb64
.quad 0x1a9c00001b1b8,0x1ce740001cb68,0x1aa500001b3f8,0x1deb40001cb6c
.quad 0x1aae00001ad3c,0x1ce780001cb70,0x1ab700001af7c,0x1deb80001cb74
.quad 0x1ac000001b1bc,0x1ce7c0001cb78,0x1ac900001b3fc,0x1debc0001cb7c
.quad 0x2124000001000,0x800040000,0x2165000001010,0x1800040010
.quad 0x21a6000001020,0x20000800040020,0x21e7000001030,0x20001800040030
.quad 0x2228000001040,0x800040040,0x2269000001050,0x1800040050
.quad 0x22aa000001060,0x20000800040060,0x22eb000001070,0x20001800040070
.quad 0x2124200001080,0x800042000,0x2165200001090,0x1800042010
.quad 0x21a62000010a0,0x20000800042020,0x21e72000010b0,0x20001800042030
.quad 0x22282000010c0,0x800042040,0x22692000010d0,0x1800042050
.quad 0x22aa2000010e0,0x20000800042060,0x22eb2000010f0,0x20001800042070
.quad 0x2124400001100,0x800044000,0x2165400001110,0x1800044010
.quad 0x21a6400001120,0x20000800044020,0x21e7400001130,0x20001800044030
.quad 0x2228400001140,0x800044040,0x2269400001150,0x1800044050
.quad 0x22aa400001160,0x20000800044060,0x22eb400001170,0x20001800044070
.quad 0x2124600001180,0x800046000,0x2165600001190,0x1800046010
.quad 0x21a66000011a0,0x20000800046020,0x21e76000011b0,0x20001800046030
.quad 0x22286000011c0,0x800046040,0x22696000011d0,0x1800046050
.quad 0x22aa6000011e0,0x20000800046060,0x22eb6000011f0,0x20001800046070
.quad 0x2124800001200,0x800048000,0x2165800001210,0x1800048010
.quad 0x21a6800001220,0x20000800048020,0x21e7800001230,0x20001800048030
.quad 0x2228800001240,0x800048040,0x2269800001250,0x1800048050
.quad 0x22aa800001260,0x20000800048060,0x22eb800001270,0x20001800048070
.quad 0x2124a00001280,0x80004a000,0x2165a00001290,0x180004a010
.quad 0x21a6a000012a0,0x2000080004a020,0x21e7a000012b0,0x2000180004a030
.quad 0x2228a000012c0,0x80004a040,0x2269a000012d0,0x180004a050
.quad 0x22aaa000012e0,0x2000080004a060,0x22eba000012f0,0x2000180004a070
.quad 0x2124c00001300,0x80004c000,0x2165c00001310,0x180004c010
.quad 0x21a6c00001320,0x2000080004c020,0x21e7c00001330,0x2000180004c030
.quad 0x2228c00001340,0x80004c040,0x2269c00001350,0x180004c050
.quad 0x22aac00001360,0x2000080004c060,0x22ebc00001370,0x2000180004c070
.quad 0x2124e00001380,0x80004e000,0x2165e00001390,0x180004e010
.quad 0x21a6e000013a0,0x2000080004e020,0x21e7e000013b0,0x2000180004e030
.quad 0x2228e000013c0,0x80004e040,0x2269e000013d0,0x180004e050
.quad 0x22aae000013e0,0x2000080004e060,0x22ebe000013f0,0x2000180004e070
.quad 0x1000001f000,0x1f10000026300,0x1100001f040,0x1f10000026308
.quad 0x1200001f000,0x1f10000026310,0x1300001f040,0x1f10000026318
.quad 0x1400001f000,0x1f10000026380,0x1500001f040,0x1f10000026388
.quad 0x1600001f000,0x1f10000026390,0x1700001f040,0x1f10000026398
.quad 0x5000001f000,0x1f10000026400,0x5100001f040,0x1f10000026408
.quad 0x5200001f000,0x1f10000026410,0x5300001f040,0x1f10000026418
.quad 0x5400001f000,0x1f10000026480,0x5500001f040,0x1f10000026488
.quad 0x5600001f000,0x1f10000026490,0x5700001f040,0x1f10000026498
.quad 0x9000001f020,0x1f10000026320,0x9100001f060,0x1f10000026328
.quad 0x9200001f020,0x1f10000026330,0x9300001f060,0x1f10000026338
.quad 0x9400001f020,0x1f100000263a0,0x9500001f060,0x1f100000263a8
.quad 0x9600001f020,0x1f100000263b0,0x9700001f060,0x1f100000263b8
.quad 0xd000001f020,0x1f10000026420,0xd100001f060,0x1f10000026428
.quad 0xd200001f020,0x1f10000026430,0xd300001f060,0x1f10000026438
.quad 0xd400001f020,0x1f100000264a0,0xd500001f060,0x1f100000264a8
.quad 0xd600001f020,0x1f100000264b0,0xd700001f060,0x1f100000264b8
.quad 0x11000001f010,0x1f10000026500,0x11100001f050,0x1f10000026508
.quad 0x11200001f010,0x1f10000026510,0x11300001f050,0x1f10000026518
.quad 0x11400001f010,0x1f10000026580,0x11500001f050,0x1f10000026588
.quad 0x11600001f010,0x1f10000026590,0x11700001f050,0x1f10000026598
.quad 0x15000001f010,0x1f10000026600,0x15100001f050,0x1f10000026608
.quad 0x15200001f010,0x1f10000026610,0x15300001f050,0x1f10000026618
.quad 0x15400001f010,0x1f10000026680,0x15500001f050,0x1f10000026688
.quad 0x15600001f010,0x1f10000026690,0x15700001f050,0x1f10000026698
.quad 0x19000001f030,0x1f10000026520,0x19100001f070,0x1f10000026528
.quad 0x19200001f030,0x1f10000026530,0x19300001f070,0x1f10000026538
.quad 0x19400001f030,0x1f100000265a0,0x19500001f070,0x1f100000265a8
.quad 0x19600001f030,0x1f100000265b0,0x19700001f070,0x1f100000265b8
.quad 0x1d000001f030,0x1f10000026620,0x1d100001f070,0x1f10000026628
.quad 0x1d200001f030,0x1f10000026630,0x1d300001f070,0x1f10000026638
.quad 0x1d400001f030,0x1f100000266a0,0x1d500001f070,0x1f100000266a8
.quad 0x1d600001f030,0x1f100000266b0,0x1d700001f070,0x1f100000266b8
.quad 0xaf600000ac000,0xb2c00,0xaf610000ac010,0x8000b2c10
.quad 0xaf620000ac020,0x10000b2c20,0xaf630000ac030,0x18000b2c30
.quad 0xaf640000ac040,0xc0000b3640,0xaf650000ac050,0xc8000b3650
.quad 0xaf660000ac060,0xd0000b3660,0xaf670000ac070,0xd8000b3670
.quad 0xb0080000ac080,0x180000b3680,0xb0090000ac090,0x188000b3690
.quad 0xb00a0000ac0a0,0x190000b36a0,0xb00b0000ac0b0,0x198000b36b0
.quad 0xb00c0000acac0,0x240000b36c0,0xb00d0000acad0,0x248000b36d0
.quad 0xb00e0000acae0,0x250000b36e0,0xb00f0000acaf0,0x258000b36f0
.quad 0xb0100000acb00,0x20000b4100,0xb0110000acb10,0x28000b4110
.quad 0xb0120000acb20,0x30000b4120,0xb0130000acb30,0x38000b4130
.quad 0xb0b40000acb40,0xe0000b4140,0xb0b50000acb50,0xe8000b4150
.quad 0xb0b60000acb60,0xf0000b4160,0xb0b70000acb70,0xf8000b4170
.quad 0xb0b80000ad580,0x1a0000b4180,0xb0b90000ad590,0x1a8000b4190
.quad 0xb0ba0000ad5a0,0x1b0000b41a0,0xb0bb0000ad5b0,0x1b8000b41b0
.quad 0xb0bc0000ad5c0,0x260000b4bc0,0xb0bd0000ad5d0,0x268000b4bd0
.quad 0xb0be0000ad5e0,0x270000b4be0,0xb0bf0000ad5f0,0x278000b4bf0
.quad 0xb1600000ad600,0x300000b4c00,0xb1610000ad610,0x308000b4c10
.quad 0xb1620000ad620,0x310000b4c20,0xb1630000ad630,0x318000b4c30
.quad 0xb1640000ae040,0x3c0000b4c40,0xb1650000ae050,0x3c8000b4c50
.quad 0xb1660000ae060,0x3d0000b4c60,0xb1670000ae070,0x3d8000b4c70
.quad 0xb1680000ae080,0x480000b5680,0xb1690000ae090,0x488000b5690
.quad 0xb16a0000ae0a0,0x490000b56a0,0xb16b0000ae0b0,0x498000b56b0
.quad 0xb20c0000ae0c0,0x540000b56c0,0xb20d0000ae0d0,0x548000b56d0
.quad 0xb20e0000ae0e0,0x550000b56e0,0xb20f0000ae0f0,0x558000b56f0
.quad 0xb2100000aeb00,0x320000b5700,0xb2110000aeb10,0x328000b5710
.quad 0xb2120000aeb20,0x330000b5720,0xb2130000aeb30,0x338000b5730
.quad 0xb2140000aeb40,0x3e0000b6140,0xb2150000aeb50,0x3e8000b6150
.quad 0xb2160000aeb60,0x3f0000b6160,0xb2170000aeb70,0x3f8000b6170
.quad 0xb2b80000aeb80,0x4a0000b6180,0xb2b90000aeb90,0x4a8000b6190
.quad 0xb2ba0000aeba0,0x4b0000b61a0,0xb2bb0000aebb0,0x4b8000b61b0
.quad 0xb2bc0000af5c0,0x560000b61c0,0xb2bd0000af5d0,0x568000b61d0
.quad 0xb2be0000af5e0,0x570000b61e0,0xb2bf0000af5f0,0x578000b61f0
.quad 0x2b00000004000,0x1000000000b00,0x2b01000004010,0x1001000000b80
.quad 0x2b02000004020,0x1002000000c00,0x2b03000004030,0x1003000000c80
.quad 0x2b04000004040,0x1004000000d00,0x2b05000004050,0x1005000000d80
.quad 0x2b06000004060,0x1006000000e00,0x2b07000004070,0x1007000000e80
.quad 0x2b08000004200,0x1008000000f00,0x2b09000004210,0x1009000000f80
.quad 0x2b0a000004220,0x100a000001000,0x2b0b000004230,0x100b000001080
.quad 0x2b0c000004240,0x100c000001100,0x2b0d000004250,0x100d000001180
.quad 0x2b0e000004260,0x100e000001200,0x2b0f000004270,0x100f000001280
.quad 0x2b10000004400,0x1010000001300,0x2b11000004410,0x1011000001380
.quad 0x2b12000004420,0x1012000001400,0x2b13000004430,0x1013000001480
.quad 0x2b14000004440,0x1014000001500,0x2b15000004450,0x1015000001580
.quad 0x2b16000004460,0x1016000001600,0x2b17000004470,0x1017000001680
.quad 0x2b18000004600,0x1018000001700,0x2b19000004610,0x1019000001780
.quad 0x2b1a000004620,0x101a000001800,0x2b1b000004630,0x101b000001880
.quad 0x2b1c000004640,0x101c000001900,0x2b1d000004650,0x101d000001980
.quad 0x2b1e000004660,0x101e000001a00,0x2b1f000004670,0x101f000001a80
.quad 0x2b20000004800,0x1020000001b00,0x2b21000004810,0x1021000001b80
.quad 0x2b22000004820,0x1022000001c00,0x2b23000004830,0x1023000001c80
.quad 0x2b24000004840,0x1024000001d00,0x2b25000004850,0x1025000001d80
.quad 0x2b26000004860,0x1026000001e00,0x2b27000004870,0x1027000001e80
.quad 0x2b28000004a00,0x1028000001f00,0x2b29000004a10,0x1029000001f80
.quad 0x2b2a000004a20,0x102a000002000,0x2b2b000004a30,0x102b000002080
.quad 0x2b2c000004a40,0x102c000002100,0x2b2d000004a50,0x102d000002180
.quad 0x2b2e000004a60,0x102e000002200,0x2b2f000004a70,0x102f000002280
.quad 0x2b30000004c00,0x1030000002300,0x2b31000004c10,0x1031000002380
.quad 0x2b32000004c20,0x1032000002400,0x2b33000004c30,0x1033000002480
.quad 0x2b34000004c40,0x1034000002500,0x2b35000004c50,0x1035000002580
.quad 0x2b36000004c60,0x1036000002600,0x2b37000004c70,0x1037000002680
.quad 0x2b38000004e00,0x1038000002700,0x2b39000004e10,0x1039000002780
.quad 0x2b3a000004e20,0x103a000002800,0x2b3b000004e30,0x103b000002880
.quad 0x2b3c000004e40,0x103c000002900,0x2b3d000004e50,0x103d000002980
.quad 0x2b3e000004e60,0x103e000002a00,0x2b3f000004e70,0x103f000002a80
.quad 0x1b50000100000,0x10000001a400,0x1b94000100010,0x10800001a410
.quad 0x1b51000110000,0x11000001a420,0x1b95000110010,0x11800001a430
.quad 0x1b52000120000,0x12000001a440,0x1b96000120010,0x12800001a450
.quad 0x1b53000130000,0x13000001a460,0x1b97000130010,0x13800001a470
.quad 0x1b54000140000,0x14000001a480,0x1b98000140010,0x14800001a490
.quad 0x1b55000150000,0x15000001a4a0,0x1b99000150010,0x15800001a4b0
.quad 0x1b56000160000,0x16000001a4c0,0x1b9a000160010,0x16800001a4d0
.quad 0x1b57000170000,0x17000001a4e0,0x1b9b000170010,0x17800001a4f0
.quad 0x1b58000180000,0x10100001a500,0x1b9c000180010,0x10900001a510
.quad 0x1b59000190000,0x11100001a520,0x1b9d000190010,0x11900001a530
.quad 0x1b5a0001a0000,0x12100001a540,0x1b9e0001a0010,0x12900001a550
.quad 0x1b5b0001b0000,0x13100001a560,0x1b9f0001b0010,0x13900001a570
.quad 0x1b5c0001c0000,0x14100001a580,0x1ba00001c0010,0x14900001a590
.quad 0x1b5d0001d0000,0x15100001a5a0,0x1ba10001d0010,0x15900001a5b0
.quad 0x1b5e0001e0000,0x16100001a5c0,0x1ba20001e0010,0x16900001a5d0
.quad 0x1b5f0001f0000,0x17100001a5e0,0x1ba30001f0010,0x17900001a5f0
.quad 0x1b60000102000,0x10200001a600,0x1ba4000102010,0x10a00001a610
.quad 0x1b61000112000,0x11200001a620,0x1ba5000112010,0x11a00001a630
.quad 0x1b62000122000,0x12200001a640,0x1ba6000122010,0x12a00001a650
.quad 0x1b63000132000,0x13200001a660,0x1ba7000132010,0x13a00001a670
.quad 0x1b64000142000,0x14200001a680,0x1ba8000142010,0x14a00001a690
.quad 0x1b65000152000,0x15200001a6a0,0x1ba9000152010,0x15a00001a6b0
.quad 0x1b66000162000,0x16200001a6c0,0x1baa000162010,0x16a00001a6d0
.quad 0x1b67000172000,0x17200001a6e0,0x1bab000172010,0x17a00001a6f0
.quad 0x1b68000182000,0x10300001a700,0x1bac000182010,0x10b00001a710
.quad 0x1b69000192000,0x11300001a720,0x1bad000192010,0x11b00001a730
.quad 0x1b6a0001a2000,0x12300001a740,0x1bae0001a2010,0x12b00001a750
.quad 0x1b6b0001b2000,0x13300001a760,0x1baf0001b2010,0x13b00001a770
.quad 0x1b6c0001c2000,0x14300001a780,0x1bb00001c2010,0x14b00001a790
.quad 0x1b6d0001d2000,0x15300001a7a0,0x1bb10001d2010,0x15b00001a7b0
.quad 0x1b6e0001e2000,0x16300001a7c0,0x1bb20001e2010,0x16b00001a7d0
.quad 0x1b6f0001f2000,0x17300001a7e0,0x1bb30001f2010,0x17b00001a7f0
.quad 0x1c6000001c640,0x80,0x1c6a00001c6e0,0x180
.quad 0x1c7400001c780,0x280,0x1c7e00001c820,0x380
.quad 0x1c8800001c8c0,0x480,0x1c9200001c960,0x580
.quad 0x1c9c00001ca00,0x680,0x1ca600001caa0,0x780
.quad 0x1cb000001cb40,0x880,0x1cba00001cbe0,0x980
.quad 0x1cc400001cc80,0xa80,0x1cce00001cd20,0xb80
.quad 0x1cd800001cdc0,0xc80,0x1ce200001ce60,0xd80
.quad 0x1cec00001cf00,0xe80,0x1cf600001cfa0,0xf80
.quad 0x1c6100001c648,0x90,0x1c6b00001c6e8,0x190
.quad 0x1c7500001c788,0x290,0x1c7f00001c828,0x390
.quad 0x1c8900001c8c8,0x490,0x1c9300001c968,0x590
.quad 0x1c9d00001ca08,0x690,0x1ca700001caa8,0x790
.quad 0x1cb100001cb48,0x890,0x1cbb00001cbe8,0x990
.quad 0x1cc500001cc88,0xa90,0x1ccf00001cd28,0xb90
.quad 0x1cd900001cdc8,0xc90,0x1ce300001ce68,0xd90
.quad 0x1ced00001cf08,0xe90,0x1cf700001cfa8,0xf90
.quad 0x1c6200001c650,0xa0,0x1c6c00001c6f0,0x1a0
.quad 0x1c7600001c790,0x2a0,0x1c8000001c830,0x3a0
.quad 0x1c8a00001c8d0,0x4a0,0x1c9400001c970,0x5a0
.quad 0x1c9e00001ca10,0x6a0,0x1ca800001cab0,0x7a0
.quad 0x1cb200001cb50,0x8a0,0x1cbc00001cbf0,0x9a0
.quad 0x1cc600001cc90,0xaa0,0x1cd000001cd30,0xba0
.quad 0x1cda00001cdd0,0xca0,0x1ce400001ce70,0xda0
.quad 0x1cee00001cf10,0xea0,0x1cf800001cfb0,0xfa0
.quad 0x1c6300001c658,0xb0,0x1c6d00001c6f8,0x1b0
.quad 0x1c7700001c798,0x2b0,0x1c8100001c838,0x3b0
.quad 0x1c8b00001c8d8,0x4b0,0x1c9500001c978,0x5b0
.quad 0x1c9f00001ca18,0x6b0,0x1ca900001cab8,0x7b0
.quad 0x1cb300001cb58,0x8b0,0x1cbd00001cbf8,0x9b0
.quad 0x1cc700001cc98,0xab0,0x1cd100001cd38,0xbb0
.quad 0x1cdb00001cdd8,0xcb0,0x1ce500001ce78,0xdb0
.quad 0x1cef00001cf18,0xeb0,0x1cf900001cfb8,0xfb0
.quad 0x1000003f800000,0x1b4400001ac00,0x100010bf800000,0x1b4500001bc40
.quad 0x1020003f800000,0x1b4600001ac10,0x102010bf800000,0x1b4700001bc50
.quad 0x1040003f800000,0x1b4800001ac20,0x104010bf800000,0x1b4900001bc60
.quad 0x1060003f800000,0x1b4a00001ac30,0x106010bf800000,0x1b4b00001bc70
.quad 0x1080003f800000,0x1b4c00001ac40,0x108010bf800000,0x1b4d00001bc80
.quad 0x10a0003f800000,0x1b4e00001ac50,0x10a010bf800000,0x1b4f00001bc90
.quad 0x10c0003f800000,0x1b5000001ac60,0x10c010bf800000,0x1b5100001bca0
.quad 0x10e0003f800000,0x1b5200001ac70,0x10e010bf800000,0x1b5300001bcb0
.quad 0x1100003f800000,0x1b5400001ac80,0x110010bf800000,0x1b5500001bcc0
.quad 0x1120003f800000,0x1b5600001ac90,0x112010bf800000,0x1b5700001bcd0
.quad 0x1140003f800000,0x1b5800001aca0,0x114010bf800000,0x1b5900001bce0
.quad 0x1160003f800000,0x1b5a00001acb0,0x116010bf800000,0x1b5b00001bcf0
.quad 0x1180003f800000,0x1b5c00001acc0,0x118010bf800000,0x1b5d00001bd00
.quad 0x11a0003f800000,0x1b5e00001acd0,0x11a010bf800000,0x1b5f00001bd10
.quad 0x11c0003f800000,0x1b6000001ace0,0x11c010bf800000,0x1b6100001bd20
.quad 0x11e0003f800000,0x1b6200001acf0,0x11e010bf800000,0x1b6300001bd30
.quad 0x12000000000000,0x1b8400001ad00,0x12001000000000,0x1b8500001bd40
.quad 0x12200000000000,0x1b8600001ad10,0x12201000000000,0x1b8700001bd50
.quad 0x12400000000000,0x1b8800001ad20,0x12401000000000,0x1b8900001bd60
.quad 0x12600000000000,0x1b8a00001ad30,0x12601000000000,0x1b8b00001bd70
.quad 0x12800000000000,0x1b8c00001ad40,0x12801000000000,0x1b8d00001bd80
.quad 0x12a00000000000,0x1b8e00001ad50,0x12a01000000000,0x1b8f00001bd90
.quad 0x12c00000000000,0x1b9000001ad60,0x12c01000000000,0x1b9100001bda0
.quad 0x12e00000000000,0x1b9200001ad70,0x12e01000000000,0x1b9300001bdb0
.quad 0x13000000000000,0x1b9400001ad80,0x13001000000000,0x1b9500001bdc0
.quad 0x13200000000000,0x1b9600001ad90,0x13201000000000,0x1b9700001bdd0
.quad 0x13400000000000,0x1b9800001ada0,0x13401000000000,0x1b9900001bde0
.quad 0x13600000000000,0x1b9a00001adb0,0x13601000000000,0x1b9b00001bdf0
.quad 0x13800000000000,0x1b9c00001adc0,0x13801000000000,0x1b9d00001be00
.quad 0x13a00000000000,0x1b9e00001add0,0x13a01000000000,0x1b9f00001be10
.quad 0x13c00000000000,0x1ba000001ade0,0x13c01000000000,0x1ba100001be20
.quad 0x13e00000000000,0x1ba200001adf0,0x13e01000000000,0x1ba300001be30
.quad 0x10000001b440,0x1c6500001c640,0x10200001b440,0x1c7600001c750
.quad 0x10400001b440,0x1c8700001c860,0x10600001b440,0x1c9000001c970
.quad 0x10800001b440,0x1ca100001ca00,0x10a00001b440,0x1cb200001cb10
.quad 0x10c00001b440,0x1cc300001cc20,0x10e00001b440,0x1cd400001cd30
.quad 0x11000001b440,0x1ce500001ce40,0x11200001b440,0x1cf600001cf50
.quad 0x11400001b440,0x1d0700001d060,0x11600001b440,0x1d1000001d170
.quad 0x11800001b440,0x1d2100001d200,0x11a00001b440,0x1d3200001d310
.quad 0x11c00001b440,0x1d4300001d420,0x11e00001b440,0x1d5400001d530
.quad 0x12000001b444,0x1d6500001d640,0x12200001b444,0x1d7600001d750
.quad 0x12400001b444,0x1d8700001d860,0x12600001b444,0x1d9000001d970
.quad 0x12800001b444,0x1da100001da00,0x12a00001b444,0x1db200001db10
.quad 0x12c00001b444,0x1dc300001dc20,0x12e00001b444,0x1dd400001dd30
.quad 0x13000001b444,0x1de500001de40,0x13200001b444,0x1df600001df50
.quad 0x13400001b444,0x1e0700001e060,0x13600001b444,0x1e1000001e170
.quad 0x13800001b444,0x1e2100001e200,0x13a00001b444,0x1e3200001e310
.quad 0x13c00001b444,0x1e4300001e420,0x13e00001b444,0x1e5400001e530
.quad 0x10100001b440,0x1c6d00001c6c0,0x10300001b440,0x1c7e00001c7d0
.quad 0x10500001b440,0x1c8f00001c8e0,0x10700001b440,0x1c9800001c9f0
.quad 0x10900001b440,0x1ca900001ca80,0x10b00001b440,0x1cba00001cb90
.quad 0x10d00001b440,0x1ccb00001cca0,0x10f00001b440,0x1cdc00001cdb0
.quad 0x11100001b440,0x1ced00001cec0,0x11300001b440,0x1cfe00001cfd0
.quad 0x11500001b440,0x1d0f00001d0e0,0x11700001b440,0x1d1800001d1f0
.quad 0x11900001b440,0x1d2900001d280,0x11b00001b440,0x1d3a00001d390
.quad 0x11d00001b440,0x1d4b00001d4a0,0x11f00001b440,0x1d5c00001d5b0
.quad 0x12100001b444,0x1d6d00001d6c0,0x12300001b444,0x1d7e00001d7d0
.quad 0x12500001b444,0x1d8f00001d8e0,0x12700001b444,0x1d9800001d9f0
.quad 0x12900001b444,0x1da900001da80,0x12b00001b444,0x1dba00001db90
.quad 0x12d00001b444,0x1dcb00001dca0,0x12f00001b444,0x1ddc00001ddb0
.quad 0x13100001b444,0x1ded00001dec0,0x13300001b444,0x1dfe00001dfd0
.quad 0x13500001b444,0x1e0f00001e0e0,0x13700001b444,0x1e1800001e1f0
.quad 0x13900001b444,0x1e2900001e280,0x13b00001b444,0x1e3a00001e390
.quad 0x13d00001b444,0x1e4b00001e4a0,0x13f00001b444,0x1e5c00001e5b0
.quad 0x1d6400001d600,0x1f20000019200,0x1d6500001d610,0x1f24000019220
.quad 0x1d6600001d620,0x1f28000019240,0x1d6700001d630,0x1f2c000019260
.quad 0x1d6000001d640,0x1f30000019280,0x1d6100001d650,0x1f340000192a0
.quad 0x1d6200001d660,0x1f380000192c0,0x1d6300001d670,0x1f3c0000192e0
.quad 0x1d6c00001d680,0x1f40000019300,0x1d6d00001d690,0x1f44000019320
.quad 0x1d6e00001d6a0,0x1f48000019340,0x1d6f00001d6b0,0x1f4c000019360
.quad 0x1d6800001d6c0,0x1f50000019380,0x1d6900001d6d0,0x1f540000193a0
.quad 0x1d6a00001d6e0,0x1f580000193c0,0x1d6b00001d6f0,0x1f5c0000193e0
.quad 0x1d7500001d710,0x1f60000019400,0x1d7600001d720,0x1f64000019420
.quad 0x1d7700001d730,0x1f68000019440,0x1d7000001d740,0x1f6c000019460
.quad 0x1d7100001d750,0x1f70000019480,0x1d7200001d760,0x1f740000194a0
.quad 0x1d7300001d770,0x1f780000194c0,0x1d7400001d700,0x1f7c0000194e0
.quad 0x1d7d00001d790,0x1f80000019500,0x1d7e00001d7a0,0x1f84000019520
.quad 0x1d7f00001d7b0,0x1f88000019540,0x1d7800001d7c0,0x1f8c000019560
.quad 0x1d7900001d7d0,0x1f90000019580,0x1d7a00001d7e0,0x1f940000195a0
.quad 0x1d7b00001d7f0,0x1f980000195c0,0x1d7c00001d780,0x1f9c0000195e0
.quad 0x1d8600001d820,0x1f21000019208,0x1d8700001d830,0x1f25000019228
.quad 0x1d8000001d840,0x1f29000019248,0x1d8100001d850,0x1f2d000019268
.quad 0x1d8200001d860,0x1f31000019288,0x1d8300001d870,0x1f350000192a8
.quad 0x1d8400001d800,0x1f390000192c8,0x1d8500001d810,0x1f3d0000192e8
.quad 0x1d8e00001d8a0,0x1f41000019308,0x1d8f00001d8b0,0x1f45000019328
.quad 0x1d8800001d8c0,0x1f49000019348,0x1d8900001d8d0,0x1f4d000019368
.quad 0x1d8a00001d8e0,0x1f51000019388,0x1d8b00001d8f0,0x1f550000193a8
.quad 0x1d8c00001d880,0x1f590000193c8,0x1d8d00001d890,0x1f5d0000193e8
.quad 0x1d9700001d930,0x1f61000019408,0x1d9000001d940,0x1f65000019428
.quad 0x1d9100001d950,0x1f69000019448,0x1d9200001d960,0x1f6d000019468
.quad 0x1d9300001d970,0x1f71000019488,0x1d9400001d900,0x1f750000194a8
.quad 0x1d9500001d910,0x1f790000194c8,0x1d9600001d920,0x1f7d0000194e8
.quad 0x1d9f00001d9b0,0x1f81000019508,0x1d9800001d9c0,0x1f85000019528
.quad 0x1d9900001d9d0,0x1f89000019548,0x1d9a00001d9e0,0x1f8d000019568
.quad 0x1d9b00001d9f0,0x1f91000019588,0x1d9c00001d980,0x1f950000195a8
.quad 0x1d9d00001d990,0x1f990000195c8,0x1d9e00001d9a0,0x1f9d0000195e8
.quad 0x1fa0000001800,0x40000000000,0x1fa1000001810,0x41000000010
.quad 0x1fa2000001820,0x42000000020,0x1fa3000001830,0x43000000030
.quad 0x1fa4000001840,0x44000000040,0x1fa5000001850,0x45000000050
.quad 0x1fa6000001860,0x46000000060,0x1fa7000001870,0x47000000070
.quad 0x1fa8000001880,0x48000000080,0x1fa9000001890,0x49000000090
.quad 0x1faa0000018a0,0x4a0000000a0,0x1fab0000018b0,0x4b0000000b0
.quad 0x1fac0000018c0,0x4c0000000c0,0x1fad0000018d0,0x4d0000000d0
.quad 0x1fae0000018e0,0x4e0000000e0,0x1faf0000018f0,0x4f0000000f0
.quad 0x1fb0000001900,0x50000000100,0x1fb1000001910,0x51000000110
.quad 0x1fb2000001920,0x52000000120,0x1fb3000001930,0x53000000130
.quad 0x1fb4000001940,0x54000000140,0x1fb5000001950,0x55000000150
.quad 0x1fb6000001960,0x56000000160,0x1fb7000001970,0x57000000170
.quad 0x1fb8000001980,0x58000000180,0x1fb9000001990,0x59000000190
.quad 0x1fba0000019a0,0x5a0000001a0,0x1fbb0000019b0,0x5b0000001b0
.quad 0x1fbc0000019c0,0x5c0000001c0,0x1fbd0000019d0,0x5d0000001d0
.quad 0x1fbe0000019e0,0x5e0000001e0,0x1fbf0000019f0,0x5f0000001f0
.quad 0x1fc0000001a00,0x60000000200,0x1fc1000001a10,0x61000000210
.quad 0x1fc2000001a20,0x62000000220,0x1fc3000001a30,0x63000000230
.quad 0x1fc4000001a40,0x64000000240,0x1fc5000001a50,0x65000000250
.quad 0x1fc6000001a60,0x66000000260,0x1fc7000001a70,0x67000000270
.quad 0x1fc8000001a80,0x68000000280,0x1fc9000001a90,0x69000000290
.quad 0x1fca000001aa0,0x6a0000002a0,0x1fcb000001ab0,0x6b0000002b0
.quad 0x1fcc000001ac0,0x6c0000002c0,0x1fcd000001ad0,0x6d0000002d0
.quad 0x1fce000001ae0,0x6e0000002e0,0x1fcf000001af0,0x6f0000002f0
.quad 0x1fd0000001b00,0x70000000300,0x1fd1000001b10,0x71000000310
.quad 0x1fd2000001b20,0x72000000320,0x1fd3000001b30,0x73000000330
.quad 0x1fd4000001b40,0x74000000340,0x1fd5000001b50,0x75000000350
.quad 0x1fd6000001b60,0x76000000360,0x1fd7000001b70,0x77000000370
.quad 0x1fd8000001b80,0x78000000380,0x1fd9000001b90,0x79000000390
.quad 0x1fda000001ba0,0x7a0000003a0,0x1fdb000001bb0,0x7b0000003b0
.quad 0x1fdc000001bc0,0x7c0000003c0,0x1fdd000001bd0,0x7d0000003d0
.quad 0x1fde000001be0,0x7e0000003e0,0x1fdf000001bf0,0x7f0000003f0
.quad 0x15800,0x20a0000008000,0x1000015810,0x20a0000008400
.quad 0x2000015820,0x20a0000008800,0x3000015830,0x20a0000008c00
.quad 0x4000015840,0x20a0000009000,0x5000015850,0x20a0000009400
.quad 0x6000015860,0x20a0000009800,0x7000015870,0x20a0000009c00
.quad 0x8000015880,0x20a000000a000,0x9000015890,0x20a000000a400
.quad 0xa0000158a0,0x20a000000a800,0xb0000158b0,0x20a000000ac00
.quad 0xc0000158c0,0x20a000000b000,0xd0000158d0,0x20a000000b400
.quad 0xe0000158e0,0x20a000000b800,0xf0000158f0,0x20a000000bc00
.quad 0x10000015900,0x20a000000c000,0x11000015910,0x20a000000c400
.quad 0x12000015920,0x20a000000c800,0x13000015930,0x20a000000cc00
.quad 0x14000015940,0x20a000000d000,0x15000015950,0x20a000000d400
.quad 0x16000015960,0x20a000000d800,0x17000015970,0x20a000000dc00
.quad 0x18000015980,0x20a000000e000,0x19000015990,0x20a000000e400
.quad 0x1a0000159a0,0x20a000000e800,0x1b0000159b0,0x20a000000ec00
.quad 0x1c0000159c0,0x20a000000f000,0x1d0000159d0,0x20a000000f400
.quad 0x1e0000159e0,0x20a000000f800,0x1f0000159f0,0x20a000000fc00
.quad 0x20000015a00,0x20a1000008010,0x21000015a10,0x20a1000008410
.quad 0x22000015a20,0x20a1000008810,0x23000015a30,0x20a1000008c10
.quad 0x24000015a40,0x20a1000009010,0x25000015a50,0x20a1000009410
.quad 0x26000015a60,0x20a1000009810,0x27000015a70,0x20a1000009c10
.quad 0x28000015a80,0x20a100000a010,0x29000015a90,0x20a100000a410
.quad 0x2a000015aa0,0x20a100000a810,0x2b000015ab0,0x20a100000ac10
.quad 0x2c000015ac0,0x20a100000b010,0x2d000015ad0,0x20a100000b410
.quad 0x2e000015ae0,0x20a100000b810,0x2f000015af0,0x20a100000bc10
.quad 0x30000015b00,0x20a100000c010,0x31000015b10,0x20a100000c410
.quad 0x32000015b20,0x20a100000c810,0x33000015b30,0x20a100000cc10
.quad 0x34000015b40,0x20a100000d010,0x35000015b50,0x20a100000d410
.quad 0x36000015b60,0x20a100000d810,0x37000015b70,0x20a100000dc10
.quad 0x38000015b80,0x20a100000e010,0x39000015b90,0x20a100000e410
.quad 0x3a000015ba0,0x20a100000e810,0x3b000015bb0,0x20a100000ec10
.quad 0x3c000015bc0,0x20a100000f010,0x3d000015bd0,0x20a100000f410
.quad 0x3e000015be0,0x20a100000f810,0x3f000015bf0,0x20a100000fc10
.quad 0x900000100000,0x500000001000,0x901000108000,0x501000001010
.quad 0x902000110000,0x502000001020,0x903000118000,0x503000001030
.quad 0x904000120000,0x504000001040,0x905000128000,0x505000001050
.quad 0x906000130000,0x506000001060,0x907000138000,0x507000001070
.quad 0x908000140000,0x508000001080,0x909000148000,0x509000001090
.quad 0x90a000150000,0x50a0000010a0,0x90b000158000,0x50b0000010b0
.quad 0x90c000160000,0x50c0000010c0,0x90d000168000,0x50d0000010d0
.quad 0x90e000170000,0x50e0000010e0,0x90f000178000,0x50f0000010f0
.quad 0x910000180000,0x510000001100,0x911000188000,0x511000001110
.quad 0x912000190000,0x512000001120,0x913000198000,0x513000001130
.quad 0x9140001a0000,0x514000001140,0x9150001a8000,0x515000001150
.quad 0x9160001b0000,0x516000001160,0x9170001b8000,0x517000001170
.quad 0x9180001c0000,0x518000001180,0x9190001c8000,0x519000001190
.quad 0x91a0001d0000,0x51a0000011a0,0x91b0001d8000,0x51b0000011b0
.quad 0x91c0001e0000,0x51c0000011c0,0x91d0001e8000,0x51d0000011d0
.quad 0x91e0001f0000,0x51e0000011e0,0x91f0001f8000,0x51f0000011f0
.quad 0x920000100010,0x520000001200,0x921000108010,0x521000001210
.quad 0x922000110010,0x522000001220,0x923000118010,0x523000001230
.quad 0x924000120010,0x524000001240,0x925000128010,0x525000001250
.quad 0x926000130010,0x526000001260,0x927000138010,0x527000001270
.quad 0x928000140010,0x528000001280,0x929000148010,0x529000001290
.quad 0x92a000150010,0x52a0000012a0,0x92b000158010,0x52b0000012b0
.quad 0x92c000160010,0x52c0000012c0,0x92d000168010,0x52d0000012d0
.quad 0x92e000170010,0x52e0000012e0,0x92f000178010,0x52f0000012f0
.quad 0x930000180010,0x530000001300,0x931000188010,0x531000001310
.quad 0x932000190010,0x532000001320,0x933000198010,0x533000001330
.quad 0x9340001a0010,0x534000001340,0x9350001a8010,0x535000001350
.quad 0x9360001b0010,0x536000001360,0x9370001b8010,0x537000001370
.quad 0x9380001c0010,0x538000001380,0x9390001c8010,0x539000001390
.quad 0x93a0001d0010,0x53a0000013a0,0x93b0001d8010,0x53b0000013b0
.quad 0x93c0001e0010,0x53c0000013c0,0x93d0001e8010,0x53d0000013d0
.quad 0x93e0001f0010,0x53e0000013e0,0x93f0001f8010,0x53f0000013f0
.Ltabw3:
.quad 0x1a4000001ad40,0x1d2000001c780,0x1a4900001af80,0x1e2400001c784
.quad 0x1a5200001b1c0,0x1d2040001c788,0x1a5b00001b400,0x1e2440001c78c
.quad 0x1a6400001ad44,0x1d2080001c790,0x1a6d00001af84,0x1e2480001c794
.quad 0x1a7600001b1c4,0x1d20c0001c798,0x1a7f00001b404,0x1e24c0001c79c
.quad 0x1a8800001ad48,0x1d2100001c7a0,0x1a9100001af88,0x1e2500001c7a4
.quad 0x1a9a00001b1c8,0x1d2140001c7a8,0x1aa300001b408,0x1e2540001c7ac
.quad 0x1aac00001ad4c,0x1d2180001c7b0,0x1ab500001af8c,0x1e2580001c7b4
.quad 0x1abe00001b1cc,0x1d21c0001c7b8,0x1ac700001b40c,0x1e25c0001c7bc
.quad 0x1a4000001ad50,0x1d2200001c7c0,0x1a4900001af90,0x1e2600001c7c4
.quad 0x1a5200001b1d0,0x1d2240001c7c8,0x1a5b00001b410,0x1e2640001c7cc
.quad 0x1a6400001ad54,0x1d2280001c7d0,0x1a6d00001af94,0x1e2680001c7d4
.quad 0x1a7600001b1d4,0x1d22c0001c7d8,0x1a7f00001b414,0x1e26c0001c7dc
.quad 0x1a8800001ad58,0x1d2300001c7e0,0x1a9100001af98,0x1e2700001c7e4
.quad 0x1a9a00001b1d8,0x1d2340001c7e8,0x1aa300001b418,0x1e2740001c7ec
.quad 0x1aac00001ad5c,0x1d2380001c7f0,0x1ab500001af9c,0x1e2780001c7f4
.quad 0x1abe00001b1dc,0x1d23c0001c7f8,0x1ac700001b41c,0x1e27c0001c7fc
.quad 0x1a4200001ad60,0x1d2400001cb80,0x1a4b00001afa0,0x1e2800001cb84
.quad 0x1a5400001b1e0,0x1d2440001cb88,0x1a5d00001b420,0x1e2840001cb8c
.quad 0x1a6600001ad64,0x1d2480001cb90,0x1a6f00001afa4,0x1e2880001cb94
.quad 0x1a7800001b1e4,0x1d24c0001cb98,0x1a8100001b424,0x1e28c0001cb9c
.quad 0x1a8a00001ad68,0x1d2500001cba0,0x1a9300001afa8,0x1e2900001cba4
.quad 0x1a9c00001b1e8,0x1d2540001cba8,0x1aa500001b428,0x1e2940001cbac
.quad 0x1aae00001ad6c,0x1d2580001cbb0,0x1ab700001afac,0x1e2980001cbb4
.quad 0x1ac000001b1ec,0x1d25c0001cbb8,0x1ac900001b42c,0x1e29c0001cbbc
.quad 0x1a4200001ad70,0x1d2600001cbc0,0x1a4b00001afb0,0x1e2a00001cbc4
.quad 0x1a5400001b1f0,0x1d2640001cbc8,0x1a5d00001b430,0x1e2a40001cbcc
.quad 0x1a6600001ad74,0x1d2680001cbd0,0x1a6f00001afb4,0x1e2a80001cbd4
.quad 0x1a7800001b1f4,0x1d26c0001cbd8,0x1a8100001b434,0x1e2ac0001cbdc
.quad 0x1a8a00001ad78,0x1d2700001cbe0,0x1a9300001afb8,0x1e2b00001cbe4
.quad 0x1a9c00001b1f8,0x1d2740001cbe8,0x1aa500001b438,0x1e2b40001cbec
.quad 0x1aae00001ad7c,0x1d2780001cbf0,0x1ab700001afbc,0x1e2b80001cbf4
.quad 0x1ac000001b1fc,0x1d27c0001cbf8,0x1ac900001b43c,0x1e2bc0001cbfc
.quad 0x2126000001800,0xc00060000,0x2167000001810,0x1c00060010
.quad 0x21a8000001820,0x20000c00060020,0x21e9000001830,0x20001c00060030
.quad 0x222a000001840,0xc00060040,0x226b000001850,0x1c00060050
.quad 0x22ac000001860,0x20000c00060060,0x22ed000001870,0x20001c00060070
.quad 0x2126200001880,0xc00062000,0x2167200001890,0x1c00062010
.quad 0x21a82000018a0,0x20000c00062020,0x21e92000018b0,0x20001c00062030
.quad 0x222a2000018c0,0xc00062040,0x226b2000018d0,0x1c00062050
.quad 0x22ac2000018e0,0x20000c00062060,0x22ed2000018f0,0x20001c00062070
.quad 0x2126400001900,0xc00064000,0x2167400001910,0x1c00064010
.quad 0x21a8400001920,0x20000c00064020,0x21e9400001930,0x20001c00064030
.quad 0x222a400001940,0xc00064040,0x226b400001950,0x1c00064050
.quad 0x22ac400001960,0x20000c00064060,0x22ed400001970,0x20001c00064070
.quad 0x2126600001980,0xc00066000,0x2167600001990,0x1c00066010
.quad 0x21a86000019a0,0x20000c00066020,0x21e96000019b0,0x20001c00066030
.quad 0x222a6000019c0,0xc00066040,0x226b6000019d0,0x1c00066050
.quad 0x22ac6000019e0,0x20000c00066060,0x22ed6000019f0,0x20001c00066070
.quad 0x2126800001a00,0xc00068000,0x2167800001a10,0x1c00068010
.quad 0x21a8800001a20,0x20000c00068020,0x21e9800001a30,0x20001c00068030
.quad 0x222a800001a40,0xc00068040,0x226b800001a50,0x1c00068050
.quad 0x22ac800001a60,0x20000c00068060,0x22ed800001a70,0x20001c00068070
.quad 0x2126a00001a80,0xc0006a000,0x2167a00001a90,0x1c0006a010
.quad 0x21a8a00001aa0,0x20000c0006a020,0x21e9a00001ab0,0x20001c0006a030
.quad 0x222aa00001ac0,0xc0006a040,0x226ba00001ad0,0x1c0006a050
.quad 0x22aca00001ae0,0x20000c0006a060,0x22eda00001af0,0x20001c0006a070
.quad 0x2126c00001b00,0xc0006c000,0x2167c00001b10,0x1c0006c010
.quad 0x21a8c00001b20,0x20000c0006c020,0x21e9c00001b30,0x20001c0006c030
.quad 0x222ac00001b40,0xc0006c040,0x226bc00001b50,0x1c0006c050
.quad 0x22acc00001b60,0x20000c0006c060,0x22edc00001b70,0x20001c0006c070
.quad 0x2126e00001b80,0xc0006e000,0x2167e00001b90,0x1c0006e010
.quad 0x21a8e00001ba0,0x20000c0006e020,0x21e9e00001bb0,0x20001c0006e030
.quad 0x222ae00001bc0,0xc0006e040,0x226be00001bd0,0x1c0006e050
.quad 0x22ace00001be0,0x20000c0006e060,0x22ede00001bf0,0x20001c0006e070
.quad 0x1800001f080,0x1f10000026b00,0x1900001f0c0,0x1f10000026b08
.quad 0x1a00001f080,0x1f10000026b10,0x1b00001f0c0,0x1f10000026b18
.quad 0x1c00001f080,0x1f10000026b80,0x1d00001f0c0,0x1f10000026b88
.quad 0x1e00001f080,0x1f10000026b90,0x1f00001f0c0,0x1f10000026b98
.quad 0x5800001f080,0x1f10000026c00,0x5900001f0c0,0x1f10000026c08
.quad 0x5a00001f080,0x1f10000026c10,0x5b00001f0c0,0x1f10000026c18
.quad 0x5c00001f080,0x1f10000026c80,0x5d00001f0c0,0x1f10000026c88
.quad 0x5e00001f080,0x1f10000026c90,0x5f00001f0c0,0x1f10000026c98
.quad 0x9800001f0a0,0x1f10000026b20,0x9900001f0e0,0x1f10000026b28
.quad 0x9a00001f0a0,0x1f10000026b30,0x9b00001f0e0,0x1f10000026b38
.quad 0x9c00001f0a0,0x1f10000026ba0,0x9d00001f0e0,0x1f10000026ba8
.quad 0x9e00001f0a0,0x1f10000026bb0,0x9f00001f0e0,0x1f10000026bb8
.quad 0xd800001f0a0,0x1f10000026c20,0xd900001f0e0,0x1f10000026c28
.quad 0xda00001f0a0,0x1f10000026c30,0xdb00001f0e0,0x1f10000026c38
.quad 0xdc00001f0a0,0x1f10000026ca0,0xdd00001f0e0,0x1f10000026ca8
.quad 0xde00001f0a0,0x1f10000026cb0,0xdf00001f0e0,0x1f10000026cb8
.quad 0x11800001f090,0x1f10000026d00,0x11900001f0d0,0x1f10000026d08
.quad 0x11a00001f090,0x1f10000026d10,0x11b00001f0d0,0x1f10000026d18
.quad 0x11c00001f090,0x1f10000026d80,0x11d00001f0d0,0x1f10000026d88
.quad 0x11e00001f090,0x1f10000026d90,0x11f00001f0d0,0x1f10000026d98
.quad 0x15800001f090,0x1f10000026e00,0x15900001f0d0,0x1f10000026e08
.quad 0x15a00001f090,0x1f10000026e10,0x15b00001f0d0,0x1f10000026e18
.quad 0x15c00001f090,0x1f10000026e80,0x15d00001f0d0,0x1f10000026e88
.quad 0x15e00001f090,0x1f10000026e90,0x15f00001f0d0,0x1f10000026e98
.quad 0x19800001f0b0,0x1f10000026d20,0x19900001f0f0,0x1f10000026d28
.quad 0x19a00001f0b0,0x1f10000026d30,0x19b00001f0f0,0x1f10000026d38
.quad 0x19c00001f0b0,0x1f10000026da0,0x19d00001f0f0,0x1f10000026da8
.quad 0x19e00001f0b0,0x1f10000026db0,0x19f00001f0f0,0x1f10000026db8
.quad 0x1d800001f0b0,0x1f10000026e20,0x1d900001f0f0,0x1f10000026e28
.quad 0x1da00001f0b0,0x1f10000026e30,0x1db00001f0f0,0x1f10000026e38
.quad 0x1dc00001f0b0,0x1f10000026ea0,0x1dd00001f0f0,0x1f10000026ea8
.quad 0x1de00001f0b0,0x1f10000026eb0,0x1df00001f0f0,0x1f10000026eb8
.quad 0x10560000102000,0x108c00,0x10561000102010,0x800108c10
.quad 0x10562000102020,0x1000108c20,0x10563000102030,0x1800108c30
.quad 0x10564000102040,0xc000109640,0x10565000102050,0xc800109650
.quad 0x10566000102060,0xd000109660,0x10567000102070,0xd800109670
.quad 0x10608000102080,0x18000109680,0x10609000102090,0x18800109690
.quad 0x1060a0001020a0,0x190001096a0,0x1060b0001020b0,0x198001096b0
.quad 0x1060c000102ac0,0x240001096c0,0x1060d000102ad0,0x248001096d0
.quad 0x1060e000102ae0,0x250001096e0,0x1060f000102af0,0x258001096f0
.quad 0x10610000102b00,0x200010a100,0x10611000102b10,0x280010a110
.quad 0x10612000102b20,0x300010a120,0x10613000102b30,0x380010a130
.quad 0x106b4000102b40,0xe00010a140,0x106b5000102b50,0xe80010a150
.quad 0x106b6000102b60,0xf00010a160,0x106b7000102b70,0xf80010a170
.quad 0x106b8000103580,0x1a00010a180,0x106b9000103590,0x1a80010a190
.quad 0x106ba0001035a0,0x1b00010a1a0,0x106bb0001035b0,0x1b80010a1b0
.quad 0x106bc0001035c0,0x2600010abc0,0x106bd0001035d0,0x2680010abd0
.quad 0x106be0001035e0,0x2700010abe0,0x106bf0001035f0,0x2780010abf0
.quad 0x10760000103600,0x3000010ac00,0x10761000103610,0x3080010ac10
.quad 0x10762000103620,0x3100010ac20,0x10763000103630,0x3180010ac30
.quad 0x10764000104040,0x3c00010ac40,0x10765000104050,0x3c80010ac50
.quad 0x10766000104060,0x3d00010ac60,0x10767000104070,0x3d80010ac70
.quad 0x10768000104080,0x4800010b680,0x10769000104090,0x4880010b690
.quad 0x1076a0001040a0,0x4900010b6a0,0x1076b0001040b0,0x4980010b6b0
.quad 0x1080c0001040c0,0x5400010b6c0,0x1080d0001040d0,0x5480010b6d0
.quad 0x1080e0001040e0,0x5500010b6e0,0x1080f0001040f0,0x5580010b6f0
.quad 0x10810000104b00,0x3200010b700,0x10811000104b10,0x3280010b710
.quad 0x10812000104b20,0x3300010b720,0x10813000104b30,0x3380010b730
.quad 0x10814000104b40,0x3e00010c140,0x10815000104b50,0x3e80010c150
.quad 0x10816000104b60,0x3f00010c160,0x10817000104b70,0x3f80010c170
.quad 0x108b8000104b80,0x4a00010c180,0x108b9000104b90,0x4a80010c190
.quad 0x108ba000104ba0,0x4b00010c1a0,0x108bb000104bb0,0x4b80010c1b0
.quad 0x108bc0001055c0,0x5600010c1c0,0x108bd0001055d0,0x5680010c1d0
.quad 0x108be0001055e0,0x5700010c1e0,0x108bf0001055f0,0x5780010c1f0
.quad 0x4080000006000,0x1800000001080,0x4081000006010,0x1801000001100
.quad 0x4082000006020,0x1802000001180,0x4083000006030,0x1803000001200
.quad 0x4084000006040,0x1804000001280,0x4085000006050,0x1805000001300
.quad 0x4086000006060,0x1806000001380,0x4087000006070,0x1807000001400
.quad 0x4088000006200,0x1808000001480,0x4089000006210,0x1809000001500
.quad 0x408a000006220,0x180a000001580,0x408b000006230,0x180b000001600
.quad 0x408c000006240,0x180c000001680,0x408d000006250,0x180d000001700
.quad 0x408e000006260,0x180e000001780,0x408f000006270,0x180f000001800
.quad 0x4090000006400,0x1810000001880,0x4091000006410,0x1811000001900
.quad 0x4092000006420,0x1812000001980,0x4093000006430,0x1813000001a00
.quad 0x4094000006440,0x1814000001a80,0x4095000006450,0x1815000001b00
.quad 0x4096000006460,0x1816000001b80,0x4097000006470,0x1817000001c00
.quad 0x4098000006600,0x1818000001c80,0x4099000006610,0x1819000001d00
.quad 0x409a000006620,0x181a000001d80,0x409b000006630,0x181b000001e00
.quad 0x409c000006640,0x181c000001e80,0x409d000006650,0x181d000001f00
.quad 0x409e000006660,0x181e000001f80,0x409f000006670,0x181f000002000
.quad 0x40a0000006800,0x1820000002080,0x40a1000006810,0x1821000002100
.quad 0x40a2000006820,0x1822000002180,0x40a3000006830,0x1823000002200
.quad 0x40a4000006840,0x1824000002280,0x40a5000006850,0x1825000002300
.quad 0x40a6000006860,0x1826000002380,0x40a7000006870,0x1827000002400
.quad 0x40a8000006a00,0x1828000002480,0x40a9000006a10,0x1829000002500
.quad 0x40aa000006a20,0x182a000002580,0x40ab000006a30,0x182b000002600
.quad 0x40ac000006a40,0x182c000002680,0x40ad000006a50,0x182d000002700
.quad 0x40ae000006a60,0x182e000002780,0x40af000006a70,0x182f000002800
.quad 0x40b0000006c00,0x1830000002880,0x40b1000006c10,0x1831000002900
.quad 0x40b2000006c20,0x1832000002980,0x40b3000006c30,0x1833000002a00
.quad 0x40b4000006c40,0x1834000002a80,0x40b5000006c50,0x1835000002b00
.quad 0x40b6000006c60,0x1836000002b80,0x40b7000006c70,0x1837000002c00
.quad 0x40b8000006e00,0x1838000002c80,0x40b9000006e10,0x1839000002d00
.quad 0x40ba000006e20,0x183a000002d80,0x40bb000006e30,0x183b000002e00
.quad 0x40bc000006e40,0x183c000002e80,0x40bd000006e50,0x183d000002f00
.quad 0x40be000006e60,0x183e000002f80,0x40bf000006e70,0x183f000003000
.quad 0x1bd8000108000,0x18000001a400,0x1c1c000108010,0x18800001a410
.quad 0x1bd9000118000,0x19000001a420,0x1c1d000118010,0x19800001a430
.quad 0x1bda000128000,0x1a000001a440,0x1c1e000128010,0x1a800001a450
.quad 0x1bdb000138000,0x1b000001a460,0x1c1f000138010,0x1b800001a470
.quad 0x1bdc000148000,0x1c000001a480,0x1c20000148010,0x1c800001a490
.quad 0x1bdd000158000,0x1d000001a4a0,0x1c21000158010,0x1d800001a4b0
.quad 0x1bde000168000,0x1e000001a4c0,0x1c22000168010,0x1e800001a4d0
.quad 0x1bdf000178000,0x1f000001a4e0,0x1c23000178010,0x1f800001a4f0
.quad 0x1be0000188000,0x18100001a500,0x1c24000188010,0x18900001a510
.quad 0x1be1000198000,0x19100001a520,0x1c25000198010,0x19900001a530
.quad 0x1be20001a8000,0x1a100001a540,0x1c260001a8010,0x1a900001a550
.quad 0x1be30001b8000,0x1b100001a560,0x1c270001b8010,0x1b900001a570
.quad 0x1be40001c8000,0x1c100001a580,0x1c280001c8010,0x1c900001a590
.quad 0x1be50001d8000,0x1d100001a5a0,0x1c290001d8010,0x1d900001a5b0
.quad 0x1be60001e8000,0x1e100001a5c0,0x1c2a0001e8010,0x1e900001a5d0
.quad 0x1be70001f8000,0x1f100001a5e0,0x1c2b0001f8010,0x1f900001a5f0
.quad 0x1be800010a000,0x18200001a600,0x1c2c00010a010,0x18a00001a610
.quad 0x1be900011a000,0x19200001a620,0x1c2d00011a010,0x19a00001a630
.quad 0x1bea00012a000,0x1a200001a640,0x1c2e00012a010,0x1aa00001a650
.quad 0x1beb00013a000,0x1b200001a660,0x1c2f00013a010,0x1ba00001a670
.quad 0x1bec00014a000,0x1c200001a680,0x1c3000014a010,0x1ca00001a690
.quad 0x1bed00015a000,0x1d200001a6a0,0x1c3100015a010,0x1da00001a6b0
.quad 0x1bee00016a000,0x1e200001a6c0,0x1c3200016a010,0x1ea00001a6d0
.quad 0x1bef00017a000,0x1f200001a6e0,0x1c3300017a010,0x1fa00001a6f0
.quad 0x1bf000018a000,0x18300001a700,0x1c3400018a010,0x18b00001a710
.quad 0x1bf100019a000,0x19300001a720,0x1c3500019a010,0x19b00001a730
.quad 0x1bf20001aa000,0x1a300001a740,0x1c360001aa010,0x1ab00001a750
.quad 0x1bf30001ba000,0x1b300001a760,0x1c370001ba010,0x1bb00001a770
.quad 0x1bf40001ca000,0x1c300001a780,0x1c380001ca010,0x1cb00001a790
.quad 0x1bf50001da000,0x1d300001a7a0,0x1c390001da010,0x1db00001a7b0
.quad 0x1bf60001ea000,0x1e300001a7c0,0x1c3a0001ea010,0x1eb00001a7d0
.quad 0x1bf70001fa000,0x1f300001a7e0,0x1c3b0001fa010,0x1fb00001a7f0
.quad 0x1c6000001c660,0xc0,0x1c6a00001c700,0x1c0
.quad 0x1c7400001c7a0,0x2c0,0x1c7e00001c840,0x3c0
.quad 0x1c8800001c8e0,0x4c0,0x1c9200001c980,0x5c0
.quad 0x1c9c00001ca20,0x6c0,0x1ca600001cac0,0x7c0
.quad 0x1cb000001cb60,0x8c0,0x1cba00001cc00,0x9c0
.quad 0x1cc400001cca0,0xac0,0x1cce00001cd40,0xbc0
.quad 0x1cd800001cde0,0xcc0,0x1ce200001ce80,0xdc0
.quad 0x1cec00001cf20,0xec0,0x1cf600001cfc0,0xfc0
.quad 0x1c6100001c668,0xd0,0x1c6b00001c708,0x1d0
.quad 0x1c7500001c7a8,0x2d0,0x1c7f00001c848,0x3d0
.quad 0x1c8900001c8e8,0x4d0,0x1c9300001c988,0x5d0
.quad 0x1c9d00001ca28,0x6d0,0x1ca700001cac8,0x7d0
.quad 0x1cb100001cb68,0x8d0,0x1cbb00001cc08,0x9d0
.quad 0x1cc500001cca8,0xad0,0x1ccf00001cd48,0xbd0
.quad 0x1cd900001cde8,0xcd0,0x1ce300001ce88,0xdd0
.quad 0x1ced00001cf28,0xed0,0x1cf700001cfc8,0xfd0
.quad 0x1c6200001c670,0xe0,0x1c6c00001c710,0x1e0
.quad 0x1c7600001c7b0,0x2e0,0x1c8000001c850,0x3e0
.quad 0x1c8a00001c8f0,0x4e0,0x1c9400001c990,0x5e0
.quad 0x1c9e00001ca30,0x6e0,0x1ca800001cad0,0x7e0
.quad 0x1cb200001cb70,0x8e0,0x1cbc00001cc10,0x9e0
.quad 0x1cc600001ccb0,0xae0,0x1cd000001cd50,0xbe0
.quad 0x1cda00001cdf0,0xce0,0x1ce400001ce90,0xde0
.quad 0x1cee00001cf30,0xee0,0x1cf800001cfd0,0xfe0
.quad 0x1c6300001c678,0xf0,0x1c6d00001c718,0x1f0
.quad 0x1c7700001c7b8,0x2f0,0x1c8100001c858,0x3f0
.quad 0x1c8b00001c8f8,0x4f0,0x1c9500001c998,0x5f0
.quad 0x1c9f00001ca38,0x6f0,0x1ca900001cad8,0x7f0
.quad 0x1cb300001cb78,0x8f0,0x1cbd00001cc18,0x9f0
.quad 0x1cc700001ccb8,0xaf0,0x1cd100001cd58,0xbf0
.quad 0x1cdb00001cdf8,0xcf0,0x1ce500001ce98,0xdf0
.quad 0x1cef00001cf38,0xef0,0x1cf900001cfd8,0xff0
.quad 0x1800003f800000,0x1b4480001b000,0x180010bf800000,0x1b4580001c040
.quad 0x1820003f800000,0x1b4680001b010,0x182010bf800000,0x1b4780001c050
.quad 0x1840003f800000,0x1b4880001b020,0x184010bf800000,0x1b4980001c060
.quad 0x1860003f800000,0x1b4a80001b030,0x186010bf800000,0x1b4b80001c070
.quad 0x1880003f800000,0x1b4c80001b040,0x188010bf800000,0x1b4d80001c080
.quad 0x18a0003f800000,0x1b4e80001b050,0x18a010bf800000,0x1b4f80001c090
.quad 0x18c0003f800000,0x1b5080001b060,0x18c010bf800000,0x1b5180001c0a0
.quad 0x18e0003f800000,0x1b5280001b070,0x18e010bf800000,0x1b5380001c0b0
.quad 0x1900003f800000,0x1b5480001b080,0x190010bf800000,0x1b5580001c0c0
.quad 0x1920003f800000,0x1b5680001b090,0x192010bf800000,0x1b5780001c0d0
.quad 0x1940003f800000,0x1b5880001b0a0,0x194010bf800000,0x1b5980001c0e0
.quad 0x1960003f800000,0x1b5a80001b0b0,0x196010bf800000,0x1b5b80001c0f0
.quad 0x1980003f800000,0x1b5c80001b0c0,0x198010bf800000,0x1b5d80001c100
.quad 0x19a0003f800000,0x1b5e80001b0d0,0x19a010bf800000,0x1b5f80001c110
.quad 0x19c0003f800000,0x1b6080001b0e0,0x19c010bf800000,0x1b6180001c120
.quad 0x19e0003f800000,0x1b6280001b0f0,0x19e010bf800000,0x1b6380001c130
.quad 0x1a000000000000,0x1b8480001b100,0x1a001000000000,0x1b8580001c140
.quad 0x1a200000000000,0x1b8680001b110,0x1a201000000000,0x1b8780001c150
.quad 0x1a400000000000,0x1b8880001b120,0x1a401000000000,0x1b8980001c160
.quad 0x1a600000000000,0x1b8a80001b130,0x1a601000000000,0x1b8b80001c170
.quad 0x1a800000000000,0x1b8c80001b140,0x1a801000000000,0x1b8d80001c180
.quad 0x1aa00000000000,0x1b8e80001b150,0x1aa01000000000,0x1b8f80001c190
.quad 0x1ac00000000000,0x1b9080001b160,0x1ac01000000000,0x1b9180001c1a0
.quad 0x1ae00000000000,0x1b9280001b170,0x1ae01000000000,0x1b9380001c1b0
.quad 0x1b000000000000,0x1b9480001b180,0x1b001000000000,0x1b9580001c1c0
.quad 0x1b200000000000,0x1b9680001b190,0x1b201000000000,0x1b9780001c1d0
.quad 0x1b400000000000,0x1b9880001b1a0,0x1b401000000000,0x1b9980001c1e0
.quad 0x1b600000000000,0x1b9a80001b1b0,0x1b601000000000,0x1b9b80001c1f0
.quad 0x1b800000000000,0x1b9c80001b1c0,0x1b801000000000,0x1b9d80001c200
.quad 0x1ba00000000000,0x1b9e80001b1d0,0x1ba01000000000,0x1b9f80001c210
.quad 0x1bc00000000000,0x1ba080001b1e0,0x1bc01000000000,0x1ba180001c220
.quad 0x1be00000000000,0x1ba280001b1f0,0x1be01000000000,0x1ba380001c230
.quad 0x18000001b448,0x1c6700001c660,0x18200001b448,0x1c7000001c770
.quad 0x18400001b448,0x1c8100001c800,0x18600001b448,0x1c9200001c910
.quad 0x18800001b448,0x1ca300001ca20,0x18a00001b448,0x1cb400001cb30
.quad 0x18c00001b448,0x1cc500001cc40,0x18e00001b448,0x1cd600001cd50
.quad 0x19000001b448,0x1ce700001ce60,0x19200001b448,0x1cf000001cf70
.quad 0x19400001b448,0x1d0100001d000,0x19600001b448,0x1d1200001d110
.quad 0x19800001b448,0x1d2300001d220,0x19a00001b448,0x1d3400001d330
.quad 0x19c00001b448,0x1d4500001d440,0x19e00001b448,0x1d5600001d550
.quad 0x1a000001b44c,0x1d6700001d660,0x1a200001b44c,0x1d7000001d770
.quad 0x1a400001b44c,0x1d8100001d800,0x1a600001b44c,0x1d9200001d910
.quad 0x1a800001b44c,0x1da300001da20,0x1aa00001b44c,0x1db400001db30
.quad 0x1ac00001b44c,0x1dc500001dc40,0x1ae00001b44c,0x1dd600001dd50
.quad 0x1b000001b44c,0x1de700001de60,0x1b200001b44c,0x1df000001df70
.quad 0x1b400001b44c,0x1e0100001e000,0x1b600001b44c,0x1e1200001e110
.quad 0x1b800001b44c,0x1e2300001e220,0x1ba00001b44c,0x1e3400001e330
.quad 0x1bc00001b44c,0x1e4500001e440,0x1be00001b44c,0x1e5600001e550
.quad 0x18100001b448,0x1c6f00001c6e0,0x18300001b448,0x1c7800001c7f0
.quad 0x18500001b448,0x1c8900001c880,0x18700001b448,0x1c9a00001c990
.quad 0x18900001b448,0x1cab00001caa0,0x18b00001b448,0x1cbc00001cbb0
.quad 0x18d00001b448,0x1ccd00001ccc0,0x18f00001b448,0x1cde00001cdd0
.quad 0x19100001b448,0x1cef00001cee0,0x19300001b448,0x1cf800001cff0
.quad 0x19500001b448,0x1d0900001d080,0x19700001b448,0x1d1a00001d190
.quad 0x19900001b448,0x1d2b00001d2a0,0x19b00001b448,0x1d3c00001d3b0
.quad 0x19d00001b448,0x1d4d00001d4c0,0x19f00001b448,0x1d5e00001d5d0
.quad 0x1a100001b44c,0x1d6f00001d6e0,0x1a300001b44c,0x1d7800001d7f0
.quad 0x1a500001b44c,0x1d8900001d880,0x1a700001b44c,0x1d9a00001d990
.quad 0x1a900001b44c,0x1dab00001daa0,0x1ab00001b44c,0x1dbc00001dbb0
.quad 0x1ad00001b44c,0x1dcd00001dcc0,0x1af00001b44c,0x1dde00001ddd0
.quad 0x1b100001b44c,0x1def00001dee0,0x1b300001b44c,0x1df800001dff0
.quad 0x1b500001b44c,0x1e0900001e080,0x1b700001b44c,0x1e1a00001e190
.quad 0x1b900001b44c,0x1e2b00001e2a0,0x1bb00001b44c,0x1e3c00001e3b0
.quad 0x1bd00001b44c,0x1e4d00001e4c0,0x1bf00001b44c,0x1e5e00001e5d0
.quad 0x1de400001de00,0x1f20000019b00,0x1de500001de10,0x1f24000019b20
.quad 0x1de600001de20,0x1f28000019b40,0x1de700001de30,0x1f2c000019b60
.quad 0x1de000001de40,0x1f30000019b80,0x1de100001de50,0x1f34000019ba0
.quad 0x1de200001de60,0x1f38000019bc0,0x1de300001de70,0x1f3c000019be0
.quad 0x1dec00001de80,0x1f40000019c00,0x1ded00001de90,0x1f44000019c20
.quad 0x1dee00001dea0,0x1f48000019c40,0x1def00001deb0,0x1f4c000019c60
.quad 0x1de800001dec0,0x1f50000019c80,0x1de900001ded0,0x1f54000019ca0
.quad 0x1dea00001dee0,0x1f58000019cc0,0x1deb00001def0,0x1f5c000019ce0
.quad 0x1df500001df10,0x1f60000019d00,0x1df600001df20,0x1f64000019d20
.quad 0x1df700001df30,0x1f68000019d40,0x1df000001df40,0x1f6c000019d60
.quad 0x1df100001df50,0x1f70000019d80,0x1df200001df60,0x1f74000019da0
.quad 0x1df300001df70,0x1f78000019dc0,0x1df400001df00,0x1f7c000019de0
.quad 0x1dfd00001df90,0x1f80000019e00,0x1dfe00001dfa0,0x1f84000019e20
.quad 0x1dff00001dfb0,0x1f88000019e40,0x1df800001dfc0,0x1f8c000019e60
.quad 0x1df900001dfd0,0x1f90000019e80,0x1dfa00001dfe0,0x1f94000019ea0
.quad 0x1dfb00001dff0,0x1f98000019ec0,0x1dfc00001df80,0x1f9c000019ee0
.quad 0x1e0600001e020,0x1f21000019b08,0x1e0700001e030,0x1f25000019b28
.quad 0x1e0000001e040,0x1f29000019b48,0x1e0100001e050,0x1f2d000019b68
.quad 0x1e0200001e060,0x1f31000019b88,0x1e0300001e070,0x1f35000019ba8
.quad 0x1e0400001e000,0x1f39000019bc8,0x1e0500001e010,0x1f3d000019be8
.quad 0x1e0e00001e0a0,0x1f41000019c08,0x1e0f00001e0b0,0x1f45000019c28
.quad 0x1e0800001e0c0,0x1f49000019c48,0x1e0900001e0d0,0x1f4d000019c68
.quad 0x1e0a00001e0e0,0x1f51000019c88,0x1e0b00001e0f0,0x1f55000019ca8
.quad 0x1e0c00001e080,0x1f59000019cc8,0x1e0d00001e090,0x1f5d000019ce8
.quad 0x1e1700001e130,0x1f61000019d08,0x1e1000001e140,0x1f65000019d28
.quad 0x1e1100001e150,0x1f69000019d48,0x1e1200001e160,0x1f6d000019d68
.quad 0x1e1300001e170,0x1f71000019d88,0x1e1400001e100,0x1f75000019da8
.quad 0x1e1500001e110,0x1f79000019dc8,0x1e1600001e120,0x1f7d000019de8
.quad 0x1e1f00001e1b0,0x1f81000019e08,0x1e1800001e1c0,0x1f85000019e28
.quad 0x1e1900001e1d0,0x1f89000019e48,0x1e1a00001e1e0,0x1f8d000019e68
.quad 0x1e1b00001e1f0,0x1f91000019e88,0x1e1c00001e180,0x1f95000019ea8
.quad 0x1e1d00001e190,0x1f99000019ec8,0x1e1e00001e1a0,0x1f9d000019ee8
.quad 0x1fe0000001c00,0x400,0x1fe1000001c10,0x1000000410
.quad 0x1fe2000001c20,0x2000000420,0x1fe3000001c30,0x3000000430
.quad 0x1fe4000001c40,0x4000000440,0x1fe5000001c50,0x5000000450
.quad 0x1fe6000001c60,0x6000000460,0x1fe7000001c70,0x7000000470
.quad 0x1fe8000001c80,0x8000000480,0x1fe9000001c90,0x9000000490
.quad 0x1fea000001ca0,0xa0000004a0,0x1feb000001cb0,0xb0000004b0
.quad 0x1fec000001cc0,0xc0000004c0,0x1fed000001cd0,0xd0000004d0
.quad 0x1fee000001ce0,0xe0000004e0,0x1fef000001cf0,0xf0000004f0
.quad 0x1ff0000001d00,0x10000000500,0x1ff1000001d10,0x11000000510
.quad 0x1ff2000001d20,0x12000000520,0x1ff3000001d30,0x13000000530
.quad 0x1ff4000001d40,0x14000000540,0x1ff5000001d50,0x15000000550
.quad 0x1ff6000001d60,0x16000000560,0x1ff7000001d70,0x17000000570
.quad 0x1ff8000001d80,0x18000000580,0x1ff9000001d90,0x19000000590
.quad 0x1ffa000001da0,0x1a0000005a0,0x1ffb000001db0,0x1b0000005b0
.quad 0x1ffc000001dc0,0x1c0000005c0,0x1ffd000001dd0,0x1d0000005d0
.quad 0x1ffe000001de0,0x1e0000005e0,0x1fff000001df0,0x1f0000005f0
.quad 0x2000000001e00,0x20000000600,0x2001000001e10,0x21000000610
.quad 0x2002000001e20,0x22000000620,0x2003000001e30,0x23000000630
.quad 0x2004000001e40,0x24000000640,0x2005000001e50,0x25000000650
.quad 0x2006000001e60,0x26000000660,0x2007000001e70,0x27000000670
.quad 0x2008000001e80,0x28000000680,0x2009000001e90,0x29000000690
.quad 0x200a000001ea0,0x2a0000006a0,0x200b000001eb0,0x2b0000006b0
.quad 0x200c000001ec0,0x2c0000006c0,0x200d000001ed0,0x2d0000006d0
.quad 0x200e000001ee0,0x2e0000006e0,0x200f000001ef0,0x2f0000006f0
.quad 0x2010000001f00,0x30000000700,0x2011000001f10,0x31000000710
.quad 0x2012000001f20,0x32000000720,0x2013000001f30,0x33000000730
.quad 0x2014000001f40,0x34000000740,0x2015000001f50,0x35000000750
.quad 0x2016000001f60,0x36000000760,0x2017000001f70,0x37000000770
.quad 0x2018000001f80,0x38000000780,0x2019000001f90,0x39000000790
.quad 0x201a000001fa0,0x3a0000007a0,0x201b000001fb0,0x3b0000007b0
.quad 0x201c000001fc0,0x3c0000007c0,0x201d000001fd0,0x3d0000007d0
.quad 0x201e000001fe0,0x3e0000007e0,0x201f000001ff0,0x3f0000007f0
.quad 0x15800,0x20a8000008040,0x1000015810,0x20a8000008440
.quad 0x2000015820,0x20a8000008840,0x3000015830,0x20a8000008c40
.quad 0x4000015840,0x20a8000009040,0x5000015850,0x20a8000009440
.quad 0x6000015860,0x20a8000009840,0x7000015870,0x20a8000009c40
.quad 0x8000015880,0x20a800000a040,0x9000015890,0x20a800000a440
.quad 0xa0000158a0,0x20a800000a840,0xb0000158b0,0x20a800000ac40
.quad 0xc0000158c0,0x20a800000b040,0xd0000158d0,0x20a800000b440
.quad 0xe0000158e0,0x20a800000b840,0xf0000158f0,0x20a800000bc40
.quad 0x10000015900,0x20a800000c040,0x11000015910,0x20a800000c440
.quad 0x12000015920,0x20a800000c840,0x13000015930,0x20a800000cc40
.quad 0x14000015940,0x20a800000d040,0x15000015950,0x20a800000d440
.quad 0x16000015960,0x20a800000d840,0x17000015970,0x20a800000dc40
.quad 0x18000015980,0x20a800000e040,0x19000015990,0x20a800000e440
.quad 0x1a0000159a0,0x20a800000e840,0x1b0000159b0,0x20a800000ec40
.quad 0x1c0000159c0,0x20a800000f040,0x1d0000159d0,0x20a800000f440
.quad 0x1e0000159e0,0x20a800000f840,0x1f0000159f0,0x20a800000fc40
.quad 0x20000015a00,0x20a9000008050,0x21000015a10,0x20a9000008450
.quad 0x22000015a20,0x20a9000008850,0x23000015a30,0x20a9000008c50
.quad 0x24000015a40,0x20a9000009050,0x25000015a50,0x20a9000009450
.quad 0x26000015a60,0x20a9000009850,0x27000015a70,0x20a9000009c50
.quad 0x28000015a80,0x20a900000a050,0x29000015a90,0x20a900000a450
.quad 0x2a000015aa0,0x20a900000a850,0x2b000015ab0,0x20a900000ac50
.quad 0x2c000015ac0,0x20a900000b050,0x2d000015ad0,0x20a900000b450
.quad 0x2e000015ae0,0x20a900000b850,0x2f000015af0,0x20a900000bc50
.quad 0x30000015b00,0x20a900000c050,0x31000015b10,0x20a900000c450
.quad 0x32000015b20,0x20a900000c850,0x33000015b30,0x20a900000cc50
.quad 0x34000015b40,0x20a900000d050,0x35000015b50,0x20a900000d450
.quad 0x36000015b60,0x20a900000d850,0x37000015b70,0x20a900000dc50
.quad 0x38000015b80,0x20a900000e050,0x39000015b90,0x20a900000e450
.quad 0x3a000015ba0,0x20a900000e850,0x3b000015bb0,0x20a900000ec50
.quad 0x3c000015bc0,0x20a900000f050,0x3d000015bd0,0x20a900000f450
.quad 0x3e000015be0,0x20a900000f850,0x3f000015bf0,0x20a900000fc50
.quad 0x600000100040,0x200000004000,0x601000108040,0x201000004010
.quad 0x602000110040,0x202000004020,0x603000118040,0x203000004030
.quad 0x604000120040,0x204000004040,0x605000128040,0x205000004050
.quad 0x606000130040,0x206000004060,0x607000138040,0x207000004070
.quad 0x608000140040,0x208000004080,0x609000148040,0x209000004090
.quad 0x60a000150040,0x20a0000040a0,0x60b000158040,0x20b0000040b0
.quad 0x60c000160040,0x20c0000040c0,0x60d000168040,0x20d0000040d0
.quad 0x60e000170040,0x20e0000040e0,0x60f000178040,0x20f0000040f0
.quad 0x610000180040,0x210000004100,0x611000188040,0x211000004110
.quad 0x612000190040,0x212000004120,0x613000198040,0x213000004130
.quad 0x6140001a0040,0x214000004140,0x6150001a8040,0x215000004150
.quad 0x6160001b0040,0x216000004160,0x6170001b8040,0x217000004170
.quad 0x6180001c0040,0x218000004180,0x6190001c8040,0x219000004190
.quad 0x61a0001d0040,0x21a0000041a0,0x61b0001d8040,0x21b0000041b0
.quad 0x61c0001e0040,0x21c0000041c0,0x61d0001e8040,0x21d0000041d0
.quad 0x61e0001f0040,0x21e0000041e0,0x61f0001f8040,0x21f0000041f0
.quad 0x620000100050,0x220000004200,0x621000108050,0x221000004210
.quad 0x622000110050,0x222000004220,0x623000118050,0x223000004230
.quad 0x624000120050,0x224000004240,0x625000128050,0x225000004250
.quad 0x626000130050,0x226000004260,0x627000138050,0x227000004270
.quad 0x628000140050,0x228000004280,0x629000148050,0x229000004290
.quad 0x62a000150050,0x22a0000042a0,0x62b000158050,0x22b0000042b0
.quad 0x62c000160050,0x22c0000042c0,0x62d000168050,0x22d0000042d0
.quad 0x62e000170050,0x22e0000042e0,0x62f000178050,0x22f0000042f0
.quad 0x630000180050,0x230000004300,0x631000188050,0x231000004310
.quad 0x632000190050,0x232000004320,0x633000198050,0x233000004330
.quad 0x6340001a0050,0x234000004340,0x6350001a8050,0x235000004350
.quad 0x6360001b0050,0x236000004360,0x6370001b8050,0x237000004370
.quad 0x6380001c0050,0x238000004380,0x6390001c8050,0x239000004390
.quad 0x63a0001d0050,0x23a0000043a0,0x63b0001d8050,0x23b0000043b0
.quad 0x63c0001e0050,0x23c0000043c0,0x63d0001e8050,0x23d0000043d0
.quad 0x63e0001f0050,0x23e0000043e0,0x63f0001f8050,0x23f0000043f0
.Lktab:
.quad 0x40000000000,0xc0000000800,0x140000001000,0x1c0000001800
.quad 0x240000002000,0x2c0000002800,0x340000003000,0x3c0000003800
.quad 0x440000004000,0x4c0000004800,0x540000005000,0x0
.quad 0x0,0x0,0x0,0x0
.quad 0x5c0000005800,0x640000006000,0x6c0000006800,0x740000007000
.quad 0x7c0000007800,0x840000008000,0x8c0000008800,0x940000009000
.quad 0x9c0000009800,0xa4000000a000,0xac000000a800,0x0
.quad 0x0,0x0,0x0,0x0
.quad 0xb4000000b000,0xbc000000b800,0xc4000000c000,0xcc000000c800
.quad 0xd4000000d000,0xdc000000d800,0xe4000000e000,0xec000000e800
.quad 0xf4000000f000,0xfc000000f800,0x1000000010000,0x0
.quad 0x0,0x0,0x0,0x0
.quad 0x1080000010400,0x1100000010c00,0x1180000011400,0x1200000011c00
.quad 0x1280000012400,0x1300000012c00,0x1380000013400,0x1400000013c00
.quad 0x1480000014400,0x1500000014c00,0x1540000015400,0x0
.quad 0x0,0x0,0x0,0x0
.quad 0x40000000000,0xc0000000800,0x140000001000,0x1c0000001800
.quad 0x240000002000,0x2c0000002800,0x340000003000,0x3c0000003800
.quad 0x440000004000,0x4c0000004800,0x540000005000,0x0
.quad 0x0,0x0,0x0,0x0
.quad 0x5c0000005800,0x640000006000,0x6c0000006800,0x740000007000
.quad 0x7c0000007800,0x840000008000,0x8c0000008800,0x940000009000
.quad 0x9c0000009800,0xa4000000a000,0xac000000a800,0x0
.quad 0x0,0x0,0x0,0x0
.quad 0xb4000000b000,0xbc000000b800,0xc4000000c000,0xcc000000c800
.quad 0xd4000000d000,0xdc000000d800,0xe4000000e000,0xec000000e800
.quad 0xf4000000f000,0xfc000000f800,0x1000000010000,0x0
.quad 0x0,0x0,0x0,0x0
.quad 0x1080000010400,0x1100000010c00,0x1180000011400,0x1200000011c00
.quad 0x1280000012400,0x1300000012c00,0x1380000013400,0x1400000013c00
.quad 0x1480000014400,0x1500000014c00,0x1540000015400,0x0
.quad 0x0,0x0,0x0,0x0
.quad 0x40000000000,0xc0000000800,0x140000001000,0x1c0000001800
.quad 0x240000002000,0x2c0000002800,0x340000003000,0x3c0000003800
.quad 0x440000004000,0x4c0000004800,0x540000005000,0x0
.quad 0x0,0x0,0x0,0x0
.quad 0x5c0000005800,0x640000006000,0x6c0000006800,0x740000007000
.quad 0x7c0000007800,0x840000008000,0x8c0000008800,0x940000009000
.quad 0x9c0000009800,0xa4000000a000,0xac000000a800,0x0
.quad 0x0,0x0,0x0,0x0
.quad 0xb4000000b000,0xbc000000b800,0xc4000000c000,0xcc000000c800
.quad 0xd4000000d000,0xdc000000d800,0xe4000000e000,0xec000000e800
.quad 0xf4000000f000,0xfc000000f800,0x1000000010000,0x0
.quad 0x0,0x0,0x0,0x0
.quad 0x1080000010400,0x1100000010c00,0x1180000011400,0x1200000011c00
.quad 0x1280000012400,0x1300000012c00,0x1380000013400,0x1400000013c00
.quad 0x1480000014400,0x1500000014c00,0x1540000015400,0x0
.quad 0x0,0x0,0x0,0x0
.quad 0x40000000000,0xc0000000800,0x140000001000,0x1c0000001800
.quad 0x240000002000,0x2c0000002800,0x340000003000,0x3c0000003800
.quad 0x440000004000,0x4c0000004800,0x540000005000,0x0
.quad 0x0,0x0,0x0,0x0
.quad 0x5c0000005800,0x640000006000,0x6c0000006800,0x740000007000
.quad 0x7c0000007800,0x840000008000,0x8c0000008800,0x940000009000
.quad 0x9c0000009800,0xa4000000a000,0xac000000a800,0x0
.quad 0x0,0x0,0x0,0x0
.quad 0xb4000000b000,0xbc000000b800,0xc4000000c000,0xcc000000c800
.quad 0xd4000000d000,0xdc000000d800,0xe4000000e000,0xec000000e800
.quad 0xf4000000f000,0xfc000000f800,0x1000000010000,0x0
.quad 0x0,0x0,0x0,0x0
.quad 0x1080000010400,0x1100000010c00,0x1180000011400,0x1200000011c00
.quad 0x1280000012400,0x1300000012c00,0x1380000013400,0x1400000013c00
.quad 0x1480000014400,0x1500000014c00,0x1540000015400,0x0
.quad 0x0,0x0,0x0,0x0
.quad 0x40000000000,0xc0000000800,0x140000001000,0x1c0000001800
.quad 0x240000002000,0x2c0000002800,0x340000003000,0x3c0000003800
.quad 0x440000004000,0x4c0000004800,0x540000005000,0x0
.quad 0x0,0x0,0x0,0x0
.quad 0x5c0000005800,0x640000006000,0x6c0000006800,0x740000007000
.quad 0x7c0000007800,0x840000008000,0x8c0000008800,0x940000009000
.quad 0x9c0000009800,0xa4000000a000,0xac000000a800,0x0
.quad 0x0,0x0,0x0,0x0
.quad 0xb4000000b000,0xbc000000b800,0xc4000000c000,0xcc000000c800
.quad 0xd4000000d000,0xdc000000d800,0xe4000000e000,0xec000000e800
.quad 0xf4000000f000,0xfc000000f800,0x1000000010000,0x0
.quad 0x0,0x0,0x0,0x0
.quad 0x1080000010400,0x1100000010c00,0x1180000011400,0x1200000011c00
.quad 0x1280000012400,0x1300000012c00,0x1380000013400,0x1400000013c00
.quad 0x1480000014400,0x1500000014c00,0x1540000015400,0x0
.quad 0x0,0x0,0x0,0x0
.quad 0x40000000000,0xc0000000800,0x140000001000,0x1c0000001800
.quad 0x240000002000,0x2c0000002800,0x340000003000,0x3c0000003800
.quad 0x440000004000,0x4c0000004800,0x540000005000,0x0
.quad 0x0,0x0,0x0,0x0
.quad 0x5c0000005800,0x640000006000,0x6c0000006800,0x740000007000
.quad 0x7c0000007800,0x840000008000,0x8c0000008800,0x940000009000
.quad 0x9c0000009800,0xa4000000a000,0xac000000a800,0x0
.quad 0x0,0x0,0x0,0x0
.quad 0xb4000000b000,0xbc000000b800,0xc4000000c000,0xcc000000c800
.quad 0xd4000000d000,0xdc000000d800,0xe4000000e000,0xec000000e800
.quad 0xf4000000f000,0xfc000000f800,0x1000000010000,0x0
.quad 0x0,0x0,0x0,0x0
.quad 0x1080000010400,0x1100000010c00,0x1180000011400,0x1200000011c00
.quad 0x1280000012400,0x1300000012c00,0x1380000013400,0x1400000013c00
.quad 0x1480000014400,0x1500000014c00,0x1540000015400,0x0
.quad 0x0,0x0,0x0,0x0
.quad 0x40000000000,0xc0000000800,0x140000001000,0x1c0000001800
.quad 0x240000002000,0x2c0000002800,0x340000003000,0x3c0000003800
.quad 0x440000004000,0x4c0000004800,0x540000005000,0x0
.quad 0x0,0x0,0x0,0x0
.quad 0x5c0000005800,0x640000006000,0x6c0000006800,0x740000007000
.quad 0x7c0000007800,0x840000008000,0x8c0000008800,0x940000009000
.quad 0x9c0000009800,0xa4000000a000,0xac000000a800,0x0
.quad 0x0,0x0,0x0,0x0
.quad 0xb4000000b000,0xbc000000b800,0xc4000000c000,0xcc000000c800
.quad 0xd4000000d000,0xdc000000d800,0xe4000000e000,0xec000000e800
.quad 0xf4000000f000,0xfc000000f800,0x1000000010000,0x0
.quad 0x0,0x0,0x0,0x0
.quad 0x1080000010400,0x1100000010c00,0x1180000011400,0x1200000011c00
.quad 0x1280000012400,0x1300000012c00,0x1380000013400,0x1400000013c00
.quad 0x1480000014400,0x1500000014c00,0x1540000015400,0x0
.quad 0x0,0x0,0x0,0x0
.quad 0x40000000000,0xc0000000800,0x140000001000,0x1c0000001800
.quad 0x240000002000,0x2c0000002800,0x340000003000,0x3c0000003800
.quad 0x440000004000,0x4c0000004800,0x540000005000,0x0
.quad 0x0,0x0,0x0,0x0
.quad 0x5c0000005800,0x640000006000,0x6c0000006800,0x740000007000
.quad 0x7c0000007800,0x840000008000,0x8c0000008800,0x940000009000
.quad 0x9c0000009800,0xa4000000a000,0xac000000a800,0x0
.quad 0x0,0x0,0x0,0x0
.quad 0xb4000000b000,0xbc000000b800,0xc4000000c000,0xcc000000c800
.quad 0xd4000000d000,0xdc000000d800,0xe4000000e000,0xec000000e800
.quad 0xf4000000f000,0xfc000000f800,0x1000000010000,0x0
.quad 0x0,0x0,0x0,0x0
.quad 0x1080000010400,0x1100000010c00,0x1180000011400,0x1200000011c00
.quad 0x1280000012400,0x1300000012c00,0x1380000013400,0x1400000013c00
.quad 0x1480000014400,0x1500000014c00,0x1540000015400,0x0
.quad 0x0,0x0,0x0,0x0
.Lwgtab:
.quad 0x0,0x60000000400000,0x400000000000,0x0
.quad 0x10000000000000,0x100000,0xc0000000000000,0x8000
.quad 0x40000000000000,0x10000000404000,0x60000000300000,0x80000000640000
.quad 0xa0000000801000,0x100100001000000,0x0,0xc0000000c00000
.quad 0x80100000800000,0x80300000802000,0x80500000804000,0x80700000806000
.quad 0x0,0xa0000001000000,0x0,0x0
.quad 0x80,0x64000000440000,0x410000001000,0x200000200
.quad 0x10008000000200,0x10000100020,0xc0200000000200,0x100008200
.quad 0x40040000000020,0x14000000404400,0x6004007f000000,0x84000000640400
.quad 0xa4000000841000,0x10ad000010ac000,0x160000000000,0xc0000000c00000
.quad 0x84100000840000,0x84300000842000,0x84500000844000,0x84700000846000
.quad 0x0,0xa40000010ac000,0x1000,0x0
.quad 0x100,0x68000000480000,0x420000002000,0x400000400
.quad 0x10010000000400,0x20000100040,0xc0400000004000,0x200008400
.quad 0x40080000000040,0x18000000404800,0x6008007f000000,0x88000000640800
.quad 0xa8000000881000,0x115900001158000,0x2c0000000000,0xc0000000c00000
.quad 0x88100000880000,0x88300000882000,0x88500000884000,0x88700000886000
.quad 0x0,0xa8000001158000,0x2000,0x0
.quad 0x180,0x6c0000004c0000,0x430000003000,0x600000600
.quad 0x10018000000600,0x30000100060,0xc0600000004200,0x300008600
.quad 0x400c0000000060,0x1c000000404c00,0x600c007f000000,0x8c000000640c00
.quad 0xac0000008c1000,0x120500001204000,0x420000000000,0xc0000000c00000
.quad 0x8c1000008c0000,0x8c3000008c2000,0x8c5000008c4000,0x8c7000008c6000
.quad 0x0,0xac000001204000,0x3000,0x0
.quad 0x200,0x70000000500000,0x440000004000,0x800000800
.quad 0x10020000000001,0x40000100080,0xc0800000008000,0x400008800
.quad 0x40100000000080,0x20000000405000,0x6010007f000000,0x90000000641000
.quad 0xb0000000901000,0x12b1000012b0000,0x580000000000,0xc0000000c00000
.quad 0x90100000900000,0x90300000902000,0x90500000904000,0x90700000906000
.quad 0x0,0xb00000012b0000,0x4000,0x0
.quad 0x280,0x74000000540000,0x450000005000,0xa00000a00
.quad 0x10028000000201,0x500001000a0,0xc0a00000008200,0x500008a00
.quad 0x401400000000a0,0x24000000405400,0x6014007f000000,0x94000000641400
.quad 0xb4000000941000,0x135d0000135c000,0x6e0000000000,0xc0000000c00000
.quad 0x94100000940000,0x94300000942000,0x94500000944000,0x94700000946000
.quad 0x0,0xb400000135c000,0x5000,0x0
.quad 0x300,0x78000000580000,0x460000006000,0xc00000c00
.quad 0x10030000000401,0x600001000c0,0xc0c0000000c000,0x600008c00
.quad 0x401800000000c0,0x28000000405800,0x6018007f000000,0x98000000641800
.quad 0xb8000000981000,0x140900001408000,0x840000000000,0xc0000000c00000
.quad 0x98100000980000,0x98300000982000,0x98500000984000,0x98700000986000
.quad 0x0,0xb8000001408000,0x6000,0x0
.quad 0x380,0x7c0000005c0000,0x470000007000,0xe00000e00
.quad 0x10038000000601,0x700001000e0,0xc0e0000000c200,0x700008e00
.quad 0x401c00000000e0,0x2c000000405c00,0x601c007f000000,0x9c000000641c00
.quad 0xbc0000009c1000,0x14b5000014b4000,0x9a0000000000,0xc0000000c00000
.quad 0x9c1000009c0000,0x9c3000009c2000,0x9c5000009c4000,0x9c7000009c6000
.quad 0x0,0xbc0000014b4000,0x7000,0x0
.quad 0x20,0x60200000402000,0x404000040000,0x80
.quad 0x18000000000002,0x4000100100,0xc1000000010000,0x8080
.quad 0x40002000000001,0x10200000404020,0x6000207f000000,0x80008000640020
.quad 0xa0200000801080,0x100280001001800,0xb000000000c0,0xc0ac0000c00800
.quad 0x80200000801000,0x80400000803000,0x80600000805000,0x80000000807000
.quad 0x3000,0xa0008001000000,0x10000000080,0x0
.quad 0xa0,0x64200000442000,0x414000041000,0x200000280
.quad 0x18008000000202,0x14000100120,0xc1200000010200,0x100008280
.quad 0x40042000000021,0x14200000404420,0x6004207f000000,0x84008000640420
.quad 0xa4200000841080,0x10ae800010ad800,0xc600000000c0,0xc0ac0000c00800
.quad 0x84200000841000,0x84400000843000,0x84600000845000,0x84000000847000
.quad 0x3000,0xa40080010ac000,0x10000001080,0x0
.quad 0x120,0x68200000482000,0x424000042000,0x400000480
.quad 0x18010000000402,0x24000100140,0xc1400000014000,0x200008480
.quad 0x40082000000041,0x18200000404820,0x6008207f000000,0x88008000640820
.quad 0xa8200000881080,0x115a80001159800,0xdc00000000c0,0xc0ac0000c00800
.quad 0x88200000881000,0x88400000883000,0x88600000885000,0x88000000887000
.quad 0x3000,0xa8008001158000,0x10000002080,0x0
.quad 0x1a0,0x6c2000004c2000,0x434000043000,0x600000680
.quad 0x18018000000602,0x34000100160,0xc1600000014200,0x300008680
.quad 0x400c2000000061,0x1c200000404c20,0x600c207f000000,0x8c008000640c20
.quad 0xac2000008c1080,0x120680001205800,0xf200000000c0,0xc0ac0000c00800
.quad 0x8c2000008c1000,0x8c4000008c3000,0x8c6000008c5000,0x8c0000008c7000
.quad 0x3000,0xac008001204000,0x10000003080,0x0
.quad 0x220,0x70200000502000,0x444000044000,0x800000880
.quad 0x18020000000003,0x44000100180,0xc1800000018000,0x400008880
.quad 0x40102000000081,0x20200000405020,0x6010207f000000,0x90008000641020
.quad 0xb0200000901080,0x12b2800012b1800,0x10800000000c0,0xc0ac0000c00800
.quad 0x90200000901000,0x90400000903000,0x90600000905000,0x90000000907000
.quad 0x3000,0xb00080012b0000,0x10000004080,0x0
.quad 0x2a0,0x74200000542000,0x454000045000,0xa00000a80
.quad 0x18028000000203,0x540001001a0,0xc1a00000018200,0x500008a80
.quad 0x401420000000a1,0x24200000405420,0x6014207f000000,0x94008000641420
.quad 0xb4200000941080,0x135e8000135d800,0x11e00000000c0,0xc0ac0000c00800
.quad 0x94200000941000,0x94400000943000,0x94600000945000,0x94000000947000
.quad 0x3000,0xb400800135c000,0x10000005080,0x0
.quad 0x320,0x78200000582000,0x464000046000,0xc00000c80
.quad 0x18030000000403,0x640001001c0,0xc1c0000001c000,0x600008c80
.quad 0x401820000000c1,0x28200000405820,0x6018207f000000,0x98008000641820
.quad 0xb8200000981080,0x140a80001409800,0x13400000000c0,0xc0ac0000c00800
.quad 0x98200000981000,0x98400000983000,0x98600000985000,0x98000000987000
.quad 0x3000,0xb8008001408000,0x10000006080,0x0
.quad 0x3a0,0x7c2000005c2000,0x474000047000,0xe00000e80
.quad 0x18038000000603,0x740001001e0,0xc1e0000001c200,0x700008e80
.quad 0x401c20000000e1,0x2c200000405c20,0x601c207f000000,0x9c008000641c20
.quad 0xbc2000009c1080,0x14b6800014b5800,0x14a00000000c0,0xc0ac0000c00800
.quad 0x9c2000009c1000,0x9c4000009c3000,0x9c6000009c5000,0x9c0000009c7000
.quad 0x3000,0xbc0080014b4000,0x10000007080,0x0
.quad 0x40,0x60400000404000,0x408000080000,0x100
.quad 0x20000000000004,0x8000100200,0xc2000000020000,0x8100
.quad 0x40004000000002,0x10400000404040,0x6000407f000000,0x80010000640040
.quad 0xa0400000801100,0x100400001003000,0x1600000000180,0xc1580000c01000
.quad 0x80300000802000,0x80500000804000,0x80700000806000,0x80100000800000
.quad 0x6000,0xa0010001000000,0x20000000100,0x0
.quad 0xc0,0x64400000444000,0x418000081000,0x200000300
.quad 0x20008000000204,0x18000100220,0xc2200000020200,0x100008300
.quad 0x40044000000022,0x14400000404440,0x6004407f000000,0x84010000640440
.quad 0xa4400000841100,0x10b0000010af000,0x1760000000180,0xc1580000c01000
.quad 0x84300000842000,0x84500000844000,0x84700000846000,0x84100000840000
.quad 0x6000,0xa40100010ac000,0x20000001100,0x0
.quad 0x140,0x68400000484000,0x428000082000,0x400000500
.quad 0x20010000000404,0x28000100240,0xc2400000024000,0x200008500
.quad 0x40084000000042,0x18400000404840,0x6008407f000000,0x88010000640840
.quad 0xa8400000881100,0x115c0000115b000,0x18c0000000180,0xc1580000c01000
.quad 0x88300000882000,0x88500000884000,0x88700000886000,0x88100000880000
.quad 0x6000,0xa8010001158000,0x20000002100,0x0
.quad 0x1c0,0x6c4000004c4000,0x438000083000,0x600000700
.quad 0x20018000000604,0x38000100260,0xc2600000024200,0x300008700
.quad 0x400c4000000062,0x1c400000404c40,0x600c407f000000,0x8c010000640c40
.quad 0xac4000008c1100,0x120800001207000,0x1a20000000180,0xc1580000c01000
.quad 0x8c3000008c2000,0x8c5000008c4000,0x8c7000008c6000,0x8c1000008c0000
.quad 0x6000,0xac010001204000,0x20000003100,0x0
.quad 0x240,0x70400000504000,0x448000084000,0x800000900
.quad 0x20020000000005,0x48000100280,0xc2800000028000,0x400008900
.quad 0x40104000000082,0x20400000405040,0x6010407f000000,0x90010000641040
.quad 0xb0400000901100,0x12b4000012b3000,0x1b80000000180,0xc1580000c01000
.quad 0x90300000902000,0x90500000904000,0x90700000906000,0x90100000900000
.quad 0x6000,0xb00100012b0000,0x20000004100,0x0
.quad 0x2c0,0x74400000544000,0x458000085000,0xa00000b00
.quad 0x20028000000205,0x580001002a0,0xc2a00000028200,0x500008b00
.quad 0x401440000000a2,0x24400000405440,0x6014407f000000,0x94010000641440
.quad 0xb4400000941100,0x13600000135f000,0x1ce0000000180,0xc1580000c01000
.quad 0x94300000942000,0x94500000944000,0x94700000946000,0x94100000940000
.quad 0x6000,0xb401000135c000,0x20000005100,0x0
.quad 0x340,0x78400000584000,0x468000086000,0xc00000d00
.quad 0x20030000000405,0x680001002c0,0xc2c0000002c000,0x600008d00
.quad 0x401840000000c2,0x28400000405840,0x6018407f000000,0x98010000641840
.quad 0xb8400000981100,0x140c0000140b000,0x1e40000000180,0xc1580000c01000
.quad 0x98300000982000,0x98500000984000,0x98700000986000,0x98100000980000
.quad 0x6000,0xb8010001408000,0x20000006100,0x0
.quad 0x3c0,0x7c4000005c4000,0x478000087000,0xe00000f00
.quad 0x20038000000605,0x780001002e0,0xc2e0000002c200,0x700008f00
.quad 0x401c40000000e2,0x2c400000405c40,0x601c407f000000,0x9c010000641c40
.quad 0xbc4000009c1100,0x14b8000014b7000,0x1fa0000000180,0xc1580000c01000
.quad 0x9c3000009c2000,0x9c5000009c4000,0x9c7000009c6000,0x9c1000009c0000
.quad 0x6000,0xbc0100014b4000,0x20000007100,0x0
.quad 0x60,0x60600000406000,0x40c0000c0000,0x180
.quad 0x28000000000006,0xc000100300,0xc3000000030000,0x8180
.quad 0x40006000000003,0x10600000404060,0x6000607f000000,0x80018000640060
.quad 0xa0600000801180,0x100580001004800,0x2100000000240,0xc2040000c01800
.quad 0x80400000803000,0x80600000805000,0x80000000807000,0x80200000801000
.quad 0x9000,0xa0018001000000,0x30000000180,0x0
.quad 0xe0,0x64600000446000,0x41c0000c1000,0x200000380
.quad 0x28008000000206,0x1c000100320,0xc3200000030200,0x100008380
.quad 0x40046000000023,0x14600000404460,0x6004607f000000,0x84018000640460
.quad 0xa4600000841180,0x10b1800010b0800,0x2260000000240,0xc2040000c01800
.quad 0x84400000843000,0x84600000845000,0x84000000847000,0x84200000841000
.quad 0x9000,0xa40180010ac000,0x30000001180,0x0
.quad 0x160,0x68600000486000,0x42c0000c2000,0x400000580
.quad 0x28010000000406,0x2c000100340,0xc3400000034000,0x200008580
.quad 0x40086000000043,0x18600000404860,0x6008607f000000,0x88018000640860
.quad 0xa8600000881180,0x115d8000115c800,0x23c0000000240,0xc2040000c01800
.quad 0x88400000883000,0x88600000885000,0x88000000887000,0x88200000881000
.quad 0x9000,0xa8018001158000,0x30000002180,0x0
.quad 0x1e0,0x6c6000004c6000,0x43c0000c3000,0x600000780
.quad 0x28018000000606,0x3c000100360,0xc3600000034200,0x300008780
.quad 0x400c6000000063,0x1c600000404c60,0x600c607f000000,0x8c018000640c60
.quad 0xac6000008c1180,0x120980001208800,0x2520000000240,0xc2040000c01800
.quad 0x8c4000008c3000,0x8c6000008c5000,0x8c0000008c7000,0x8c2000008c1000
.quad 0x9000,0xac018001204000,0x30000003180,0x0
.quad 0x260,0x70600000506000,0x44c0000c4000,0x800000980
.quad 0x28020000000007,0x4c000100380,0xc3800000038000,0x400008980
.quad 0x40106000000083,0x20600000405060,0x6010607f000000,0x90018000641060
.quad 0xb0600000901180,0x12b5800012b4800,0x2680000000240,0xc2040000c01800
.quad 0x90400000903000,0x90600000905000,0x90000000907000,0x90200000901000
.quad 0x9000,0xb00180012b0000,0x30000004180,0x0
.quad 0x2e0,0x74600000546000,0x45c0000c5000,0xa00000b80
.quad 0x28028000000207,0x5c0001003a0,0xc3a00000038200,0x500008b80
.quad 0x401460000000a3,0x24600000405460,0x6014607f000000,0x94018000641460
.quad 0xb4600000941180,0x136180001360800,0x27e0000000240,0xc2040000c01800
.quad 0x94400000943000,0x94600000945000,0x94000000947000,0x94200000941000
.quad 0x9000,0xb401800135c000,0x30000005180,0x0
.quad 0x360,0x78600000586000,0x46c0000c6000,0xc00000d80
.quad 0x28030000000407,0x6c0001003c0,0xc3c0000003c000,0x600008d80
.quad 0x401860000000c3,0x28600000405860,0x6018607f000000,0x98018000641860
.quad 0xb8600000981180,0x140d8000140c800,0x2940000000240,0xc2040000c01800
.quad 0x98400000983000,0x98600000985000,0x98000000987000,0x98200000981000
.quad 0x9000,0xb8018001408000,0x30000006180,0x0
.quad 0x3e0,0x7c6000005c6000,0x47c0000c7000,0xe00000f80
.quad 0x28038000000607,0x7c0001003e0,0xc3e0000003c200,0x700008f80
.quad 0x401c60000000e3,0x2c600000405c60,0x601c607f000000,0x9c018000641c60
.quad 0xbc6000009c1180,0x14b9800014b8800,0x2aa0000000240,0xc2040000c01800
.quad 0x9c4000009c3000,0x9c6000009c5000,0x9c0000009c7000,0x9c2000009c1000
.quad 0x9000,0xbc0180014b4000,0x30000007180,0x0
.quad 0x100000c0000,0x60800000408000,0x500000100000,0x1010
.quad 0x10040000000008,0xc000000100400,0xc4000000040000,0xa000
.quad 0x40008000000004,0x10800000404080,0x6000807f000000,0x80800000640080
.quad 0xa0800000809000,0x100700001006000,0x2c00000000300,0xc2b00000c02000
.quad 0x80500000804000,0x80700000806000,0x80100000800000,0x80300000802000
.quad 0xc000,0xa0020001000000,0x40000000200,0x0
.quad 0x100000c0080,0x64800000448000,0x510000101000,0x200001210
.quad 0x10048000000208,0xc010000100420,0xc4200000040200,0x10000a200
.quad 0x40048000000024,0x14800000404480,0x6004807f000000,0x84800000640480
.quad 0xa4800000849000,0x10b3000010b2000,0x2d60000000300,0xc2b00000c02000
.quad 0x84500000844000,0x84700000846000,0x84100000840000,0x84300000842000
.quad 0xc000,0xa40200010ac000,0x40000001200,0x0
.quad 0x100000c0100,0x68800000488000,0x520000102000,0x400001410
.quad 0x10050000000408,0xc020000100440,0xc4400000044000,0x20000a400
.quad 0x40088000000044,0x18800000404880,0x6008807f000000,0x88800000640880
.quad 0xa8800000889000,0x115f0000115e000,0x2ec0000000300,0xc2b00000c02000
.quad 0x88500000884000,0x88700000886000,0x88100000880000,0x88300000882000
.quad 0xc000,0xa8020001158000,0x40000002200,0x0
.quad 0x100000c0180,0x6c8000004c8000,0x530000103000,0x600001610
.quad 0x10058000000608,0xc030000100460,0xc4600000044200,0x30000a600
.quad 0x400c8000000064,0x1c800000404c80,0x600c807f000000,0x8c800000640c80
.quad 0xac8000008c9000,0x120b0000120a000,0x3020000000300,0xc2b00000c02000
.quad 0x8c5000008c4000,0x8c7000008c6000,0x8c1000008c0000,0x8c3000008c2000
.quad 0xc000,0xac020001204000,0x40000003200,0x0
.quad 0x100000c0200,0x70800000508000,0x540000104000,0x800001810
.quad 0x10060000000009,0xc040000100480,0xc4800000048000,0x40000a800
.quad 0x40108000000084,0x20800000405080,0x6010807f000000,0x90800000641080
.quad 0xb0800000909000,0x12b7000012b6000,0x3180000000300,0xc2b00000c02000
.quad 0x90500000904000,0x90700000906000,0x90100000900000,0x90300000902000
.quad 0xc000,0xb00200012b0000,0x40000004200,0x0
.quad 0x100000c0280,0x74800000548000,0x550000105000,0xa00001a10
.quad 0x10068000000209,0xc0500001004a0,0xc4a00000048200,0x50000aa00
.quad 0x401480000000a4,0x24800000405480,0x6014807f000000,0x94800000641480
.quad 0xb4800000949000,0x136300001362000,0x32e0000000300,0xc2b00000c02000
.quad 0x94500000944000,0x94700000946000,0x94100000940000,0x94300000942000
.quad 0xc000,0xb402000135c000,0x40000005200,0x0
.quad 0x100000c0300,0x78800000588000,0x560000106000,0xc00001c10
.quad 0x10070000000409,0xc0600001004c0,0xc4c0000004c000,0x60000ac00
.quad 0x401880000000c4,0x28800000405880,0x6018807f000000,0x98800000641880
.quad 0xb8800000989000,0x140f0000140e000,0x3440000000300,0xc2b00000c02000
.quad 0x98500000984000,0x98700000986000,0x98100000980000,0x98300000982000
.quad 0xc000,0xb8020001408000,0x40000006200,0x0
.quad 0x100000c0380,0x7c8000005c8000,0x570000107000,0xe00001e10
.quad 0x10078000000609,0xc0700001004e0,0xc4e0000004c200,0x70000ae00
.quad 0x401c80000000e4,0x2c800000405c80,0x601c807f000000,0x9c800000641c80
.quad 0xbc8000009c9000,0x14bb000014ba000,0x35a0000000300,0xc2b00000c02000
.quad 0x9c5000009c4000,0x9c7000009c6000,0x9c1000009c0000,0x9c3000009c2000
.quad 0xc000,0xbc0200014b4000,0x40000007200,0x0
.quad 0x100000c0020,0x60a0000040a000,0x504000140000,0x1090
.quad 0x1804000000000a,0xc004000100500,0xc5000000050000,0xa080
.quad 0x4000a000000005,0x10a000004040a0,0x6000a07f000000,0x808080006400a0
.quad 0xa0a00000809080,0x100880001007800,0x37000000003c0,0xc35c0000c02800
.quad 0x80600000805000,0x80000000807000,0x80200000801000,0x80400000803000
.quad 0xf000,0xa0028001000000,0x50000000280,0x0
.quad 0x100000c00a0,0x64a0000044a000,0x514000141000,0x200001290
.quad 0x1804800000020a,0xc014000100520,0xc5200000050200,0x10000a280
.quad 0x4004a000000025,0x14a000004044a0,0x6004a07f000000,0x848080006404a0
.quad 0xa4a00000849080,0x10b4800010b3800,0x38600000003c0,0xc35c0000c02800
.quad 0x84600000845000,0x84000000847000,0x84200000841000,0x84400000843000
.quad 0xf000,0xa40280010ac000,0x50000001280,0x0
.quad 0x100000c0120,0x68a0000048a000,0x524000142000,0x400001490
.quad 0x1805000000040a,0xc024000100540,0xc5400000054000,0x20000a480
.quad 0x4008a000000045,0x18a000004048a0,0x6008a07f000000,0x888080006408a0
.quad 0xa8a00000889080,0x11608000115f800,0x39c00000003c0,0xc35c0000c02800
.quad 0x88600000885000,0x88000000887000,0x88200000881000,0x88400000883000
.quad 0xf000,0xa8028001158000,0x50000002280,0x0
.quad 0x100000c01a0,0x6ca000004ca000,0x534000143000,0x600001690
.quad 0x1805800000060a,0xc034000100560,0xc5600000054200,0x30000a680
.quad 0x400ca000000065,0x1ca00000404ca0,0x600ca07f000000,0x8c808000640ca0
.quad 0xaca000008c9080,0x120c8000120b800,0x3b200000003c0,0xc35c0000c02800
.quad 0x8c6000008c5000,0x8c0000008c7000,0x8c2000008c1000,0x8c4000008c3000
.quad 0xf000,0xac028001204000,0x50000003280,0x0
.quad 0x100000c0220,0x70a0000050a000,0x544000144000,0x800001890
.quad 0x1806000000000b,0xc044000100580,0xc5800000058000,0x40000a880
.quad 0x4010a000000085,0x20a000004050a0,0x6010a07f000000,0x908080006410a0
.quad 0xb0a00000909080,0x12b8800012b7800,0x3c800000003c0,0xc35c0000c02800
.quad 0x90600000905000,0x90000000907000,0x90200000901000,0x90400000903000
.quad 0xf000,0xb00280012b0000,0x50000004280,0x0
.quad 0x100000c02a0,0x74a0000054a000,0x554000145000,0xa00001a90
.quad 0x1806800000020b,0xc0540001005a0,0xc5a00000058200,0x50000aa80
.quad 0x4014a0000000a5,0x24a000004054a0,0x6014a07f000000,0x948080006414a0
.quad 0xb4a00000949080,0x136480001363800,0x3de00000003c0,0xc35c0000c02800
.quad 0x94600000945000,0x94000000947000,0x94200000941000,0x94400000943000
.quad 0xf000,0xb402800135c000,0x50000005280,0x0
.quad 0x100000c0320,0x78a0000058a000,0x564000146000,0xc00001c90
.quad 0x1807000000040b,0xc0640001005c0,0xc5c0000005c000,0x60000ac80
.quad 0x4018a0000000c5,0x28a000004058a0,0x6018a07f000000,0x988080006418a0
.quad 0xb8a00000989080,0x14108000140f800,0x3f400000003c0,0xc35c0000c02800
.quad 0x98600000985000,0x98000000987000,0x98200000981000,0x98400000983000
.quad 0xf000,0xb8028001408000,0x50000006280,0x0
.quad 0x100000c03a0,0x7ca000005ca000,0x574000147000,0xe00001e90
.quad 0x1807800000060b,0xc0740001005e0,0xc5e0000005c200,0x70000ae80
.quad 0x401ca0000000e5,0x2ca00000405ca0,0x601ca07f000000,0x9c808000641ca0
.quad 0xbca000009c9080,0x14bc800014bb800,0x40a00000003c0,0xc35c0000c02800
.quad 0x9c6000009c5000,0x9c0000009c7000,0x9c2000009c1000,0x9c4000009c3000
.quad 0xf000,0xbc0280014b4000,0x50000007280,0x0
.quad 0x100000c0040,0x60c0000040c000,0x508000180000,0x1110
.quad 0x2004000000000c,0xc008000100600,0xc6000000060000,0xa100
.quad 0x4000c000000006,0x10c000004040c0,0x6000c07f000000,0x808100006400c0
.quad 0xa0c00000809100,0x100a00001009000,0x4200000000480,0xc4080000c03000
.quad 0x80700000806000,0x80100000800000,0x80300000802000,0x80500000804000
.quad 0x12000,0xa0030001000000,0x60000000300,0x0
.quad 0x100000c00c0,0x64c0000044c000,0x518000181000,0x200001310
.quad 0x2004800000020c,0xc018000100620,0xc6200000060200,0x10000a300
.quad 0x4004c000000026,0x14c000004044c0,0x6004c07f000000,0x848100006404c0
.quad 0xa4c00000849100,0x10b6000010b5000,0x4360000000480,0xc4080000c03000
.quad 0x84700000846000,0x84100000840000,0x84300000842000,0x84500000844000
.quad 0x12000,0xa40300010ac000,0x60000001300,0x0
.quad 0x100000c0140,0x68c0000048c000,0x528000182000,0x400001510
.quad 0x2005000000040c,0xc028000100640,0xc6400000064000,0x20000a500
.quad 0x4008c000000046,0x18c000004048c0,0x6008c07f000000,0x888100006408c0
.quad 0xa8c00000889100,0x116200001161000,0x44c0000000480,0xc4080000c03000
.quad 0x88700000886000,0x88100000880000,0x88300000882000,0x88500000884000
.quad 0x12000,0xa8030001158000,0x60000002300,0x0
.quad 0x100000c01c0,0x6cc000004cc000,0x538000183000,0x600001710
.quad 0x2005800000060c,0xc038000100660,0xc6600000064200,0x30000a700
.quad 0x400cc000000066,0x1cc00000404cc0,0x600cc07f000000,0x8c810000640cc0
.quad 0xacc000008c9100,0x120e0000120d000,0x4620000000480,0xc4080000c03000
.quad 0x8c7000008c6000,0x8c1000008c0000,0x8c3000008c2000,0x8c5000008c4000
.quad 0x12000,0xac030001204000,0x60000003300,0x0
.quad 0x100000c0240,0x70c0000050c000,0x548000184000,0x800001910
.quad 0x2006000000000d,0xc048000100680,0xc6800000068000,0x40000a900
.quad 0x4010c000000086,0x20c000004050c0,0x6010c07f000000,0x908100006410c0
.quad 0xb0c00000909100,0x12ba000012b9000,0x4780000000480,0xc4080000c03000
.quad 0x90700000906000,0x90100000900000,0x90300000902000,0x90500000904000
.quad 0x12000,0xb00300012b0000,0x60000004300,0x0
.quad 0x100000c02c0,0x74c0000054c000,0x558000185000,0xa00001b10
.quad 0x2006800000020d,0xc0580001006a0,0xc6a00000068200,0x50000ab00
.quad 0x4014c0000000a6,0x24c000004054c0,0x6014c07f000000,0x948100006414c0
.quad 0xb4c00000949100,0x136600001365000,0x48e0000000480,0xc4080000c03000
.quad 0x94700000946000,0x94100000940000,0x94300000942000,0x94500000944000
.quad 0x12000,0xb403000135c000,0x60000005300,0x0
.quad 0x100000c0340,0x78c0000058c000,0x568000186000,0xc00001d10
.quad 0x2007000000040d,0xc0680001006c0,0xc6c0000006c000,0x60000ad00
.quad 0x4018c0000000c6,0x28c000004058c0,0x6018c07f000000,0x988100006418c0
.quad 0xb8c00000989100,0x141200001411000,0x4a40000000480,0xc4080000c03000
.quad 0x98700000986000,0x98100000980000,0x98300000982000,0x98500000984000
.quad 0x12000,0xb8030001408000,0x60000006300,0x0
.quad 0x100000c03c0,0x7cc000005cc000,0x578000187000,0xe00001f10
.quad 0x2007800000060d,0xc0780001006e0,0xc6e0000006c200,0x70000af00
.quad 0x401cc0000000e6,0x2cc00000405cc0,0x601cc07f000000,0x9c810000641cc0
.quad 0xbcc000009c9100,0x14be000014bd000,0x4ba0000000480,0xc4080000c03000
.quad 0x9c7000009c6000,0x9c1000009c0000,0x9c3000009c2000,0x9c5000009c4000
.quad 0x12000,0xbc0300014b4000,0x60000007300,0x0
.quad 0x100000c0060,0x60e0000040e000,0x50c0001c0000,0x1190
.quad 0x2804000000000e,0xc00c000100700,0xc7000000070000,0xa180
.quad 0x4000e000000007,0x10e000004040e0,0x6000e07f000000,0x808180006400e0
.quad 0xa0e00000809180,0x100b8000100a800,0x4d00000000540,0xc4b40000c03800
.quad 0x80000000807000,0x80200000801000,0x80400000803000,0x80600000805000
.quad 0x15000,0xa0038001000000,0x70000000380,0x0
.quad 0x100000c00e0,0x64e0000044e000,0x51c0001c1000,0x200001390
.quad 0x2804800000020e,0xc01c000100720,0xc7200000070200,0x10000a380
.quad 0x4004e000000027,0x14e000004044e0,0x6004e07f000000,0x848180006404e0
.quad 0xa4e00000849180,0x10b7800010b6800,0x4e60000000540,0xc4b40000c03800
.quad 0x84000000847000,0x84200000841000,0x84400000843000,0x84600000845000
.quad 0x15000,0xa40380010ac000,0x70000001380,0x0
.quad 0x100000c0160,0x68e0000048e000,0x52c0001c2000,0x400001590
.quad 0x2805000000040e,0xc02c000100740,0xc7400000074000,0x20000a580
.quad 0x4008e000000047,0x18e000004048e0,0x6008e07f000000,0x888180006408e0
.quad 0xa8e00000889180,0x116380001162800,0x4fc0000000540,0xc4b40000c03800
.quad 0x88000000887000,0x88200000881000,0x88400000883000,0x88600000885000
.quad 0x15000,0xa8038001158000,0x70000002380,0x0
.quad 0x100000c01e0,0x6ce000004ce000,0x53c0001c3000,0x600001790
.quad 0x2805800000060e,0xc03c000100760,0xc7600000074200,0x30000a780
.quad 0x400ce000000067,0x1ce00000404ce0,0x600ce07f000000,0x8c818000640ce0
.quad 0xace000008c9180,0x120f8000120e800,0x5120000000540,0xc4b40000c03800
.quad 0x8c0000008c7000,0x8c2000008c1000,0x8c4000008c3000,0x8c6000008c5000
.quad 0x15000,0xac038001204000,0x70000003380,0x0
.quad 0x100000c0260,0x70e0000050e000,0x54c0001c4000,0x800001990
.quad 0x2806000000000f,0xc04c000100780,0xc7800000078000,0x40000a980
.quad 0x4010e000000087,0x20e000004050e0,0x6010e07f000000,0x908180006410e0
.quad 0xb0e00000909180,0x12bb800012ba800,0x5280000000540,0xc4b40000c03800
.quad 0x90000000907000,0x90200000901000,0x90400000903000,0x90600000905000
.quad 0x15000,0xb00380012b0000,0x70000004380,0x0
.quad 0x100000c02e0,0x74e0000054e000,0x55c0001c5000,0xa00001b90
.quad 0x2806800000020f,0xc05c0001007a0,0xc7a00000078200,0x50000ab80
.quad 0x4014e0000000a7,0x24e000004054e0,0x6014e07f000000,0x948180006414e0
.quad 0xb4e00000949180,0x136780001366800,0x53e0000000540,0xc4b40000c03800
.quad 0x94000000947000,0x94200000941000,0x94400000943000,0x94600000945000
.quad 0x15000,0xb403800135c000,0x70000005380,0x0
.quad 0x100000c0360,0x78e0000058e000,0x56c0001c6000,0xc00001d90
.quad 0x2807000000040f,0xc06c0001007c0,0xc7c0000007c000,0x60000ad80
.quad 0x4018e0000000c7,0x28e000004058e0,0x6018e07f000000,0x988180006418e0
.quad 0xb8e00000989180,0x141380001412800,0x5540000000540,0xc4b40000c03800
.quad 0x98000000987000,0x98200000981000,0x98400000983000,0x98600000985000
.quad 0x15000,0xb8038001408000,0x70000006380,0x0
.quad 0x100000c03e0,0x7ce000005ce000,0x57c0001c7000,0xe00001f90
.quad 0x2807800000060f,0xc07c0001007e0,0xc7e0000007c200,0x70000af80
.quad 0x401ce0000000e7,0x2ce00000405ce0,0x601ce07f000000,0x9c818000641ce0
.quad 0xbce000009c9180,0x14bf800014be800,0x56a0000000540,0xc4b40000c03800
.quad 0x9c0000009c7000,0x9c2000009c1000,0x9c4000009c3000,0x9c6000009c5000
.quad 0x15000,0xbc0380014b4000,0x70000007380,0x0
.quad 0x20000180000,0x61000000410000,0x600000000400,0x2020
.quad 0x10080000000010,0x18000000100800,0xc8000000080000,0xc000
.quad 0x40010000000008,0x11000000404100,0x6001007f000000,0x81000000640100
.quad 0xa1000000811000,0x100d0000100c000,0x5800000000600,0xc5600000c00000
.quad 0x80100000800000,0x80300000802000,0x80500000804000,0x80700000806000
.quad 0x0,0xa100000102b000,0x400,0x0
.quad 0x20000180080,0x65000000450000,0x610000001400,0x200002220
.quad 0x10088000000210,0x18010000100820,0xc8200000080200,0x10000c200
.quad 0x40050000000028,0x15000000404500,0x6005007f000000,0x85000000640500
.quad 0xa5000000851000,0x10b9000010b8000,0x5960000000600,0xc5600000c00000
.quad 0x84100000840000,0x84300000842000,0x84500000844000,0x84700000846000
.quad 0x0,0xa50000010d7000,0x1400,0x0
.quad 0x20000180100,0x69000000490000,0x620000002400,0x400002420
.quad 0x10090000000410,0x18020000100840,0xc8400000084000,0x20000c400
.quad 0x40090000000048,0x19000000404900,0x6009007f000000,0x89000000640900
.quad 0xa9000000891000,0x116500001164000,0x5ac0000000600,0xc5600000c00000
.quad 0x88100000880000,0x88300000882000,0x88500000884000,0x88700000886000
.quad 0x0,0xa9000001183000,0x2400,0x0
.quad 0x20000180180,0x6d0000004d0000,0x630000003400,0x600002620
.quad 0x10098000000610,0x18030000100860,0xc8600000084200,0x30000c600
.quad 0x400d0000000068,0x1d000000404d00,0x600d007f000000,0x8d000000640d00
.quad 0xad0000008d1000,0x121100001210000,0x5c20000000600,0xc5600000c00000
.quad 0x8c1000008c0000,0x8c3000008c2000,0x8c5000008c4000,0x8c7000008c6000
.quad 0x0,0xad00000122f000,0x3400,0x0
.quad 0x20000180200,0x71000000510000,0x640000004400,0x800002820
.quad 0x100a0000000011,0x18040000100880,0xc8800000088000,0x40000c800
.quad 0x40110000000088,0x21000000405100,0x6011007f000000,0x91000000641100
.quad 0xb1000000911000,0x12bd000012bc000,0x5d80000000600,0xc5600000c00000
.quad 0x90100000900000,0x90300000902000,0x90500000904000,0x90700000906000
.quad 0x0,0xb10000012db000,0x4400,0x0
.quad 0x20000180280,0x75000000550000,0x650000005400,0xa00002a20
.quad 0x100a8000000211,0x180500001008a0,0xc8a00000088200,0x50000ca00
.quad 0x401500000000a8,0x25000000405500,0x6015007f000000,0x95000000641500
.quad 0xb5000000951000,0x136900001368000,0x5ee0000000600,0xc5600000c00000
.quad 0x94100000940000,0x94300000942000,0x94500000944000,0x94700000946000
.quad 0x0,0xb5000001387000,0x5400,0x0
.quad 0x20000180300,0x79000000590000,0x660000006400,0xc00002c20
.quad 0x100b0000000411,0x180600001008c0,0xc8c0000008c000,0x60000cc00
.quad 0x401900000000c8,0x29000000405900,0x6019007f000000,0x99000000641900
.quad 0xb9000000991000,0x141500001414000,0x6040000000600,0xc5600000c00000
.quad 0x98100000980000,0x98300000982000,0x98500000984000,0x98700000986000
.quad 0x0,0xb9000001433000,0x6400,0x0
.quad 0x20000180380,0x7d0000005d0000,0x670000007400,0xe00002e20
.quad 0x100b8000000611,0x180700001008e0,0xc8e0000008c200,0x70000ce00
.quad 0x401d00000000e8,0x2d000000405d00,0x601d007f000000,0x9d000000641d00
.quad 0xbd0000009d1000,0x14c1000014c0000,0x61a0000000600,0xc5600000c00000
.quad 0x9c1000009c0000,0x9c3000009c2000,0x9c5000009c4000,0x9c7000009c6000
.quad 0x0,0xbd0000014df000,0x7400,0x0
.quad 0x20000180020,0x61200000412000,0x604000040400,0x20a0
.quad 0x18080000000012,0x18004000100900,0xc9000000090000,0xc080
.quad 0x40012000000009,0x11200000404120,0x6001207f000000,0x81008000640120
.quad 0xa1200000811080,0x100e8000100d800,0x63000000006c0,0xc60c0000c00800
.quad 0x80200000801000,0x80400000803000,0x80600000805000,0x80000000807000
.quad 0x3000,0xa100800102b000,0x10000000480,0x0
.quad 0x200001800a0,0x65200000452000,0x614000041400,0x2000022a0
.quad 0x18088000000212,0x18014000100920,0xc9200000090200,0x10000c280
.quad 0x40052000000029,0x15200000404520,0x6005207f000000,0x85008000640520
.quad 0xa5200000851080,0x10ba800010b9800,0x64600000006c0,0xc60c0000c00800
.quad 0x84200000841000,0x84400000843000,0x84600000845000,0x84000000847000
.quad 0x3000,0xa50080010d7000,0x10000001480,0x0
.quad 0x20000180120,0x69200000492000,0x624000042400,0x4000024a0
.quad 0x18090000000412,0x18024000100940,0xc9400000094000,0x20000c480
.quad 0x40092000000049,0x19200000404920,0x6009207f000000,0x89008000640920
.quad 0xa9200000891080,0x116680001165800,0x65c00000006c0,0xc60c0000c00800
.quad 0x88200000881000,0x88400000883000,0x88600000885000,0x88000000887000
.quad 0x3000,0xa9008001183000,0x10000002480,0x0
.quad 0x200001801a0,0x6d2000004d2000,0x634000043400,0x6000026a0
.quad 0x18098000000612,0x18034000100960,0xc9600000094200,0x30000c680
.quad 0x400d2000000069,0x1d200000404d20,0x600d207f000000,0x8d008000640d20
.quad 0xad2000008d1080,0x121280001211800,0x67200000006c0,0xc60c0000c00800
.quad 0x8c2000008c1000,0x8c4000008c3000,0x8c6000008c5000,0x8c0000008c7000
.quad 0x3000,0xad00800122f000,0x10000003480,0x0
.quad 0x20000180220,0x71200000512000,0x644000044400,0x8000028a0
.quad 0x180a0000000013,0x18044000100980,0xc9800000098000,0x40000c880
.quad 0x40112000000089,0x21200000405120,0x6011207f000000,0x91008000641120
.quad 0xb1200000911080,0x12be800012bd800,0x68800000006c0,0xc60c0000c00800
.quad 0x90200000901000,0x90400000903000,0x90600000905000,0x90000000907000
.quad 0x3000,0xb10080012db000,0x10000004480,0x0
.quad 0x200001802a0,0x75200000552000,0x654000045400,0xa00002aa0
.quad 0x180a8000000213,0x180540001009a0,0xc9a00000098200,0x50000ca80
.quad 0x401520000000a9,0x25200000405520,0x6015207f000000,0x95008000641520
.quad 0xb5200000951080,0x136a80001369800,0x69e00000006c0,0xc60c0000c00800
.quad 0x94200000941000,0x94400000943000,0x94600000945000,0x94000000947000
.quad 0x3000,0xb5008001387000,0x10000005480,0x0
.quad 0x20000180320,0x79200000592000,0x664000046400,0xc00002ca0
.quad 0x180b0000000413,0x180640001009c0,0xc9c0000009c000,0x60000cc80
.quad 0x401920000000c9,0x29200000405920,0x6019207f000000,0x99008000641920
.quad 0xb9200000991080,0x141680001415800,0x6b400000006c0,0xc60c0000c00800
.quad 0x98200000981000,0x98400000983000,0x98600000985000,0x98000000987000
.quad 0x3000,0xb9008001433000,0x10000006480,0x0
.quad 0x200001803a0,0x7d2000005d2000,0x674000047400,0xe00002ea0
.quad 0x180b8000000613,0x180740001009e0,0xc9e0000009c200,0x70000ce80
.quad 0x401d20000000e9,0x2d200000405d20,0x601d207f000000,0x9d008000641d20
.quad 0xbd2000009d1080,0x14c2800014c1800,0x6ca00000006c0,0xc60c0000c00800
.quad 0x9c2000009c1000,0x9c4000009c3000,0x9c6000009c5000,0x9c0000009c7000
.quad 0x3000,0xbd0080014df000,0x10000007480,0x0
.quad 0x20000180040,0x61400000414000,0x608000080400,0x2120
.quad 0x20080000000014,0x18008000100a00,0xca0000000a0000,0xc100
.quad 0x4001400000000a,0x11400000404140,0x6001407f000000,0x81010000640140
.quad 0xa1400000811100,0x10100000100f000,0x6e00000000780,0xc6b80000c01000
.quad 0x80300000802000,0x80500000804000,0x80700000806000,0x80100000800000
.quad 0x6000,0xa101000102b000,0x20000000500,0x0
.quad 0x200001800c0,0x65400000454000,0x618000081400,0x200002320
.quad 0x20088000000214,0x18018000100a20,0xca2000000a0200,0x10000c300
.quad 0x4005400000002a,0x15400000404540,0x6005407f000000,0x85010000640540
.quad 0xa5400000851100,0x10bc000010bb000,0x6f60000000780,0xc6b80000c01000
.quad 0x84300000842000,0x84500000844000,0x84700000846000,0x84100000840000
.quad 0x6000,0xa50100010d7000,0x20000001500,0x0
.quad 0x20000180140,0x69400000494000,0x628000082400,0x400002520
.quad 0x20090000000414,0x18028000100a40,0xca4000000a4000,0x20000c500
.quad 0x4009400000004a,0x19400000404940,0x6009407f000000,0x89010000640940
.quad 0xa9400000891100,0x116800001167000,0x70c0000000780,0xc6b80000c01000
.quad 0x88300000882000,0x88500000884000,0x88700000886000,0x88100000880000
.quad 0x6000,0xa9010001183000,0x20000002500,0x0
.quad 0x200001801c0,0x6d4000004d4000,0x638000083400,0x600002720
.quad 0x20098000000614,0x18038000100a60,0xca6000000a4200,0x30000c700
.quad 0x400d400000006a,0x1d400000404d40,0x600d407f000000,0x8d010000640d40
.quad 0xad4000008d1100,0x121400001213000,0x7220000000780,0xc6b80000c01000
.quad 0x8c3000008c2000,0x8c5000008c4000,0x8c7000008c6000,0x8c1000008c0000
.quad 0x6000,0xad01000122f000,0x20000003500,0x0
.quad 0x20000180240,0x71400000514000,0x648000084400,0x800002920
.quad 0x200a0000000015,0x18048000100a80,0xca8000000a8000,0x40000c900
.quad 0x4011400000008a,0x21400000405140,0x6011407f000000,0x91010000641140
.quad 0xb1400000911100,0x12c0000012bf000,0x7380000000780,0xc6b80000c01000
.quad 0x90300000902000,0x90500000904000,0x90700000906000,0x90100000900000
.quad 0x6000,0xb10100012db000,0x20000004500,0x0
.quad 0x200001802c0,0x75400000554000,0x658000085400,0xa00002b20
.quad 0x200a8000000215,0x18058000100aa0,0xcaa000000a8200,0x50000cb00
.quad 0x401540000000aa,0x25400000405540,0x6015407f000000,0x95010000641540
.quad 0xb5400000951100,0x136c0000136b000,0x74e0000000780,0xc6b80000c01000
.quad 0x94300000942000,0x94500000944000,0x94700000946000,0x94100000940000
.quad 0x6000,0xb5010001387000,0x20000005500,0x0
.quad 0x20000180340,0x79400000594000,0x668000086400,0xc00002d20
.quad 0x200b0000000415,0x18068000100ac0,0xcac000000ac000,0x60000cd00
.quad 0x401940000000ca,0x29400000405940,0x6019407f000000,0x99010000641940
.quad 0xb9400000991100,0x141800001417000,0x7640000000780,0xc6b80000c01000
.quad 0x98300000982000,0x98500000984000,0x98700000986000,0x98100000980000
.quad 0x6000,0xb9010001433000,0x20000006500,0x0
.quad 0x200001803c0,0x7d4000005d4000,0x678000087400,0xe00002f20
.quad 0x200b8000000615,0x18078000100ae0,0xcae000000ac200,0x70000cf00
.quad 0x401d40000000ea,0x2d400000405d40,0x601d407f000000,0x9d010000641d40
.quad 0xbd4000009d1100,0x14c4000014c3000,0x77a0000000780,0xc6b80000c01000
.quad 0x9c3000009c2000,0x9c5000009c4000,0x9c7000009c6000,0x9c1000009c0000
.quad 0x6000,0xbd0100014df000,0x20000007500,0x0
.quad 0x20000180060,0x61600000416000,0x60c0000c0400,0x21a0
.quad 0x28080000000016,0x1800c000100b00,0xcb0000000b0000,0xc180
.quad 0x4001600000000b,0x11600000404160,0x6001607f000000,0x81018000640160
.quad 0xa1600000811180,0x7f00000001010800,0x7900000000840,0xc7640000c01800
.quad 0x80400000803000,0x80600000805000,0x80000000807000,0x80200000801000
.quad 0x100009000,0xa101800102b000,0x30000000580,0x0
.quad 0x200001800e0,0x65600000456000,0x61c0000c1400,0x2000023a0
.quad 0x28088000000216,0x1801c000100b20,0xcb2000000b0200,0x10000c380
.quad 0x4005600000002b,0x15600000404560,0x6005607f000000,0x85018000640560
.quad 0xa5600000851180,0x7f000000010bc800,0x7a60000000840,0xc7640000c01800
.quad 0x84400000843000,0x84600000845000,0x84000000847000,0x84200000841000
.quad 0x100009000,0xa50180010d7000,0x30000001580,0x0
.quad 0x20000180160,0x69600000496000,0x62c0000c2400,0x4000025a0
.quad 0x28090000000416,0x1802c000100b40,0xcb4000000b4000,0x20000c580
.quad 0x4009600000004b,0x19600000404960,0x6009607f000000,0x89018000640960
.quad 0xa9600000891180,0x7f00000001168800,0x7bc0000000840,0xc7640000c01800
.quad 0x88400000883000,0x88600000885000,0x88000000887000,0x88200000881000
.quad 0x100009000,0xa9018001183000,0x30000002580,0x0
.quad 0x200001801e0,0x6d6000004d6000,0x63c0000c3400,0x6000027a0
.quad 0x28098000000616,0x1803c000100b60,0xcb6000000b4200,0x30000c780
.quad 0x400d600000006b,0x1d600000404d60,0x600d607f000000,0x8d018000640d60
.quad 0xad6000008d1180,0x7f00000001214800,0x7d20000000840,0xc7640000c01800
.quad 0x8c4000008c3000,0x8c6000008c5000,0x8c0000008c7000,0x8c2000008c1000
.quad 0x100009000,0xad01800122f000,0x30000003580,0x0
.quad 0x20000180260,0x71600000516000,0x64c0000c4400,0x8000029a0
.quad 0x280a0000000017,0x1804c000100b80,0xcb8000000b8000,0x40000c980
.quad 0x4011600000008b,0x21600000405160,0x6011607f000000,0x91018000641160
.quad 0xb1600000911180,0x7f000000012c0800,0x7e80000000840,0xc7640000c01800
.quad 0x90400000903000,0x90600000905000,0x90000000907000,0x90200000901000
.quad 0x100009000,0xb10180012db000,0x30000004580,0x0
.quad 0x200001802e0,0x75600000556000,0x65c0000c5400,0xa00002ba0
.quad 0x280a8000000217,0x1805c000100ba0,0xcba000000b8200,0x50000cb80
.quad 0x401560000000ab,0x25600000405560,0x6015607f000000,0x95018000641560
.quad 0xb5600000951180,0x7f0000000136c800,0x7fe0000000840,0xc7640000c01800
.quad 0x94400000943000,0x94600000945000,0x94000000947000,0x94200000941000
.quad 0x100009000,0xb5018001387000,0x30000005580,0x0
.quad 0x20000180360,0x79600000596000,0x66c0000c6400,0xc00002da0
.quad 0x280b0000000417,0x1806c000100bc0,0xcbc000000bc000,0x60000cd80
.quad 0x401960000000cb,0x29600000405960,0x6019607f000000,0x99018000641960
.quad 0xb9600000991180,0x7f00000001418800,0x8140000000840,0xc7640000c01800
.quad 0x98400000983000,0x98600000985000,0x98000000987000,0x98200000981000
.quad 0x100009000,0xb9018001433000,0x30000006580,0x0
.quad 0x200001803e0,0x7d6000005d6000,0x67c0000c7400,0xe00002fa0
.quad 0x280b8000000617,0x1807c000100be0,0xcbe000000bc200,0x70000cf80
.quad 0x401d60000000eb,0x2d600000405d60,0x601d607f000000,0x9d018000641d60
.quad 0xbd6000009d1180,0x7f000000014c4800,0x82a0000000840,0xc7640000c01800
.quad 0x9c4000009c3000,0x9c6000009c5000,0x9c0000009c7000,0x9c2000009c1000
.quad 0x100009000,0xbd0180014df000,0x30000007580,0x0
.quad 0x30000240000,0x61800000418000,0x700000100400,0x3030
.quad 0x100c0000000018,0x24000000100c00,0xcc0000000c0000,0xe000
.quad 0x4001800000000c,0x11800000404180,0x6001807f000000,0x81800000640180
.quad 0xa1800000819000,0x7f00000001011800,0x84000000008c0,0xc8100000c02000
.quad 0x80500000804000,0x80700000806000,0x80100000800000,0x80300000802000
.quad 0x10000c000,0xa102000102b000,0x40000000600,0x0
.quad 0x30000240080,0x65800000458000,0x710000101400,0x200003230
.quad 0x100c8000000218,0x24010000100c20,0xcc2000000c0200,0x10000e200
.quad 0x4005800000002c,0x15800000404580,0x6005807f000000,0x85800000640580
.quad 0xa5800000859000,0x7f000000010bd800,0x85600000008c0,0xc8100000c02000
.quad 0x84500000844000,0x84700000846000,0x84100000840000,0x84300000842000
.quad 0x10000c000,0xa50200010d7000,0x40000001600,0x0
.quad 0x30000240100,0x69800000498000,0x720000102400,0x400003430
.quad 0x100d0000000418,0x24020000100c40,0xcc4000000c4000,0x20000e400
.quad 0x4009800000004c,0x19800000404980,0x6009807f000000,0x89800000640980
.quad 0xa9800000899000,0x7f00000001169800,0x86c00000008c0,0xc8100000c02000
.quad 0x88500000884000,0x88700000886000,0x88100000880000,0x88300000882000
.quad 0x10000c000,0xa9020001183000,0x40000002600,0x0
.quad 0x30000240180,0x6d8000004d8000,0x730000103400,0x600003630
.quad 0x100d8000000618,0x24030000100c60,0xcc6000000c4200,0x30000e600
.quad 0x400d800000006c,0x1d800000404d80,0x600d807f000000,0x8d800000640d80
.quad 0xad8000008d9000,0x7f00000001215800,0x88200000008c0,0xc8100000c02000
.quad 0x8c5000008c4000,0x8c7000008c6000,0x8c1000008c0000,0x8c3000008c2000
.quad 0x10000c000,0xad02000122f000,0x40000003600,0x0
.quad 0x30000240200,0x71800000518000,0x740000104400,0x800003830
.quad 0x100e0000000019,0x24040000100c80,0xcc8000000c8000,0x40000e800
.quad 0x4011800000008c,0x21800000405180,0x6011807f000000,0x91800000641180
.quad 0xb1800000919000,0x7f000000012c1800,0x89800000008c0,0xc8100000c02000
.quad 0x90500000904000,0x90700000906000,0x90100000900000,0x90300000902000
.quad 0x10000c000,0xb10200012db000,0x40000004600,0x0
.quad 0x30000240280,0x75800000558000,0x750000105400,0xa00003a30
.quad 0x100e8000000219,0x24050000100ca0,0xcca000000c8200,0x50000ea00
.quad 0x401580000000ac,0x25800000405580,0x6015807f000000,0x95800000641580
.quad 0xb5800000959000,0x7f0000000136d800,0x8ae00000008c0,0xc8100000c02000
.quad 0x94500000944000,0x94700000946000,0x94100000940000,0x94300000942000
.quad 0x10000c000,0xb5020001387000,0x40000005600,0x0
.quad 0x30000240300,0x79800000598000,0x760000106400,0xc00003c30
.quad 0x100f0000000419,0x24060000100cc0,0xccc000000cc000,0x60000ec00
.quad 0x401980000000cc,0x29800000405980,0x6019807f000000,0x99800000641980
.quad 0xb9800000999000,0x7f00000001419800,0x8c400000008c0,0xc8100000c02000
.quad 0x98500000984000,0x98700000986000,0x98100000980000,0x98300000982000
.quad 0x10000c000,0xb9020001433000,0x40000006600,0x0
.quad 0x30000240380,0x7d8000005d8000,0x770000107400,0xe00003e30
.quad 0x100f8000000619,0x24070000100ce0,0xcce000000cc200,0x70000ee00
.quad 0x401d80000000ec,0x2d800000405d80,0x601d807f000000,0x9d800000641d80
.quad 0xbd8000009d9000,0x7f000000014c5800,0x8da00000008c0,0xc8100000c02000
.quad 0x9c5000009c4000,0x9c7000009c6000,0x9c1000009c0000,0x9c3000009c2000
.quad 0x10000c000,0xbd0200014df000,0x40000007600,0x0
.quad 0x30000240020,0x61a0000041a000,0x704000140400,0x30b0
.quad 0x180c000000001a,0x24004000100d00,0xcd0000000d0000,0xe080
.quad 0x4001a00000000d,0x11a000004041a0,0x6001a07f000000,0x818080006401a0
.quad 0xa1a00000819080,0x7f00000001012800,0x8f00000000940,0xc8bc0000c02800
.quad 0x80600000805000,0x80000000807000,0x80200000801000,0x80400000803000
.quad 0x10000f000,0xa102800102b000,0x50000000680,0x0
.quad 0x300002400a0,0x65a0000045a000,0x714000141400,0x2000032b0
.quad 0x180c800000021a,0x24014000100d20,0xcd2000000d0200,0x10000e280
.quad 0x4005a00000002d,0x15a000004045a0,0x6005a07f000000,0x858080006405a0
.quad 0xa5a00000859080,0x7f000000010be800,0x9060000000940,0xc8bc0000c02800
.quad 0x84600000845000,0x84000000847000,0x84200000841000,0x84400000843000
.quad 0x10000f000,0xa50280010d7000,0x50000001680,0x0
.quad 0x30000240120,0x69a0000049a000,0x724000142400,0x4000034b0
.quad 0x180d000000041a,0x24024000100d40,0xcd4000000d4000,0x20000e480
.quad 0x4009a00000004d,0x19a000004049a0,0x6009a07f000000,0x898080006409a0
.quad 0xa9a00000899080,0x7f0000000116a800,0x91c0000000940,0xc8bc0000c02800
.quad 0x88600000885000,0x88000000887000,0x88200000881000,0x88400000883000
.quad 0x10000f000,0xa9028001183000,0x50000002680,0x0
.quad 0x300002401a0,0x6da000004da000,0x734000143400,0x6000036b0
.quad 0x180d800000061a,0x24034000100d60,0xcd6000000d4200,0x30000e680
.quad 0x400da00000006d,0x1da00000404da0,0x600da07f000000,0x8d808000640da0
.quad 0xada000008d9080,0x7f00000001216800,0x9320000000940,0xc8bc0000c02800
.quad 0x8c6000008c5000,0x8c0000008c7000,0x8c2000008c1000,0x8c4000008c3000
.quad 0x10000f000,0xad02800122f000,0x50000003680,0x0
.quad 0x30000240220,0x71a0000051a000,0x744000144400,0x8000038b0
.quad 0x180e000000001b,0x24044000100d80,0xcd8000000d8000,0x40000e880
.quad 0x4011a00000008d,0x21a000004051a0,0x6011a07f000000,0x918080006411a0
.quad 0xb1a00000919080,0x7f000000012c2800,0x9480000000940,0xc8bc0000c02800
.quad 0x90600000905000,0x90000000907000,0x90200000901000,0x90400000903000
.quad 0x10000f000,0xb10280012db000,0x50000004680,0x0
.quad 0x300002402a0,0x75a0000055a000,0x754000145400,0xa00003ab0
.quad 0x180e800000021b,0x24054000100da0,0xcda000000d8200,0x50000ea80
.quad 0x4015a0000000ad,0x25a000004055a0,0x6015a07f000000,0x958080006415a0
.quad 0xb5a00000959080,0x7f0000000136e800,0x95e0000000940,0xc8bc0000c02800
.quad 0x94600000945000,0x94000000947000,0x94200000941000,0x94400000943000
.quad 0x10000f000,0xb5028001387000,0x50000005680,0x0
.quad 0x30000240320,0x79a0000059a000,0x764000146400,0xc00003cb0
.quad 0x180f000000041b,0x24064000100dc0,0xcdc000000dc000,0x60000ec80
.quad 0x4019a0000000cd,0x29a000004059a0,0x6019a07f000000,0x998080006419a0
.quad 0xb9a00000999080,0x7f0000000141a800,0x9740000000940,0xc8bc0000c02800
.quad 0x98600000985000,0x98000000987000,0x98200000981000,0x98400000983000
.quad 0x10000f000,0xb9028001433000,0x50000006680,0x0
.quad 0x300002403a0,0x7da000005da000,0x774000147400,0xe00003eb0
.quad 0x180f800000061b,0x24074000100de0,0xcde000000dc200,0x70000ee80
.quad 0x401da0000000ed,0x2da00000405da0,0x601da07f000000,0x9d808000641da0
.quad 0xbda000009d9080,0x7f000000014c6800,0x98a0000000940,0xc8bc0000c02800
.quad 0x9c6000009c5000,0x9c0000009c7000,0x9c2000009c1000,0x9c4000009c3000
.quad 0x10000f000,0xbd0280014df000,0x50000007680,0x0
.quad 0x30000240040,0x61c0000041c000,0x708000180400,0x3130
.quad 0x200c000000001c,0x24008000100e00,0xce0000000e0000,0xe100
.quad 0x4001c00000000e,0x11c000004041c0,0x6001c07f000000,0x818100006401c0
.quad 0xa1c00000819100,0x7f00000001013800,0x9a000000009c0,0xc9680000c03000
.quad 0x80700000806000,0x80100000800000,0x80300000802000,0x80500000804000
.quad 0x100012000,0xa103000102b000,0x60000000700,0x0
.quad 0x300002400c0,0x65c0000045c000,0x718000181400,0x200003330
.quad 0x200c800000021c,0x24018000100e20,0xce2000000e0200,0x10000e300
.quad 0x4005c00000002e,0x15c000004045c0,0x6005c07f000000,0x858100006405c0
.quad 0xa5c00000859100,0x7f000000010bf800,0x9b600000009c0,0xc9680000c03000
.quad 0x84700000846000,0x84100000840000,0x84300000842000,0x84500000844000
.quad 0x100012000,0xa50300010d7000,0x60000001700,0x0
.quad 0x30000240140,0x69c0000049c000,0x728000182400,0x400003530
.quad 0x200d000000041c,0x24028000100e40,0xce4000000e4000,0x20000e500
.quad 0x4009c00000004e,0x19c000004049c0,0x6009c07f000000,0x898100006409c0
.quad 0xa9c00000899100,0x7f0000000116b800,0x9cc00000009c0,0xc9680000c03000
.quad 0x88700000886000,0x88100000880000,0x88300000882000,0x88500000884000
.quad 0x100012000,0xa9030001183000,0x60000002700,0x0
.quad 0x300002401c0,0x6dc000004dc000,0x738000183400,0x600003730
.quad 0x200d800000061c,0x24038000100e60,0xce6000000e4200,0x30000e700
.quad 0x400dc00000006e,0x1dc00000404dc0,0x600dc07f000000,0x8d810000640dc0
.quad 0xadc000008d9100,0x7f00000001217800,0x9e200000009c0,0xc9680000c03000
.quad 0x8c7000008c6000,0x8c1000008c0000,0x8c3000008c2000,0x8c5000008c4000
.quad 0x100012000,0xad03000122f000,0x60000003700,0x0
.quad 0x30000240240,0x71c0000051c000,0x748000184400,0x800003930
.quad 0x200e000000001d,0x24048000100e80,0xce8000000e8000,0x40000e900
.quad 0x4011c00000008e,0x21c000004051c0,0x6011c07f000000,0x918100006411c0
.quad 0xb1c00000919100,0x7f000000012c3800,0x9f800000009c0,0xc9680000c03000
.quad 0x90700000906000,0x90100000900000,0x90300000902000,0x90500000904000
.quad 0x100012000,0xb10300012db000,0x60000004700,0x0
.quad 0x300002402c0,0x75c0000055c000,0x758000185400,0xa00003b30
.quad 0x200e800000021d,0x24058000100ea0,0xcea000000e8200,0x50000eb00
.quad 0x4015c0000000ae,0x25c000004055c0,0x6015c07f000000,0x958100006415c0
.quad 0xb5c00000959100,0x7f0000000136f800,0xa0e00000009c0,0xc9680000c03000
.quad 0x94700000946000,0x94100000940000,0x94300000942000,0x94500000944000
.quad 0x100012000,0xb5030001387000,0x60000005700,0x0
.quad 0x30000240340,0x79c0000059c000,0x768000186400,0xc00003d30
.quad 0x200f000000041d,0x24068000100ec0,0xcec000000ec000,0x60000ed00
.quad 0x4019c0000000ce,0x29c000004059c0,0x6019c07f000000,0x998100006419c0
.quad 0xb9c00000999100,0x7f0000000141b800,0xa2400000009c0,0xc9680000c03000
.quad 0x98700000986000,0x98100000980000,0x98300000982000,0x98500000984000
.quad 0x100012000,0xb9030001433000,0x60000006700,0x0
.quad 0x300002403c0,0x7dc000005dc000,0x778000187400,0xe00003f30
.quad 0x200f800000061d,0x24078000100ee0,0xcee000000ec200,0x70000ef00
.quad 0x401dc0000000ee,0x2dc00000405dc0,0x601dc07f000000,0x9d810000641dc0
.quad 0xbdc000009d9100,0x7f000000014c7800,0xa3a00000009c0,0xc9680000c03000
.quad 0x9c7000009c6000,0x9c1000009c0000,0x9c3000009c2000,0x9c5000009c4000
.quad 0x100012000,0xbd0300014df000,0x60000007700,0x0
.quad 0x30000240060,0x61e0000041e000,0x70c0001c0400,0x31b0
.quad 0x280c000000001e,0x2400c000100f00,0xcf0000000f0000,0xe180
.quad 0x4001e00000000f,0x11e000004041e0,0x6001e07f000000,0x818180006401e0
.quad 0xa1e00000819180,0x7f00000001014800,0xa500000000a40,0xca140000c03800
.quad 0x80000000807000,0x80200000801000,0x80400000803000,0x80600000805000
.quad 0x100015000,0xa103800102b000,0x70000000780,0x0
.quad 0x300002400e0,0x65e0000045e000,0x71c0001c1400,0x2000033b0
.quad 0x280c800000021e,0x2401c000100f20,0xcf2000000f0200,0x10000e380
.quad 0x4005e00000002f,0x15e000004045e0,0x6005e07f000000,0x858180006405e0
.quad 0xa5e00000859180,0x7f000000010c0800,0xa660000000a40,0xca140000c03800
.quad 0x84000000847000,0x84200000841000,0x84400000843000,0x84600000845000
.quad 0x100015000,0xa50380010d7000,0x70000001780,0x0
.quad 0x30000240160,0x69e0000049e000,0x72c0001c2400,0x4000035b0
.quad 0x280d000000041e,0x2402c000100f40,0xcf4000000f4000,0x20000e580
.quad 0x4009e00000004f,0x19e000004049e0,0x6009e07f000000,0x898180006409e0
.quad 0xa9e00000899180,0x7f0000000116c800,0xa7c0000000a40,0xca140000c03800
.quad 0x88000000887000,0x88200000881000,0x88400000883000,0x88600000885000
.quad 0x100015000,0xa9038001183000,0x70000002780,0x0
.quad 0x300002401e0,0x6de000004de000,0x73c0001c3400,0x6000037b0
.quad 0x280d800000061e,0x2403c000100f60,0xcf6000000f4200,0x30000e780
.quad 0x400de00000006f,0x1de00000404de0,0x600de07f000000,0x8d818000640de0
.quad 0xade000008d9180,0x7f00000001218800,0xa920000000a40,0xca140000c03800
.quad 0x8c0000008c7000,0x8c2000008c1000,0x8c4000008c3000,0x8c6000008c5000
.quad 0x100015000,0xad03800122f000,0x70000003780,0x0
.quad 0x30000240260,0x71e0000051e000,0x74c0001c4400,0x8000039b0
.quad 0x280e000000001f,0x2404c000100f80,0xcf8000000f8000,0x40000e980
.quad 0x4011e00000008f,0x21e000004051e0,0x6011e07f000000,0x918180006411e0
.quad 0xb1e00000919180,0x7f000000012c4800,0xaa80000000a40,0xca140000c03800
.quad 0x90000000907000,0x90200000901000,0x90400000903000,0x90600000905000
.quad 0x100015000,0xb10380012db000,0x70000004780,0x0
.quad 0x300002402e0,0x75e0000055e000,0x75c0001c5400,0xa00003bb0
.quad 0x280e800000021f,0x2405c000100fa0,0xcfa000000f8200,0x50000eb80
.quad 0x4015e0000000af,0x25e000004055e0,0x6015e07f000000,0x958180006415e0
.quad 0xb5e00000959180,0x7f00000001370800,0xabe0000000a40,0xca140000c03800
.quad 0x94000000947000,0x94200000941000,0x94400000943000,0x94600000945000
.quad 0x100015000,0xb5038001387000,0x70000005780,0x0
.quad 0x30000240360,0x79e0000059e000,0x76c0001c6400,0xc00003db0
.quad 0x280f000000041f,0x2406c000100fc0,0xcfc000000fc000,0x60000ed80
.quad 0x4019e0000000cf,0x29e000004059e0,0x6019e07f000000,0x998180006419e0
.quad 0xb9e00000999180,0x7f0000000141c800,0xad40000000a40,0xca140000c03800
.quad 0x98000000987000,0x98200000981000,0x98400000983000,0x98600000985000
.quad 0x100015000,0xb9038001433000,0x70000006780,0x0
.quad 0x300002403e0,0x7de000005de000,0x77c0001c7400,0xe00003fb0
.quad 0x280f800000061f,0x2407c000100fe0,0xcfe000000fc200,0x70000ef80
.quad 0x401de0000000ef,0x2de00000405de0,0x601de07f000000,0x9d818000641de0
.quad 0xbde000009d9180,0x7f000000014c8800,0xaea0000000a40,0xca140000c03800
.quad 0x9c0000009c7000,0x9c2000009c1000,0x9c4000009c3000,0x9c6000009c5000
.quad 0x100015000,0xbd0380014df000,0x70000007780,0x0
.quad 0x400,0x62000000420000,0x480000000800,0x4040
.quad 0x10100000000020,0x80000101000,0xd0000000100000,0x9000
.quad 0x40020000000010,0x12000000404200,0x6002007f000000,0x82000000640200
.quad 0xa2000000821000,0x105700001056000,0xb000000000000,0xcac00000c00000
.quad 0x82100000820000,0x82300000822000,0x82500000824000,0x82700000826000
.quad 0x0,0xa2000001056000,0x800,0x0
.quad 0x480,0x66000000460000,0x490000001800,0x200004240
.quad 0x10108000000220,0x90000101020,0xd0200000100200,0x100009200
.quad 0x40060000000030,0x16000000404600,0x6006007f000000,0x86000000640600
.quad 0xa6000000861000,0x110300001102000,0xb160000000000,0xcac00000c00000
.quad 0x86100000860000,0x86300000862000,0x86500000864000,0x86700000866000
.quad 0x0,0xa6000001102000,0x1800,0x0
.quad 0x500,0x6a0000004a0000,0x4a0000002800,0x400004440
.quad 0x10110000000420,0xa0000101040,0xd0400000104000,0x200009400
.quad 0x400a0000000050,0x1a000000404a00,0x600a007f000000,0x8a000000640a00
.quad 0xaa0000008a1000,0x11af000011ae000,0xb2c0000000000,0xcac00000c00000
.quad 0x8a1000008a0000,0x8a3000008a2000,0x8a5000008a4000,0x8a7000008a6000
.quad 0x0,0xaa0000011ae000,0x2800,0x0
.quad 0x580,0x6e0000004e0000,0x4b0000003800,0x600004640
.quad 0x10118000000620,0xb0000101060,0xd0600000104200,0x300009600
.quad 0x400e0000000070,0x1e000000404e00,0x600e007f000000,0x8e000000640e00
.quad 0xae0000008e1000,0x125b0000125a000,0xb420000000000,0xcac00000c00000
.quad 0x8e1000008e0000,0x8e3000008e2000,0x8e5000008e4000,0x8e7000008e6000
.quad 0x0,0xae00000125a000,0x3800,0x0
.quad 0x600,0x72000000520000,0x4c0000004800,0x800004840
.quad 0x10120000000021,0xc0000101080,0xd0800000108000,0x400009800
.quad 0x40120000000090,0x22000000405200,0x6012007f000000,0x92000000641200
.quad 0xb2000000921000,0x130700001306000,0xb580000000000,0xcac00000c00000
.quad 0x92100000920000,0x92300000922000,0x92500000924000,0x92700000926000
.quad 0x0,0xb2000001306000,0x4800,0x0
.quad 0x680,0x76000000560000,0x4d0000005800,0xa00004a40
.quad 0x10128000000221,0xd00001010a0,0xd0a00000108200,0x500009a00
.quad 0x401600000000b0,0x26000000405600,0x6016007f000000,0x96000000641600
.quad 0xb6000000961000,0x13b3000013b2000,0xb6e0000000000,0xcac00000c00000
.quad 0x96100000960000,0x96300000962000,0x96500000964000,0x96700000966000
.quad 0x0,0xb60000013b2000,0x5800,0x0
.quad 0x700,0x7a0000005a0000,0x4e0000006800,0xc00004c40
.quad 0x10130000000421,0xe00001010c0,0xd0c0000010c000,0x600009c00
.quad 0x401a00000000d0,0x2a000000405a00,0x601a007f000000,0x9a000000641a00
.quad 0xba0000009a1000,0x145f0000145e000,0xb840000000000,0xcac00000c00000
.quad 0x9a1000009a0000,0x9a3000009a2000,0x9a5000009a4000,0x9a7000009a6000
.quad 0x0,0xba00000145e000,0x6800,0x0
.quad 0x780,0x7e0000005e0000,0x4f0000007800,0xe00004e40
.quad 0x10138000000621,0xf00001010e0,0xd0e0000010c200,0x700009e00
.quad 0x401e00000000f0,0x2e000000405e00,0x601e007f000000,0x9e000000641e00
.quad 0xbe0000009e1000,0x150b0000150a000,0xb9a0000000000,0xcac00000c00000
.quad 0x9e1000009e0000,0x9e3000009e2000,0x9e5000009e4000,0x9e7000009e6000
.quad 0x0,0xbe00000150a000,0x7800,0x0
.quad 0x420,0x62200000422000,0x484000040800,0x40c0
.quad 0x18100000000022,0x84000101100,0xd1000000110000,0x9080
.quad 0x40022000000011,0x12200000404220,0x6002207f000000,0x82008000640220
.quad 0xa2200000821080,0x105880001057800,0xbb000000000c0,0xcb6c0000c00800
.quad 0x82200000821000,0x82400000823000,0x82600000825000,0x82000000827000
.quad 0x3000,0xa2008001056000,0x10000000880,0x0
.quad 0x4a0,0x66200000462000,0x494000041800,0x2000042c0
.quad 0x18108000000222,0x94000101120,0xd1200000110200,0x100009280
.quad 0x40062000000031,0x16200000404620,0x6006207f000000,0x86008000640620
.quad 0xa6200000861080,0x110480001103800,0xbc600000000c0,0xcb6c0000c00800
.quad 0x86200000861000,0x86400000863000,0x86600000865000,0x86000000867000
.quad 0x3000,0xa6008001102000,0x10000001880,0x0
.quad 0x520,0x6a2000004a2000,0x4a4000042800,0x4000044c0
.quad 0x18110000000422,0xa4000101140,0xd1400000114000,0x200009480
.quad 0x400a2000000051,0x1a200000404a20,0x600a207f000000,0x8a008000640a20
.quad 0xaa2000008a1080,0x11b0800011af800,0xbdc00000000c0,0xcb6c0000c00800
.quad 0x8a2000008a1000,0x8a4000008a3000,0x8a6000008a5000,0x8a0000008a7000
.quad 0x3000,0xaa0080011ae000,0x10000002880,0x0
.quad 0x5a0,0x6e2000004e2000,0x4b4000043800,0x6000046c0
.quad 0x18118000000622,0xb4000101160,0xd1600000114200,0x300009680
.quad 0x400e2000000071,0x1e200000404e20,0x600e207f000000,0x8e008000640e20
.quad 0xae2000008e1080,0x125c8000125b800,0xbf200000000c0,0xcb6c0000c00800
.quad 0x8e2000008e1000,0x8e4000008e3000,0x8e6000008e5000,0x8e0000008e7000
.quad 0x3000,0xae00800125a000,0x10000003880,0x0
.quad 0x620,0x72200000522000,0x4c4000044800,0x8000048c0
.quad 0x18120000000023,0xc4000101180,0xd1800000118000,0x400009880
.quad 0x40122000000091,0x22200000405220,0x6012207f000000,0x92008000641220
.quad 0xb2200000921080,0x130880001307800,0xc0800000000c0,0xcb6c0000c00800
.quad 0x92200000921000,0x92400000923000,0x92600000925000,0x92000000927000
.quad 0x3000,0xb2008001306000,0x10000004880,0x0
.quad 0x6a0,0x76200000562000,0x4d4000045800,0xa00004ac0
.quad 0x18128000000223,0xd40001011a0,0xd1a00000118200,0x500009a80
.quad 0x401620000000b1,0x26200000405620,0x6016207f000000,0x96008000641620
.quad 0xb6200000961080,0x13b4800013b3800,0xc1e00000000c0,0xcb6c0000c00800
.quad 0x96200000961000,0x96400000963000,0x96600000965000,0x96000000967000
.quad 0x3000,0xb60080013b2000,0x10000005880,0x0
.quad 0x720,0x7a2000005a2000,0x4e4000046800,0xc00004cc0
.quad 0x18130000000423,0xe40001011c0,0xd1c0000011c000,0x600009c80
.quad 0x401a20000000d1,0x2a200000405a20,0x601a207f000000,0x9a008000641a20
.quad 0xba2000009a1080,0x14608000145f800,0xc3400000000c0,0xcb6c0000c00800
.quad 0x9a2000009a1000,0x9a4000009a3000,0x9a6000009a5000,0x9a0000009a7000
.quad 0x3000,0xba00800145e000,0x10000006880,0x0
.quad 0x7a0,0x7e2000005e2000,0x4f4000047800,0xe00004ec0
.quad 0x18138000000623,0xf40001011e0,0xd1e0000011c200,0x700009e80
.quad 0x401e20000000f1,0x2e200000405e20,0x601e207f000000,0x9e008000641e20
.quad 0xbe2000009e1080,0x150c8000150b800,0xc4a00000000c0,0xcb6c0000c00800
.quad 0x9e2000009e1000,0x9e4000009e3000,0x9e6000009e5000,0x9e0000009e7000
.quad 0x3000,0xbe00800150a000,0x10000007880,0x0
.quad 0x440,0x62400000424000,0x488000080800,0x4140
.quad 0x20100000000024,0x88000101200,0xd2000000120000,0x9100
.quad 0x40024000000012,0x12400000404240,0x6002407f000000,0x82010000640240
.quad 0xa2400000821100,0x105a00001059000,0xc600000000180,0xcc180000c01000
.quad 0x82300000822000,0x82500000824000,0x82700000826000,0x82100000820000
.quad 0x6000,0xa2010001056000,0x20000000900,0x0
.quad 0x4c0,0x66400000464000,0x498000081800,0x200004340
.quad 0x20108000000224,0x98000101220,0xd2200000120200,0x100009300
.quad 0x40064000000032,0x16400000404640,0x6006407f000000,0x86010000640640
.quad 0xa6400000861100,0x110600001105000,0xc760000000180,0xcc180000c01000
.quad 0x86300000862000,0x86500000864000,0x86700000866000,0x86100000860000
.quad 0x6000,0xa6010001102000,0x20000001900,0x0
.quad 0x540,0x6a4000004a4000,0x4a8000082800,0x400004540
.quad 0x20110000000424,0xa8000101240,0xd2400000124000,0x200009500
.quad 0x400a4000000052,0x1a400000404a40,0x600a407f000000,0x8a010000640a40
.quad 0xaa4000008a1100,0x11b2000011b1000,0xc8c0000000180,0xcc180000c01000
.quad 0x8a3000008a2000,0x8a5000008a4000,0x8a7000008a6000,0x8a1000008a0000
.quad 0x6000,0xaa0100011ae000,0x20000002900,0x0
.quad 0x5c0,0x6e4000004e4000,0x4b8000083800,0x600004740
.quad 0x20118000000624,0xb8000101260,0xd2600000124200,0x300009700
.quad 0x400e4000000072,0x1e400000404e40,0x600e407f000000,0x8e010000640e40
.quad 0xae4000008e1100,0x125e0000125d000,0xca20000000180,0xcc180000c01000
.quad 0x8e3000008e2000,0x8e5000008e4000,0x8e7000008e6000,0x8e1000008e0000
.quad 0x6000,0xae01000125a000,0x20000003900,0x0
.quad 0x640,0x72400000524000,0x4c8000084800,0x800004940
.quad 0x20120000000025,0xc8000101280,0xd2800000128000,0x400009900
.quad 0x40124000000092,0x22400000405240,0x6012407f000000,0x92010000641240
.quad 0xb2400000921100,0x130a00001309000,0xcb80000000180,0xcc180000c01000
.quad 0x92300000922000,0x92500000924000,0x92700000926000,0x92100000920000
.quad 0x6000,0xb2010001306000,0x20000004900,0x0
.quad 0x6c0,0x76400000564000,0x4d8000085800,0xa00004b40
.quad 0x20128000000225,0xd80001012a0,0xd2a00000128200,0x500009b00
.quad 0x401640000000b2,0x26400000405640,0x6016407f000000,0x96010000641640
.quad 0xb6400000961100,0x13b6000013b5000,0xcce0000000180,0xcc180000c01000
.quad 0x96300000962000,0x96500000964000,0x96700000966000,0x96100000960000
.quad 0x6000,0xb60100013b2000,0x20000005900,0x0
.quad 0x740,0x7a4000005a4000,0x4e8000086800,0xc00004d40
.quad 0x20130000000425,0xe80001012c0,0xd2c0000012c000,0x600009d00
.quad 0x401a40000000d2,0x2a400000405a40,0x601a407f000000,0x9a010000641a40
.quad 0xba4000009a1100,0x146200001461000,0xce40000000180,0xcc180000c01000
.quad 0x9a3000009a2000,0x9a5000009a4000,0x9a7000009a6000,0x9a1000009a0000
.quad 0x6000,0xba01000145e000,0x20000006900,0x0
.quad 0x7c0,0x7e4000005e4000,0x4f8000087800,0xe00004f40
.quad 0x20138000000625,0xf80001012e0,0xd2e0000012c200,0x700009f00
.quad 0x401e40000000f2,0x2e400000405e40,0x601e407f000000,0x9e010000641e40
.quad 0xbe4000009e1100,0x150e0000150d000,0xcfa0000000180,0xcc180000c01000
.quad 0x9e3000009e2000,0x9e5000009e4000,0x9e7000009e6000,0x9e1000009e0000
.quad 0x6000,0xbe01000150a000,0x20000007900,0x0
.quad 0x460,0x62600000426000,0x48c0000c0800,0x41c0
.quad 0x28100000000026,0x8c000101300,0xd3000000130000,0x9180
.quad 0x40026000000013,0x12600000404260,0x6002607f000000,0x82018000640260
.quad 0xa2600000821180,0x105b8000105a800,0xd100000000240,0xccc40000c01800
.quad 0x82400000823000,0x82600000825000,0x82000000827000,0x82200000821000
.quad 0x9000,0xa2018001056000,0x30000000980,0x0
.quad 0x4e0,0x66600000466000,0x49c0000c1800,0x2000043c0
.quad 0x28108000000226,0x9c000101320,0xd3200000130200,0x100009380
.quad 0x40066000000033,0x16600000404660,0x6006607f000000,0x86018000640660
.quad 0xa6600000861180,0x110780001106800,0xd260000000240,0xccc40000c01800
.quad 0x86400000863000,0x86600000865000,0x86000000867000,0x86200000861000
.quad 0x9000,0xa6018001102000,0x30000001980,0x0
.quad 0x560,0x6a6000004a6000,0x4ac0000c2800,0x4000045c0
.quad 0x28110000000426,0xac000101340,0xd3400000134000,0x200009580
.quad 0x400a6000000053,0x1a600000404a60,0x600a607f000000,0x8a018000640a60
.quad 0xaa6000008a1180,0x11b3800011b2800,0xd3c0000000240,0xccc40000c01800
.quad 0x8a4000008a3000,0x8a6000008a5000,0x8a0000008a7000,0x8a2000008a1000
.quad 0x9000,0xaa0180011ae000,0x30000002980,0x0
.quad 0x5e0,0x6e6000004e6000,0x4bc0000c3800,0x6000047c0
.quad 0x28118000000626,0xbc000101360,0xd3600000134200,0x300009780
.quad 0x400e6000000073,0x1e600000404e60,0x600e607f000000,0x8e018000640e60
.quad 0xae6000008e1180,0x125f8000125e800,0xd520000000240,0xccc40000c01800
.quad 0x8e4000008e3000,0x8e6000008e5000,0x8e0000008e7000,0x8e2000008e1000
.quad 0x9000,0xae01800125a000,0x30000003980,0x0
.quad 0x660,0x72600000526000,0x4cc0000c4800,0x8000049c0
.quad 0x28120000000027,0xcc000101380,0xd3800000138000,0x400009980
.quad 0x40126000000093,0x22600000405260,0x6012607f000000,0x92018000641260
.quad 0xb2600000921180,0x130b8000130a800,0xd680000000240,0xccc40000c01800
.quad 0x92400000923000,0x92600000925000,0x92000000927000,0x92200000921000
.quad 0x9000,0xb2018001306000,0x30000004980,0x0
.quad 0x6e0,0x76600000566000,0x4dc0000c5800,0xa00004bc0
.quad 0x28128000000227,0xdc0001013a0,0xd3a00000138200,0x500009b80
.quad 0x401660000000b3,0x26600000405660,0x6016607f000000,0x96018000641660
.quad 0xb6600000961180,0x13b7800013b6800,0xd7e0000000240,0xccc40000c01800
.quad 0x96400000963000,0x96600000965000,0x96000000967000,0x96200000961000
.quad 0x9000,0xb60180013b2000,0x30000005980,0x0
.quad 0x760,0x7a6000005a6000,0x4ec0000c6800,0xc00004dc0
.quad 0x28130000000427,0xec0001013c0,0xd3c0000013c000,0x600009d80
.quad 0x401a60000000d3,0x2a600000405a60,0x601a607f000000,0x9a018000641a60
.quad 0xba6000009a1180,0x146380001462800,0xd940000000240,0xccc40000c01800
.quad 0x9a4000009a3000,0x9a6000009a5000,0x9a0000009a7000,0x9a2000009a1000
.quad 0x9000,0xba01800145e000,0x30000006980,0x0
.quad 0x7e0,0x7e6000005e6000,0x4fc0000c7800,0xe00004fc0
.quad 0x28138000000627,0xfc0001013e0,0xd3e0000013c200,0x700009f80
.quad 0x401e60000000f3,0x2e600000405e60,0x601e607f000000,0x9e018000641e60
.quad 0xbe6000009e1180,0x150f8000150e800,0xdaa0000000240,0xccc40000c01800
.quad 0x9e4000009e3000,0x9e6000009e5000,0x9e0000009e7000,0x9e2000009e1000
.quad 0x9000,0xbe01800150a000,0x30000007980,0x0
.quad 0x100000c0400,0x62800000428000,0x580000100800,0x5050
.quad 0x10140000000028,0xc080000101400,0xd4000000140000,0xb000
.quad 0x40028000000014,0x12800000404280,0x6002807f000000,0x82800000640280
.quad 0xa2800000829000,0x105d0000105c000,0xdc00000000300,0xcd700000c02000
.quad 0x82500000824000,0x82700000826000,0x82100000820000,0x82300000822000
.quad 0xc000,0xa2020001056000,0x40000000a00,0x0
.quad 0x100000c0480,0x66800000468000,0x590000101800,0x200005250
.quad 0x10148000000228,0xc090000101420,0xd4200000140200,0x10000b200
.quad 0x40068000000034,0x16800000404680,0x6006807f000000,0x86800000640680
.quad 0xa6800000869000,0x110900001108000,0xdd60000000300,0xcd700000c02000
.quad 0x86500000864000,0x86700000866000,0x86100000860000,0x86300000862000
.quad 0xc000,0xa6020001102000,0x40000001a00,0x0
.quad 0x100000c0500,0x6a8000004a8000,0x5a0000102800,0x400005450
.quad 0x10150000000428,0xc0a0000101440,0xd4400000144000,0x20000b400
.quad 0x400a8000000054,0x1a800000404a80,0x600a807f000000,0x8a800000640a80
.quad 0xaa8000008a9000,0x11b5000011b4000,0xdec0000000300,0xcd700000c02000
.quad 0x8a5000008a4000,0x8a7000008a6000,0x8a1000008a0000,0x8a3000008a2000
.quad 0xc000,0xaa0200011ae000,0x40000002a00,0x0
.quad 0x100000c0580,0x6e8000004e8000,0x5b0000103800,0x600005650
.quad 0x10158000000628,0xc0b0000101460,0xd4600000144200,0x30000b600
.quad 0x400e8000000074,0x1e800000404e80,0x600e807f000000,0x8e800000640e80
.quad 0xae8000008e9000,0x126100001260000,0xe020000000300,0xcd700000c02000
.quad 0x8e5000008e4000,0x8e7000008e6000,0x8e1000008e0000,0x8e3000008e2000
.quad 0xc000,0xae02000125a000,0x40000003a00,0x0
.quad 0x100000c0600,0x72800000528000,0x5c0000104800,0x800005850
.quad 0x10160000000029,0xc0c0000101480,0xd4800000148000,0x40000b800
.quad 0x40128000000094,0x22800000405280,0x6012807f000000,0x92800000641280
.quad 0xb2800000929000,0x130d0000130c000,0xe180000000300,0xcd700000c02000
.quad 0x92500000924000,0x92700000926000,0x92100000920000,0x92300000922000
.quad 0xc000,0xb2020001306000,0x40000004a00,0x0
.quad 0x100000c0680,0x76800000568000,0x5d0000105800,0xa00005a50
.quad 0x10168000000229,0xc0d00001014a0,0xd4a00000148200,0x50000ba00
.quad 0x401680000000b4,0x26800000405680,0x6016807f000000,0x96800000641680
.quad 0xb6800000969000,0x13b9000013b8000,0xe2e0000000300,0xcd700000c02000
.quad 0x96500000964000,0x96700000966000,0x96100000960000,0x96300000962000
.quad 0xc000,0xb60200013b2000,0x40000005a00,0x0
.quad 0x100000c0700,0x7a8000005a8000,0x5e0000106800,0xc00005c50
.quad 0x10170000000429,0xc0e00001014c0,0xd4c0000014c000,0x60000bc00
.quad 0x401a80000000d4,0x2a800000405a80,0x601a807f000000,0x9a800000641a80
.quad 0xba8000009a9000,0x146500001464000,0xe440000000300,0xcd700000c02000
.quad 0x9a5000009a4000,0x9a7000009a6000,0x9a1000009a0000,0x9a3000009a2000
.quad 0xc000,0xba02000145e000,0x40000006a00,0x0
.quad 0x100000c0780,0x7e8000005e8000,0x5f0000107800,0xe00005e50
.quad 0x10178000000629,0xc0f00001014e0,0xd4e0000014c200,0x70000be00
.quad 0x401e80000000f4,0x2e800000405e80,0x601e807f000000,0x9e800000641e80
.quad 0xbe8000009e9000,0x151100001510000,0xe5a0000000300,0xcd700000c02000
.quad 0x9e5000009e4000,0x9e7000009e6000,0x9e1000009e0000,0x9e3000009e2000
.quad 0xc000,0xbe02000150a000,0x40000007a00,0x0
.quad 0x100000c0420,0x62a0000042a000,0x584000140800,0x50d0
.quad 0x1814000000002a,0xc084000101500,0xd5000000150000,0xb080
.quad 0x4002a000000015,0x12a000004042a0,0x6002a07f000000,0x828080006402a0
.quad 0xa2a00000829080,0x105e8000105d800,0xe7000000003c0,0xce1c0000c02800
.quad 0x82600000825000,0x82000000827000,0x82200000821000,0x82400000823000
.quad 0xf000,0xa2028001056000,0x50000000a80,0x0
.quad 0x100000c04a0,0x66a0000046a000,0x594000141800,0x2000052d0
.quad 0x1814800000022a,0xc094000101520,0xd5200000150200,0x10000b280
.quad 0x4006a000000035,0x16a000004046a0,0x6006a07f000000,0x868080006406a0
.quad 0xa6a00000869080,0x110a80001109800,0xe8600000003c0,0xce1c0000c02800
.quad 0x86600000865000,0x86000000867000,0x86200000861000,0x86400000863000
.quad 0xf000,0xa6028001102000,0x50000001a80,0x0
.quad 0x100000c0520,0x6aa000004aa000,0x5a4000142800,0x4000054d0
.quad 0x1815000000042a,0xc0a4000101540,0xd5400000154000,0x20000b480
.quad 0x400aa000000055,0x1aa00000404aa0,0x600aa07f000000,0x8a808000640aa0
.quad 0xaaa000008a9080,0x11b6800011b5800,0xe9c00000003c0,0xce1c0000c02800
.quad 0x8a6000008a5000,0x8a0000008a7000,0x8a2000008a1000,0x8a4000008a3000
.quad 0xf000,0xaa0280011ae000,0x50000002a80,0x0
.quad 0x100000c05a0,0x6ea000004ea000,0x5b4000143800,0x6000056d0
.quad 0x1815800000062a,0xc0b4000101560,0xd5600000154200,0x30000b680
.quad 0x400ea000000075,0x1ea00000404ea0,0x600ea07f000000,0x8e808000640ea0
.quad 0xaea000008e9080,0x126280001261800,0xeb200000003c0,0xce1c0000c02800
.quad 0x8e6000008e5000,0x8e0000008e7000,0x8e2000008e1000,0x8e4000008e3000
.quad 0xf000,0xae02800125a000,0x50000003a80,0x0
.quad 0x100000c0620,0x72a0000052a000,0x5c4000144800,0x8000058d0
.quad 0x1816000000002b,0xc0c4000101580,0x7f00000000158000,0x40000b880
.quad 0x4012a000000095,0x22a000004052a0,0x6012a07f000000,0x928080006412a0
.quad 0xb2a00000929080,0x130e8000130d800,0xec800000003c0,0xce1c0000c02800
.quad 0x92600000925000,0x92000000927000,0x92200000921000,0x92400000923000
.quad 0xf000,0xb2028001306000,0x50000004a80,0x0
.quad 0x100000c06a0,0x76a0000056a000,0x5d4000145800,0xa00005ad0
.quad 0x1816800000022b,0xc0d40001015a0,0x7f00000000158200,0x50000ba80
.quad 0x4016a0000000b5,0x26a000004056a0,0x6016a07f000000,0x968080006416a0
.quad 0xb6a00000969080,0x13ba800013b9800,0xede00000003c0,0xce1c0000c02800
.quad 0x96600000965000,0x96000000967000,0x96200000961000,0x96400000963000
.quad 0xf000,0xb60280013b2000,0x50000005a80,0x0
.quad 0x100000c0720,0x7aa000005aa000,0x5e4000146800,0xc00005cd0
.quad 0x1817000000042b,0xc0e40001015c0,0x7f0000000015c000,0x60000bc80
.quad 0x401aa0000000d5,0x2aa00000405aa0,0x601aa07f000000,0x9a808000641aa0
.quad 0xbaa000009a9080,0x146680001465800,0xef400000003c0,0xce1c0000c02800
.quad 0x9a6000009a5000,0x9a0000009a7000,0x9a2000009a1000,0x9a4000009a3000
.quad 0xf000,0xba02800145e000,0x50000006a80,0x0
.quad 0x100000c07a0,0x7ea000005ea000,0x5f4000147800,0xe00005ed0
.quad 0x1817800000062b,0xc0f40001015e0,0x7f0000000015c200,0x70000be80
.quad 0x401ea0000000f5,0x2ea00000405ea0,0x601ea07f000000,0x9e808000641ea0
.quad 0xbea000009e9080,0x151280001511800,0xf0a00000003c0,0xce1c0000c02800
.quad 0x9e6000009e5000,0x9e0000009e7000,0x9e2000009e1000,0x9e4000009e3000
.quad 0xf000,0xbe02800150a000,0x50000007a80,0x0
.quad 0x100000c0440,0x62c0000042c000,0x588000180800,0x5150
.quad 0x2014000000002c,0xc088000101600,0x7f00000000160000,0xb100
.quad 0x4002c000000016,0x12c000004042c0,0x6002c07f000000,0x828100006402c0
.quad 0xa2c00000829100,0x10600000105f000,0xf200000000480,0xcec80000c03000
.quad 0x82700000826000,0x82100000820000,0x82300000822000,0x82500000824000
.quad 0x12000,0xa2030001056000,0x60000000b00,0x0
.quad 0x100000c04c0,0x66c0000046c000,0x598000181800,0x200005350
.quad 0x2014800000022c,0xc098000101620,0x7f00000000160200,0x10000b300
.quad 0x4006c000000036,0x16c000004046c0,0x6006c07f000000,0x868100006406c0
.quad 0xa6c00000869100,0x110c0000110b000,0xf360000000480,0xcec80000c03000
.quad 0x86700000866000,0x86100000860000,0x86300000862000,0x86500000864000
.quad 0x12000,0xa6030001102000,0x60000001b00,0x0
.quad 0x100000c0540,0x6ac000004ac000,0x5a8000182800,0x400005550
.quad 0x2015000000042c,0xc0a8000101640,0x7f00000000164000,0x20000b500
.quad 0x400ac000000056,0x1ac00000404ac0,0x600ac07f000000,0x8a810000640ac0
.quad 0xaac000008a9100,0x11b8000011b7000,0xf4c0000000480,0xcec80000c03000
.quad 0x8a7000008a6000,0x8a1000008a0000,0x8a3000008a2000,0x8a5000008a4000
.quad 0x12000,0xaa0300011ae000,0x60000002b00,0x0
.quad 0x100000c05c0,0x6ec000004ec000,0x5b8000183800,0x600005750
.quad 0x2015800000062c,0xc0b8000101660,0x7f00000000164200,0x30000b700
.quad 0x400ec000000076,0x1ec00000404ec0,0x600ec07f000000,0x8e810000640ec0
.quad 0xaec000008e9100,0x126400001263000,0xf620000000480,0xcec80000c03000
.quad 0x8e7000008e6000,0x8e1000008e0000,0x8e3000008e2000,0x8e5000008e4000
.quad 0x12000,0xae03000125a000,0x60000003b00,0x0
.quad 0x100000c0640,0x72c0000052c000,0x5c8000184800,0x800005950
.quad 0x2016000000002d,0xc0c8000101680,0x7f00000000168000,0x40000b900
.quad 0x4012c000000096,0x22c000004052c0,0x6012c07f000000,0x928100006412c0
.quad 0xb2c00000929100,0x13100000130f000,0xf780000000480,0xcec80000c03000
.quad 0x92700000926000,0x92100000920000,0x92300000922000,0x92500000924000
.quad 0x12000,0xb2030001306000,0x60000004b00,0x0
.quad 0x100000c06c0,0x76c0000056c000,0x5d8000185800,0xa00005b50
.quad 0x2016800000022d,0xc0d80001016a0,0x7f00000000168200,0x50000bb00
.quad 0x4016c0000000b6,0x26c000004056c0,0x6016c07f000000,0x968100006416c0
.quad 0xb6c00000969100,0x13bc000013bb000,0xf8e0000000480,0xcec80000c03000
.quad 0x96700000966000,0x96100000960000,0x96300000962000,0x96500000964000
.quad 0x12000,0xb60300013b2000,0x60000005b00,0x0
.quad 0x100000c0740,0x7ac000005ac000,0x5e8000186800,0xc00005d50
.quad 0x2017000000042d,0xc0e80001016c0,0x7f0000000016c000,0x60000bd00
.quad 0x401ac0000000d6,0x2ac00000405ac0,0x601ac07f000000,0x9a810000641ac0
.quad 0xbac000009a9100,0x146800001467000,0xfa40000000480,0xcec80000c03000
.quad 0x9a7000009a6000,0x9a1000009a0000,0x9a3000009a2000,0x9a5000009a4000
.quad 0x12000,0xba03000145e000,0x60000006b00,0x0
.quad 0x100000c07c0,0x7ec000005ec000,0x5f8000187800,0xe00005f50
.quad 0x2017800000062d,0xc0f80001016e0,0x7f0000000016c200,0x70000bf00
.quad 0x401ec0000000f6,0x2ec00000405ec0,0x601ec07f000000,0x9e810000641ec0
.quad 0xbec000009e9100,0x151400001513000,0xfba0000000480,0xcec80000c03000
.quad 0x9e7000009e6000,0x9e1000009e0000,0x9e3000009e2000,0x9e5000009e4000
.quad 0x12000,0xbe03000150a000,0x60000007b00,0x0
.quad 0x100000c0460,0x62e0000042e000,0x58c0001c0800,0x51d0
.quad 0x2814000000002e,0xc08c000101700,0x7f00000000170000,0xb180
.quad 0x4002e000000017,0x12e000004042e0,0x6002e07f000000,0x828180006402e0
.quad 0xa2e00000829180,0x106180001060800,0xfd00000000540,0xcf740000c03800
.quad 0x82000000827000,0x82200000821000,0x82400000823000,0x82600000825000
.quad 0x15000,0xa2038001056000,0x70000000b80,0x0
.quad 0x100000c04e0,0x66e0000046e000,0x59c0001c1800,0x2000053d0
.quad 0x2814800000022e,0xc09c000101720,0x7f00000000170200,0x10000b380
.quad 0x4006e000000037,0x16e000004046e0,0x6006e07f000000,0x868180006406e0
.quad 0xa6e00000869180,0x110d8000110c800,0xfe60000000540,0xcf740000c03800
.quad 0x86000000867000,0x86200000861000,0x86400000863000,0x86600000865000
.quad 0x15000,0xa6038001102000,0x70000001b80,0x0
.quad 0x100000c0560,0x6ae000004ae000,0x5ac0001c2800,0x4000055d0
.quad 0x2815000000042e,0xc0ac000101740,0x7f00000000174000,0x20000b580
.quad 0x400ae000000057,0x1ae00000404ae0,0x600ae07f000000,0x8a818000640ae0
.quad 0xaae000008a9180,0x11b9800011b8800,0xffc0000000540,0xcf740000c03800
.quad 0x8a0000008a7000,0x8a2000008a1000,0x8a4000008a3000,0x8a6000008a5000
.quad 0x15000,0xaa0380011ae000,0x70000002b80,0x0
.quad 0x100000c05e0,0x6ee000004ee000,0x5bc0001c3800,0x6000057d0
.quad 0x2815800000062e,0xc0bc000101760,0x7f00000000174200,0x30000b780
.quad 0x400ee000000077,0x1ee00000404ee0,0x600ee07f000000,0x8e818000640ee0
.quad 0xaee000008e9180,0x126580001264800,0x10120000000540,0xcf740000c03800
.quad 0x8e0000008e7000,0x8e2000008e1000,0x8e4000008e3000,0x8e6000008e5000
.quad 0x15000,0xae03800125a000,0x70000003b80,0x0
.quad 0x100000c0660,0x72e0000052e000,0x5cc0001c4800,0x8000059d0
.quad 0x2816000000002f,0xc0cc000101780,0x7f00000000178000,0x40000b980
.quad 0x4012e000000097,0x22e000004052e0,0x6012e07f000000,0x928180006412e0
.quad 0xb2e00000929180,0x131180001310800,0x10280000000540,0xcf740000c03800
.quad 0x92000000927000,0x92200000921000,0x92400000923000,0x92600000925000
.quad 0x15000,0xb2038001306000,0x70000004b80,0x0
.quad 0x100000c06e0,0x76e0000056e000,0x5dc0001c5800,0xa00005bd0
.quad 0x2816800000022f,0xc0dc0001017a0,0x7f00000000178200,0x50000bb80
.quad 0x4016e0000000b7,0x26e000004056e0,0x6016e07f000000,0x968180006416e0
.quad 0xb6e00000969180,0x13bd800013bc800,0x103e0000000540,0xcf740000c03800
.quad 0x96000000967000,0x96200000961000,0x96400000963000,0x96600000965000
.quad 0x15000,0xb60380013b2000,0x70000005b80,0x0
.quad 0x100000c0760,0x7ae000005ae000,0x5ec0001c6800,0xc00005dd0
.quad 0x2817000000042f,0xc0ec0001017c0,0x7f0000000017c000,0x60000bd80
.quad 0x401ae0000000d7,0x2ae00000405ae0,0x601ae07f000000,0x9a818000641ae0
.quad 0xbae000009a9180,0x146980001468800,0x10540000000540,0xcf740000c03800
.quad 0x9a0000009a7000,0x9a2000009a1000,0x9a4000009a3000,0x9a6000009a5000
.quad 0x15000,0xba03800145e000,0x70000006b80,0x0
.quad 0x100000c07e0,0x7ee000005ee000,0x5fc0001c7800,0xe00005fd0
.quad 0x2817800000062f,0xc0fc0001017e0,0x7f0000000017c200,0x70000bf80
.quad 0x401ee0000000f7,0x2ee00000405ee0,0x601ee07f000000,0x9e818000641ee0
.quad 0xbee000009e9180,0x151580001514800,0x106a0000000540,0xcf740000c03800
.quad 0x9e0000009e7000,0x9e2000009e1000,0x9e4000009e3000,0x9e6000009e5000
.quad 0x15000,0xbe03800150a000,0x70000007b80,0x0
.quad 0x20000180400,0x63000000430000,0x680000000c00,0x6060
.quad 0x10180000000030,0x18080000101800,0x7f00000000180000,0xd000
.quad 0x40030000000018,0x13000000404300,0x6003007f000000,0x83000000640300
.quad 0xa3000000831000,0x106300001062000,0x10800000000600,0xd0200000c00000
.quad 0x82100000820000,0x82300000822000,0x82500000824000,0x82700000826000
.quad 0x0,0xa3000001081000,0xc00,0x0
.quad 0x20000180480,0x67000000470000,0x690000001c00,0x200006260
.quad 0x10188000000230,0x18090000101820,0x7f00000000180200,0x10000d200
.quad 0x40070000000038,0x17000000404700,0x6007007f000000,0x87000000640700
.quad 0xa7000000871000,0x110f0000110e000,0x10960000000600,0xd0200000c00000
.quad 0x86100000860000,0x86300000862000,0x86500000864000,0x86700000866000
.quad 0x0,0xa700000112d000,0x1c00,0x0
.quad 0x20000180500,0x6b0000004b0000,0x6a0000002c00,0x400006460
.quad 0x10190000000430,0x180a0000101840,0x7f00000000184000,0x20000d400
.quad 0x400b0000000058,0x1b000000404b00,0x600b007f000000,0x8b000000640b00
.quad 0xab0000008b1000,0x11bb000011ba000,0x10ac0000000600,0xd0200000c00000
.quad 0x8a1000008a0000,0x8a3000008a2000,0x8a5000008a4000,0x8a7000008a6000
.quad 0x0,0xab0000011d9000,0x2c00,0x0
.quad 0x20000180580,0x6f0000004f0000,0x6b0000003c00,0x600006660
.quad 0x10198000000630,0x180b0000101860,0x7f00000000184200,0x30000d600
.quad 0x400f0000000078,0x1f000000404f00,0x600f007f000000,0x8f000000640f00
.quad 0xaf0000008f1000,0x126700001266000,0x10c20000000600,0xd0200000c00000
.quad 0x8e1000008e0000,0x8e3000008e2000,0x8e5000008e4000,0x8e7000008e6000
.quad 0x0,0xaf000001285000,0x3c00,0x0
.quad 0x20000180600,0x73000000530000,0x6c0000004c00,0x800006860
.quad 0x101a0000000031,0x180c0000101880,0x7f00000000188000,0x40000d800
.quad 0x40130000000098,0x23000000405300,0x6013007f000000,0x93000000641300
.quad 0xb3000000931000,0x131300001312000,0x10d80000000600,0xd0200000c00000
.quad 0x92100000920000,0x92300000922000,0x92500000924000,0x92700000926000
.quad 0x0,0xb3000001331000,0x4c00,0x0
.quad 0x20000180680,0x77000000570000,0x6d0000005c00,0xa00006a60
.quad 0x101a8000000231,0x180d00001018a0,0x7f00000000188200,0x50000da00
.quad 0x401700000000b8,0x27000000405700,0x6017007f000000,0x97000000641700
.quad 0xb7000000971000,0x13bf000013be000,0x10ee0000000600,0xd0200000c00000
.quad 0x96100000960000,0x96300000962000,0x96500000964000,0x96700000966000
.quad 0x0,0xb70000013dd000,0x5c00,0x0
.quad 0x20000180700,0x7b0000005b0000,0x6e0000006c00,0xc00006c60
.quad 0x101b0000000431,0x180e00001018c0,0x7f0000000018c000,0x60000dc00
.quad 0x401b00000000d8,0x2b000000405b00,0x601b007f000000,0x9b000000641b00
.quad 0xbb0000009b1000,0x146b0000146a000,0x11040000000600,0xd0200000c00000
.quad 0x9a1000009a0000,0x9a3000009a2000,0x9a5000009a4000,0x9a7000009a6000
.quad 0x0,0xbb000001489000,0x6c00,0x0
.quad 0x20000180780,0x7f0000005f0000,0x6f0000007c00,0xe00006e60
.quad 0x101b8000000631,0x180f00001018e0,0x7f0000000018c200,0x70000de00
.quad 0x401f00000000f8,0x2f000000405f00,0x601f007f000000,0x9f000000641f00
.quad 0xbf0000009f1000,0x151700001516000,0x111a0000000600,0xd0200000c00000
.quad 0x9e1000009e0000,0x9e3000009e2000,0x9e5000009e4000,0x9e7000009e6000
.quad 0x0,0xbf000001535000,0x7c00,0x0
.quad 0x20000180420,0x63200000432000,0x684000040c00,0x60e0
.quad 0x18180000000032,0x18084000101900,0x7f00000000190000,0xd080
.quad 0x40032000000019,0x13200000404320,0x6003207f000000,0x83008000640320
.quad 0xa3200000831080,0x106480001063800,0x113000000006c0,0xd0cc0000c00800
.quad 0x82200000821000,0x82400000823000,0x82600000825000,0x82000000827000
.quad 0x3000,0xa3008001081000,0x10000000c80,0x0
.quad 0x200001804a0,0x67200000472000,0x694000041c00,0x2000062e0
.quad 0x18188000000232,0x18094000101920,0x7f00000000190200,0x10000d280
.quad 0x40072000000039,0x17200000404720,0x6007207f000000,0x87008000640720
.quad 0xa7200000871080,0x11108000110f800,0x114600000006c0,0xd0cc0000c00800
.quad 0x86200000861000,0x86400000863000,0x86600000865000,0x86000000867000
.quad 0x3000,0xa700800112d000,0x10000001c80,0x0
.quad 0x20000180520,0x6b2000004b2000,0x6a4000042c00,0x4000064e0
.quad 0x18190000000432,0x180a4000101940,0x7f00000000194000,0x20000d480
.quad 0x400b2000000059,0x1b200000404b20,0x600b207f000000,0x8b008000640b20
.quad 0xab2000008b1080,0x11bc800011bb800,0x115c00000006c0,0xd0cc0000c00800
.quad 0x8a2000008a1000,0x8a4000008a3000,0x8a6000008a5000,0x8a0000008a7000
.quad 0x3000,0xab0080011d9000,0x10000002c80,0x0
.quad 0x200001805a0,0x6f2000004f2000,0x6b4000043c00,0x6000066e0
.quad 0x18198000000632,0x180b4000101960,0x7f00000000194200,0x30000d680
.quad 0x400f2000000079,0x1f200000404f20,0x600f207f000000,0x8f008000640f20
.quad 0xaf2000008f1080,0x126880001267800,0x117200000006c0,0xd0cc0000c00800
.quad 0x8e2000008e1000,0x8e4000008e3000,0x8e6000008e5000,0x8e0000008e7000
.quad 0x3000,0xaf008001285000,0x10000003c80,0x0
.quad 0x20000180620,0x73200000532000,0x6c4000044c00,0x8000068e0
.quad 0x181a0000000033,0x180c4000101980,0x7f00000000198000,0x40000d880
.quad 0x40132000000099,0x23200000405320,0x6013207f000000,0x93008000641320
.quad 0xb3200000931080,0x131480001313800,0x118800000006c0,0xd0cc0000c00800
.quad 0x92200000921000,0x92400000923000,0x92600000925000,0x92000000927000
.quad 0x3000,0xb3008001331000,0x10000004c80,0x0
.quad 0x200001806a0,0x77200000572000,0x6d4000045c00,0xa00006ae0
.quad 0x181a8000000233,0x180d40001019a0,0x7f00000000198200,0x50000da80
.quad 0x401720000000b9,0x27200000405720,0x6017207f000000,0x97008000641720
.quad 0xb7200000971080,0x13c0800013bf800,0x119e00000006c0,0xd0cc0000c00800
.quad 0x96200000961000,0x96400000963000,0x96600000965000,0x96000000967000
.quad 0x3000,0xb70080013dd000,0x10000005c80,0x0
.quad 0x20000180720,0x7b2000005b2000,0x6e4000046c00,0xc00006ce0
.quad 0x181b0000000433,0x180e40001019c0,0x7f0000000019c000,0x60000dc80
.quad 0x401b20000000d9,0x2b200000405b20,0x601b207f000000,0x9b008000641b20
.quad 0xbb2000009b1080,0x146c8000146b800,0x11b400000006c0,0xd0cc0000c00800
.quad 0x9a2000009a1000,0x9a4000009a3000,0x9a6000009a5000,0x9a0000009a7000
.quad 0x3000,0xbb008001489000,0x10000006c80,0x0
.quad 0x200001807a0,0x7f2000005f2000,0x6f4000047c00,0xe00006ee0
.quad 0x181b8000000633,0x180f40001019e0,0x7f0000000019c200,0x70000de80
.quad 0x401f20000000f9,0x2f200000405f20,0x601f207f000000,0x9f008000641f20
.quad 0xbf2000009f1080,0x151880001517800,0x11ca00000006c0,0xd0cc0000c00800
.quad 0x9e2000009e1000,0x9e4000009e3000,0x9e6000009e5000,0x9e0000009e7000
.quad 0x3000,0xbf008001535000,0x10000007c80,0x0
.quad 0x20000180440,0x63400000434000,0x688000080c00,0x6160
.quad 0x20180000000034,0x18088000101a00,0x7f000000001a0000,0xd100
.quad 0x4003400000001a,0x13400000404340,0x6003407f000000,0x83010000640340
.quad 0xa3400000831100,0x106600001065000,0x11e00000000780,0xd1780000c01000
.quad 0x82300000822000,0x82500000824000,0x82700000826000,0x82100000820000
.quad 0x6000,0xa3010001081000,0x20000000d00,0x0
.quad 0x200001804c0,0x67400000474000,0x698000081c00,0x200006360
.quad 0x20188000000234,0x18098000101a20,0x7f000000001a0200,0x10000d300
.quad 0x4007400000003a,0x17400000404740,0x6007407f000000,0x87010000640740
.quad 0xa7400000871100,0x111200001111000,0x11f60000000780,0xd1780000c01000
.quad 0x86300000862000,0x86500000864000,0x86700000866000,0x86100000860000
.quad 0x6000,0xa701000112d000,0x20000001d00,0x0
.quad 0x20000180540,0x6b4000004b4000,0x6a8000082c00,0x400006560
.quad 0x20190000000434,0x180a8000101a40,0x7f000000001a4000,0x20000d500
.quad 0x400b400000005a,0x1b400000404b40,0x600b407f000000,0x8b010000640b40
.quad 0xab4000008b1100,0x11be000011bd000,0x120c0000000780,0xd1780000c01000
.quad 0x8a3000008a2000,0x8a5000008a4000,0x8a7000008a6000,0x8a1000008a0000
.quad 0x6000,0xab0100011d9000,0x20000002d00,0x0
.quad 0x200001805c0,0x6f4000004f4000,0x6b8000083c00,0x600006760
.quad 0x20198000000634,0x180b8000101a60,0x7f000000001a4200,0x30000d700
.quad 0x400f400000007a,0x1f400000404f40,0x600f407f000000,0x8f010000640f40
.quad 0xaf4000008f1100,0x126a00001269000,0x12220000000780,0xd1780000c01000
.quad 0x8e3000008e2000,0x8e5000008e4000,0x8e7000008e6000,0x8e1000008e0000
.quad 0x6000,0xaf010001285000,0x20000003d00,0x0
.quad 0x20000180640,0x73400000534000,0x6c8000084c00,0x800006960
.quad 0x201a0000000035,0x180c8000101a80,0x7f000000001a8000,0x40000d900
.quad 0x4013400000009a,0x23400000405340,0x6013407f000000,0x93010000641340
.quad 0xb3400000931100,0x131600001315000,0x12380000000780,0xd1780000c01000
.quad 0x92300000922000,0x92500000924000,0x92700000926000,0x92100000920000
.quad 0x6000,0xb3010001331000,0x20000004d00,0x0
.quad 0x200001806c0,0x77400000574000,0x6d8000085c00,0xa00006b60
.quad 0x201a8000000235,0x180d8000101aa0,0x7f000000001a8200,0x50000db00
.quad 0x401740000000ba,0x27400000405740,0x6017407f000000,0x97010000641740
.quad 0xb7400000971100,0x13c2000013c1000,0x124e0000000780,0xd1780000c01000
.quad 0x96300000962000,0x96500000964000,0x96700000966000,0x96100000960000
.quad 0x6000,0xb70100013dd000,0x20000005d00,0x0
.quad 0x20000180740,0x7b4000005b4000,0x6e8000086c00,0xc00006d60
.quad 0x201b0000000435,0x180e8000101ac0,0x7f000000001ac000,0x60000dd00
.quad 0x401b40000000da,0x2b400000405b40,0x601b407f000000,0x9b010000641b40
.quad 0xbb4000009b1100,0x146e0000146d000,0x12640000000780,0xd1780000c01000
.quad 0x9a3000009a2000,0x9a5000009a4000,0x9a7000009a6000,0x9a1000009a0000
.quad 0x6000,0xbb010001489000,0x20000006d00,0x0
.quad 0x200001807c0,0x7f4000005f4000,0x6f8000087c00,0xe00006f60
.quad 0x201b8000000635,0x180f8000101ae0,0x7f000000001ac200,0x70000df00
.quad 0x401f40000000fa,0x2f400000405f40,0x601f407f000000,0x9f010000641f40
.quad 0xbf4000009f1100,0x151a00001519000,0x127a0000000780,0xd1780000c01000
.quad 0x9e3000009e2000,0x9e5000009e4000,0x9e7000009e6000,0x9e1000009e0000
.quad 0x6000,0xbf010001535000,0x20000007d00,0x0
.quad 0x20000180460,0x63600000436000,0x68c0000c0c00,0x61e0
.quad 0x28180000000036,0x1808c000101b00,0x7f000000001b0000,0xd180
.quad 0x4003600000001b,0x13600000404360,0x6003607f000000,0x83018000640360
.quad 0xa3600000831180,0x7f00000001066800,0x12900000000840,0xd2240000c01800
.quad 0x82400000823000,0x82600000825000,0x82000000827000,0x82200000821000
.quad 0x100009000,0xa3018001081000,0x30000000d80,0x0
.quad 0x200001804e0,0x67600000476000,0x69c0000c1c00,0x2000063e0
.quad 0x28188000000236,0x1809c000101b20,0x7f000000001b0200,0x10000d380
.quad 0x4007600000003b,0x17600000404760,0x6007607f000000,0x87018000640760
.quad 0xa7600000871180,0x7f00000001112800,0x12a60000000840,0xd2240000c01800
.quad 0x86400000863000,0x86600000865000,0x86000000867000,0x86200000861000
.quad 0x100009000,0xa701800112d000,0x30000001d80,0x0
.quad 0x20000180560,0x6b6000004b6000,0x6ac0000c2c00,0x4000065e0
.quad 0x28190000000436,0x180ac000101b40,0x7f000000001b4000,0x20000d580
.quad 0x400b600000005b,0x1b600000404b60,0x600b607f000000,0x8b018000640b60
.quad 0xab6000008b1180,0x7f000000011be800,0x12bc0000000840,0xd2240000c01800
.quad 0x8a4000008a3000,0x8a6000008a5000,0x8a0000008a7000,0x8a2000008a1000
.quad 0x100009000,0xab0180011d9000,0x30000002d80,0x0
.quad 0x200001805e0,0x6f6000004f6000,0x6bc0000c3c00,0x6000067e0
.quad 0x28198000000636,0x180bc000101b60,0x7f000000001b4200,0x30000d780
.quad 0x400f600000007b,0x1f600000404f60,0x600f607f000000,0x8f018000640f60
.quad 0xaf6000008f1180,0x7f0000000126a800,0x12d20000000840,0xd2240000c01800
.quad 0x8e4000008e3000,0x8e6000008e5000,0x8e0000008e7000,0x8e2000008e1000
.quad 0x100009000,0xaf018001285000,0x30000003d80,0x0
.quad 0x20000180660,0x73600000536000,0x6cc0000c4c00,0x8000069e0
.quad 0x281a0000000037,0x180cc000101b80,0x7f000000001b8000,0x40000d980
.quad 0x4013600000009b,0x23600000405360,0x6013607f000000,0x93018000641360
.quad 0xb3600000931180,0x7f00000001316800,0x12e80000000840,0xd2240000c01800
.quad 0x92400000923000,0x92600000925000,0x92000000927000,0x92200000921000
.quad 0x100009000,0xb3018001331000,0x30000004d80,0x0
.quad 0x200001806e0,0x77600000576000,0x6dc0000c5c00,0xa00006be0
.quad 0x281a8000000237,0x180dc000101ba0,0x7f000000001b8200,0x50000db80
.quad 0x401760000000bb,0x27600000405760,0x6017607f000000,0x97018000641760
.quad 0xb7600000971180,0x7f000000013c2800,0x12fe0000000840,0xd2240000c01800
.quad 0x96400000963000,0x96600000965000,0x96000000967000,0x96200000961000
.quad 0x100009000,0xb70180013dd000,0x30000005d80,0x0
.quad 0x20000180760,0x7b6000005b6000,0x6ec0000c6c00,0xc00006de0
.quad 0x281b0000000437,0x180ec000101bc0,0x7f000000001bc000,0x60000dd80
.quad 0x401b60000000db,0x2b600000405b60,0x601b607f000000,0x9b018000641b60
.quad 0xbb6000009b1180,0x7f0000000146e800,0x13140000000840,0xd2240000c01800
.quad 0x9a4000009a3000,0x9a6000009a5000,0x9a0000009a7000,0x9a2000009a1000
.quad 0x100009000,0xbb018001489000,0x30000006d80,0x0
.quad 0x200001807e0,0x7f6000005f6000,0x6fc0000c7c00,0xe00006fe0
.quad 0x281b8000000637,0x180fc000101be0,0x7f000000001bc200,0x70000df80
.quad 0x401f60000000fb,0x2f600000405f60,0x601f607f000000,0x9f018000641f60
.quad 0xbf6000009f1180,0x7f0000000151a800,0x132a0000000840,0xd2240000c01800
.quad 0x9e4000009e3000,0x9e6000009e5000,0x9e0000009e7000,0x9e2000009e1000
.quad 0x100009000,0xbf018001535000,0x30000007d80,0x0
.quad 0x30000240400,0x63800000438000,0x780000100c00,0x7070
.quad 0x101c0000000038,0x24080000101c00,0x7f000000001c0000,0xf000
.quad 0x4003800000001c,0x13800000404380,0x6003807f000000,0x83800000640380
.quad 0xa3800000839000,0x7f00000001067800,0x134000000008c0,0xd2d00000c02000
.quad 0x82500000824000,0x82700000826000,0x82100000820000,0x82300000822000
.quad 0x10000c000,0xa3020001081000,0x40000000e00,0x0
.quad 0x30000240480,0x67800000478000,0x790000101c00,0x200007270
.quad 0x101c8000000238,0x24090000101c20,0x7f000000001c0200,0x10000f200
.quad 0x4007800000003c,0x17800000404780,0x6007807f000000,0x87800000640780
.quad 0xa7800000879000,0x7f00000001113800,0x135600000008c0,0xd2d00000c02000
.quad 0x86500000864000,0x86700000866000,0x86100000860000,0x86300000862000
.quad 0x10000c000,0xa702000112d000,0x40000001e00,0x0
.quad 0x30000240500,0x6b8000004b8000,0x7a0000102c00,0x400007470
.quad 0x101d0000000438,0x240a0000101c40,0x7f000000001c4000,0x20000f400
.quad 0x400b800000005c,0x1b800000404b80,0x600b807f000000,0x8b800000640b80
.quad 0xab8000008b9000,0x7f000000011bf800,0x136c00000008c0,0xd2d00000c02000
.quad 0x8a5000008a4000,0x8a7000008a6000,0x8a1000008a0000,0x8a3000008a2000
.quad 0x10000c000,0xab0200011d9000,0x40000002e00,0x0
.quad 0x30000240580,0x6f8000004f8000,0x7b0000103c00,0x600007670
.quad 0x101d8000000638,0x240b0000101c60,0x7f000000001c4200,0x30000f600
.quad 0x400f800000007c,0x1f800000404f80,0x600f807f000000,0x8f800000640f80
.quad 0xaf8000008f9000,0x7f0000000126b800,0x138200000008c0,0xd2d00000c02000
.quad 0x8e5000008e4000,0x8e7000008e6000,0x8e1000008e0000,0x8e3000008e2000
.quad 0x10000c000,0xaf020001285000,0x40000003e00,0x0
.quad 0x30000240600,0x73800000538000,0x7c0000104c00,0x800007870
.quad 0x101e0000000039,0x240c0000101c80,0x7f000000001c8000,0x40000f800
.quad 0x4013800000009c,0x23800000405380,0x6013807f000000,0x93800000641380
.quad 0xb3800000939000,0x7f00000001317800,0x139800000008c0,0xd2d00000c02000
.quad 0x92500000924000,0x92700000926000,0x92100000920000,0x92300000922000
.quad 0x10000c000,0xb3020001331000,0x40000004e00,0x0
.quad 0x30000240680,0x77800000578000,0x7d0000105c00,0xa00007a70
.quad 0x101e8000000239,0x240d0000101ca0,0x7f000000001c8200,0x50000fa00
.quad 0x401780000000bc,0x27800000405780,0x6017807f000000,0x97800000641780
.quad 0xb7800000979000,0x7f000000013c3800,0x13ae00000008c0,0xd2d00000c02000
.quad 0x96500000964000,0x96700000966000,0x96100000960000,0x96300000962000
.quad 0x10000c000,0xb70200013dd000,0x40000005e00,0x0
.quad 0x30000240700,0x7b8000005b8000,0x7e0000106c00,0xc00007c70
.quad 0x101f0000000439,0x240e0000101cc0,0x7f000000001cc000,0x60000fc00
.quad 0x401b80000000dc,0x2b800000405b80,0x601b807f000000,0x9b800000641b80
.quad 0xbb8000009b9000,0x7f0000000146f800,0x13c400000008c0,0xd2d00000c02000
.quad 0x9a5000009a4000,0x9a7000009a6000,0x9a1000009a0000,0x9a3000009a2000
.quad 0x10000c000,0xbb020001489000,0x40000006e00,0x0
.quad 0x30000240780,0x7f8000005f8000,0x7f0000107c00,0xe00007e70
.quad 0x101f8000000639,0x240f0000101ce0,0x7f000000001cc200,0x70000fe00
.quad 0x401f80000000fc,0x2f800000405f80,0x601f807f000000,0x9f800000641f80
.quad 0xbf8000009f9000,0x7f0000000151b800,0x13da00000008c0,0xd2d00000c02000
.quad 0x9e5000009e4000,0x9e7000009e6000,0x9e1000009e0000,0x9e3000009e2000
.quad 0x10000c000,0xbf020001535000,0x40000007e00,0x0
.quad 0x30000240420,0x63a0000043a000,0x784000140c00,0x70f0
.quad 0x181c000000003a,0x24084000101d00,0x7f000000001d0000,0xf080
.quad 0x4003a00000001d,0x13a000004043a0,0x6003a07f000000,0x838080006403a0
.quad 0xa3a00000839080,0x7f00000001068800,0x13f00000000940,0xd37c0000c02800
.quad 0x82600000825000,0x82000000827000,0x82200000821000,0x82400000823000
.quad 0x10000f000,0xa3028001081000,0x50000000e80,0x0
.quad 0x300002404a0,0x67a0000047a000,0x794000141c00,0x2000072f0
.quad 0x181c800000023a,0x24094000101d20,0x7f000000001d0200,0x10000f280
.quad 0x4007a00000003d,0x17a000004047a0,0x6007a07f000000,0x878080006407a0
.quad 0xa7a00000879080,0x7f00000001114800,0x14060000000940,0xd37c0000c02800
.quad 0x86600000865000,0x86000000867000,0x86200000861000,0x86400000863000
.quad 0x10000f000,0xa702800112d000,0x50000001e80,0x0
.quad 0x30000240520,0x6ba000004ba000,0x7a4000142c00,0x4000074f0
.quad 0x181d000000043a,0x240a4000101d40,0x7f000000001d4000,0x20000f480
.quad 0x400ba00000005d,0x1ba00000404ba0,0x600ba07f000000,0x8b808000640ba0
.quad 0xaba000008b9080,0x7f000000011c0800,0x141c0000000940,0xd37c0000c02800
.quad 0x8a6000008a5000,0x8a0000008a7000,0x8a2000008a1000,0x8a4000008a3000
.quad 0x10000f000,0xab0280011d9000,0x50000002e80,0x0
.quad 0x300002405a0,0x6fa000004fa000,0x7b4000143c00,0x6000076f0
.quad 0x181d800000063a,0x240b4000101d60,0x7f000000001d4200,0x30000f680
.quad 0x400fa00000007d,0x1fa00000404fa0,0x600fa07f000000,0x8f808000640fa0
.quad 0xafa000008f9080,0x7f0000000126c800,0x14320000000940,0xd37c0000c02800
.quad 0x8e6000008e5000,0x8e0000008e7000,0x8e2000008e1000,0x8e4000008e3000
.quad 0x10000f000,0xaf028001285000,0x50000003e80,0x0
.quad 0x30000240620,0x73a0000053a000,0x7c4000144c00,0x8000078f0
.quad 0x181e000000003b,0x240c4000101d80,0x7f000000001d8000,0x40000f880
.quad 0x4013a00000009d,0x23a000004053a0,0x6013a07f000000,0x938080006413a0
.quad 0xb3a00000939080,0x7f00000001318800,0x14480000000940,0xd37c0000c02800
.quad 0x92600000925000,0x92000000927000,0x92200000921000,0x92400000923000
.quad 0x10000f000,0xb3028001331000,0x50000004e80,0x0
.quad 0x300002406a0,0x77a0000057a000,0x7d4000145c00,0xa00007af0
.quad 0x181e800000023b,0x240d4000101da0,0x7f000000001d8200,0x50000fa80
.quad 0x4017a0000000bd,0x27a000004057a0,0x6017a07f000000,0x978080006417a0
.quad 0xb7a00000979080,0x7f000000013c4800,0x145e0000000940,0xd37c0000c02800
.quad 0x96600000965000,0x96000000967000,0x96200000961000,0x96400000963000
.quad 0x10000f000,0xb70280013dd000,0x50000005e80,0x0
.quad 0x30000240720,0x7ba000005ba000,0x7e4000146c00,0xc00007cf0
.quad 0x181f000000043b,0x240e4000101dc0,0x7f000000001dc000,0x60000fc80
.quad 0x401ba0000000dd,0x2ba00000405ba0,0x601ba07f000000,0x9b808000641ba0
.quad 0xbba000009b9080,0x7f00000001470800,0x14740000000940,0xd37c0000c02800
.quad 0x9a6000009a5000,0x9a0000009a7000,0x9a2000009a1000,0x9a4000009a3000
.quad 0x10000f000,0xbb028001489000,0x50000006e80,0x0
.quad 0x300002407a0,0x7fa000005fa000,0x7f4000147c00,0xe00007ef0
.quad 0x181f800000063b,0x240f4000101de0,0x7f000000001dc200,0x70000fe80
.quad 0x401fa0000000fd,0x2fa00000405fa0,0x601fa07f000000,0x9f808000641fa0
.quad 0xbfa000009f9080,0x7f0000000151c800,0x148a0000000940,0xd37c0000c02800
.quad 0x9e6000009e5000,0x9e0000009e7000,0x9e2000009e1000,0x9e4000009e3000
.quad 0x10000f000,0xbf028001535000,0x50000007e80,0x0
.quad 0x30000240440,0x63c0000043c000,0x788000180c00,0x7170
.quad 0x201c000000003c,0x24088000101e00,0x7f000000001e0000,0xf100
.quad 0x4003c00000001e,0x13c000004043c0,0x6003c07f000000,0x838100006403c0
.quad 0xa3c00000839100,0x7f00000001069800,0x14a000000009c0,0xd4280000c03000
.quad 0x82700000826000,0x82100000820000,0x82300000822000,0x82500000824000
.quad 0x100012000,0xa3030001081000,0x60000000f00,0x0
.quad 0x300002404c0,0x67c0000047c000,0x798000181c00,0x200007370
.quad 0x201c800000023c,0x24098000101e20,0x7f000000001e0200,0x10000f300
.quad 0x4007c00000003e,0x17c000004047c0,0x6007c07f000000,0x878100006407c0
.quad 0xa7c00000879100,0x7f00000001115800,0x14b600000009c0,0xd4280000c03000
.quad 0x86700000866000,0x86100000860000,0x86300000862000,0x86500000864000
.quad 0x100012000,0xa703000112d000,0x60000001f00,0x0
.quad 0x30000240540,0x6bc000004bc000,0x7a8000182c00,0x400007570
.quad 0x201d000000043c,0x240a8000101e40,0x7f000000001e4000,0x20000f500
.quad 0x400bc00000005e,0x1bc00000404bc0,0x600bc07f000000,0x8b810000640bc0
.quad 0xabc000008b9100,0x7f000000011c1800,0x14cc00000009c0,0xd4280000c03000
.quad 0x8a7000008a6000,0x8a1000008a0000,0x8a3000008a2000,0x8a5000008a4000
.quad 0x100012000,0xab0300011d9000,0x60000002f00,0x0
.quad 0x300002405c0,0x6fc000004fc000,0x7b8000183c00,0x600007770
.quad 0x201d800000063c,0x240b8000101e60,0x7f000000001e4200,0x30000f700
.quad 0x400fc00000007e,0x1fc00000404fc0,0x600fc07f000000,0x8f810000640fc0
.quad 0xafc000008f9100,0x7f0000000126d800,0x14e200000009c0,0xd4280000c03000
.quad 0x8e7000008e6000,0x8e1000008e0000,0x8e3000008e2000,0x8e5000008e4000
.quad 0x100012000,0xaf030001285000,0x60000003f00,0x0
.quad 0x30000240640,0x73c0000053c000,0x7c8000184c00,0x800007970
.quad 0x201e000000003d,0x240c8000101e80,0x7f000000001e8000,0x40000f900
.quad 0x4013c00000009e,0x23c000004053c0,0x6013c07f000000,0x938100006413c0
.quad 0xb3c00000939100,0x7f00000001319800,0x14f800000009c0,0xd4280000c03000
.quad 0x92700000926000,0x92100000920000,0x92300000922000,0x92500000924000
.quad 0x100012000,0xb3030001331000,0x60000004f00,0x0
.quad 0x300002406c0,0x77c0000057c000,0x7d8000185c00,0xa00007b70
.quad 0x201e800000023d,0x240d8000101ea0,0x7f000000001e8200,0x50000fb00
.quad 0x4017c0000000be,0x27c000004057c0,0x6017c07f000000,0x978100006417c0
.quad 0xb7c00000979100,0x7f000000013c5800,0x150e00000009c0,0xd4280000c03000
.quad 0x96700000966000,0x96100000960000,0x96300000962000,0x96500000964000
.quad 0x100012000,0xb70300013dd000,0x60000005f00,0x0
.quad 0x30000240740,0x7bc000005bc000,0x7e8000186c00,0xc00007d70
.quad 0x201f000000043d,0x240e8000101ec0,0x7f000000001ec000,0x60000fd00
.quad 0x401bc0000000de,0x2bc00000405bc0,0x601bc07f000000,0x9b810000641bc0
.quad 0xbbc000009b9100,0x7f00000001471800,0x152400000009c0,0xd4280000c03000
.quad 0x9a7000009a6000,0x9a1000009a0000,0x9a3000009a2000,0x9a5000009a4000
.quad 0x100012000,0xbb030001489000,0x60000006f00,0x0
.quad 0x300002407c0,0x7fc000005fc000,0x7f8000187c00,0xe00007f70
.quad 0x201f800000063d,0x240f8000101ee0,0x7f000000001ec200,0x70000ff00
.quad 0x401fc0000000fe,0x2fc00000405fc0,0x601fc07f000000,0x9f810000641fc0
.quad 0xbfc000009f9100,0x7f0000000151d800,0x153a00000009c0,0xd4280000c03000
.quad 0x9e7000009e6000,0x9e1000009e0000,0x9e3000009e2000,0x9e5000009e4000
.quad 0x100012000,0xbf030001535000,0x60000007f00,0x0
.quad 0x30000240460,0x63e0000043e000,0x78c0001c0c00,0x71f0
.quad 0x281c000000003e,0x2408c000101f00,0x7f000000001f0000,0xf180
.quad 0x4003e00000001f,0x13e000004043e0,0x6003e07f000000,0x838180006403e0
.quad 0xa3e00000839180,0x7f0000000106a800,0x15500000000a40,0xd4d40000c03800
.quad 0x82000000827000,0x82200000821000,0x82400000823000,0x82600000825000
.quad 0x100015000,0xa3038001081000,0x70000000f80,0x0
.quad 0x300002404e0,0x67e0000047e000,0x79c0001c1c00,0x2000073f0
.quad 0x281c800000023e,0x2409c000101f20,0x7f000000001f0200,0x10000f380
.quad 0x4007e00000003f,0x17e000004047e0,0x6007e07f000000,0x878180006407e0
.quad 0xa7e00000879180,0x7f00000001116800,0x15660000000a40,0xd4d40000c03800
.quad 0x86000000867000,0x86200000861000,0x86400000863000,0x86600000865000
.quad 0x100015000,0xa703800112d000,0x70000001f80,0x0
.quad 0x30000240560,0x6be000004be000,0x7ac0001c2c00,0x4000075f0
.quad 0x281d000000043e,0x240ac000101f40,0x7f000000001f4000,0x20000f580
.quad 0x400be00000005f,0x1be00000404be0,0x600be07f000000,0x8b818000640be0
.quad 0xabe000008b9180,0x7f000000011c2800,0x157c0000000a40,0xd4d40000c03800
.quad 0x8a0000008a7000,0x8a2000008a1000,0x8a4000008a3000,0x8a6000008a5000
.quad 0x100015000,0xab0380011d9000,0x70000002f80,0x0
.quad 0x300002405e0,0x6fe000004fe000,0x7bc0001c3c00,0x6000077f0
.quad 0x281d800000063e,0x240bc000101f60,0x7f000000001f4200,0x30000f780
.quad 0x400fe00000007f,0x1fe00000404fe0,0x600fe07f000000,0x8f818000640fe0
.quad 0xafe000008f9180,0x7f0000000126e800,0x15920000000a40,0xd4d40000c03800
.quad 0x8e0000008e7000,0x8e2000008e1000,0x8e4000008e3000,0x8e6000008e5000
.quad 0x100015000,0xaf038001285000,0x70000003f80,0x0
.quad 0x30000240660,0x73e0000053e000,0x7cc0001c4c00,0x8000079f0
.quad 0x281e000000003f,0x240cc000101f80,0x7f000000001f8000,0x40000f980
.quad 0x4013e00000009f,0x23e000004053e0,0x6013e07f000000,0x938180006413e0
.quad 0xb3e00000939180,0x7f0000000131a800,0x15a80000000a40,0xd4d40000c03800
.quad 0x92000000927000,0x92200000921000,0x92400000923000,0x92600000925000
.quad 0x100015000,0xb3038001331000,0x70000004f80,0x0
.quad 0x300002406e0,0x77e0000057e000,0x7dc0001c5c00,0xa00007bf0
.quad 0x281e800000023f,0x240dc000101fa0,0x7f000000001f8200,0x50000fb80
.quad 0x4017e0000000bf,0x27e000004057e0,0x6017e07f000000,0x978180006417e0
.quad 0xb7e00000979180,0x7f000000013c6800,0x15be0000000a40,0xd4d40000c03800
.quad 0x96000000967000,0x96200000961000,0x96400000963000,0x96600000965000
.quad 0x100015000,0xb70380013dd000,0x70000005f80,0x0
.quad 0x30000240760,0x7be000005be000,0x7ec0001c6c00,0xc00007df0
.quad 0x281f000000043f,0x240ec000101fc0,0x7f000000001fc000,0x60000fd80
.quad 0x401be0000000df,0x2be00000405be0,0x601be07f000000,0x9b818000641be0
.quad 0xbbe000009b9180,0x7f00000001472800,0x15d40000000a40,0xd4d40000c03800
.quad 0x9a0000009a7000,0x9a2000009a1000,0x9a4000009a3000,0x9a6000009a5000
.quad 0x100015000,0xbb038001489000,0x70000006f80,0x0
.quad 0x300002407e0,0x7fe000005fe000,0x7fc0001c7c00,0xe00007ff0
.quad 0x281f800000063f,0x240fc000101fe0,0x7f000000001fc200,0x70000ff80
.quad 0x401fe0000000ff,0x2fe00000405fe0,0x601fe07f000000,0x9f818000641fe0
.quad 0xbfe000009f9180,0x7f0000000151e800,0x15ea0000000a40,0xd4d40000c03800
.quad 0x9e0000009e7000,0x9e2000009e1000,0x9e4000009e3000,0x9e6000009e5000
.quad 0x100015000,0xbf038001535000,0x70000007f80,0x0
.Ltabend:
.size L_tabc, .Ltabend-L_tabc
.section .rodata,"a"
.p2align 6
.amdhsa_kernel adaLN_cond__spectral_gfnet__dense_activation_silu__prompt_kernel
  .amdhsa_next_free_vgpr 484
  .amdhsa_next_free_sgpr 96
  .amdhsa_accum_offset 248
  .amdhsa_group_segment_fixed_size 0
  .amdhsa_kernarg_size 88
  .amdhsa_user_sgpr_count 2
  .amdhsa_user_sgpr_kernarg_segment_ptr 1
  .amdhsa_system_sgpr_workgroup_id_x 1
  .amdhsa_float_denorm_mode_32 3
  .amdhsa_float_denorm_mode_16_64 3
.end_amdhsa_kernel
```
